```python
import torch

def _softmax(x, axis=-1):
    return torch.softmax(x, dim=axis)
def _gelu(x):
    return torch.nn.functional.gelu(x, approximate="tanh")
def _silu(x):
    return torch.nn.functional.silu(x)
def _sigmoid(x):
    return torch.sigmoid(x)
def _layernorm(x, axis=-1, eps=1e-5):
    m = x.mean(dim=axis, keepdim=True)
    v = x.var(dim=axis, keepdim=True, unbiased=False)
    return (x - m) / torch.sqrt(v + eps)
def _scatter_add(tgt, idx, src, axis=0):
    return tgt.clone().index_add_(axis, idx, src)
def _segment_sum(src, seg, n):
    out = torch.zeros((n,) + src.shape[1:], dtype=src.dtype)
    return out.index_add_(0, seg, src)
def _pad(x, pw):
    flat = tuple(v for pair in reversed(pw) for v in pair)
    return torch.nn.functional.pad(x, flat)

kernel_name = 'parallel_sum__mha_block__glu_gated_bilinear__prompt'

def setup_inputs():

    _w = (lambda a: (lambda t: t.to(torch.bfloat16) if t.is_floating_point() else t)(torch.as_tensor(a)))
    def _A_setup():
        B, S, D, H = 1, 2048, 576, 32
        return {
            "x": _w((lambda *s: torch.randn(*s, dtype=torch.bfloat16) * 0.05)(B, S, D)),
            "wqkv": _w((lambda *s: torch.randn(*s, dtype=torch.bfloat16) * 0.05)(D, 3 * D)),
            "wo": _w((lambda *s: torch.randn(*s, dtype=torch.bfloat16) * 0.05)(D, D)),
        }
    _A_in = _A_setup()

    def _B_setup():
        B, S, D, F = 1, 2048, 576, 4608
        return {
            "x": _w((lambda *s: torch.randn(*s, dtype=torch.bfloat16) * 0.05)(B, S, D)),
            "w_gate": _w((lambda *s: torch.randn(*s, dtype=torch.bfloat16) * 0.4)(D, F) * (D ** -0.5)),
            "w_up": _w((lambda *s: torch.randn(*s, dtype=torch.bfloat16) * 0.4)(D, F) * (D ** -0.5)),
            "w_down": _w((lambda *s: torch.randn(*s, dtype=torch.bfloat16) * 0.4)(F, D) * (F ** -0.5)),
        }
    _B_in = _B_setup()

    return {
        "A_x": _A_in["x"],
        "A_wqkv": _A_in["wqkv"],
        "A_wo": _A_in["wo"],
        "B_x": _B_in["x"],
        "B_w_gate": _B_in["w_gate"],
        "B_w_up": _B_in["w_up"],
        "B_w_down": _B_in["w_down"],
    }

def reference(A_x, A_wqkv, A_wo, B_x, B_w_gate, B_w_up, B_w_down):
    def _A_ref(x, wqkv, wo):
        B, S, D = x.shape
        H = 32
        Dh = D // H
        qkv = (lambda x, *d: x.permute(*d))((x @ wqkv).reshape(B, S, 3, H, Dh), 2, 0, 3, 1, 4)
        q, k, v = qkv[0], qkv[1], qkv[2]
        scores = torch.einsum("bhqd,bhkd->bhqk", q, k) * (Dh ** -0.5)
        p = _softmax(scores, axis=-1)
        o = torch.einsum("bhqk,bhkd->bhqd", p, v)
        return (lambda x, *d: x.permute(*d))(o, 0, 2, 1, 3).reshape(B, S, D) @ wo

    def _B_ref(x, w_gate, w_up, w_down):
        g = torch.einsum("bsd,df->bsf", x, w_gate)
        u = torch.einsum("bsd,df->bsf", x, w_up)
        h = g * u
        return torch.einsum("bsf,fd->bsd", h, w_down)

    x = A_x
    xn = _layernorm(x, axis=-1)
    return x + _A_ref(xn, A_wqkv, A_wo) + _B_ref(xn, B_w_gate, B_w_up, B_w_down)
```

```asm
; @launch grid=(256,1,1) block=(256,1,1) lds=163840
.amdgcn_target "amdgcn-amd-amdhsa--gfx950"
.text
.globl parallel_sum__mha_block__glu_gated_bilinear__prompt_kernel
.p2align 8
.type parallel_sum__mha_block__glu_gated_bilinear__prompt_kernel,@function
parallel_sum__mha_block__glu_gated_bilinear__prompt_kernel:
 s_load_dwordx2 s[4:5], s[0:1], 0
 s_load_dwordx2 s[8:9], s[0:1], 8
 s_getpc_b64 s[44:45]
 s_cmp_ge_u32 s2, 256
 s_cbranch_scc1 L_exit
 s_lshr_b32 s80, s2, 3
 v_lshrrev_b32 v1, 3, v0
 s_and_b32 s44, s44, 0xffffff00
 s_mov_b32 s46, L_code_end-parallel_sum__mha_block__glu_gated_bilinear__prompt_kernel
 s_mov_b32 s47, 0x20000
 s_lshl_b32 s79, s80, 12
 v_lshlrev_b32 v1, 7, v1
 buffer_load_dword v106, v1, s[44:47], s79 offen
 v_lshrrev_b32 v1, 6, v0
 v_and_b32 v0, 63, v0
 s_and_b32 s79, s2, 7
 v_readfirstlane_b32 s68, v1
 s_and_b32 s71, s79, 1
 s_lshl_b32 s71, s71, 3
 s_and_b32 s78, s80, 7
 s_add_u32 s71, s71, s78
 s_lshr_b32 s70, s79, 1
 s_lshl_b32 s70, s70, 2
 s_lshr_b32 s81, s80, 3
 s_add_u32 s70, s70, s81
 s_mov_b32 s6, 2359296
 s_mov_b32 s7, 0x20000
 v_min_u32 v47, 17, v0
 s_lshl_b32 s78, s71, 2
 s_add_u32 s78, s78, s68
 s_mul_i32 s78, s78, 2304
 s_mul_i32 s97, s70, 147456
 v_lshlrev_b32 v47, 7, v47
 s_add_u32 s78, s78, s97
 v_lshrrev_b32 v2, 4, v0
 v_lshrrev_b32 v3, 3, v0
 v_and_b32 v46, 7, v0
 v_xor_b32 v46, v46, v2
 v_mul_u32_u24 v3, 1152, v3
 v_lshl_add_u32 v44, v46, 4, v3
 v_xor_b32 v46, 4, v46
 v_lshl_add_u32 v45, v46, 4, v3
 v_add_u32 v45, 9216, v45
 s_mul_i32 s86, s68, 36864
 s_add_u32 s97, s97, s86
 s_add_u32 s98, s97, 18432
 s_add_u32 s79, s86, 16384
 s_cmp_lt_u32 s68, 2
 s_cselect_b32 s89, s86, s79
 s_cmp_lt_u32 s71, 11
 s_cselect_b32 s86, s79, s89
 s_mov_b32 s10, 1990656
 s_mov_b32 s11, 0x20000
 s_lshl_b32 s73, s71, 7
 s_add_u32 s79, s71, 18
 s_add_u32 s99, s71, 7
 s_cmp_lt_u32 s71, 9
 s_cselect_b32 s72, s79, s99
 s_lshl_b32 s72, s72, 7
 s_cmp_lt_u32 s71, 11
 s_cselect_b32 s89, s72, s73
 s_lshl_b32 s81, s70, 2
 s_add_u32 s81, s81, s68
 s_mul_i32 s81, s81, 9
 v_min_u32 v103, 8, v0
 v_add_u32 v103, s81, v103
 v_mul_u32_u24 v102, 3456, v103
 s_lshl_b32 s79, s70, 2
 s_add_u32 s79, s79, s68
 s_mul_i32 s79, s79, 0
 v_min_u32 v101, 0, v0
 v_add_u32 v101, s79, v101
 v_mul_u32_u24 v101, 3456, v101
 s_waitcnt lgkmcnt(0)
 buffer_load_dword v107, v47, s[4:7], s78 offen
 s_add_u32 m0, s86, 0
 s_nop 0
 buffer_load_dwordx4 v44, s[4:7], s97 offen offset:0 lds
 s_add_u32 m0, s86, 1024
 s_nop 0
 buffer_load_dwordx4 v45, s[4:7], s97 offen offset:0 lds
 s_add_u32 m0, s86, 3968
 s_nop 0
 buffer_load_dwordx4 v44, s[4:7], s97 offen offset:128 lds
 s_add_u32 m0, s86, 4992
 s_nop 0
 buffer_load_dwordx4 v45, s[4:7], s97 offen offset:128 lds
 s_add_u32 m0, s86, 7936
 s_nop 0
 buffer_load_dwordx4 v44, s[4:7], s97 offen offset:256 lds
 s_add_u32 m0, s86, 8960
 s_nop 0
 buffer_load_dwordx4 v45, s[4:7], s97 offen offset:256 lds
 s_add_u32 m0, s86, 11904
 s_nop 0
 buffer_load_dwordx4 v44, s[4:7], s97 offen offset:384 lds
 s_add_u32 m0, s86, 12928
 s_nop 0
 buffer_load_dwordx4 v45, s[4:7], s97 offen offset:384 lds
 s_add_u32 m0, s86, 15872
 s_nop 0
 buffer_load_dwordx4 v44, s[4:7], s97 offen offset:512 lds
 s_add_u32 m0, s86, 16896
 s_nop 0
 buffer_load_dwordx4 v45, s[4:7], s97 offen offset:512 lds
 s_add_u32 m0, s86, 19840
 s_nop 0
 buffer_load_dwordx4 v44, s[4:7], s97 offen offset:640 lds
 s_add_u32 m0, s86, 20864
 s_nop 0
 buffer_load_dwordx4 v45, s[4:7], s97 offen offset:640 lds
 s_add_u32 m0, s86, 23808
 s_nop 0
 buffer_load_dwordx4 v44, s[4:7], s97 offen offset:768 lds
 s_add_u32 m0, s86, 24832
 s_nop 0
 buffer_load_dwordx4 v45, s[4:7], s97 offen offset:768 lds
 s_load_dwordx2 s[12:13], s[0:1], 16
 s_load_dwordx2 s[16:17], s[0:1], 32
 s_load_dwordx2 s[20:21], s[0:1], 40
 s_load_dwordx2 s[24:25], s[0:1], 48
 s_load_dwordx2 s[28:29], s[0:1], 56
 s_load_dwordx2 s[32:33], s[0:1], 64
 s_load_dwordx2 s[36:37], s[0:1], 72
 v_and_b32 v1, 15, v0
 v_lshrrev_b32 v38, 3, v1
 v_and_b32 v39, 7, v1
 v_lshlrev_b32 v39, 7, v39
 v_lshl_add_u32 v38, v38, 10, v39
 v_add_u32 v38, s86, v38
 v_lshrrev_b32 v39, 1, v1
 v_xor_b32 v39, v39, v2
 v_lshl_add_u32 v108, v39, 4, v38
 v_xor_b32 v39, 4, v39
 v_lshl_add_u32 v109, v39, 4, v38
 v_mov_b32 v40, 0x3f803f80
 v_mov_b32 v41, v40
 v_mov_b32 v42, v40
 v_mov_b32 v43, v40
 v_mov_b32 v28, 0
 v_mov_b32 v29, 0
 v_mov_b32 v30, 0
 v_mov_b32 v31, 0
 s_waitcnt lgkmcnt(0)
 s_waitcnt vmcnt(12)
 ds_read_b128 v[112:115], v108 offset:0
 ds_read_b128 v[120:123], v109 offset:0
 s_add_u32 m0, s86, 27776
 s_nop 0
 buffer_load_dwordx4 v44, s[4:7], s97 offen offset:896 lds
 s_add_u32 m0, s86, 28800
 s_nop 0
 buffer_load_dwordx4 v45, s[4:7], s97 offen offset:896 lds
 s_waitcnt vmcnt(12)
 ds_read_b128 v[128:131], v108 offset:4096
 ds_read_b128 v[136:139], v109 offset:4096
 s_waitcnt lgkmcnt(2)
 v_mfma_f32_16x16x32_bf16 v[48:51], v[40:43], v[112:115], 0
 s_lshl_b32 s69, s68, 10
 v_lshrrev_b32 v60, 3, v0
 s_lshl_b32 s78, s68, 3
 v_mfma_f32_16x16x32_bf16 a[236:239], v[112:115], v[112:115], 0
 v_add_u32 v61, s78, v60
 v_and_b32 v62, 1, v2
 s_and_b32 s79, s68, 1
 v_mfma_f32_16x16x32_bf16 v[48:51], v[40:43], v[120:123], v[48:51]
 s_lshl_b32 s79, s79, 1
 v_or_b32 v62, s79, v62
 v_lshlrev_b32 v62, 1, v62
 v_mfma_f32_16x16x32_bf16 a[236:239], v[120:123], v[120:123], a[236:239]
 s_add_u32 m0, s86, 31744
 s_nop 0
 buffer_load_dwordx4 v44, s[4:7], s97 offen offset:1024 lds
 s_add_u32 m0, s86, 32768
 s_nop 0
 buffer_load_dwordx4 v45, s[4:7], s97 offen offset:1024 lds
 s_waitcnt vmcnt(12)
 ds_read_b128 v[144:147], v108 offset:8192
 ds_read_b128 v[152:155], v109 offset:8192
 s_waitcnt lgkmcnt(2)
 v_mfma_f32_16x16x32_bf16 v[48:51], v[40:43], v[128:131], v[48:51]
 v_and_b32 v63, 7, v0
 v_xor_b32 v62, v62, v63
 v_lshlrev_b32 v62, 4, v62
 v_mfma_f32_16x16x32_bf16 a[236:239], v[128:131], v[128:131], a[236:239]
 v_mul_u32_u24 v20, 3456, v61
 v_add_u32 v20, v20, v62
 v_mul_u32_u24 v21, 9216, v61
 v_mfma_f32_16x16x32_bf16 v[48:51], v[40:43], v[136:139], v[48:51]
 v_add_u32 v21, v21, v62
 s_mov_b32 s78, 0x3eae1a93
 s_cmp_lt_u32 s71, 9
 s_cselect_b32 s82, s78, 1.0
 v_mfma_f32_16x16x32_bf16 a[236:239], v[136:139], v[136:139], a[236:239]
 s_add_u32 m0, s86, 2048
 s_nop 0
 buffer_load_dwordx4 v44, s[4:7], s98 offen offset:0 lds
 s_add_u32 m0, s86, 3072
 s_nop 0
 buffer_load_dwordx4 v45, s[4:7], s98 offen offset:0 lds
 s_waitcnt vmcnt(12)
 ds_read_b128 v[160:163], v108 offset:12288
 ds_read_b128 v[168:171], v109 offset:12288
 s_waitcnt lgkmcnt(2)
 v_mfma_f32_16x16x32_bf16 v[48:51], v[40:43], v[144:147], v[48:51]
 s_lshr_b32 s79, s71, 1
 s_mul_i32 s79, s79, 1152
 s_and_b32 s99, s71, 1
 v_mfma_f32_16x16x32_bf16 a[236:239], v[144:147], v[144:147], a[236:239]
 s_mul_i32 s74, s99, 640
 s_add_u32 s74, s74, s79
 v_mul_u32_u24 v3, 9216, v103
 v_mfma_f32_16x16x32_bf16 v[48:51], v[40:43], v[152:155], v[48:51]
 v_mov_b32 v19, v102
 v_lshrrev_b32 v60, 2, v1
 v_and_b32 v61, 1, v1
 v_mfma_f32_16x16x32_bf16 a[236:239], v[152:155], v[152:155], a[236:239]
 s_add_u32 m0, s86, 6016
 s_nop 0
 buffer_load_dwordx4 v44, s[4:7], s98 offen offset:128 lds
 s_add_u32 m0, s86, 7040
 s_nop 0
 buffer_load_dwordx4 v45, s[4:7], s98 offen offset:128 lds
 s_waitcnt vmcnt(12)
 ds_read_b128 v[176:179], v108 offset:16384
 ds_read_b128 v[184:187], v109 offset:16384
 s_waitcnt lgkmcnt(2)
 v_mfma_f32_16x16x32_bf16 v[48:51], v[40:43], v[160:163], v[48:51]
 v_lshlrev_b32 v61, 4, v61
 v_mov_b32 v62, 0x3f80
 v_lshlrev_b32 v62, v61, v62
 v_mfma_f32_16x16x32_bf16 a[236:239], v[160:163], v[160:163], a[236:239]
 v_cmp_eq_u32 vcc, v60, v2
 s_nop 1
 v_cndmask_b32 v62, 0, v62, vcc
 v_bfe_u32 v61, v1, 1, 1
 v_mfma_f32_16x16x32_bf16 v[48:51], v[40:43], v[168:171], v[48:51]
 v_cmp_eq_u32 vcc, 0, v61
 s_nop 1
 v_cndmask_b32 v63, 0, v62, vcc
 v_sub_u32 v64, v62, v63
 v_mfma_f32_16x16x32_bf16 a[236:239], v[168:171], v[168:171], a[236:239]
 s_add_u32 m0, s86, 9984
 s_nop 0
 buffer_load_dwordx4 v44, s[4:7], s98 offen offset:256 lds
 s_add_u32 m0, s86, 11008
 s_nop 0
 buffer_load_dwordx4 v45, s[4:7], s98 offen offset:256 lds
 s_waitcnt vmcnt(12)
 ds_read_b128 v[192:195], v108 offset:20480
 ds_read_b128 v[200:203], v109 offset:20480
 s_waitcnt lgkmcnt(2)
 v_mfma_f32_16x16x32_bf16 v[48:51], v[40:43], v[176:179], v[48:51]
 v_accvgpr_write_b32 a148, v63
 v_accvgpr_write_b32 a149, v64
 v_accvgpr_write_b32 a150, 0
 v_mfma_f32_16x16x32_bf16 a[236:239], v[176:179], v[176:179], a[236:239]
 v_accvgpr_write_b32 a151, 0
 v_accvgpr_write_b32 a152, 0
 v_accvgpr_write_b32 a153, 0
 v_mfma_f32_16x16x32_bf16 v[48:51], v[40:43], v[184:187], v[48:51]
 v_accvgpr_write_b32 a154, v63
 v_accvgpr_write_b32 a155, v64
 v_lshl_add_u32 v61, v2, 3, v60
 v_mfma_f32_16x16x32_bf16 a[236:239], v[184:187], v[184:187], a[236:239]
 s_add_u32 m0, s86, 13952
 s_nop 0
 buffer_load_dwordx4 v44, s[4:7], s98 offen offset:384 lds
 s_add_u32 m0, s86, 14976
 s_nop 0
 buffer_load_dwordx4 v45, s[4:7], s98 offen offset:384 lds
 s_waitcnt vmcnt(12)
 ds_read_b128 v[208:211], v108 offset:24576
 ds_read_b128 v[216:219], v109 offset:24576
 s_waitcnt lgkmcnt(2)
 v_mfma_f32_16x16x32_bf16 v[48:51], v[40:43], v[192:195], v[48:51]
 v_lshrrev_b32 v62, 1, v60
 v_and_b32 v63, 1, v2
 v_lshl_add_u32 v62, v63, 1, v62
 v_mfma_f32_16x16x32_bf16 a[236:239], v[192:195], v[192:195], a[236:239]
 v_and_b32 v64, 3, v0
 v_lshlrev_b32 v64, 3, v64
 v_lshl_add_u32 v65, v61, 7, v64
 v_mfma_f32_16x16x32_bf16 v[48:51], v[40:43], v[200:203], v[48:51]
 v_lshl_add_u32 v4, v62, 5, v65
 v_add_u32 v8, 0x10000, v4
 v_add_u32 v12, 0x20000, v4
 v_mfma_f32_16x16x32_bf16 a[236:239], v[200:203], v[200:203], a[236:239]
 s_add_u32 m0, s86, 17920
 s_nop 0
 buffer_load_dwordx4 v44, s[4:7], s98 offen offset:512 lds
 s_add_u32 m0, s86, 18944
 s_nop 0
 buffer_load_dwordx4 v45, s[4:7], s98 offen offset:512 lds
 s_waitcnt vmcnt(12)
 ds_read_b128 v[224:227], v108 offset:28672
 ds_read_b128 v[232:235], v109 offset:28672
 s_waitcnt lgkmcnt(2)
 v_mfma_f32_16x16x32_bf16 v[48:51], v[40:43], v[208:211], v[48:51]
 v_xor_b32 v5, 32, v4
 v_xor_b32 v6, 64, v4
 v_xor_b32 v7, 96, v4
 v_mfma_f32_16x16x32_bf16 a[236:239], v[208:211], v[208:211], a[236:239]
 v_xor_b32 v9, 32, v8
 v_xor_b32 v10, 64, v8
 v_xor_b32 v11, 96, v8
 v_mfma_f32_16x16x32_bf16 v[48:51], v[40:43], v[216:219], v[48:51]
 v_xor_b32 v13, 32, v12
 v_xor_b32 v14, 64, v12
 v_xor_b32 v15, 96, v12
 v_mfma_f32_16x16x32_bf16 a[236:239], v[216:219], v[216:219], a[236:239]
 s_add_u32 m0, s86, 21888
 s_nop 0
 buffer_load_dwordx4 v44, s[4:7], s98 offen offset:640 lds
 s_add_u32 m0, s86, 22912
 s_nop 0
 buffer_load_dwordx4 v45, s[4:7], s98 offen offset:640 lds
 s_waitcnt vmcnt(12)
 ds_read_b128 v[240:243], v108 offset:32768
 ds_read_b128 v[248:251], v109 offset:32768
 s_waitcnt lgkmcnt(2)
 v_mfma_f32_16x16x32_bf16 v[48:51], v[40:43], v[224:227], v[48:51]
 s_mov_b32 s14, 663552
 s_mov_b32 s15, 0x20000
 s_mov_b32 s18, 5308416
 v_mfma_f32_16x16x32_bf16 a[236:239], v[224:227], v[224:227], a[236:239]
 s_mov_b32 s19, 0x20000
 s_mov_b32 s22, 5308416
 s_mov_b32 s23, 0x20000
 v_mfma_f32_16x16x32_bf16 v[48:51], v[40:43], v[232:235], v[48:51]
 s_mov_b32 s26, 5308416
 s_mov_b32 s27, 0x20000
 s_mov_b32 s30, 2359296
 v_mfma_f32_16x16x32_bf16 a[236:239], v[232:235], v[232:235], a[236:239]
 s_add_u32 m0, s86, 25856
 s_nop 0
 buffer_load_dwordx4 v44, s[4:7], s98 offen offset:768 lds
 s_add_u32 m0, s86, 26880
 s_nop 0
 buffer_load_dwordx4 v45, s[4:7], s98 offen offset:768 lds
 s_waitcnt vmcnt(12)
 ds_read_b128 v[116:119], v108 offset:2048
 ds_read_b128 v[124:127], v109 offset:2048
 s_waitcnt lgkmcnt(2)
 v_mfma_f32_16x16x32_bf16 v[48:51], v[40:43], v[240:243], v[48:51]
 s_mov_b32 s31, 0x20000
 s_mov_b32 s34, 256
 v_mfma_f32_16x16x32_bf16 a[236:239], v[240:243], v[240:243], a[236:239]
 s_mov_b32 s35, 0x20000
 s_mov_b32 s38, 51380224
 v_mfma_f32_16x16x32_bf16 v[48:51], v[40:43], v[248:251], v[48:51]
 s_mov_b32 s39, 0x20000
 v_mfma_f32_16x16x32_bf16 a[236:239], v[248:251], v[248:251], a[236:239]
 s_nop 6
 v_mul_f32 v32, 0x3ae38e39, v48
 v_cvt_pk_bf16_f32 v38, v32, v32
 v_and_b32 v38, 0xffff0000, v38
 v_xor_b32 v64, 0x80000000, v38
 v_mov_b32 v65, v64
 v_mov_b32 v66, v64
 v_mov_b32 v67, v64
 s_add_u32 m0, s86, 29824
 s_nop 0
 buffer_load_dwordx4 v44, s[4:7], s98 offen offset:896 lds
 s_add_u32 m0, s86, 30848
 s_nop 0
 buffer_load_dwordx4 v45, s[4:7], s98 offen offset:896 lds
 s_waitcnt vmcnt(12)
 ds_read_b128 v[132:135], v108 offset:6144
 ds_read_b128 v[140:143], v109 offset:6144
 s_waitcnt lgkmcnt(2)
 v_mfma_f32_16x16x32_bf16 v[52:55], v[40:43], v[116:119], 0
 v_mfma_f32_16x16x32_bf16 a[240:243], v[116:119], v[116:119], 0
 v_mfma_f32_16x16x32_bf16 v[52:55], v[40:43], v[124:127], v[52:55]
 v_mfma_f32_16x16x32_bf16 a[240:243], v[124:127], v[124:127], a[240:243]
 v_mfma_f32_16x16x32_bf16 v[68:71], a[148:151], v[112:115], v[64:67]
 v_mfma_f32_16x16x32_bf16 v[72:75], a[152:155], v[112:115], v[64:67]
 v_mfma_f32_16x16x32_bf16 v[76:79], a[148:151], v[120:123], v[64:67]
 v_mfma_f32_16x16x32_bf16 v[80:83], a[152:155], v[120:123], v[64:67]
 s_add_u32 m0, s86, 33792
 s_nop 0
 buffer_load_dwordx4 v44, s[4:7], s98 offen offset:1024 lds
 s_add_u32 m0, s86, 34816
 s_nop 0
 buffer_load_dwordx4 v45, s[4:7], s98 offen offset:1024 lds
 s_waitcnt vmcnt(12)
 ds_read_b128 v[148:151], v108 offset:10240
 ds_read_b128 v[156:159], v109 offset:10240
 s_waitcnt lgkmcnt(2)
 v_mfma_f32_16x16x32_bf16 v[52:55], v[40:43], v[132:135], v[52:55]
 v_mfma_f32_16x16x32_bf16 a[240:243], v[132:135], v[132:135], a[240:243]
 v_mfma_f32_16x16x32_bf16 v[52:55], v[40:43], v[140:143], v[52:55]
 v_mfma_f32_16x16x32_bf16 a[240:243], v[140:143], v[140:143], a[240:243]
 v_mfma_f32_16x16x32_bf16 v[84:87], a[148:151], v[128:131], v[64:67]
 v_cvt_pk_bf16_f32 v112, v68, v69
 v_cvt_pk_bf16_f32 v113, v70, v71
 v_mfma_f32_16x16x32_bf16 v[88:91], a[152:155], v[128:131], v[64:67]
 v_cvt_pk_bf16_f32 v114, v72, v73
 v_cvt_pk_bf16_f32 v115, v74, v75
 v_mfma_f32_16x16x32_bf16 v[92:95], a[148:151], v[136:139], v[64:67]
 v_cvt_pk_bf16_f32 v120, v76, v77
 v_cvt_pk_bf16_f32 v121, v78, v79
 v_mfma_f32_16x16x32_bf16 v[96:99], a[152:155], v[136:139], v[64:67]
 v_cvt_pk_bf16_f32 v122, v80, v81
 v_cvt_pk_bf16_f32 v123, v82, v83
    s_cmp_lt_u32 s71, 9
    s_cbranch_scc1 L_s1_V
    s_cmp_lt_u32 s71, 11
    s_cbranch_scc1 L_s1_K
 s_add_u32 m0, s69, 73728
 s_add_u32 s78, s73, 0
 buffer_load_dwordx4 v20, s[8:11], s78 offen  lds
 s_add_u32 m0, s69, 77824
 s_add_u32 s78, s73, 110592
 buffer_load_dwordx4 v20, s[8:11], s78 offen  lds
 s_add_u32 m0, s69, 81920
 s_add_u32 s78, s73, 221184
 buffer_load_dwordx4 v20, s[8:11], s78 offen  lds
 buffer_load_dword a212, v102, s[8:11], s73 offen offset:0
 buffer_load_dword a213, v3, s[16:19], s74 offen offset:0
    s_branch L_s1_end
L_s1_K:
 s_add_u32 m0, s69, 0
 s_add_u32 s78, s72, 0
 buffer_load_dwordx4 v20, s[8:11], s78 offen  lds
 s_add_u32 m0, s69, 4096
 s_add_u32 s78, s72, 110592
 buffer_load_dwordx4 v20, s[8:11], s78 offen  lds
 s_add_u32 m0, s69, 8192
 s_add_u32 s78, s72, 221184
 buffer_load_dwordx4 v20, s[8:11], s78 offen  lds
 buffer_load_dword a212, v102, s[8:11], s72 offen offset:0
 buffer_load_dword a213, v102, s[8:11], s73 offen offset:0
    s_branch L_s1_end
L_s1_V:
 s_add_u32 m0, s69, 0
 s_add_u32 s78, s72, 0
 buffer_load_dwordx4 v20, s[8:11], s78 offen  lds
 s_add_u32 m0, s69, 4096
 s_add_u32 s78, s72, 110592
 buffer_load_dwordx4 v20, s[8:11], s78 offen  lds
 s_add_u32 m0, s69, 8192
 s_add_u32 s78, s72, 221184
 buffer_load_dwordx4 v20, s[8:11], s78 offen  lds
 buffer_load_dword a212, v102, s[8:11], s72 offen offset:0
 buffer_load_dword a213, v102, s[8:11], s73 offen offset:0
L_s1_end:
 s_waitcnt vmcnt(15)
 ds_read_b128 v[164:167], v108 offset:14336
 ds_read_b128 v[172:175], v109 offset:14336
 s_waitcnt lgkmcnt(2)
 v_mfma_f32_16x16x32_bf16 v[52:55], v[40:43], v[148:151], v[52:55]
 v_mfma_f32_16x16x32_bf16 a[240:243], v[148:151], v[148:151], a[240:243]
 v_mfma_f32_16x16x32_bf16 v[52:55], v[40:43], v[156:159], v[52:55]
 v_mfma_f32_16x16x32_bf16 a[240:243], v[156:159], v[156:159], a[240:243]
 v_mfma_f32_16x16x32_bf16 v[68:71], a[148:151], v[144:147], v[64:67]
 v_cvt_pk_bf16_f32 v128, v84, v85
 v_cvt_pk_bf16_f32 v129, v86, v87
 v_mfma_f32_16x16x32_bf16 v[72:75], a[152:155], v[144:147], v[64:67]
 v_cvt_pk_bf16_f32 v130, v88, v89
 v_cvt_pk_bf16_f32 v131, v90, v91
 v_mfma_f32_16x16x32_bf16 v[76:79], a[148:151], v[152:155], v[64:67]
 v_cvt_pk_bf16_f32 v136, v92, v93
 v_cvt_pk_bf16_f32 v137, v94, v95
 v_mfma_f32_16x16x32_bf16 v[80:83], a[152:155], v[152:155], v[64:67]
 v_cvt_pk_bf16_f32 v138, v96, v97
 v_cvt_pk_bf16_f32 v139, v98, v99
 s_waitcnt vmcnt(13)
 ds_read_b128 v[180:183], v108 offset:18432
 ds_read_b128 v[188:191], v109 offset:18432
 s_waitcnt lgkmcnt(2)
 v_mfma_f32_16x16x32_bf16 v[52:55], v[40:43], v[164:167], v[52:55]
 v_mfma_f32_16x16x32_bf16 a[240:243], v[164:167], v[164:167], a[240:243]
 v_mfma_f32_16x16x32_bf16 v[52:55], v[40:43], v[172:175], v[52:55]
 v_mfma_f32_16x16x32_bf16 a[240:243], v[172:175], v[172:175], a[240:243]
 v_mfma_f32_16x16x32_bf16 v[84:87], a[148:151], v[160:163], v[64:67]
 v_cvt_pk_bf16_f32 v144, v68, v69
 v_cvt_pk_bf16_f32 v145, v70, v71
 v_mfma_f32_16x16x32_bf16 v[88:91], a[152:155], v[160:163], v[64:67]
 v_cvt_pk_bf16_f32 v146, v72, v73
 v_cvt_pk_bf16_f32 v147, v74, v75
 v_mfma_f32_16x16x32_bf16 v[92:95], a[148:151], v[168:171], v[64:67]
 v_cvt_pk_bf16_f32 v152, v76, v77
 v_cvt_pk_bf16_f32 v153, v78, v79
 v_mfma_f32_16x16x32_bf16 v[96:99], a[152:155], v[168:171], v[64:67]
 v_cvt_pk_bf16_f32 v154, v80, v81
 v_cvt_pk_bf16_f32 v155, v82, v83
 s_waitcnt vmcnt(11)
 ds_read_b128 v[196:199], v108 offset:22528
 ds_read_b128 v[204:207], v109 offset:22528
 s_waitcnt lgkmcnt(2)
 v_mfma_f32_16x16x32_bf16 v[52:55], v[40:43], v[180:183], v[52:55]
 v_mfma_f32_16x16x32_bf16 a[240:243], v[180:183], v[180:183], a[240:243]
 v_mfma_f32_16x16x32_bf16 v[52:55], v[40:43], v[188:191], v[52:55]
 v_mfma_f32_16x16x32_bf16 a[240:243], v[188:191], v[188:191], a[240:243]
 v_mfma_f32_16x16x32_bf16 v[68:71], a[148:151], v[176:179], v[64:67]
 v_cvt_pk_bf16_f32 v160, v84, v85
 v_cvt_pk_bf16_f32 v161, v86, v87
 v_mfma_f32_16x16x32_bf16 v[72:75], a[152:155], v[176:179], v[64:67]
 v_cvt_pk_bf16_f32 v162, v88, v89
 v_cvt_pk_bf16_f32 v163, v90, v91
 v_mfma_f32_16x16x32_bf16 v[76:79], a[148:151], v[184:187], v[64:67]
 v_cvt_pk_bf16_f32 v168, v92, v93
 v_cvt_pk_bf16_f32 v169, v94, v95
 v_mfma_f32_16x16x32_bf16 v[80:83], a[152:155], v[184:187], v[64:67]
 v_cvt_pk_bf16_f32 v170, v96, v97
 v_cvt_pk_bf16_f32 v171, v98, v99
 s_waitcnt vmcnt(9)
 ds_read_b128 v[212:215], v108 offset:26624
 ds_read_b128 v[220:223], v109 offset:26624
 s_waitcnt lgkmcnt(2)
 v_mfma_f32_16x16x32_bf16 v[52:55], v[40:43], v[196:199], v[52:55]
 v_mfma_f32_16x16x32_bf16 a[240:243], v[196:199], v[196:199], a[240:243]
 v_mfma_f32_16x16x32_bf16 v[52:55], v[40:43], v[204:207], v[52:55]
 v_mfma_f32_16x16x32_bf16 a[240:243], v[204:207], v[204:207], a[240:243]
 v_mfma_f32_16x16x32_bf16 v[84:87], a[148:151], v[192:195], v[64:67]
 v_cvt_pk_bf16_f32 v176, v68, v69
 v_cvt_pk_bf16_f32 v177, v70, v71
 v_mfma_f32_16x16x32_bf16 v[88:91], a[152:155], v[192:195], v[64:67]
 v_cvt_pk_bf16_f32 v178, v72, v73
 v_cvt_pk_bf16_f32 v179, v74, v75
 v_mfma_f32_16x16x32_bf16 v[92:95], a[148:151], v[200:203], v[64:67]
 v_cvt_pk_bf16_f32 v184, v76, v77
 v_cvt_pk_bf16_f32 v185, v78, v79
 v_mfma_f32_16x16x32_bf16 v[96:99], a[152:155], v[200:203], v[64:67]
 v_cvt_pk_bf16_f32 v186, v80, v81
 v_cvt_pk_bf16_f32 v187, v82, v83
 s_waitcnt vmcnt(7)
 ds_read_b128 v[228:231], v108 offset:30720
 ds_read_b128 v[236:239], v109 offset:30720
 s_waitcnt lgkmcnt(2)
 v_mfma_f32_16x16x32_bf16 v[52:55], v[40:43], v[212:215], v[52:55]
 v_mfma_f32_16x16x32_bf16 a[240:243], v[212:215], v[212:215], a[240:243]
 v_mfma_f32_16x16x32_bf16 v[52:55], v[40:43], v[220:223], v[52:55]
 v_mfma_f32_16x16x32_bf16 a[240:243], v[220:223], v[220:223], a[240:243]
 v_mfma_f32_16x16x32_bf16 v[68:71], a[148:151], v[208:211], v[64:67]
 v_cvt_pk_bf16_f32 v192, v84, v85
 v_cvt_pk_bf16_f32 v193, v86, v87
 v_mfma_f32_16x16x32_bf16 v[72:75], a[152:155], v[208:211], v[64:67]
 v_cvt_pk_bf16_f32 v194, v88, v89
 v_cvt_pk_bf16_f32 v195, v90, v91
 v_mfma_f32_16x16x32_bf16 v[76:79], a[148:151], v[216:219], v[64:67]
 v_cvt_pk_bf16_f32 v200, v92, v93
 v_cvt_pk_bf16_f32 v201, v94, v95
 v_mfma_f32_16x16x32_bf16 v[80:83], a[152:155], v[216:219], v[64:67]
 v_cvt_pk_bf16_f32 v202, v96, v97
 v_cvt_pk_bf16_f32 v203, v98, v99
 s_waitcnt vmcnt(5)
 ds_read_b128 v[244:247], v108 offset:34816
 ds_read_b128 v[252:255], v109 offset:34816
 s_waitcnt lgkmcnt(2)
 v_mfma_f32_16x16x32_bf16 v[52:55], v[40:43], v[228:231], v[52:55]
 v_mfma_f32_16x16x32_bf16 a[240:243], v[228:231], v[228:231], a[240:243]
 v_mfma_f32_16x16x32_bf16 v[52:55], v[40:43], v[236:239], v[52:55]
 v_mfma_f32_16x16x32_bf16 a[240:243], v[236:239], v[236:239], a[240:243]
 v_mfma_f32_16x16x32_bf16 v[84:87], a[148:151], v[224:227], v[64:67]
 v_cvt_pk_bf16_f32 v208, v68, v69
 v_cvt_pk_bf16_f32 v209, v70, v71
 v_mfma_f32_16x16x32_bf16 v[88:91], a[152:155], v[224:227], v[64:67]
 v_cvt_pk_bf16_f32 v210, v72, v73
 v_cvt_pk_bf16_f32 v211, v74, v75
 v_mfma_f32_16x16x32_bf16 v[92:95], a[148:151], v[232:235], v[64:67]
 v_cvt_pk_bf16_f32 v216, v76, v77
 v_cvt_pk_bf16_f32 v217, v78, v79
 v_mfma_f32_16x16x32_bf16 v[96:99], a[152:155], v[232:235], v[64:67]
 v_cvt_pk_bf16_f32 v218, v80, v81
 v_cvt_pk_bf16_f32 v219, v82, v83
 s_waitcnt lgkmcnt(0)
 s_barrier
    s_cmp_lt_u32 s71, 9
    s_cbranch_scc1 L_s3_V
    s_cmp_lt_u32 s71, 11
    s_cbranch_scc1 L_s3_K
 s_add_u32 m0, s69, 86016
 s_add_u32 s78, s73, 331776
 buffer_load_dwordx4 v20, s[8:11], s78 offen  lds
 s_add_u32 m0, s69, 90112
 s_add_u32 s78, s73, 442368
 buffer_load_dwordx4 v20, s[8:11], s78 offen  lds
 s_add_u32 m0, s69, 94208
 s_add_u32 s78, s73, 552960
 buffer_load_dwordx4 v20, s[8:11], s78 offen  lds
 v_mfma_f32_16x16x32_bf16 v[52:55], v[40:43], v[244:247], v[52:55]
 v_mfma_f32_16x16x32_bf16 a[240:243], v[244:247], v[244:247], a[240:243]
 v_mfma_f32_16x16x32_bf16 v[52:55], v[40:43], v[252:255], v[52:55]
 v_mfma_f32_16x16x32_bf16 a[240:243], v[252:255], v[252:255], a[240:243]
 v_mfma_f32_16x16x32_bf16 v[68:71], a[148:151], v[240:243], v[64:67]
 v_cvt_pk_bf16_f32 v224, v84, v85
 v_cvt_pk_bf16_f32 v225, v86, v87
 v_mfma_f32_16x16x32_bf16 v[72:75], a[152:155], v[240:243], v[64:67]
 v_cvt_pk_bf16_f32 v226, v88, v89
 v_cvt_pk_bf16_f32 v227, v90, v91
 v_mfma_f32_16x16x32_bf16 v[76:79], a[148:151], v[248:251], v[64:67]
 v_cvt_pk_bf16_f32 v232, v92, v93
 v_cvt_pk_bf16_f32 v233, v94, v95
 v_mfma_f32_16x16x32_bf16 v[80:83], a[152:155], v[248:251], v[64:67]
 v_cvt_pk_bf16_f32 v234, v96, v97
 v_cvt_pk_bf16_f32 v235, v98, v99
 s_add_u32 m0, s69, 98304
 s_add_u32 s78, s73, 663552
 buffer_load_dwordx4 v20, s[8:11], s78 offen  lds
 v_cvt_pk_bf16_f32 v240, v68, v69
 v_cvt_pk_bf16_f32 v241, v70, v71
 v_cvt_pk_bf16_f32 v242, v72, v73
 v_cvt_pk_bf16_f32 v243, v74, v75
 v_cvt_pk_bf16_f32 v248, v76, v77
 v_cvt_pk_bf16_f32 v249, v78, v79
 v_cvt_pk_bf16_f32 v250, v80, v81
 v_cvt_pk_bf16_f32 v251, v82, v83
 v_mul_f32 v33, 0x3ae38e39, v52
 v_cvt_pk_bf16_f32 v39, v33, v33
 v_and_b32 v39, 0xffff0000, v39
 v_xor_b32 v72, 0x80000000, v39
 v_mov_b32 v73, v72
 v_mov_b32 v74, v72
 v_mov_b32 v75, v72
 s_nop 1
 v_mfma_f32_16x16x32_bf16 v[48:51], a[148:151], v[116:119], v[72:75]
 v_mfma_f32_16x16x32_bf16 v[52:55], a[152:155], v[116:119], v[72:75]
 s_add_u32 m0, s69, 102400
 s_add_u32 s78, s73, 774144
 buffer_load_dwordx4 v20, s[8:11], s78 offen  lds
 v_mfma_f32_16x16x32_bf16 v[56:59], a[148:151], v[124:127], v[72:75]
 v_mfma_f32_16x16x32_bf16 v[60:63], a[152:155], v[124:127], v[72:75]
 s_add_u32 m0, s69, 106496
 s_add_u32 s78, s73, 884736
 buffer_load_dwordx4 v20, s[8:11], s78 offen  lds
 v_mfma_f32_16x16x32_bf16 v[64:67], a[148:151], v[132:135], v[72:75]
 v_cvt_pk_bf16_f32 v116, v48, v49
 v_cvt_pk_bf16_f32 v117, v50, v51
 v_mfma_f32_16x16x32_bf16 v[68:71], a[152:155], v[132:135], v[72:75]
 s_nop 2
 v_cvt_pk_bf16_f32 v118, v52, v53
 v_cvt_pk_bf16_f32 v119, v54, v55
 v_cvt_pk_bf16_f32 v124, v56, v57
 v_cvt_pk_bf16_f32 v125, v58, v59
 s_nop 2
 v_cvt_pk_bf16_f32 v126, v60, v61
 v_cvt_pk_bf16_f32 v127, v62, v63
 v_cvt_pk_bf16_f32 v132, v64, v65
 v_cvt_pk_bf16_f32 v133, v66, v67
 s_nop 2
 v_cvt_pk_bf16_f32 v134, v68, v69
 v_cvt_pk_bf16_f32 v135, v70, v71
 s_waitcnt vmcnt(8)
 s_barrier
 ds_read_b64_tr_b16 a[80:81], v8 offset:8192
 ds_read_b64_tr_b16 a[82:83], v8 offset:8704
 ds_read_b64_tr_b16 a[84:85], v9 offset:8192
 ds_read_b64_tr_b16 a[86:87], v9 offset:8704
 ds_read_b64_tr_b16 a[88:89], v10 offset:8192
 ds_read_b64_tr_b16 a[90:91], v10 offset:8704
 ds_read_b64_tr_b16 a[92:93], v11 offset:8192
 ds_read_b64_tr_b16 a[94:95], v11 offset:8704
 ds_read_b64_tr_b16 a[96:97], v8 offset:12288
 ds_read_b64_tr_b16 a[98:99], v8 offset:12800
 ds_read_b64_tr_b16 a[72:73], v9 offset:12288
 ds_read_b64_tr_b16 a[74:75], v9 offset:12800
 s_waitcnt lgkmcnt(10)
 v_mfma_f32_16x16x32_bf16 v[80:83], a[80:83], v[112:115], 0
 s_add_u32 s78, s73, 995328
 ds_read_b64_tr_b16 a[76:77], v10 offset:12288
 v_accvgpr_read_b32 v34, a236
 v_mfma_f32_16x16x32_bf16 v[84:87], a[80:83], v[116:119], 0
 s_waitcnt lgkmcnt(9)
 ds_read_b64_tr_b16 a[78:79], v10 offset:12800
 v_accvgpr_read_b32 v35, a237
 v_mfma_f32_16x16x32_bf16 v[88:91], a[84:87], v[112:115], 0
 s_add_u32 m0, s69, 110592
 ds_read_b64_tr_b16 a[80:81], v11 offset:12288
 buffer_load_dwordx4 v20, s[8:11], s78 offen  lds
 v_mfma_f32_16x16x32_bf16 v[48:51], a[148:151], v[140:143], v[72:75]
 v_accvgpr_read_b32 v36, a238
 v_mfma_f32_16x16x32_bf16 v[92:95], a[84:87], v[116:119], 0
 s_waitcnt lgkmcnt(9)
 ds_read_b64_tr_b16 a[82:83], v11 offset:12800
 v_accvgpr_read_b32 v37, a239
 v_mfma_f32_16x16x32_bf16 v[96:99], a[88:91], v[112:115], 0
 s_add_u32 s78, s73, 1105920
 ds_read_b64_tr_b16 a[84:85], v8 offset:16384
 s_mov_b32 vcc_lo, 0x22222222
 v_mfma_f32_16x16x32_bf16 v[52:55], a[152:155], v[140:143], v[72:75]
 v_mfma_f32_16x16x32_bf16 v[100:103], a[88:91], v[116:119], 0
 s_waitcnt lgkmcnt(9)
 ds_read_b64_tr_b16 a[86:87], v8 offset:16896
 s_mov_b32 vcc_hi, 0x22222222
 v_mfma_f32_16x16x32_bf16 v[104:107], a[92:95], v[112:115], 0
 s_add_u32 m0, s69, 114688
 ds_read_b64_tr_b16 a[88:89], v9 offset:16384
 buffer_load_dwordx4 v20, s[8:11], s78 offen  lds
 v_cvt_pk_bf16_f32 v140, v48, v49
 v_mfma_f32_16x16x32_bf16 v[108:111], a[92:95], v[116:119], 0
 s_waitcnt lgkmcnt(9)
 ds_read_b64_tr_b16 a[90:91], v9 offset:16896
 v_cvt_pk_bf16_f32 v141, v50, v51
 v_cndmask_b32 v34, v34, v35, vcc
 v_mfma_f32_16x16x32_bf16 v[80:83], a[96:99], v[120:123], v[80:83]
 s_add_u32 s78, s73, 1216512
 ds_read_b64_tr_b16 a[92:93], v10 offset:16384
 buffer_load_dword a158, v3, s[16:19], s74 offen offset:128
 v_cvt_pk_bf16_f32 v142, v52, v53
 v_mfma_f32_16x16x32_bf16 v[84:87], a[96:99], v[124:127], v[84:87]
 s_waitcnt lgkmcnt(9)
 ds_read_b64_tr_b16 a[94:95], v10 offset:16896
 buffer_load_dword a159, v3, s[20:23], s74 offen offset:128
 v_cvt_pk_bf16_f32 v143, v54, v55
 v_mfma_f32_16x16x32_bf16 v[88:91], a[72:75], v[120:123], v[88:91]
 ds_read_b64_tr_b16 a[96:97], v11 offset:16384
 buffer_load_dword a214, v3, s[20:23], s74 offen offset:0
 v_mfma_f32_16x16x32_bf16 v[56:59], a[148:151], v[148:151], v[72:75]
 s_mov_b32 vcc_lo, 0x44444444
 v_mfma_f32_16x16x32_bf16 v[92:95], a[72:75], v[124:127], v[92:95]
 s_waitcnt lgkmcnt(9)
 ds_read_b64_tr_b16 a[98:99], v11 offset:16896
 s_mov_b32 vcc_hi, 0x44444444
 v_mfma_f32_16x16x32_bf16 v[96:99], a[76:79], v[120:123], v[96:99]
 s_waitcnt vmcnt(8)
 s_barrier
 ds_read_b64_tr_b16 a[72:73], v8 offset:20480
 v_cndmask_b32 v34, v34, v36, vcc
 v_mfma_f32_16x16x32_bf16 v[60:63], a[152:155], v[148:151], v[72:75]
 v_mfma_f32_16x16x32_bf16 v[100:103], a[76:79], v[124:127], v[100:103]
 s_waitcnt lgkmcnt(9)
 ds_read_b64_tr_b16 a[74:75], v8 offset:20992
 s_mov_b32 vcc_lo, 0x88888888
 v_mfma_f32_16x16x32_bf16 v[104:107], a[80:83], v[120:123], v[104:107]
 s_add_u32 m0, s69, 118784
 ds_read_b64_tr_b16 a[76:77], v9 offset:20480
 buffer_load_dwordx4 v20, s[8:11], s78 offen  lds
 v_cvt_pk_bf16_f32 v148, v56, v57
 v_mfma_f32_16x16x32_bf16 v[108:111], a[80:83], v[124:127], v[108:111]
 s_waitcnt lgkmcnt(9)
 ds_read_b64_tr_b16 a[78:79], v9 offset:20992
 v_cvt_pk_bf16_f32 v149, v58, v59
 s_mov_b32 vcc_hi, 0x88888888
 v_mfma_f32_16x16x32_bf16 v[80:83], a[84:87], v[128:131], v[80:83]
 s_add_u32 s78, s73, 1327104
 ds_read_b64_tr_b16 a[80:81], v10 offset:20480
 v_cvt_pk_bf16_f32 v150, v60, v61
 v_cndmask_b32 v34, v34, v37, vcc
 v_mfma_f32_16x16x32_bf16 v[84:87], a[84:87], v[132:135], v[84:87]
 s_waitcnt lgkmcnt(9)
 ds_read_b64_tr_b16 a[82:83], v10 offset:20992
 v_cvt_pk_bf16_f32 v151, v62, v63
 s_mov_b32 vcc_lo, 0xf0000f
 v_mfma_f32_16x16x32_bf16 v[88:91], a[88:91], v[128:131], v[88:91]
 s_add_u32 m0, s69, 122880
 ds_read_b64_tr_b16 a[84:85], v11 offset:20480
 buffer_load_dwordx4 v20, s[8:11], s78 offen  lds
 v_mfma_f32_16x16x32_bf16 v[64:67], a[148:151], v[156:159], v[72:75]
 s_mov_b32 vcc_hi, 0xf0000f00
 v_mfma_f32_16x16x32_bf16 v[92:95], a[88:91], v[132:135], v[92:95]
 s_waitcnt lgkmcnt(9)
 ds_read_b64_tr_b16 a[86:87], v11 offset:20992
 s_add_u32 s78, s73, 1437696
 v_cndmask_b32 v28, 0, v34, vcc
 v_mfma_f32_16x16x32_bf16 v[96:99], a[92:95], v[128:131], v[96:99]
 s_add_u32 m0, s69, 126976
 ds_read_b64_tr_b16 a[88:89], v8 offset:24576
 buffer_load_dwordx4 v20, s[8:11], s78 offen  lds
 v_mfma_f32_16x16x32_bf16 v[68:71], a[152:155], v[156:159], v[72:75]
 v_accvgpr_read_b32 v34, a240
 v_mfma_f32_16x16x32_bf16 v[100:103], a[92:95], v[132:135], v[100:103]
 s_waitcnt lgkmcnt(9)
 ds_read_b64_tr_b16 a[90:91], v8 offset:25088
 v_accvgpr_read_b32 v35, a241
 v_mfma_f32_16x16x32_bf16 v[104:107], a[96:99], v[128:131], v[104:107]
 ds_read_b64_tr_b16 a[92:93], v9 offset:24576
 v_cvt_pk_bf16_f32 v156, v64, v65
 v_accvgpr_read_b32 v36, a242
 v_mfma_f32_16x16x32_bf16 v[108:111], a[96:99], v[132:135], v[108:111]
 s_waitcnt lgkmcnt(9)
 ds_read_b64_tr_b16 a[94:95], v9 offset:25088
 v_cvt_pk_bf16_f32 v157, v66, v67
 v_accvgpr_read_b32 v37, a243
 v_mfma_f32_16x16x32_bf16 v[80:83], a[72:75], v[136:139], v[80:83]
 s_add_u32 s78, s73, 1548288
 ds_read_b64_tr_b16 a[96:97], v10 offset:24576
 v_cvt_pk_bf16_f32 v158, v68, v69
 s_mov_b32 vcc_lo, 0x22222222
 v_mfma_f32_16x16x32_bf16 v[84:87], a[72:75], v[140:143], v[84:87]
 s_waitcnt lgkmcnt(9)
 ds_read_b64_tr_b16 a[98:99], v10 offset:25088
 v_cvt_pk_bf16_f32 v159, v70, v71
 s_mov_b32 vcc_hi, 0x22222222
 v_mfma_f32_16x16x32_bf16 v[88:91], a[76:79], v[136:139], v[88:91]
 s_add_u32 m0, s69, 131072
 ds_read_b64_tr_b16 a[72:73], v11 offset:24576
 buffer_load_dwordx4 v20, s[8:11], s78 offen  lds
 v_mfma_f32_16x16x32_bf16 v[48:51], a[148:151], v[164:167], v[72:75]
 v_cndmask_b32 v34, v34, v35, vcc
 v_mfma_f32_16x16x32_bf16 v[92:95], a[76:79], v[140:143], v[92:95]
 s_waitcnt lgkmcnt(9)
 ds_read_b64_tr_b16 a[74:75], v11 offset:25088
 s_add_u32 s78, s73, 1658880
 s_mov_b32 vcc_lo, 0x44444444
 v_mfma_f32_16x16x32_bf16 v[96:99], a[80:83], v[136:139], v[96:99]
 s_add_u32 m0, s69, 135168
 ds_read_b64_tr_b16 a[76:77], v8 offset:28672
 buffer_load_dwordx4 v20, s[8:11], s78 offen  lds
 v_mfma_f32_16x16x32_bf16 v[52:55], a[152:155], v[164:167], v[72:75]
 s_mov_b32 vcc_hi, 0x44444444
 v_mfma_f32_16x16x32_bf16 v[100:103], a[80:83], v[140:143], v[100:103]
 s_waitcnt lgkmcnt(9)
 ds_read_b64_tr_b16 a[78:79], v8 offset:29184
 v_cndmask_b32 v34, v34, v36, vcc
 v_mfma_f32_16x16x32_bf16 v[104:107], a[84:87], v[136:139], v[104:107]
 ds_read_b64_tr_b16 a[80:81], v9 offset:28672
 v_cvt_pk_bf16_f32 v164, v48, v49
 s_mov_b32 vcc_lo, 0x88888888
 v_mfma_f32_16x16x32_bf16 v[108:111], a[84:87], v[140:143], v[108:111]
 s_waitcnt lgkmcnt(9)
 ds_read_b64_tr_b16 a[82:83], v9 offset:29184
 v_cvt_pk_bf16_f32 v165, v50, v51
 s_mov_b32 vcc_hi, 0x88888888
 v_mfma_f32_16x16x32_bf16 v[80:83], a[88:91], v[144:147], v[80:83]
 s_add_u32 s78, s73, 1769472
 ds_read_b64_tr_b16 a[84:85], v10 offset:28672
 v_cvt_pk_bf16_f32 v166, v52, v53
 v_cndmask_b32 v34, v34, v37, vcc
 v_mfma_f32_16x16x32_bf16 v[84:87], a[88:91], v[148:151], v[84:87]
 s_waitcnt lgkmcnt(9)
 ds_read_b64_tr_b16 a[86:87], v10 offset:29184
 v_cvt_pk_bf16_f32 v167, v54, v55
 s_mov_b32 vcc_lo, 0xf0000f
 v_mfma_f32_16x16x32_bf16 v[88:91], a[92:95], v[144:147], v[88:91]
 s_add_u32 m0, s69, 139264
 ds_read_b64_tr_b16 a[88:89], v11 offset:28672
 buffer_load_dwordx4 v20, s[8:11], s78 offen  lds
 v_mfma_f32_16x16x32_bf16 v[56:59], a[148:151], v[172:175], v[72:75]
 s_mov_b32 vcc_hi, 0xf0000f00
 v_mfma_f32_16x16x32_bf16 v[92:95], a[92:95], v[148:151], v[92:95]
 s_waitcnt lgkmcnt(9)
 ds_read_b64_tr_b16 a[90:91], v11 offset:29184
 s_add_u32 s78, s73, 1880064
 v_cndmask_b32 v29, 0, v34, vcc
 v_mfma_f32_16x16x32_bf16 v[96:99], a[96:99], v[144:147], v[96:99]
 s_waitcnt vmcnt(11)
 s_barrier
 ds_read_b64_tr_b16 a[92:93], v8 offset:32768
 v_mov_b32 v30, v28
 v_mfma_f32_16x16x32_bf16 v[60:63], a[152:155], v[172:175], v[72:75]
 v_mfma_f32_16x16x32_bf16 v[100:103], a[96:99], v[148:151], v[100:103]
 s_waitcnt lgkmcnt(9)
 ds_read_b64_tr_b16 a[94:95], v8 offset:33280
 v_mov_b32 v31, v29
 v_mfma_f32_16x16x32_bf16 v[104:107], a[72:75], v[144:147], v[104:107]
 s_add_u32 m0, s69, 143360
 ds_read_b64_tr_b16 a[96:97], v9 offset:32768
 buffer_load_dwordx4 v20, s[8:11], s78 offen  lds
 v_cvt_pk_bf16_f32 v172, v56, v57
 v_mfma_f32_16x16x32_bf16 v[108:111], a[72:75], v[148:151], v[108:111]
 s_waitcnt lgkmcnt(9)
 ds_read_b64_tr_b16 a[98:99], v9 offset:33280
 v_cvt_pk_bf16_f32 v173, v58, v59
 v_permlane16_swap_b32 v28, v30
 v_mfma_f32_16x16x32_bf16 v[80:83], a[76:79], v[152:155], v[80:83]
 s_add_u32 s78, s74, 0
 ds_read_b64_tr_b16 a[72:73], v10 offset:32768
 v_cvt_pk_bf16_f32 v174, v60, v61
 v_permlane16_swap_b32 v29, v31
 v_mfma_f32_16x16x32_bf16 v[84:87], a[76:79], v[156:159], v[84:87]
 s_waitcnt lgkmcnt(9)
 ds_read_b64_tr_b16 a[74:75], v10 offset:33280
 v_cvt_pk_bf16_f32 v175, v62, v63
 v_add_f32 v28, v28, v30
 v_mfma_f32_16x16x32_bf16 v[88:91], a[80:83], v[152:155], v[88:91]
 s_add_u32 m0, s69, 0
 ds_read_b64_tr_b16 a[76:77], v11 offset:32768
 buffer_load_dwordx4 v21, s[16:19], s78 offen  lds
 v_mfma_f32_16x16x32_bf16 v[64:67], a[148:151], v[180:183], v[72:75]
 v_add_f32 v29, v29, v31
 v_mfma_f32_16x16x32_bf16 v[92:95], a[80:83], v[156:159], v[92:95]
 s_waitcnt lgkmcnt(9)
 ds_read_b64_tr_b16 a[78:79], v11 offset:33280
 s_add_u32 s78, s74, 294912
 v_mov_b32 v30, v28
 v_mfma_f32_16x16x32_bf16 v[96:99], a[84:87], v[152:155], v[96:99]
 s_add_u32 m0, s69, 4096
 ds_read_b64_tr_b16 a[80:81], v8 offset:36864
 buffer_load_dwordx4 v21, s[16:19], s78 offen  lds
 v_mfma_f32_16x16x32_bf16 v[68:71], a[152:155], v[180:183], v[72:75]
 v_mov_b32 v31, v29
 v_mfma_f32_16x16x32_bf16 v[100:103], a[84:87], v[156:159], v[100:103]
 s_waitcnt lgkmcnt(9)
 ds_read_b64_tr_b16 a[82:83], v8 offset:37376
 v_permlane32_swap_b32 v28, v30
 v_mfma_f32_16x16x32_bf16 v[104:107], a[88:91], v[152:155], v[104:107]
 ds_read_b64_tr_b16 a[84:85], v9 offset:36864
 v_cvt_pk_bf16_f32 v180, v64, v65
 v_permlane32_swap_b32 v29, v31
 v_mfma_f32_16x16x32_bf16 v[108:111], a[88:91], v[156:159], v[108:111]
 s_waitcnt lgkmcnt(9)
 ds_read_b64_tr_b16 a[86:87], v9 offset:37376
 v_cvt_pk_bf16_f32 v181, v66, v67
 v_add_f32 v28, v28, v30
 v_mfma_f32_16x16x32_bf16 v[80:83], a[92:95], v[160:163], v[80:83]
 s_add_u32 s78, s74, 589824
 ds_read_b64_tr_b16 a[88:89], v10 offset:36864
 v_cvt_pk_bf16_f32 v182, v68, v69
 v_add_f32 v29, v29, v31
 v_mfma_f32_16x16x32_bf16 v[84:87], a[92:95], v[164:167], v[84:87]
 s_waitcnt lgkmcnt(9)
 ds_read_b64_tr_b16 a[90:91], v10 offset:37376
 v_cvt_pk_bf16_f32 v183, v70, v71
 v_mul_f32 v28, 0x3ae38e39, v28
 v_mfma_f32_16x16x32_bf16 v[88:91], a[96:99], v[160:163], v[88:91]
 s_add_u32 m0, s69, 8192
 ds_read_b64_tr_b16 a[92:93], v11 offset:36864
 buffer_load_dwordx4 v21, s[16:19], s78 offen  lds
 v_mfma_f32_16x16x32_bf16 v[48:51], a[148:151], v[188:191], v[72:75]
 v_fma_f32 v28, -v32, v32, v28
 v_mfma_f32_16x16x32_bf16 v[92:95], a[96:99], v[164:167], v[92:95]
 s_waitcnt lgkmcnt(9)
 ds_read_b64_tr_b16 a[94:95], v11 offset:37376
 s_add_u32 s78, s74, 884736
 v_max_f32 v28, 0, v28
 v_mfma_f32_16x16x32_bf16 v[96:99], a[72:75], v[160:163], v[96:99]
 s_add_u32 m0, s69, 12288
 ds_read_b64_tr_b16 a[96:97], v8 offset:40960
 buffer_load_dwordx4 v21, s[16:19], s78 offen  lds
 v_mfma_f32_16x16x32_bf16 v[52:55], a[152:155], v[188:191], v[72:75]
 v_cvt_pk_bf16_f32 v30, v28, v28
 v_mfma_f32_16x16x32_bf16 v[100:103], a[72:75], v[164:167], v[100:103]
 s_waitcnt lgkmcnt(9)
 ds_read_b64_tr_b16 a[98:99], v8 offset:41472
 v_and_b32 v28, 0xffff0000, v30
 v_mfma_f32_16x16x32_bf16 v[104:107], a[76:79], v[160:163], v[104:107]
 ds_read_b64_tr_b16 a[72:73], v9 offset:40960
 v_cvt_pk_bf16_f32 v188, v48, v49
 v_add_f32 v28, 0x3727c5ac, v28
 v_mfma_f32_16x16x32_bf16 v[108:111], a[76:79], v[164:167], v[108:111]
 s_waitcnt lgkmcnt(9)
 ds_read_b64_tr_b16 a[74:75], v9 offset:41472
 v_cvt_pk_bf16_f32 v189, v50, v51
 v_cvt_pk_bf16_f32 v30, v28, v28
 v_mfma_f32_16x16x32_bf16 v[80:83], a[80:83], v[168:171], v[80:83]
 s_add_u32 s78, s74, 1179648
 ds_read_b64_tr_b16 a[76:77], v10 offset:40960
 v_cvt_pk_bf16_f32 v190, v52, v53
 v_lshlrev_b32 v28, 16, v30
 v_mfma_f32_16x16x32_bf16 v[84:87], a[80:83], v[172:175], v[84:87]
 s_waitcnt lgkmcnt(9)
 ds_read_b64_tr_b16 a[78:79], v10 offset:41472
 v_cvt_pk_bf16_f32 v191, v54, v55
 v_sqrt_f32 v28, v28
 v_mfma_f32_16x16x32_bf16 v[88:91], a[84:87], v[168:171], v[88:91]
 s_add_u32 m0, s69, 16384
 ds_read_b64_tr_b16 a[80:81], v11 offset:40960
 buffer_load_dwordx4 v21, s[16:19], s78 offen  lds
 v_mfma_f32_16x16x32_bf16 v[56:59], a[148:151], v[196:199], v[72:75]
 v_cvt_pk_bf16_f32 v30, v28, v28
 v_mfma_f32_16x16x32_bf16 v[92:95], a[84:87], v[172:175], v[92:95]
 s_waitcnt lgkmcnt(9)
 ds_read_b64_tr_b16 a[82:83], v11 offset:41472
 s_add_u32 s78, s74, 1474560
 v_lshlrev_b32 v28, 16, v30
 v_mfma_f32_16x16x32_bf16 v[96:99], a[88:91], v[168:171], v[96:99]
 s_waitcnt vmcnt(11)
 s_barrier
 ds_read_b64_tr_b16 a[84:85], v8 offset:45056
 v_rcp_f32 v28, v28
 v_mfma_f32_16x16x32_bf16 v[60:63], a[152:155], v[196:199], v[72:75]
 v_mfma_f32_16x16x32_bf16 v[100:103], a[88:91], v[172:175], v[100:103]
 s_waitcnt lgkmcnt(9)
 ds_read_b64_tr_b16 a[86:87], v8 offset:45568
 v_mul_f32 v30, v28, v28
 v_mfma_f32_16x16x32_bf16 v[104:107], a[92:95], v[168:171], v[104:107]
 s_add_u32 m0, s69, 20480
 ds_read_b64_tr_b16 a[88:89], v9 offset:45056
 buffer_load_dwordx4 v21, s[16:19], s78 offen  lds
 v_cvt_pk_bf16_f32 v196, v56, v57
 v_mfma_f32_16x16x32_bf16 v[108:111], a[92:95], v[172:175], v[108:111]
 s_waitcnt lgkmcnt(9)
 ds_read_b64_tr_b16 a[90:91], v9 offset:45568
 v_cvt_pk_bf16_f32 v197, v58, v59
 v_mul_f32 v32, s82, v28
 v_mfma_f32_16x16x32_bf16 v[80:83], a[96:99], v[176:179], v[80:83]
 s_add_u32 s78, s74, 1769472
 ds_read_b64_tr_b16 a[92:93], v10 offset:45056
 v_cvt_pk_bf16_f32 v198, v60, v61
 v_mul_f32 v29, 0x3ae38e39, v29
 v_mfma_f32_16x16x32_bf16 v[84:87], a[96:99], v[180:183], v[84:87]
 s_waitcnt lgkmcnt(9)
 ds_read_b64_tr_b16 a[94:95], v10 offset:45568
 v_cvt_pk_bf16_f32 v199, v62, v63
 v_fma_f32 v29, -v33, v33, v29
 v_mfma_f32_16x16x32_bf16 v[88:91], a[72:75], v[176:179], v[88:91]
 s_add_u32 m0, s69, 24576
 ds_read_b64_tr_b16 a[96:97], v11 offset:45056
 buffer_load_dwordx4 v21, s[16:19], s78 offen  lds
 v_mfma_f32_16x16x32_bf16 v[64:67], a[148:151], v[204:207], v[72:75]
 v_max_f32 v29, 0, v29
 v_mfma_f32_16x16x32_bf16 v[92:95], a[72:75], v[180:183], v[92:95]
 s_waitcnt lgkmcnt(9)
 ds_read_b64_tr_b16 a[98:99], v11 offset:45568
 s_add_u32 s78, s74, 2064384
 v_cvt_pk_bf16_f32 v31, v29, v29
 v_mfma_f32_16x16x32_bf16 v[96:99], a[76:79], v[176:179], v[96:99]
 s_add_u32 m0, s69, 28672
 ds_read_b64_tr_b16 a[72:73], v8 offset:49152
 buffer_load_dwordx4 v21, s[16:19], s78 offen  lds
 v_mfma_f32_16x16x32_bf16 v[68:71], a[152:155], v[204:207], v[72:75]
 v_and_b32 v29, 0xffff0000, v31
 v_mfma_f32_16x16x32_bf16 v[100:103], a[76:79], v[180:183], v[100:103]
 s_waitcnt lgkmcnt(9)
 ds_read_b64_tr_b16 a[74:75], v8 offset:49664
 v_add_f32 v29, 0x3727c5ac, v29
 v_mfma_f32_16x16x32_bf16 v[104:107], a[80:83], v[176:179], v[104:107]
 ds_read_b64_tr_b16 a[76:77], v9 offset:49152
 v_cvt_pk_bf16_f32 v204, v64, v65
 v_cvt_pk_bf16_f32 v31, v29, v29
 v_mfma_f32_16x16x32_bf16 v[108:111], a[80:83], v[180:183], v[108:111]
 s_waitcnt lgkmcnt(9)
 ds_read_b64_tr_b16 a[78:79], v9 offset:49664
 v_cvt_pk_bf16_f32 v205, v66, v67
 v_lshlrev_b32 v29, 16, v31
 v_mfma_f32_16x16x32_bf16 v[80:83], a[84:87], v[184:187], v[80:83]
 s_add_u32 s78, s74, 2359296
 ds_read_b64_tr_b16 a[80:81], v10 offset:49152
 v_cvt_pk_bf16_f32 v206, v68, v69
 v_sqrt_f32 v29, v29
 v_mfma_f32_16x16x32_bf16 v[84:87], a[84:87], v[188:191], v[84:87]
 s_waitcnt lgkmcnt(9)
 ds_read_b64_tr_b16 a[82:83], v10 offset:49664
 v_cvt_pk_bf16_f32 v207, v70, v71
 v_cvt_pk_bf16_f32 v31, v29, v29
 v_mfma_f32_16x16x32_bf16 v[88:91], a[88:91], v[184:187], v[88:91]
 s_add_u32 m0, s69, 32768
 ds_read_b64_tr_b16 a[84:85], v11 offset:49152
 buffer_load_dwordx4 v21, s[16:19], s78 offen  lds
 v_mfma_f32_16x16x32_bf16 v[48:51], a[148:151], v[212:215], v[72:75]
 v_lshlrev_b32 v29, 16, v31
 v_mfma_f32_16x16x32_bf16 v[92:95], a[88:91], v[188:191], v[92:95]
 s_waitcnt lgkmcnt(9)
 ds_read_b64_tr_b16 a[86:87], v11 offset:49664
 s_add_u32 s78, s74, 2654208
 v_rcp_f32 v29, v29
 v_mfma_f32_16x16x32_bf16 v[96:99], a[92:95], v[184:187], v[96:99]
 s_add_u32 m0, s69, 36864
 ds_read_b64_tr_b16 a[88:89], v8 offset:53248
 buffer_load_dwordx4 v21, s[16:19], s78 offen  lds
 v_mfma_f32_16x16x32_bf16 v[52:55], a[152:155], v[212:215], v[72:75]
 v_mul_f32 v31, v29, v29
 v_mfma_f32_16x16x32_bf16 v[100:103], a[92:95], v[188:191], v[100:103]
 s_waitcnt lgkmcnt(9)
 ds_read_b64_tr_b16 a[90:91], v8 offset:53760
 v_mul_f32 v33, s82, v29
 v_mfma_f32_16x16x32_bf16 v[104:107], a[96:99], v[184:187], v[104:107]
 ds_read_b64_tr_b16 a[92:93], v9 offset:53248
 v_cvt_pk_bf16_f32 v212, v48, v49
 s_mul_i32 s48, s70, 304128
 v_mfma_f32_16x16x32_bf16 v[108:111], a[96:99], v[188:191], v[108:111]
 s_waitcnt lgkmcnt(9)
 ds_read_b64_tr_b16 a[94:95], v9 offset:53760
 v_cvt_pk_bf16_f32 v213, v50, v51
 s_add_u32 s83, s48, 2424832
 v_mfma_f32_16x16x32_bf16 v[80:83], a[72:75], v[192:195], v[80:83]
 s_add_u32 s78, s74, 2949120
 ds_read_b64_tr_b16 a[96:97], v10 offset:53248
 v_cvt_pk_bf16_f32 v214, v52, v53
 s_mul_i32 s49, s70, 147456
 v_mfma_f32_16x16x32_bf16 v[84:87], a[72:75], v[196:199], v[84:87]
 s_waitcnt lgkmcnt(9)
 ds_read_b64_tr_b16 a[98:99], v10 offset:53760
 v_cvt_pk_bf16_f32 v215, v54, v55
 s_add_u32 s90, s49, 65536
 v_mfma_f32_16x16x32_bf16 v[88:91], a[76:79], v[192:195], v[88:91]
 s_add_u32 m0, s69, 40960
 ds_read_b64_tr_b16 a[72:73], v11 offset:53248
 buffer_load_dwordx4 v21, s[16:19], s78 offen  lds
 v_mfma_f32_16x16x32_bf16 v[56:59], a[148:151], v[220:223], v[72:75]
 s_sub_u32 s50, s71, 9
 v_mfma_f32_16x16x32_bf16 v[92:95], a[76:79], v[196:199], v[92:95]
 s_waitcnt lgkmcnt(9)
 ds_read_b64_tr_b16 a[74:75], v11 offset:53760
 s_add_u32 s78, s74, 3244032
 s_cmp_lt_u32 s71, 9
 s_cselect_b32 s84, s90, s83
 s_cselect_b32 s49, s71, s50
 v_mfma_f32_16x16x32_bf16 v[96:99], a[80:83], v[192:195], v[96:99]
 s_waitcnt vmcnt(11)
 s_barrier
 ds_read_b64_tr_b16 a[76:77], v8 offset:57344
 s_lshl_b32 s49, s49, 12
 v_mfma_f32_16x16x32_bf16 v[60:63], a[152:155], v[220:223], v[72:75]
 v_mfma_f32_16x16x32_bf16 v[100:103], a[80:83], v[196:199], v[100:103]
 s_waitcnt lgkmcnt(9)
 ds_read_b64_tr_b16 a[78:79], v8 offset:57856
 s_mul_i32 s48, s68, 36864
 v_mfma_f32_16x16x32_bf16 v[104:107], a[84:87], v[192:195], v[104:107]
 s_add_u32 m0, s69, 45056
 ds_read_b64_tr_b16 a[80:81], v9 offset:57344
 buffer_load_dwordx4 v21, s[16:19], s78 offen  lds
 v_cvt_pk_bf16_f32 v220, v56, v57
 v_mfma_f32_16x16x32_bf16 v[108:111], a[84:87], v[196:199], v[108:111]
 s_waitcnt lgkmcnt(9)
 ds_read_b64_tr_b16 a[82:83], v9 offset:57856
 v_cvt_pk_bf16_f32 v221, v58, v59
 s_add_u32 s49, s49, s48
 v_mfma_f32_16x16x32_bf16 v[80:83], a[88:91], v[200:203], v[80:83]
 s_add_u32 s78, s74, 3538944
 ds_read_b64_tr_b16 a[84:85], v10 offset:57344
 v_cvt_pk_bf16_f32 v222, v60, v61
 v_lshlrev_b32 v42, 8, v2
 v_mfma_f32_16x16x32_bf16 v[84:87], a[88:91], v[204:207], v[84:87]
 s_waitcnt lgkmcnt(9)
 ds_read_b64_tr_b16 a[86:87], v10 offset:57856
 v_cvt_pk_bf16_f32 v223, v62, v63
 v_lshl_add_u32 v42, v1, 4, v42
 v_mfma_f32_16x16x32_bf16 v[88:91], a[92:95], v[200:203], v[88:91]
 s_add_u32 m0, s69, 49152
 ds_read_b64_tr_b16 a[88:89], v11 offset:57344
 buffer_load_dwordx4 v21, s[16:19], s78 offen  lds
 v_mfma_f32_16x16x32_bf16 v[64:67], a[148:151], v[228:231], v[72:75]
 v_add_u32 v27, s49, v42
 v_mfma_f32_16x16x32_bf16 v[92:95], a[92:95], v[204:207], v[92:95]
 s_waitcnt lgkmcnt(9)
 ds_read_b64_tr_b16 a[90:91], v11 offset:57856
 s_add_u32 s78, s74, 3833856
 s_sub_u32 s49, s71, 2
 v_mfma_f32_16x16x32_bf16 v[96:99], a[96:99], v[200:203], v[96:99]
 s_add_u32 m0, s69, 53248
 ds_read_b64_tr_b16 a[92:93], v8 offset:61440
 buffer_load_dwordx4 v21, s[16:19], s78 offen  lds
 v_mfma_f32_16x16x32_bf16 v[68:71], a[152:155], v[228:231], v[72:75]
 s_lshl_b32 s49, s49, 12
 v_mfma_f32_16x16x32_bf16 v[100:103], a[96:99], v[204:207], v[100:103]
 s_waitcnt lgkmcnt(9)
 ds_read_b64_tr_b16 a[94:95], v8 offset:61952
 s_add_u32 s49, s49, s48
 v_mfma_f32_16x16x32_bf16 v[104:107], a[72:75], v[200:203], v[104:107]
 ds_read_b64_tr_b16 a[96:97], v9 offset:61440
 v_cvt_pk_bf16_f32 v228, v64, v65
 v_add_u32 v42, s49, v42
 v_mfma_f32_16x16x32_bf16 v[108:111], a[72:75], v[204:207], v[108:111]
 s_waitcnt lgkmcnt(9)
 ds_read_b64_tr_b16 a[98:99], v9 offset:61952
 v_cvt_pk_bf16_f32 v229, v66, v67
 s_lshl_b32 s49, s71, 10
 v_mfma_f32_16x16x32_bf16 v[80:83], a[76:79], v[208:211], v[80:83]
 s_add_u32 s78, s74, 4128768
 ds_read_b64_tr_b16 a[72:73], v10 offset:61440
 v_cvt_pk_bf16_f32 v230, v68, v69
 s_add_u32 s49, s49, s48
 v_mfma_f32_16x16x32_bf16 v[84:87], a[76:79], v[212:215], v[84:87]
 s_waitcnt lgkmcnt(9)
 ds_read_b64_tr_b16 a[74:75], v10 offset:61952
 v_cvt_pk_bf16_f32 v231, v70, v71
 s_add_u32 s49, s49, 147456
 v_mfma_f32_16x16x32_bf16 v[88:91], a[80:83], v[208:211], v[88:91]
 s_add_u32 m0, s69, 57344
 ds_read_b64_tr_b16 a[76:77], v11 offset:61440
 buffer_load_dwordx4 v21, s[16:19], s78 offen  lds
 v_mfma_f32_16x16x32_bf16 v[48:51], a[148:151], v[236:239], v[72:75]
 v_mul_u32_u24 v43, 9216, v2
 v_mfma_f32_16x16x32_bf16 v[92:95], a[80:83], v[212:215], v[92:95]
 s_waitcnt lgkmcnt(9)
 ds_read_b64_tr_b16 a[78:79], v11 offset:61952
 s_add_u32 s78, s74, 4423680
 v_lshl_add_u32 v43, v1, 4, v43
 v_mfma_f32_16x16x32_bf16 v[96:99], a[84:87], v[208:211], v[96:99]
 s_add_u32 m0, s69, 61440
 ds_read_b64_tr_b16 a[80:81], v12 offset:0
 buffer_load_dwordx4 v21, s[16:19], s78 offen  lds
 v_mfma_f32_16x16x32_bf16 v[52:55], a[152:155], v[236:239], v[72:75]
 v_add_u32 v43, s49, v43
 v_mfma_f32_16x16x32_bf16 v[100:103], a[84:87], v[212:215], v[100:103]
 s_waitcnt lgkmcnt(9)
 ds_read_b64_tr_b16 a[82:83], v12 offset:512
 v_mov_b32 v44, s71
 v_mfma_f32_16x16x32_bf16 v[104:107], a[88:91], v[208:211], v[104:107]
 ds_read_b64_tr_b16 a[84:85], v13 offset:0
 v_cvt_pk_bf16_f32 v236, v48, v49
 v_cmp_gt_u32 vcc, 9, v44
 v_mfma_f32_16x16x32_bf16 v[108:111], a[88:91], v[212:215], v[108:111]
 s_waitcnt lgkmcnt(9)
 ds_read_b64_tr_b16 a[86:87], v13 offset:512
 v_cvt_pk_bf16_f32 v237, v50, v51
 v_cndmask_b32 v26, v42, v43, vcc
 v_mfma_f32_16x16x32_bf16 v[80:83], a[92:95], v[216:219], v[80:83]
 s_add_u32 s78, s74, 4718592
 ds_read_b64_tr_b16 a[88:89], v14 offset:0
 v_cvt_pk_bf16_f32 v238, v52, v53
 v_mfma_f32_16x16x32_bf16 v[84:87], a[92:95], v[220:223], v[84:87]
 s_waitcnt lgkmcnt(9)
 ds_read_b64_tr_b16 a[90:91], v14 offset:512
 v_cvt_pk_bf16_f32 v239, v54, v55
 v_mfma_f32_16x16x32_bf16 v[88:91], a[96:99], v[216:219], v[88:91]
 s_add_u32 m0, s69, 65536
 ds_read_b64_tr_b16 a[92:93], v15 offset:0
 buffer_load_dwordx4 v21, s[16:19], s78 offen  lds
 v_mfma_f32_16x16x32_bf16 v[56:59], a[148:151], v[244:247], v[72:75]
 v_mfma_f32_16x16x32_bf16 v[92:95], a[96:99], v[220:223], v[92:95]
 s_waitcnt lgkmcnt(9)
 ds_read_b64_tr_b16 a[94:95], v15 offset:512
 s_add_u32 s78, s74, 5013504
 v_mfma_f32_16x16x32_bf16 v[96:99], a[72:75], v[216:219], v[96:99]
 s_add_u32 m0, s69, 69632
 ds_read_b64_tr_b16 a[96:97], v12 offset:4096
 buffer_load_dwordx4 v21, s[16:19], s78 offen  lds
 v_mfma_f32_16x16x32_bf16 v[60:63], a[152:155], v[244:247], v[72:75]
 v_mfma_f32_16x16x32_bf16 v[100:103], a[72:75], v[220:223], v[100:103]
 s_waitcnt lgkmcnt(9)
 ds_read_b64_tr_b16 a[98:99], v12 offset:4608
 v_mfma_f32_16x16x32_bf16 v[104:107], a[76:79], v[216:219], v[104:107]
 ds_read_b64_tr_b16 a[72:73], v13 offset:4096
 v_cvt_pk_bf16_f32 v244, v56, v57
 v_mfma_f32_16x16x32_bf16 v[108:111], a[76:79], v[220:223], v[108:111]
 s_waitcnt lgkmcnt(9)
 ds_read_b64_tr_b16 a[74:75], v13 offset:4608
 v_cvt_pk_bf16_f32 v245, v58, v59
 v_mfma_f32_16x16x32_bf16 v[80:83], a[80:83], v[224:227], v[80:83]
 s_add_u32 s78, s74, 0
 ds_read_b64_tr_b16 a[76:77], v14 offset:4096
 v_cvt_pk_bf16_f32 v246, v60, v61
 v_mfma_f32_16x16x32_bf16 v[84:87], a[80:83], v[228:231], v[84:87]
 s_waitcnt lgkmcnt(9)
 ds_read_b64_tr_b16 a[78:79], v14 offset:4608
 v_cvt_pk_bf16_f32 v247, v62, v63
 v_mfma_f32_16x16x32_bf16 v[88:91], a[84:87], v[224:227], v[88:91]
 s_add_u32 m0, s69, 73728
 ds_read_b64_tr_b16 a[80:81], v15 offset:4096
 buffer_load_dwordx4 v21, s[20:23], s78 offen  lds
 v_mfma_f32_16x16x32_bf16 v[64:67], a[148:151], v[252:255], v[72:75]
 v_mfma_f32_16x16x32_bf16 v[92:95], a[84:87], v[228:231], v[92:95]
 s_waitcnt lgkmcnt(9)
 ds_read_b64_tr_b16 a[82:83], v15 offset:4608
 s_add_u32 s78, s74, 294912
 v_mfma_f32_16x16x32_bf16 v[96:99], a[88:91], v[224:227], v[96:99]
 s_add_u32 m0, s69, 77824
 ds_read_b64_tr_b16 a[84:85], v12 offset:8192
 buffer_load_dwordx4 v21, s[20:23], s78 offen  lds
 v_mfma_f32_16x16x32_bf16 v[68:71], a[152:155], v[252:255], v[72:75]
 v_mfma_f32_16x16x32_bf16 v[100:103], a[88:91], v[228:231], v[100:103]
 s_waitcnt lgkmcnt(9)
 ds_read_b64_tr_b16 a[86:87], v12 offset:8704
 v_mfma_f32_16x16x32_bf16 v[104:107], a[92:95], v[224:227], v[104:107]
 ds_read_b64_tr_b16 a[88:89], v13 offset:8192
 v_cvt_pk_bf16_f32 v252, v64, v65
 v_mfma_f32_16x16x32_bf16 v[108:111], a[92:95], v[228:231], v[108:111]
 s_waitcnt lgkmcnt(9)
 ds_read_b64_tr_b16 a[90:91], v13 offset:8704
 v_cvt_pk_bf16_f32 v253, v66, v67
 v_mfma_f32_16x16x32_bf16 v[80:83], a[96:99], v[232:235], v[80:83]
 s_add_u32 s78, s74, 589824
 ds_read_b64_tr_b16 a[92:93], v14 offset:8192
 v_cvt_pk_bf16_f32 v254, v68, v69
 v_mfma_f32_16x16x32_bf16 v[84:87], a[96:99], v[236:239], v[84:87]
 s_waitcnt lgkmcnt(9)
 ds_read_b64_tr_b16 a[94:95], v14 offset:8704
 v_cvt_pk_bf16_f32 v255, v70, v71
 v_mfma_f32_16x16x32_bf16 v[88:91], a[72:75], v[232:235], v[88:91]
 s_add_u32 m0, s69, 81920
 ds_read_b64_tr_b16 a[96:97], v15 offset:8192
 buffer_load_dwordx4 v21, s[20:23], s78 offen  lds
 v_mfma_f32_16x16x32_bf16 v[92:95], a[72:75], v[236:239], v[92:95]
 s_waitcnt lgkmcnt(9)
 ds_read_b64_tr_b16 a[98:99], v15 offset:8704
 v_mfma_f32_16x16x32_bf16 v[96:99], a[76:79], v[232:235], v[96:99]
 ds_read_b64_tr_b16 a[72:73], v12 offset:12288
 v_mfma_f32_16x16x32_bf16 v[100:103], a[76:79], v[236:239], v[100:103]
 s_waitcnt lgkmcnt(9)
 ds_read_b64_tr_b16 a[74:75], v12 offset:12800
 v_mfma_f32_16x16x32_bf16 v[104:107], a[80:83], v[232:235], v[104:107]
 ds_read_b64_tr_b16 a[76:77], v13 offset:12288
 v_mfma_f32_16x16x32_bf16 v[108:111], a[80:83], v[236:239], v[108:111]
 s_waitcnt lgkmcnt(9)
 ds_read_b64_tr_b16 a[78:79], v13 offset:12800
 v_mfma_f32_16x16x32_bf16 v[80:83], a[84:87], v[240:243], v[80:83]
 ds_read_b64_tr_b16 a[80:81], v14 offset:12288
 v_mfma_f32_16x16x32_bf16 v[84:87], a[84:87], v[244:247], v[84:87]
 s_waitcnt lgkmcnt(9)
 ds_read_b64_tr_b16 a[82:83], v14 offset:12800
 v_mfma_f32_16x16x32_bf16 v[88:91], a[88:91], v[240:243], v[88:91]
 ds_read_b64_tr_b16 a[84:85], v15 offset:12288
 v_mfma_f32_16x16x32_bf16 v[92:95], a[88:91], v[244:247], v[92:95]
 s_waitcnt lgkmcnt(9)
 ds_read_b64_tr_b16 a[86:87], v15 offset:12800
 v_mfma_f32_16x16x32_bf16 v[96:99], a[92:95], v[240:243], v[96:99]
 s_waitcnt vmcnt(15)
 s_barrier
 ds_read_b64_tr_b16 a[88:89], v4 offset:0
 v_mfma_f32_16x16x32_bf16 v[100:103], a[92:95], v[244:247], v[100:103]
 s_waitcnt lgkmcnt(9)
 ds_read_b64_tr_b16 a[90:91], v4 offset:512
 v_mfma_f32_16x16x32_bf16 v[104:107], a[96:99], v[240:243], v[104:107]
 ds_read_b64_tr_b16 a[92:93], v5 offset:0
 v_mfma_f32_16x16x32_bf16 v[108:111], a[96:99], v[244:247], v[108:111]
 s_waitcnt lgkmcnt(9)
 ds_read_b64_tr_b16 a[94:95], v5 offset:512
 v_mfma_f32_16x16x32_bf16 v[80:83], a[72:75], v[248:251], v[80:83]
 ds_read_b64_tr_b16 a[96:97], v6 offset:0
 v_mfma_f32_16x16x32_bf16 v[84:87], a[72:75], v[252:255], v[84:87]
 s_waitcnt lgkmcnt(9)
 ds_read_b64_tr_b16 a[98:99], v6 offset:512
 v_mfma_f32_16x16x32_bf16 v[88:91], a[76:79], v[248:251], v[88:91]
 ds_read_b64_tr_b16 a[72:73], v7 offset:0
 v_mfma_f32_16x16x32_bf16 v[92:95], a[76:79], v[252:255], v[92:95]
 s_waitcnt lgkmcnt(9)
 ds_read_b64_tr_b16 a[74:75], v7 offset:512
 v_mfma_f32_16x16x32_bf16 v[96:99], a[80:83], v[248:251], v[96:99]
 ds_read_b64_tr_b16 a[76:77], v4 offset:4096
    s_branch L_s3_end
L_s3_K:
 s_add_u32 m0, s69, 12288
 s_add_u32 s78, s72, 331776
 buffer_load_dwordx4 v20, s[8:11], s78 offen  lds
 s_add_u32 m0, s69, 16384
 s_add_u32 s78, s72, 442368
 buffer_load_dwordx4 v20, s[8:11], s78 offen  lds
 s_add_u32 m0, s69, 20480
 s_add_u32 s78, s72, 552960
 buffer_load_dwordx4 v20, s[8:11], s78 offen  lds
 v_mfma_f32_16x16x32_bf16 v[52:55], v[40:43], v[244:247], v[52:55]
 v_mfma_f32_16x16x32_bf16 a[240:243], v[244:247], v[244:247], a[240:243]
 v_mfma_f32_16x16x32_bf16 v[52:55], v[40:43], v[252:255], v[52:55]
 v_mfma_f32_16x16x32_bf16 a[240:243], v[252:255], v[252:255], a[240:243]
 v_mfma_f32_16x16x32_bf16 v[68:71], a[148:151], v[240:243], v[64:67]
 v_cvt_pk_bf16_f32 v224, v84, v85
 v_cvt_pk_bf16_f32 v225, v86, v87
 v_mfma_f32_16x16x32_bf16 v[72:75], a[152:155], v[240:243], v[64:67]
 v_cvt_pk_bf16_f32 v226, v88, v89
 v_cvt_pk_bf16_f32 v227, v90, v91
 v_mfma_f32_16x16x32_bf16 v[76:79], a[148:151], v[248:251], v[64:67]
 v_cvt_pk_bf16_f32 v232, v92, v93
 v_cvt_pk_bf16_f32 v233, v94, v95
 v_mfma_f32_16x16x32_bf16 v[80:83], a[152:155], v[248:251], v[64:67]
 v_cvt_pk_bf16_f32 v234, v96, v97
 v_cvt_pk_bf16_f32 v235, v98, v99
 s_add_u32 m0, s69, 24576
 s_add_u32 s78, s72, 663552
 buffer_load_dwordx4 v20, s[8:11], s78 offen  lds
 v_cvt_pk_bf16_f32 v240, v68, v69
 v_cvt_pk_bf16_f32 v241, v70, v71
 v_cvt_pk_bf16_f32 v242, v72, v73
 v_cvt_pk_bf16_f32 v243, v74, v75
 v_cvt_pk_bf16_f32 v248, v76, v77
 v_cvt_pk_bf16_f32 v249, v78, v79
 v_cvt_pk_bf16_f32 v250, v80, v81
 v_cvt_pk_bf16_f32 v251, v82, v83
 v_mul_f32 v33, 0x3ae38e39, v52
 v_cvt_pk_bf16_f32 v39, v33, v33
 v_and_b32 v39, 0xffff0000, v39
 v_xor_b32 v104, 0x80000000, v39
 v_mov_b32 v105, v104
 v_mov_b32 v106, v104
 v_mov_b32 v107, v104
 s_nop 1
 v_mfma_f32_16x16x32_bf16 v[80:83], a[148:151], v[116:119], v[104:107]
 v_mfma_f32_16x16x32_bf16 v[84:87], a[152:155], v[116:119], v[104:107]
 s_add_u32 m0, s69, 28672
 s_add_u32 s78, s72, 774144
 buffer_load_dwordx4 v20, s[8:11], s78 offen  lds
 v_mfma_f32_16x16x32_bf16 v[88:91], a[148:151], v[124:127], v[104:107]
 v_mfma_f32_16x16x32_bf16 v[92:95], a[152:155], v[124:127], v[104:107]
 s_add_u32 m0, s69, 32768
 s_add_u32 s78, s72, 884736
 buffer_load_dwordx4 v20, s[8:11], s78 offen  lds
 v_mfma_f32_16x16x32_bf16 v[96:99], a[148:151], v[132:135], v[104:107]
 v_cvt_pk_bf16_f32 v116, v80, v81
 v_cvt_pk_bf16_f32 v117, v82, v83
 v_mfma_f32_16x16x32_bf16 v[100:103], a[152:155], v[132:135], v[104:107]
 s_nop 2
 v_cvt_pk_bf16_f32 v118, v84, v85
 v_cvt_pk_bf16_f32 v119, v86, v87
 v_cvt_pk_bf16_f32 v124, v88, v89
 v_cvt_pk_bf16_f32 v125, v90, v91
 s_nop 2
 v_cvt_pk_bf16_f32 v126, v92, v93
 v_cvt_pk_bf16_f32 v127, v94, v95
 v_cvt_pk_bf16_f32 v132, v96, v97
 v_cvt_pk_bf16_f32 v133, v98, v99
 s_nop 2
 v_cvt_pk_bf16_f32 v134, v100, v101
 v_cvt_pk_bf16_f32 v135, v102, v103
 s_waitcnt vmcnt(8)
 s_barrier
 ds_read_b64_tr_b16 a[72:73], v4 offset:0
 ds_read_b64_tr_b16 a[74:75], v4 offset:512
 ds_read_b64_tr_b16 a[76:77], v5 offset:0
 ds_read_b64_tr_b16 a[78:79], v5 offset:512
 ds_read_b64_tr_b16 a[80:81], v6 offset:0
 ds_read_b64_tr_b16 a[82:83], v6 offset:512
 ds_read_b64_tr_b16 a[84:85], v7 offset:0
 ds_read_b64_tr_b16 a[86:87], v7 offset:512
 ds_read_b64_tr_b16 a[88:89], v4 offset:4096
 ds_read_b64_tr_b16 a[90:91], v4 offset:4608
 ds_read_b64_tr_b16 a[92:93], v5 offset:4096
 ds_read_b64_tr_b16 a[94:95], v5 offset:4608
 s_waitcnt lgkmcnt(10)
 v_mfma_f32_16x16x32_bf16 v[48:51], a[72:75], v[112:115], 0
 s_add_u32 s78, s72, 995328
 ds_read_b64_tr_b16 a[96:97], v6 offset:4096
 v_accvgpr_read_b32 v34, a236
 v_mfma_f32_16x16x32_bf16 v[52:55], a[72:75], v[116:119], 0
 s_waitcnt lgkmcnt(9)
 ds_read_b64_tr_b16 a[98:99], v6 offset:4608
 v_accvgpr_read_b32 v35, a237
 v_mfma_f32_16x16x32_bf16 v[56:59], a[76:79], v[112:115], 0
 s_add_u32 m0, s69, 36864
 ds_read_b64_tr_b16 a[72:73], v7 offset:4096
 buffer_load_dwordx4 v20, s[8:11], s78 offen  lds
 v_mfma_f32_16x16x32_bf16 v[80:83], a[148:151], v[140:143], v[104:107]
 v_accvgpr_read_b32 v36, a238
 v_mfma_f32_16x16x32_bf16 v[60:63], a[76:79], v[116:119], 0
 s_waitcnt lgkmcnt(9)
 ds_read_b64_tr_b16 a[74:75], v7 offset:4608
 v_accvgpr_read_b32 v37, a239
 v_mfma_f32_16x16x32_bf16 v[64:67], a[80:83], v[112:115], 0
 ds_read_b64_tr_b16 a[76:77], v4 offset:8192
 s_mov_b32 vcc_lo, 0x22222222
 v_mfma_f32_16x16x32_bf16 v[84:87], a[152:155], v[140:143], v[104:107]
 v_mfma_f32_16x16x32_bf16 v[68:71], a[80:83], v[116:119], 0
 s_waitcnt lgkmcnt(9)
 ds_read_b64_tr_b16 a[78:79], v4 offset:8704
 s_mov_b32 vcc_hi, 0x22222222
 v_mfma_f32_16x16x32_bf16 v[72:75], a[84:87], v[112:115], 0
 s_add_u32 s78, s72, 1105920
 ds_read_b64_tr_b16 a[80:81], v5 offset:8192
 v_cvt_pk_bf16_f32 v140, v80, v81
 v_cndmask_b32 v34, v34, v35, vcc
 v_mfma_f32_16x16x32_bf16 v[76:79], a[84:87], v[116:119], 0
 s_waitcnt lgkmcnt(9)
 ds_read_b64_tr_b16 a[82:83], v5 offset:8704
 v_cvt_pk_bf16_f32 v141, v82, v83
 s_mov_b32 vcc_lo, 0x44444444
 v_mfma_f32_16x16x32_bf16 v[48:51], a[88:91], v[120:123], v[48:51]
 ds_read_b64_tr_b16 a[84:85], v6 offset:8192
 buffer_load_dword a214, v3, s[16:19], s74 offen offset:0
 v_cvt_pk_bf16_f32 v142, v84, v85
 v_mfma_f32_16x16x32_bf16 v[52:55], a[88:91], v[124:127], v[52:55]
 s_waitcnt lgkmcnt(9)
 ds_read_b64_tr_b16 a[86:87], v6 offset:8704
 v_cvt_pk_bf16_f32 v143, v86, v87
 s_mov_b32 vcc_hi, 0x44444444
 v_mfma_f32_16x16x32_bf16 v[56:59], a[92:95], v[120:123], v[56:59]
 s_add_u32 m0, s69, 40960
 ds_read_b64_tr_b16 a[88:89], v7 offset:8192
 buffer_load_dwordx4 v20, s[8:11], s78 offen  lds
 v_mfma_f32_16x16x32_bf16 v[88:91], a[148:151], v[148:151], v[104:107]
 v_cndmask_b32 v34, v34, v36, vcc
 v_mfma_f32_16x16x32_bf16 v[60:63], a[92:95], v[124:127], v[60:63]
 s_waitcnt lgkmcnt(9)
 ds_read_b64_tr_b16 a[90:91], v7 offset:8704
 s_mov_b32 vcc_lo, 0x88888888
 v_mfma_f32_16x16x32_bf16 v[64:67], a[96:99], v[120:123], v[64:67]
 s_waitcnt vmcnt(6)
 s_barrier
 ds_read_b64_tr_b16 a[92:93], v4 offset:12288
 s_add_u32 s78, s72, 1216512
 v_mfma_f32_16x16x32_bf16 v[92:95], a[152:155], v[148:151], v[104:107]
 s_mov_b32 vcc_hi, 0x88888888
 v_mfma_f32_16x16x32_bf16 v[68:71], a[96:99], v[124:127], v[68:71]
 s_waitcnt lgkmcnt(9)
 ds_read_b64_tr_b16 a[94:95], v4 offset:12800
 v_cndmask_b32 v34, v34, v37, vcc
 v_mfma_f32_16x16x32_bf16 v[72:75], a[72:75], v[120:123], v[72:75]
 s_add_u32 m0, s69, 45056
 ds_read_b64_tr_b16 a[96:97], v5 offset:12288
 buffer_load_dwordx4 v20, s[8:11], s78 offen  lds
 v_cvt_pk_bf16_f32 v148, v88, v89
 v_mfma_f32_16x16x32_bf16 v[76:79], a[72:75], v[124:127], v[76:79]
 s_waitcnt lgkmcnt(9)
 ds_read_b64_tr_b16 a[98:99], v5 offset:12800
 v_cvt_pk_bf16_f32 v149, v90, v91
 s_mov_b32 vcc_lo, 0xf0000f
 v_mfma_f32_16x16x32_bf16 v[48:51], a[76:79], v[128:131], v[48:51]
 ds_read_b64_tr_b16 a[72:73], v6 offset:12288
 v_cvt_pk_bf16_f32 v150, v92, v93
 s_mov_b32 vcc_hi, 0xf0000f00
 v_mfma_f32_16x16x32_bf16 v[52:55], a[76:79], v[132:135], v[52:55]
 s_waitcnt lgkmcnt(9)
 ds_read_b64_tr_b16 a[74:75], v6 offset:12800
 v_cvt_pk_bf16_f32 v151, v94, v95
 v_cndmask_b32 v28, 0, v34, vcc
 v_mfma_f32_16x16x32_bf16 v[56:59], a[80:83], v[128:131], v[56:59]
 s_add_u32 s78, s72, 1327104
 ds_read_b64_tr_b16 a[76:77], v7 offset:12288
 v_accvgpr_read_b32 v34, a240
 v_mfma_f32_16x16x32_bf16 v[96:99], a[148:151], v[156:159], v[104:107]
 v_mfma_f32_16x16x32_bf16 v[60:63], a[80:83], v[132:135], v[60:63]
 s_waitcnt lgkmcnt(9)
 ds_read_b64_tr_b16 a[78:79], v7 offset:12800
 v_accvgpr_read_b32 v35, a241
 v_mfma_f32_16x16x32_bf16 v[64:67], a[84:87], v[128:131], v[64:67]
 s_add_u32 m0, s69, 49152
 ds_read_b64_tr_b16 a[80:81], v4 offset:16384
 buffer_load_dwordx4 v20, s[8:11], s78 offen  lds
 v_mfma_f32_16x16x32_bf16 v[100:103], a[152:155], v[156:159], v[104:107]
 v_accvgpr_read_b32 v36, a242
 v_mfma_f32_16x16x32_bf16 v[68:71], a[84:87], v[132:135], v[68:71]
 s_waitcnt lgkmcnt(9)
 ds_read_b64_tr_b16 a[82:83], v4 offset:16896
 v_accvgpr_read_b32 v37, a243
 v_mfma_f32_16x16x32_bf16 v[72:75], a[88:91], v[128:131], v[72:75]
 ds_read_b64_tr_b16 a[84:85], v5 offset:16384
 v_cvt_pk_bf16_f32 v156, v96, v97
 s_mov_b32 vcc_lo, 0x22222222
 v_mfma_f32_16x16x32_bf16 v[76:79], a[88:91], v[132:135], v[76:79]
 s_waitcnt lgkmcnt(9)
 ds_read_b64_tr_b16 a[86:87], v5 offset:16896
 v_cvt_pk_bf16_f32 v157, v98, v99
 s_mov_b32 vcc_hi, 0x22222222
 v_mfma_f32_16x16x32_bf16 v[48:51], a[92:95], v[136:139], v[48:51]
 s_add_u32 s78, s72, 1437696
 ds_read_b64_tr_b16 a[88:89], v6 offset:16384
 v_cvt_pk_bf16_f32 v158, v100, v101
 v_cndmask_b32 v34, v34, v35, vcc
 v_mfma_f32_16x16x32_bf16 v[52:55], a[92:95], v[140:143], v[52:55]
 s_waitcnt lgkmcnt(9)
 ds_read_b64_tr_b16 a[90:91], v6 offset:16896
 v_cvt_pk_bf16_f32 v159, v102, v103
 s_mov_b32 vcc_lo, 0x44444444
 v_mfma_f32_16x16x32_bf16 v[56:59], a[96:99], v[136:139], v[56:59]
 s_add_u32 m0, s69, 53248
 ds_read_b64_tr_b16 a[92:93], v7 offset:16384
 buffer_load_dwordx4 v20, s[8:11], s78 offen  lds
 v_mfma_f32_16x16x32_bf16 v[80:83], a[148:151], v[164:167], v[104:107]
 s_mov_b32 vcc_hi, 0x44444444
 v_mfma_f32_16x16x32_bf16 v[60:63], a[96:99], v[140:143], v[60:63]
 s_waitcnt lgkmcnt(9)
 ds_read_b64_tr_b16 a[94:95], v7 offset:16896
 v_cndmask_b32 v34, v34, v36, vcc
 v_mfma_f32_16x16x32_bf16 v[64:67], a[72:75], v[136:139], v[64:67]
 ds_read_b64_tr_b16 a[96:97], v4 offset:20480
 s_mov_b32 vcc_lo, 0x88888888
 v_mfma_f32_16x16x32_bf16 v[84:87], a[152:155], v[164:167], v[104:107]
 v_mfma_f32_16x16x32_bf16 v[68:71], a[72:75], v[140:143], v[68:71]
 s_waitcnt lgkmcnt(9)
 ds_read_b64_tr_b16 a[98:99], v4 offset:20992
 s_mov_b32 vcc_hi, 0x88888888
 v_mfma_f32_16x16x32_bf16 v[72:75], a[76:79], v[136:139], v[72:75]
 s_add_u32 s78, s72, 1548288
 ds_read_b64_tr_b16 a[72:73], v5 offset:20480
 v_cvt_pk_bf16_f32 v164, v80, v81
 v_cndmask_b32 v34, v34, v37, vcc
 v_mfma_f32_16x16x32_bf16 v[76:79], a[76:79], v[140:143], v[76:79]
 s_waitcnt lgkmcnt(9)
 ds_read_b64_tr_b16 a[74:75], v5 offset:20992
 v_cvt_pk_bf16_f32 v165, v82, v83
 s_mov_b32 vcc_lo, 0xf0000f
 v_mfma_f32_16x16x32_bf16 v[48:51], a[80:83], v[144:147], v[48:51]
 s_add_u32 m0, s69, 57344
 ds_read_b64_tr_b16 a[76:77], v6 offset:20480
 buffer_load_dwordx4 v20, s[8:11], s78 offen  lds
 v_cvt_pk_bf16_f32 v166, v84, v85
 v_mfma_f32_16x16x32_bf16 v[52:55], a[80:83], v[148:151], v[52:55]
 s_waitcnt lgkmcnt(9)
 ds_read_b64_tr_b16 a[78:79], v6 offset:20992
 v_cvt_pk_bf16_f32 v167, v86, v87
 s_mov_b32 vcc_hi, 0xf0000f00
 v_mfma_f32_16x16x32_bf16 v[56:59], a[84:87], v[144:147], v[56:59]
 ds_read_b64_tr_b16 a[80:81], v7 offset:20480
 v_cndmask_b32 v29, 0, v34, vcc
 v_mfma_f32_16x16x32_bf16 v[88:91], a[148:151], v[172:175], v[104:107]
 v_mfma_f32_16x16x32_bf16 v[60:63], a[84:87], v[148:151], v[60:63]
 s_waitcnt lgkmcnt(9)
 ds_read_b64_tr_b16 a[82:83], v7 offset:20992
 v_mov_b32 v30, v28
 v_mfma_f32_16x16x32_bf16 v[64:67], a[88:91], v[144:147], v[64:67]
 s_waitcnt vmcnt(7)
 s_barrier
 ds_read_b64_tr_b16 a[84:85], v4 offset:24576
 s_add_u32 s78, s72, 1658880
 v_mfma_f32_16x16x32_bf16 v[92:95], a[152:155], v[172:175], v[104:107]
 v_mov_b32 v31, v29
 v_mfma_f32_16x16x32_bf16 v[68:71], a[88:91], v[148:151], v[68:71]
 s_waitcnt lgkmcnt(9)
 ds_read_b64_tr_b16 a[86:87], v4 offset:25088
 v_permlane16_swap_b32 v28, v30
 v_mfma_f32_16x16x32_bf16 v[72:75], a[92:95], v[144:147], v[72:75]
 s_add_u32 m0, s69, 61440
 ds_read_b64_tr_b16 a[88:89], v5 offset:24576
 buffer_load_dwordx4 v20, s[8:11], s78 offen  lds
 v_cvt_pk_bf16_f32 v172, v88, v89
 v_mfma_f32_16x16x32_bf16 v[76:79], a[92:95], v[148:151], v[76:79]
 s_waitcnt lgkmcnt(9)
 ds_read_b64_tr_b16 a[90:91], v5 offset:25088
 v_cvt_pk_bf16_f32 v173, v90, v91
 v_permlane16_swap_b32 v29, v31
 v_mfma_f32_16x16x32_bf16 v[48:51], a[96:99], v[152:155], v[48:51]
 ds_read_b64_tr_b16 a[92:93], v6 offset:24576
 v_cvt_pk_bf16_f32 v174, v92, v93
 v_add_f32 v28, v28, v30
 v_mfma_f32_16x16x32_bf16 v[52:55], a[96:99], v[156:159], v[52:55]
 s_waitcnt lgkmcnt(9)
 ds_read_b64_tr_b16 a[94:95], v6 offset:25088
 v_cvt_pk_bf16_f32 v175, v94, v95
 v_add_f32 v29, v29, v31
 v_mfma_f32_16x16x32_bf16 v[56:59], a[72:75], v[152:155], v[56:59]
 s_add_u32 s78, s72, 1769472
 ds_read_b64_tr_b16 a[96:97], v7 offset:24576
 v_mov_b32 v30, v28
 v_mfma_f32_16x16x32_bf16 v[96:99], a[148:151], v[180:183], v[104:107]
 v_mfma_f32_16x16x32_bf16 v[60:63], a[72:75], v[156:159], v[60:63]
 s_waitcnt lgkmcnt(9)
 ds_read_b64_tr_b16 a[98:99], v7 offset:25088
 v_mov_b32 v31, v29
 v_mfma_f32_16x16x32_bf16 v[64:67], a[76:79], v[152:155], v[64:67]
 s_add_u32 m0, s69, 65536
 ds_read_b64_tr_b16 a[72:73], v4 offset:28672
 buffer_load_dwordx4 v20, s[8:11], s78 offen  lds
 v_mfma_f32_16x16x32_bf16 v[100:103], a[152:155], v[180:183], v[104:107]
 v_permlane32_swap_b32 v28, v30
 v_mfma_f32_16x16x32_bf16 v[68:71], a[76:79], v[156:159], v[68:71]
 s_waitcnt lgkmcnt(9)
 ds_read_b64_tr_b16 a[74:75], v4 offset:29184
 v_permlane32_swap_b32 v29, v31
 v_mfma_f32_16x16x32_bf16 v[72:75], a[80:83], v[152:155], v[72:75]
 ds_read_b64_tr_b16 a[76:77], v5 offset:28672
 v_cvt_pk_bf16_f32 v180, v96, v97
 v_add_f32 v28, v28, v30
 v_mfma_f32_16x16x32_bf16 v[76:79], a[80:83], v[156:159], v[76:79]
 s_waitcnt lgkmcnt(9)
 ds_read_b64_tr_b16 a[78:79], v5 offset:29184
 v_cvt_pk_bf16_f32 v181, v98, v99
 v_add_f32 v29, v29, v31
 v_mfma_f32_16x16x32_bf16 v[48:51], a[84:87], v[160:163], v[48:51]
 s_add_u32 s78, s72, 1880064
 ds_read_b64_tr_b16 a[80:81], v6 offset:28672
 v_cvt_pk_bf16_f32 v182, v100, v101
 v_mul_f32 v28, 0x3ae38e39, v28
 v_mfma_f32_16x16x32_bf16 v[52:55], a[84:87], v[164:167], v[52:55]
 s_waitcnt lgkmcnt(9)
 ds_read_b64_tr_b16 a[82:83], v6 offset:29184
 v_cvt_pk_bf16_f32 v183, v102, v103
 v_fma_f32 v28, -v32, v32, v28
 v_mfma_f32_16x16x32_bf16 v[56:59], a[88:91], v[160:163], v[56:59]
 s_add_u32 m0, s69, 69632
 ds_read_b64_tr_b16 a[84:85], v7 offset:28672
 buffer_load_dwordx4 v20, s[8:11], s78 offen  lds
 v_mfma_f32_16x16x32_bf16 v[80:83], a[148:151], v[188:191], v[104:107]
 v_max_f32 v28, 0, v28
 v_mfma_f32_16x16x32_bf16 v[60:63], a[88:91], v[164:167], v[60:63]
 s_waitcnt lgkmcnt(9)
 ds_read_b64_tr_b16 a[86:87], v7 offset:29184
 v_cvt_pk_bf16_f32 v30, v28, v28
 v_mfma_f32_16x16x32_bf16 v[64:67], a[92:95], v[160:163], v[64:67]
 ds_read_b64_tr_b16 a[88:89], v4 offset:32768
 v_and_b32 v28, 0xffff0000, v30
 v_mfma_f32_16x16x32_bf16 v[84:87], a[152:155], v[188:191], v[104:107]
 v_mfma_f32_16x16x32_bf16 v[68:71], a[92:95], v[164:167], v[68:71]
 s_waitcnt lgkmcnt(9)
 ds_read_b64_tr_b16 a[90:91], v4 offset:33280
 v_add_f32 v28, 0x3727c5ac, v28
 v_mfma_f32_16x16x32_bf16 v[72:75], a[96:99], v[160:163], v[72:75]
 s_add_u32 s78, s73, 0
 ds_read_b64_tr_b16 a[92:93], v5 offset:32768
 v_cvt_pk_bf16_f32 v188, v80, v81
 v_cvt_pk_bf16_f32 v30, v28, v28
 v_mfma_f32_16x16x32_bf16 v[76:79], a[96:99], v[164:167], v[76:79]
 s_waitcnt lgkmcnt(9)
 ds_read_b64_tr_b16 a[94:95], v5 offset:33280
 v_cvt_pk_bf16_f32 v189, v82, v83
 v_lshlrev_b32 v28, 16, v30
 v_mfma_f32_16x16x32_bf16 v[48:51], a[72:75], v[168:171], v[48:51]
 s_add_u32 m0, s69, 73728
 ds_read_b64_tr_b16 a[96:97], v6 offset:32768
 buffer_load_dwordx4 v20, s[8:11], s78 offen  lds
 v_cvt_pk_bf16_f32 v190, v84, v85
 v_mfma_f32_16x16x32_bf16 v[52:55], a[72:75], v[172:175], v[52:55]
 s_waitcnt lgkmcnt(9)
 ds_read_b64_tr_b16 a[98:99], v6 offset:33280
 v_cvt_pk_bf16_f32 v191, v86, v87
 v_sqrt_f32 v28, v28
 v_mfma_f32_16x16x32_bf16 v[56:59], a[76:79], v[168:171], v[56:59]
 ds_read_b64_tr_b16 a[72:73], v7 offset:32768
 v_cvt_pk_bf16_f32 v30, v28, v28
 v_mfma_f32_16x16x32_bf16 v[88:91], a[148:151], v[196:199], v[104:107]
 v_mfma_f32_16x16x32_bf16 v[60:63], a[76:79], v[172:175], v[60:63]
 s_waitcnt lgkmcnt(9)
 ds_read_b64_tr_b16 a[74:75], v7 offset:33280
 v_lshlrev_b32 v28, 16, v30
 v_mfma_f32_16x16x32_bf16 v[64:67], a[80:83], v[168:171], v[64:67]
 s_waitcnt vmcnt(7)
 s_barrier
 ds_read_b64_tr_b16 a[76:77], v4 offset:36864
 s_add_u32 s78, s73, 110592
 v_mfma_f32_16x16x32_bf16 v[92:95], a[152:155], v[196:199], v[104:107]
 v_rcp_f32 v28, v28
 v_mfma_f32_16x16x32_bf16 v[68:71], a[80:83], v[172:175], v[68:71]
 s_waitcnt lgkmcnt(9)
 ds_read_b64_tr_b16 a[78:79], v4 offset:37376
 v_mul_f32 v30, v28, v28
 v_mfma_f32_16x16x32_bf16 v[72:75], a[84:87], v[168:171], v[72:75]
 s_add_u32 m0, s69, 77824
 ds_read_b64_tr_b16 a[80:81], v5 offset:36864
 buffer_load_dwordx4 v20, s[8:11], s78 offen  lds
 v_cvt_pk_bf16_f32 v196, v88, v89
 v_mfma_f32_16x16x32_bf16 v[76:79], a[84:87], v[172:175], v[76:79]
 s_waitcnt lgkmcnt(9)
 ds_read_b64_tr_b16 a[82:83], v5 offset:37376
 v_cvt_pk_bf16_f32 v197, v90, v91
 v_mul_f32 v32, s82, v28
 v_mfma_f32_16x16x32_bf16 v[48:51], a[88:91], v[176:179], v[48:51]
 ds_read_b64_tr_b16 a[84:85], v6 offset:36864
 v_cvt_pk_bf16_f32 v198, v92, v93
 v_mul_f32 v29, 0x3ae38e39, v29
 v_mfma_f32_16x16x32_bf16 v[52:55], a[88:91], v[180:183], v[52:55]
 s_waitcnt lgkmcnt(9)
 ds_read_b64_tr_b16 a[86:87], v6 offset:37376
 v_cvt_pk_bf16_f32 v199, v94, v95
 v_fma_f32 v29, -v33, v33, v29
 v_mfma_f32_16x16x32_bf16 v[56:59], a[92:95], v[176:179], v[56:59]
 s_add_u32 s78, s73, 221184
 ds_read_b64_tr_b16 a[88:89], v7 offset:36864
 v_max_f32 v29, 0, v29
 v_mfma_f32_16x16x32_bf16 v[96:99], a[148:151], v[204:207], v[104:107]
 v_mfma_f32_16x16x32_bf16 v[60:63], a[92:95], v[180:183], v[60:63]
 s_waitcnt lgkmcnt(9)
 ds_read_b64_tr_b16 a[90:91], v7 offset:37376
 v_cvt_pk_bf16_f32 v31, v29, v29
 v_mfma_f32_16x16x32_bf16 v[64:67], a[96:99], v[176:179], v[64:67]
 s_add_u32 m0, s69, 81920
 ds_read_b64_tr_b16 a[92:93], v4 offset:40960
 buffer_load_dwordx4 v20, s[8:11], s78 offen  lds
 v_mfma_f32_16x16x32_bf16 v[100:103], a[152:155], v[204:207], v[104:107]
 v_and_b32 v29, 0xffff0000, v31
 v_mfma_f32_16x16x32_bf16 v[68:71], a[96:99], v[180:183], v[68:71]
 s_waitcnt lgkmcnt(9)
 ds_read_b64_tr_b16 a[94:95], v4 offset:41472
 v_add_f32 v29, 0x3727c5ac, v29
 v_mfma_f32_16x16x32_bf16 v[72:75], a[72:75], v[176:179], v[72:75]
 ds_read_b64_tr_b16 a[96:97], v5 offset:40960
 v_cvt_pk_bf16_f32 v204, v96, v97
 v_cvt_pk_bf16_f32 v31, v29, v29
 v_mfma_f32_16x16x32_bf16 v[76:79], a[72:75], v[180:183], v[76:79]
 s_waitcnt lgkmcnt(9)
 ds_read_b64_tr_b16 a[98:99], v5 offset:41472
 v_cvt_pk_bf16_f32 v205, v98, v99
 v_lshlrev_b32 v29, 16, v31
 v_mfma_f32_16x16x32_bf16 v[48:51], a[76:79], v[184:187], v[48:51]
 s_add_u32 s78, s73, 331776
 ds_read_b64_tr_b16 a[72:73], v6 offset:40960
 buffer_load_dword a157, v3, s[20:23], s74 offen offset:0
 v_cvt_pk_bf16_f32 v206, v100, v101
 v_mfma_f32_16x16x32_bf16 v[52:55], a[76:79], v[188:191], v[52:55]
 s_waitcnt lgkmcnt(9)
 ds_read_b64_tr_b16 a[74:75], v6 offset:41472
 v_cvt_pk_bf16_f32 v207, v102, v103
 v_sqrt_f32 v29, v29
 v_mfma_f32_16x16x32_bf16 v[56:59], a[80:83], v[184:187], v[56:59]
 ds_read_b64_tr_b16 a[76:77], v7 offset:40960
 buffer_load_dword a158, v3, s[16:19], s74 offen offset:128
 v_mfma_f32_16x16x32_bf16 v[80:83], a[148:151], v[212:215], v[104:107]
 v_cvt_pk_bf16_f32 v31, v29, v29
 v_mfma_f32_16x16x32_bf16 v[60:63], a[80:83], v[188:191], v[60:63]
 s_waitcnt lgkmcnt(9)
 ds_read_b64_tr_b16 a[78:79], v7 offset:41472
 v_lshlrev_b32 v29, 16, v31
 v_mfma_f32_16x16x32_bf16 v[64:67], a[84:87], v[184:187], v[64:67]
 ds_read_b64_tr_b16 a[80:81], v4 offset:45056
 buffer_load_dword a159, v3, s[20:23], s74 offen offset:128
 v_mfma_f32_16x16x32_bf16 v[84:87], a[152:155], v[212:215], v[104:107]
 v_rcp_f32 v29, v29
 v_mfma_f32_16x16x32_bf16 v[68:71], a[84:87], v[188:191], v[68:71]
 s_waitcnt lgkmcnt(9)
 ds_read_b64_tr_b16 a[82:83], v4 offset:45568
 v_mul_f32 v31, v29, v29
 v_mfma_f32_16x16x32_bf16 v[72:75], a[88:91], v[184:187], v[72:75]
 s_add_u32 m0, s69, 86016
 ds_read_b64_tr_b16 a[84:85], v5 offset:45056
 buffer_load_dwordx4 v20, s[8:11], s78 offen  lds
 v_cvt_pk_bf16_f32 v212, v80, v81
 v_mfma_f32_16x16x32_bf16 v[76:79], a[88:91], v[188:191], v[76:79]
 s_waitcnt lgkmcnt(9)
 ds_read_b64_tr_b16 a[86:87], v5 offset:45568
 v_cvt_pk_bf16_f32 v213, v82, v83
 v_mul_f32 v33, s82, v29
 v_mfma_f32_16x16x32_bf16 v[48:51], a[92:95], v[192:195], v[48:51]
 s_add_u32 s78, s73, 442368
 ds_read_b64_tr_b16 a[88:89], v6 offset:45056
 v_cvt_pk_bf16_f32 v214, v84, v85
 s_mul_i32 s48, s70, 304128
 v_mfma_f32_16x16x32_bf16 v[52:55], a[92:95], v[196:199], v[52:55]
 s_waitcnt lgkmcnt(9)
 ds_read_b64_tr_b16 a[90:91], v6 offset:45568
 v_cvt_pk_bf16_f32 v215, v86, v87
 s_add_u32 s83, s48, 2424832
 v_mfma_f32_16x16x32_bf16 v[56:59], a[96:99], v[192:195], v[56:59]
 s_add_u32 m0, s69, 90112
 ds_read_b64_tr_b16 a[92:93], v7 offset:45056
 buffer_load_dwordx4 v20, s[8:11], s78 offen  lds
 v_mfma_f32_16x16x32_bf16 v[88:91], a[148:151], v[220:223], v[104:107]
 s_mul_i32 s49, s70, 147456
 v_mfma_f32_16x16x32_bf16 v[60:63], a[96:99], v[196:199], v[60:63]
 s_waitcnt lgkmcnt(9)
 ds_read_b64_tr_b16 a[94:95], v7 offset:45568
 s_add_u32 s90, s49, 65536
 v_mfma_f32_16x16x32_bf16 v[64:67], a[72:75], v[192:195], v[64:67]
 s_waitcnt vmcnt(8)
 s_barrier
 ds_read_b64_tr_b16 a[96:97], v4 offset:49152
 s_sub_u32 s50, s71, 9
 v_mfma_f32_16x16x32_bf16 v[92:95], a[152:155], v[220:223], v[104:107]
 v_mfma_f32_16x16x32_bf16 v[68:71], a[72:75], v[196:199], v[68:71]
 s_waitcnt lgkmcnt(9)
 ds_read_b64_tr_b16 a[98:99], v4 offset:49664
 s_add_u32 s78, s73, 552960
 s_cmp_lt_u32 s71, 9
 s_cselect_b32 s84, s90, s83
 s_cselect_b32 s49, s71, s50
 v_mfma_f32_16x16x32_bf16 v[72:75], a[76:79], v[192:195], v[72:75]
 s_add_u32 m0, s69, 94208
 ds_read_b64_tr_b16 a[72:73], v5 offset:49152
 buffer_load_dwordx4 v20, s[8:11], s78 offen  lds
 v_cvt_pk_bf16_f32 v220, v88, v89
 v_mfma_f32_16x16x32_bf16 v[76:79], a[76:79], v[196:199], v[76:79]
 s_waitcnt lgkmcnt(9)
 ds_read_b64_tr_b16 a[74:75], v5 offset:49664
 v_cvt_pk_bf16_f32 v221, v90, v91
 s_lshl_b32 s49, s49, 12
 v_mfma_f32_16x16x32_bf16 v[48:51], a[80:83], v[200:203], v[48:51]
 ds_read_b64_tr_b16 a[76:77], v6 offset:49152
 v_cvt_pk_bf16_f32 v222, v92, v93
 s_mul_i32 s48, s68, 36864
 v_mfma_f32_16x16x32_bf16 v[52:55], a[80:83], v[204:207], v[52:55]
 s_waitcnt lgkmcnt(9)
 ds_read_b64_tr_b16 a[78:79], v6 offset:49664
 v_cvt_pk_bf16_f32 v223, v94, v95
 s_add_u32 s49, s49, s48
 v_mfma_f32_16x16x32_bf16 v[56:59], a[84:87], v[200:203], v[56:59]
 ds_read_b64_tr_b16 a[80:81], v7 offset:49152
 v_lshlrev_b32 v42, 8, v2
 v_mfma_f32_16x16x32_bf16 v[96:99], a[148:151], v[228:231], v[104:107]
 v_mfma_f32_16x16x32_bf16 v[60:63], a[84:87], v[204:207], v[60:63]
 s_waitcnt lgkmcnt(9)
 ds_read_b64_tr_b16 a[82:83], v7 offset:49664
 s_add_u32 s78, s73, 663552
 v_lshl_add_u32 v42, v1, 4, v42
 v_mfma_f32_16x16x32_bf16 v[64:67], a[88:91], v[200:203], v[64:67]
 s_add_u32 m0, s69, 98304
 ds_read_b64_tr_b16 a[84:85], v4 offset:53248
 buffer_load_dwordx4 v20, s[8:11], s78 offen  lds
 v_mfma_f32_16x16x32_bf16 v[100:103], a[152:155], v[228:231], v[104:107]
 v_add_u32 v27, s49, v42
 v_mfma_f32_16x16x32_bf16 v[68:71], a[88:91], v[204:207], v[68:71]
 s_waitcnt lgkmcnt(9)
 ds_read_b64_tr_b16 a[86:87], v4 offset:53760
 s_sub_u32 s49, s71, 2
 v_mfma_f32_16x16x32_bf16 v[72:75], a[92:95], v[200:203], v[72:75]
 ds_read_b64_tr_b16 a[88:89], v5 offset:53248
 v_cvt_pk_bf16_f32 v228, v96, v97
 s_lshl_b32 s49, s49, 12
 v_mfma_f32_16x16x32_bf16 v[76:79], a[92:95], v[204:207], v[76:79]
 s_waitcnt lgkmcnt(9)
 ds_read_b64_tr_b16 a[90:91], v5 offset:53760
 v_cvt_pk_bf16_f32 v229, v98, v99
 s_add_u32 s49, s49, s48
 v_mfma_f32_16x16x32_bf16 v[48:51], a[96:99], v[208:211], v[48:51]
 ds_read_b64_tr_b16 a[92:93], v6 offset:53248
 v_cvt_pk_bf16_f32 v230, v100, v101
 v_add_u32 v42, s49, v42
 v_mfma_f32_16x16x32_bf16 v[52:55], a[96:99], v[212:215], v[52:55]
 s_waitcnt lgkmcnt(9)
 ds_read_b64_tr_b16 a[94:95], v6 offset:53760
 v_cvt_pk_bf16_f32 v231, v102, v103
 s_lshl_b32 s49, s71, 10
 v_mfma_f32_16x16x32_bf16 v[56:59], a[72:75], v[208:211], v[56:59]
 s_add_u32 s78, s73, 774144
 ds_read_b64_tr_b16 a[96:97], v7 offset:53248
 s_add_u32 s49, s49, s48
 v_mfma_f32_16x16x32_bf16 v[80:83], a[148:151], v[236:239], v[104:107]
 v_mfma_f32_16x16x32_bf16 v[60:63], a[72:75], v[212:215], v[60:63]
 s_waitcnt lgkmcnt(9)
 ds_read_b64_tr_b16 a[98:99], v7 offset:53760
 s_add_u32 s49, s49, 147456
 v_mfma_f32_16x16x32_bf16 v[64:67], a[76:79], v[208:211], v[64:67]
 s_add_u32 m0, s69, 102400
 ds_read_b64_tr_b16 a[72:73], v4 offset:57344
 buffer_load_dwordx4 v20, s[8:11], s78 offen  lds
 v_mfma_f32_16x16x32_bf16 v[84:87], a[152:155], v[236:239], v[104:107]
 v_mul_u32_u24 v43, 9216, v2
 v_mfma_f32_16x16x32_bf16 v[68:71], a[76:79], v[212:215], v[68:71]
 s_waitcnt lgkmcnt(9)
 ds_read_b64_tr_b16 a[74:75], v4 offset:57856
 v_lshl_add_u32 v43, v1, 4, v43
 v_mfma_f32_16x16x32_bf16 v[72:75], a[80:83], v[208:211], v[72:75]
 ds_read_b64_tr_b16 a[76:77], v5 offset:57344
 v_cvt_pk_bf16_f32 v236, v80, v81
 v_add_u32 v43, s49, v43
 v_mfma_f32_16x16x32_bf16 v[76:79], a[80:83], v[212:215], v[76:79]
 s_waitcnt lgkmcnt(9)
 ds_read_b64_tr_b16 a[78:79], v5 offset:57856
 v_cvt_pk_bf16_f32 v237, v82, v83
 v_mov_b32 v44, s71
 v_mfma_f32_16x16x32_bf16 v[48:51], a[84:87], v[216:219], v[48:51]
 s_add_u32 s78, s73, 884736
 ds_read_b64_tr_b16 a[80:81], v6 offset:57344
 v_cvt_pk_bf16_f32 v238, v84, v85
 v_cmp_gt_u32 vcc, 9, v44
 v_mfma_f32_16x16x32_bf16 v[52:55], a[84:87], v[220:223], v[52:55]
 s_waitcnt lgkmcnt(9)
 ds_read_b64_tr_b16 a[82:83], v6 offset:57856
 v_cvt_pk_bf16_f32 v239, v86, v87
 v_cndmask_b32 v26, v42, v43, vcc
 v_mfma_f32_16x16x32_bf16 v[56:59], a[88:91], v[216:219], v[56:59]
 s_add_u32 m0, s69, 106496
 ds_read_b64_tr_b16 a[84:85], v7 offset:57344
 buffer_load_dwordx4 v20, s[8:11], s78 offen  lds
 v_mfma_f32_16x16x32_bf16 v[88:91], a[148:151], v[244:247], v[104:107]
 v_mfma_f32_16x16x32_bf16 v[60:63], a[88:91], v[220:223], v[60:63]
 s_waitcnt lgkmcnt(9)
 ds_read_b64_tr_b16 a[86:87], v7 offset:57856
 v_mfma_f32_16x16x32_bf16 v[64:67], a[92:95], v[216:219], v[64:67]
 ds_read_b64_tr_b16 a[88:89], v4 offset:61440
 v_mfma_f32_16x16x32_bf16 v[92:95], a[152:155], v[244:247], v[104:107]
 v_mfma_f32_16x16x32_bf16 v[68:71], a[92:95], v[220:223], v[68:71]
 s_waitcnt lgkmcnt(9)
 ds_read_b64_tr_b16 a[90:91], v4 offset:61952
 s_add_u32 s78, s73, 995328
 v_mfma_f32_16x16x32_bf16 v[72:75], a[96:99], v[216:219], v[72:75]
 s_add_u32 m0, s69, 110592
 ds_read_b64_tr_b16 a[92:93], v5 offset:61440
 buffer_load_dwordx4 v20, s[8:11], s78 offen  lds
 v_cvt_pk_bf16_f32 v244, v88, v89
 v_mfma_f32_16x16x32_bf16 v[76:79], a[96:99], v[220:223], v[76:79]
 s_waitcnt lgkmcnt(9)
 ds_read_b64_tr_b16 a[94:95], v5 offset:61952
 v_cvt_pk_bf16_f32 v245, v90, v91
 v_mfma_f32_16x16x32_bf16 v[48:51], a[72:75], v[224:227], v[48:51]
 ds_read_b64_tr_b16 a[96:97], v6 offset:61440
 v_cvt_pk_bf16_f32 v246, v92, v93
 v_mfma_f32_16x16x32_bf16 v[52:55], a[72:75], v[228:231], v[52:55]
 s_waitcnt lgkmcnt(9)
 ds_read_b64_tr_b16 a[98:99], v6 offset:61952
 v_cvt_pk_bf16_f32 v247, v94, v95
 v_mfma_f32_16x16x32_bf16 v[56:59], a[76:79], v[224:227], v[56:59]
 ds_read_b64_tr_b16 a[72:73], v7 offset:61440
 v_mfma_f32_16x16x32_bf16 v[96:99], a[148:151], v[252:255], v[104:107]
 v_mfma_f32_16x16x32_bf16 v[60:63], a[76:79], v[228:231], v[60:63]
 s_waitcnt lgkmcnt(9)
 ds_read_b64_tr_b16 a[74:75], v7 offset:61952
 s_add_u32 s78, s73, 1105920
 v_mfma_f32_16x16x32_bf16 v[64:67], a[80:83], v[224:227], v[64:67]
 s_add_u32 m0, s69, 114688
 ds_read_b64_tr_b16 a[76:77], v8 offset:0
 buffer_load_dwordx4 v20, s[8:11], s78 offen  lds
 v_mfma_f32_16x16x32_bf16 v[100:103], a[152:155], v[252:255], v[104:107]
 v_mfma_f32_16x16x32_bf16 v[68:71], a[80:83], v[228:231], v[68:71]
 s_waitcnt lgkmcnt(9)
 ds_read_b64_tr_b16 a[78:79], v8 offset:512
 v_mfma_f32_16x16x32_bf16 v[72:75], a[84:87], v[224:227], v[72:75]
 ds_read_b64_tr_b16 a[80:81], v9 offset:0
 v_cvt_pk_bf16_f32 v252, v96, v97
 v_mfma_f32_16x16x32_bf16 v[76:79], a[84:87], v[228:231], v[76:79]
 s_waitcnt lgkmcnt(9)
 ds_read_b64_tr_b16 a[82:83], v9 offset:512
 v_cvt_pk_bf16_f32 v253, v98, v99
 v_mfma_f32_16x16x32_bf16 v[48:51], a[88:91], v[232:235], v[48:51]
 ds_read_b64_tr_b16 a[84:85], v10 offset:0
 v_cvt_pk_bf16_f32 v254, v100, v101
 v_mfma_f32_16x16x32_bf16 v[52:55], a[88:91], v[236:239], v[52:55]
 s_waitcnt lgkmcnt(9)
 ds_read_b64_tr_b16 a[86:87], v10 offset:512
 v_cvt_pk_bf16_f32 v255, v102, v103
 v_mfma_f32_16x16x32_bf16 v[56:59], a[92:95], v[232:235], v[56:59]
 s_add_u32 s78, s73, 1216512
 ds_read_b64_tr_b16 a[88:89], v11 offset:0
 v_mfma_f32_16x16x32_bf16 v[60:63], a[92:95], v[236:239], v[60:63]
 s_waitcnt lgkmcnt(9)
 ds_read_b64_tr_b16 a[90:91], v11 offset:512
 v_mfma_f32_16x16x32_bf16 v[64:67], a[96:99], v[232:235], v[64:67]
 s_add_u32 m0, s69, 118784
 ds_read_b64_tr_b16 a[92:93], v8 offset:4096
 buffer_load_dwordx4 v20, s[8:11], s78 offen  lds
 v_mfma_f32_16x16x32_bf16 v[68:71], a[96:99], v[236:239], v[68:71]
 s_waitcnt lgkmcnt(9)
 ds_read_b64_tr_b16 a[94:95], v8 offset:4608
 v_mfma_f32_16x16x32_bf16 v[72:75], a[72:75], v[232:235], v[72:75]
 ds_read_b64_tr_b16 a[96:97], v9 offset:4096
 v_mfma_f32_16x16x32_bf16 v[76:79], a[72:75], v[236:239], v[76:79]
 s_waitcnt lgkmcnt(9)
 ds_read_b64_tr_b16 a[98:99], v9 offset:4608
 s_add_u32 s78, s73, 1327104
 v_mfma_f32_16x16x32_bf16 v[48:51], a[76:79], v[240:243], v[48:51]
 s_add_u32 m0, s69, 122880
 ds_read_b64_tr_b16 a[72:73], v10 offset:4096
 buffer_load_dwordx4 v20, s[8:11], s78 offen  lds
 v_mfma_f32_16x16x32_bf16 v[52:55], a[76:79], v[244:247], v[52:55]
 s_waitcnt lgkmcnt(9)
 ds_read_b64_tr_b16 a[74:75], v10 offset:4608
 v_mfma_f32_16x16x32_bf16 v[56:59], a[80:83], v[240:243], v[56:59]
 ds_read_b64_tr_b16 a[76:77], v11 offset:4096
 v_mfma_f32_16x16x32_bf16 v[60:63], a[80:83], v[244:247], v[60:63]
 s_waitcnt lgkmcnt(9)
 ds_read_b64_tr_b16 a[78:79], v11 offset:4608
 v_mfma_f32_16x16x32_bf16 v[64:67], a[84:87], v[240:243], v[64:67]
 s_waitcnt vmcnt(7)
 s_barrier
 ds_read_b64_tr_b16 a[80:81], v8 offset:8192
 v_mfma_f32_16x16x32_bf16 v[68:71], a[84:87], v[244:247], v[68:71]
 s_waitcnt lgkmcnt(9)
 ds_read_b64_tr_b16 a[82:83], v8 offset:8704
 s_add_u32 s78, s73, 1437696
 v_mfma_f32_16x16x32_bf16 v[72:75], a[88:91], v[240:243], v[72:75]
 s_add_u32 m0, s69, 126976
 ds_read_b64_tr_b16 a[84:85], v9 offset:8192
 buffer_load_dwordx4 v20, s[8:11], s78 offen  lds
 v_mfma_f32_16x16x32_bf16 v[76:79], a[88:91], v[244:247], v[76:79]
 s_waitcnt lgkmcnt(9)
 ds_read_b64_tr_b16 a[86:87], v9 offset:8704
 v_mfma_f32_16x16x32_bf16 v[48:51], a[92:95], v[248:251], v[48:51]
 ds_read_b64_tr_b16 a[88:89], v10 offset:8192
 v_mfma_f32_16x16x32_bf16 v[52:55], a[92:95], v[252:255], v[52:55]
 s_waitcnt lgkmcnt(9)
 ds_read_b64_tr_b16 a[90:91], v10 offset:8704
 v_mfma_f32_16x16x32_bf16 v[56:59], a[96:99], v[248:251], v[56:59]
 ds_read_b64_tr_b16 a[92:93], v11 offset:8192
 v_mfma_f32_16x16x32_bf16 v[60:63], a[96:99], v[252:255], v[60:63]
 s_waitcnt lgkmcnt(9)
 ds_read_b64_tr_b16 a[94:95], v11 offset:8704
 s_add_u32 s78, s73, 1548288
 v_mfma_f32_16x16x32_bf16 v[64:67], a[72:75], v[248:251], v[64:67]
 s_add_u32 m0, s69, 131072
 ds_read_b64_tr_b16 a[96:97], v8 offset:12288
 buffer_load_dwordx4 v20, s[8:11], s78 offen  lds
 v_mfma_f32_16x16x32_bf16 v[68:71], a[72:75], v[252:255], v[68:71]
 s_waitcnt lgkmcnt(9)
 ds_read_b64_tr_b16 a[98:99], v8 offset:12800
 v_mul_f32 v48, v28, v48
 v_mfma_f32_16x16x32_bf16 v[72:75], a[76:79], v[248:251], v[72:75]
 ds_read_b64_tr_b16 a[72:73], v9 offset:12288
 v_mul_f32 v49, v28, v49
 v_mfma_f32_16x16x32_bf16 v[76:79], a[76:79], v[252:255], v[76:79]
 s_waitcnt lgkmcnt(9)
 ds_read_b64_tr_b16 a[74:75], v9 offset:12800
 v_mul_f32 v50, v28, v50
 v_mfma_f32_16x16x32_bf16 v[80:83], a[80:83], v[112:115], 0
 ds_read_b64_tr_b16 a[76:77], v10 offset:12288
 v_mul_f32 v51, v28, v51
 v_mfma_f32_16x16x32_bf16 v[84:87], a[80:83], v[116:119], 0
 s_waitcnt lgkmcnt(9)
 ds_read_b64_tr_b16 a[78:79], v10 offset:12800
 s_add_u32 s78, s73, 1658880
 v_mfma_f32_16x16x32_bf16 v[88:91], a[84:87], v[112:115], 0
 s_add_u32 m0, s69, 135168
 ds_read_b64_tr_b16 a[80:81], v11 offset:12288
 buffer_load_dwordx4 v20, s[8:11], s78 offen  lds
 v_mfma_f32_16x16x32_bf16 v[92:95], a[84:87], v[116:119], 0
 s_waitcnt lgkmcnt(9)
 ds_read_b64_tr_b16 a[82:83], v11 offset:12800
 v_cvt_pk_bf16_f32 v44, v48, v49
 v_mfma_f32_16x16x32_bf16 v[96:99], a[88:91], v[112:115], 0
 ds_read_b64_tr_b16 a[84:85], v8 offset:16384
 v_cvt_pk_bf16_f32 v45, v50, v51
 v_mfma_f32_16x16x32_bf16 v[100:103], a[88:91], v[116:119], 0
 s_waitcnt lgkmcnt(9)
 ds_read_b64_tr_b16 a[86:87], v8 offset:16896
 v_mul_f32 v52, v29, v52
 v_mfma_f32_16x16x32_bf16 v[104:107], a[92:95], v[112:115], 0
 ds_read_b64_tr_b16 a[88:89], v9 offset:16384
 v_mul_f32 v53, v29, v53
 v_mfma_f32_16x16x32_bf16 v[108:111], a[92:95], v[116:119], 0
 s_waitcnt lgkmcnt(9)
 ds_read_b64_tr_b16 a[90:91], v9 offset:16896
 s_add_u32 s78, s73, 1769472
 v_mfma_f32_16x16x32_bf16 v[80:83], a[96:99], v[120:123], v[80:83]
 s_add_u32 m0, s69, 139264
 ds_read_b64_tr_b16 a[92:93], v10 offset:16384
 buffer_load_dwordx4 v20, s[8:11], s78 offen  lds
 v_mfma_f32_16x16x32_bf16 v[84:87], a[96:99], v[124:127], v[84:87]
 s_waitcnt lgkmcnt(9)
 ds_read_b64_tr_b16 a[94:95], v10 offset:16896
 v_mul_f32 v54, v29, v54
 v_mfma_f32_16x16x32_bf16 v[88:91], a[72:75], v[120:123], v[88:91]
 ds_read_b64_tr_b16 a[96:97], v11 offset:16384
 v_mul_f32 v55, v29, v55
 v_mfma_f32_16x16x32_bf16 v[92:95], a[72:75], v[124:127], v[92:95]
 s_waitcnt lgkmcnt(9)
 ds_read_b64_tr_b16 a[98:99], v11 offset:16896
 v_cvt_pk_bf16_f32 v46, v52, v53
 v_mfma_f32_16x16x32_bf16 v[96:99], a[76:79], v[120:123], v[96:99]
 ds_read_b64_tr_b16 a[72:73], v8 offset:20480
 v_cvt_pk_bf16_f32 v47, v54, v55
 v_mfma_f32_16x16x32_bf16 v[100:103], a[76:79], v[124:127], v[100:103]
 s_waitcnt lgkmcnt(9)
 ds_read_b64_tr_b16 a[74:75], v8 offset:20992
 s_add_u32 s78, s73, 1880064
 v_mfma_f32_16x16x32_bf16 v[104:107], a[80:83], v[120:123], v[104:107]
 s_add_u32 m0, s69, 143360
 ds_read_b64_tr_b16 a[76:77], v9 offset:20480
 buffer_load_dwordx4 v20, s[8:11], s78 offen  lds
 v_mfma_f32_16x16x32_bf16 v[108:111], a[80:83], v[124:127], v[108:111]
 s_waitcnt lgkmcnt(9)
 ds_read_b64_tr_b16 a[78:79], v9 offset:20992
 buffer_store_dwordx4 v[44:47], v26, s[36:39], s83 offen offset:0 sc1
 v_mfma_f32_16x16x32_bf16 v[80:83], a[84:87], v[128:131], v[80:83]
 ds_read_b64_tr_b16 a[80:81], v10 offset:20480
 v_mul_f32 v56, v28, v56
 v_mfma_f32_16x16x32_bf16 v[84:87], a[84:87], v[132:135], v[84:87]
 s_waitcnt lgkmcnt(9)
 ds_read_b64_tr_b16 a[82:83], v10 offset:20992
 v_mul_f32 v57, v28, v57
 v_mfma_f32_16x16x32_bf16 v[88:91], a[88:91], v[128:131], v[88:91]
 ds_read_b64_tr_b16 a[84:85], v11 offset:20480
 v_mul_f32 v58, v28, v58
 v_mfma_f32_16x16x32_bf16 v[92:95], a[88:91], v[132:135], v[92:95]
 s_waitcnt lgkmcnt(9)
 ds_read_b64_tr_b16 a[86:87], v11 offset:20992
 s_add_u32 s78, s74, 0
 v_mfma_f32_16x16x32_bf16 v[96:99], a[92:95], v[128:131], v[96:99]
 s_add_u32 m0, s69, 0
 ds_read_b64_tr_b16 a[88:89], v8 offset:24576
 buffer_load_dwordx4 v21, s[16:19], s78 offen  lds
 v_mfma_f32_16x16x32_bf16 v[100:103], a[92:95], v[132:135], v[100:103]
 s_waitcnt lgkmcnt(9)
 ds_read_b64_tr_b16 a[90:91], v8 offset:25088
 v_mul_f32 v59, v28, v59
 v_mfma_f32_16x16x32_bf16 v[104:107], a[96:99], v[128:131], v[104:107]
 ds_read_b64_tr_b16 a[92:93], v9 offset:24576
 v_cvt_pk_bf16_f32 v40, v56, v57
 v_mfma_f32_16x16x32_bf16 v[108:111], a[96:99], v[132:135], v[108:111]
 s_waitcnt lgkmcnt(9)
 ds_read_b64_tr_b16 a[94:95], v9 offset:25088
 v_cvt_pk_bf16_f32 v41, v58, v59
 v_mfma_f32_16x16x32_bf16 v[80:83], a[72:75], v[136:139], v[80:83]
 ds_read_b64_tr_b16 a[96:97], v10 offset:24576
 v_mul_f32 v60, v29, v60
 v_mfma_f32_16x16x32_bf16 v[84:87], a[72:75], v[140:143], v[84:87]
 s_waitcnt lgkmcnt(9)
 ds_read_b64_tr_b16 a[98:99], v10 offset:25088
 s_add_u32 s78, s74, 294912
 v_mfma_f32_16x16x32_bf16 v[88:91], a[76:79], v[136:139], v[88:91]
 s_add_u32 m0, s69, 4096
 ds_read_b64_tr_b16 a[72:73], v11 offset:24576
 buffer_load_dwordx4 v21, s[16:19], s78 offen  lds
 v_mfma_f32_16x16x32_bf16 v[92:95], a[76:79], v[140:143], v[92:95]
 s_waitcnt lgkmcnt(9)
 ds_read_b64_tr_b16 a[74:75], v11 offset:25088
 v_mul_f32 v61, v29, v61
 v_mfma_f32_16x16x32_bf16 v[96:99], a[80:83], v[136:139], v[96:99]
 ds_read_b64_tr_b16 a[76:77], v8 offset:28672
 v_mul_f32 v62, v29, v62
 v_mfma_f32_16x16x32_bf16 v[100:103], a[80:83], v[140:143], v[100:103]
 s_waitcnt lgkmcnt(9)
 ds_read_b64_tr_b16 a[78:79], v8 offset:29184
 v_mul_f32 v63, v29, v63
 v_mfma_f32_16x16x32_bf16 v[104:107], a[84:87], v[136:139], v[104:107]
 ds_read_b64_tr_b16 a[80:81], v9 offset:28672
 v_cvt_pk_bf16_f32 v42, v60, v61
 v_mfma_f32_16x16x32_bf16 v[108:111], a[84:87], v[140:143], v[108:111]
 s_waitcnt lgkmcnt(9)
 ds_read_b64_tr_b16 a[82:83], v9 offset:29184
 s_add_u32 s78, s74, 589824
 v_mfma_f32_16x16x32_bf16 v[80:83], a[88:91], v[144:147], v[80:83]
 s_add_u32 m0, s69, 8192
 ds_read_b64_tr_b16 a[84:85], v10 offset:28672
 buffer_load_dwordx4 v21, s[16:19], s78 offen  lds
 v_mfma_f32_16x16x32_bf16 v[84:87], a[88:91], v[148:151], v[84:87]
 s_waitcnt lgkmcnt(9)
 ds_read_b64_tr_b16 a[86:87], v10 offset:29184
 v_cvt_pk_bf16_f32 v43, v62, v63
 v_mfma_f32_16x16x32_bf16 v[88:91], a[92:95], v[144:147], v[88:91]
 ds_read_b64_tr_b16 a[88:89], v11 offset:28672
 buffer_store_dwordx4 v[40:43], v26, s[36:39], s83 offen offset:1024 sc1
 v_mfma_f32_16x16x32_bf16 v[92:95], a[92:95], v[148:151], v[92:95]
 s_waitcnt lgkmcnt(9)
 ds_read_b64_tr_b16 a[90:91], v11 offset:29184
 v_mul_f32 v64, v28, v64
 v_mfma_f32_16x16x32_bf16 v[96:99], a[96:99], v[144:147], v[96:99]
 s_waitcnt vmcnt(11)
 s_barrier
 ds_read_b64_tr_b16 a[92:93], v8 offset:32768
 v_mul_f32 v65, v28, v65
 v_mfma_f32_16x16x32_bf16 v[100:103], a[96:99], v[148:151], v[100:103]
 s_waitcnt lgkmcnt(9)
 ds_read_b64_tr_b16 a[94:95], v8 offset:33280
 s_add_u32 s78, s74, 884736
 v_mfma_f32_16x16x32_bf16 v[104:107], a[72:75], v[144:147], v[104:107]
 s_add_u32 m0, s69, 12288
 ds_read_b64_tr_b16 a[96:97], v9 offset:32768
 buffer_load_dwordx4 v21, s[16:19], s78 offen  lds
 v_mfma_f32_16x16x32_bf16 v[108:111], a[72:75], v[148:151], v[108:111]
 s_waitcnt lgkmcnt(9)
 ds_read_b64_tr_b16 a[98:99], v9 offset:33280
 v_mul_f32 v66, v28, v66
 v_mfma_f32_16x16x32_bf16 v[80:83], a[76:79], v[152:155], v[80:83]
 ds_read_b64_tr_b16 a[72:73], v10 offset:32768
 v_mul_f32 v67, v28, v67
 v_mfma_f32_16x16x32_bf16 v[84:87], a[76:79], v[156:159], v[84:87]
 s_waitcnt lgkmcnt(9)
 ds_read_b64_tr_b16 a[74:75], v10 offset:33280
 v_cvt_pk_bf16_f32 v44, v64, v65
 v_mfma_f32_16x16x32_bf16 v[88:91], a[80:83], v[152:155], v[88:91]
 ds_read_b64_tr_b16 a[76:77], v11 offset:32768
 v_cvt_pk_bf16_f32 v45, v66, v67
 v_mfma_f32_16x16x32_bf16 v[92:95], a[80:83], v[156:159], v[92:95]
 s_waitcnt lgkmcnt(9)
 ds_read_b64_tr_b16 a[78:79], v11 offset:33280
 s_add_u32 s78, s74, 1179648
 v_mfma_f32_16x16x32_bf16 v[96:99], a[84:87], v[152:155], v[96:99]
 s_add_u32 m0, s69, 16384
 ds_read_b64_tr_b16 a[80:81], v8 offset:36864
 buffer_load_dwordx4 v21, s[16:19], s78 offen  lds
 v_mfma_f32_16x16x32_bf16 v[100:103], a[84:87], v[156:159], v[100:103]
 s_waitcnt lgkmcnt(9)
 ds_read_b64_tr_b16 a[82:83], v8 offset:37376
 v_mul_f32 v68, v29, v68
 v_mfma_f32_16x16x32_bf16 v[104:107], a[88:91], v[152:155], v[104:107]
 ds_read_b64_tr_b16 a[84:85], v9 offset:36864
 v_mul_f32 v69, v29, v69
 v_mfma_f32_16x16x32_bf16 v[108:111], a[88:91], v[156:159], v[108:111]
 s_waitcnt lgkmcnt(9)
 ds_read_b64_tr_b16 a[86:87], v9 offset:37376
 v_mul_f32 v70, v29, v70
 v_mfma_f32_16x16x32_bf16 v[80:83], a[92:95], v[160:163], v[80:83]
 ds_read_b64_tr_b16 a[88:89], v10 offset:36864
 v_mul_f32 v71, v29, v71
 v_mfma_f32_16x16x32_bf16 v[84:87], a[92:95], v[164:167], v[84:87]
 s_waitcnt lgkmcnt(9)
 ds_read_b64_tr_b16 a[90:91], v10 offset:37376
 s_add_u32 s78, s74, 1474560
 v_mfma_f32_16x16x32_bf16 v[88:91], a[96:99], v[160:163], v[88:91]
 s_add_u32 m0, s69, 20480
 ds_read_b64_tr_b16 a[92:93], v11 offset:36864
 buffer_load_dwordx4 v21, s[16:19], s78 offen  lds
 v_mfma_f32_16x16x32_bf16 v[92:95], a[96:99], v[164:167], v[92:95]
 s_waitcnt lgkmcnt(9)
 ds_read_b64_tr_b16 a[94:95], v11 offset:37376
 v_cvt_pk_bf16_f32 v46, v68, v69
 v_mfma_f32_16x16x32_bf16 v[96:99], a[72:75], v[160:163], v[96:99]
 ds_read_b64_tr_b16 a[96:97], v8 offset:40960
 v_cvt_pk_bf16_f32 v47, v70, v71
 v_mfma_f32_16x16x32_bf16 v[100:103], a[72:75], v[164:167], v[100:103]
 s_waitcnt lgkmcnt(9)
 ds_read_b64_tr_b16 a[98:99], v8 offset:41472
 buffer_store_dwordx4 v[44:47], v26, s[36:39], s83 offen offset:2048 sc1
 v_mfma_f32_16x16x32_bf16 v[104:107], a[76:79], v[160:163], v[104:107]
 ds_read_b64_tr_b16 a[72:73], v9 offset:40960
 v_mul_f32 v72, v28, v72
 v_mfma_f32_16x16x32_bf16 v[108:111], a[76:79], v[164:167], v[108:111]
 s_waitcnt lgkmcnt(9)
 ds_read_b64_tr_b16 a[74:75], v9 offset:41472
 s_add_u32 s78, s74, 1769472
 v_mfma_f32_16x16x32_bf16 v[80:83], a[80:83], v[168:171], v[80:83]
 s_add_u32 m0, s69, 24576
 ds_read_b64_tr_b16 a[76:77], v10 offset:40960
 buffer_load_dwordx4 v21, s[16:19], s78 offen  lds
 v_mfma_f32_16x16x32_bf16 v[84:87], a[80:83], v[172:175], v[84:87]
 s_waitcnt lgkmcnt(9)
 ds_read_b64_tr_b16 a[78:79], v10 offset:41472
 v_mul_f32 v73, v28, v73
 v_mfma_f32_16x16x32_bf16 v[88:91], a[84:87], v[168:171], v[88:91]
 ds_read_b64_tr_b16 a[80:81], v11 offset:40960
 v_mul_f32 v74, v28, v74
 v_mfma_f32_16x16x32_bf16 v[92:95], a[84:87], v[172:175], v[92:95]
 s_waitcnt lgkmcnt(9)
 ds_read_b64_tr_b16 a[82:83], v11 offset:41472
 v_mul_f32 v75, v28, v75
 v_mfma_f32_16x16x32_bf16 v[96:99], a[88:91], v[168:171], v[96:99]
 ds_read_b64_tr_b16 a[84:85], v8 offset:45056
 v_cvt_pk_bf16_f32 v40, v72, v73
 v_mfma_f32_16x16x32_bf16 v[100:103], a[88:91], v[172:175], v[100:103]
 s_waitcnt lgkmcnt(9)
 ds_read_b64_tr_b16 a[86:87], v8 offset:45568
 s_add_u32 s78, s74, 2064384
 v_mfma_f32_16x16x32_bf16 v[104:107], a[92:95], v[168:171], v[104:107]
 s_add_u32 m0, s69, 28672
 ds_read_b64_tr_b16 a[88:89], v9 offset:45056
 buffer_load_dwordx4 v21, s[16:19], s78 offen  lds
 v_mfma_f32_16x16x32_bf16 v[108:111], a[92:95], v[172:175], v[108:111]
 s_waitcnt lgkmcnt(9)
 ds_read_b64_tr_b16 a[90:91], v9 offset:45568
 v_cvt_pk_bf16_f32 v41, v74, v75
 v_mfma_f32_16x16x32_bf16 v[80:83], a[96:99], v[176:179], v[80:83]
 ds_read_b64_tr_b16 a[92:93], v10 offset:45056
 v_mul_f32 v76, v29, v76
 v_mfma_f32_16x16x32_bf16 v[84:87], a[96:99], v[180:183], v[84:87]
 s_waitcnt lgkmcnt(9)
 ds_read_b64_tr_b16 a[94:95], v10 offset:45568
 v_mul_f32 v77, v29, v77
 v_mfma_f32_16x16x32_bf16 v[88:91], a[72:75], v[176:179], v[88:91]
 ds_read_b64_tr_b16 a[96:97], v11 offset:45056
 v_mul_f32 v78, v29, v78
 v_mfma_f32_16x16x32_bf16 v[92:95], a[72:75], v[180:183], v[92:95]
 s_waitcnt lgkmcnt(9)
 ds_read_b64_tr_b16 a[98:99], v11 offset:45568
 s_add_u32 s78, s74, 2359296
 v_mfma_f32_16x16x32_bf16 v[96:99], a[76:79], v[176:179], v[96:99]
 s_add_u32 m0, s69, 32768
 ds_read_b64_tr_b16 a[72:73], v8 offset:49152
 buffer_load_dwordx4 v21, s[16:19], s78 offen  lds
 v_mfma_f32_16x16x32_bf16 v[100:103], a[76:79], v[180:183], v[100:103]
 s_waitcnt lgkmcnt(9)
 ds_read_b64_tr_b16 a[74:75], v8 offset:49664
 v_mul_f32 v79, v29, v79
 v_mfma_f32_16x16x32_bf16 v[104:107], a[80:83], v[176:179], v[104:107]
 ds_read_b64_tr_b16 a[76:77], v9 offset:49152
 v_cvt_pk_bf16_f32 v42, v76, v77
 v_mfma_f32_16x16x32_bf16 v[108:111], a[80:83], v[180:183], v[108:111]
 s_waitcnt lgkmcnt(9)
 ds_read_b64_tr_b16 a[78:79], v9 offset:49664
 v_cvt_pk_bf16_f32 v43, v78, v79
 v_mfma_f32_16x16x32_bf16 v[80:83], a[84:87], v[184:187], v[80:83]
 ds_read_b64_tr_b16 a[80:81], v10 offset:49152
 buffer_store_dwordx4 v[40:43], v26, s[36:39], s83 offen offset:3072 sc1
 v_mfma_f32_16x16x32_bf16 v[84:87], a[84:87], v[188:191], v[84:87]
 s_waitcnt lgkmcnt(9)
 ds_read_b64_tr_b16 a[82:83], v10 offset:49664
 s_add_u32 s78, s74, 2654208
 v_mfma_f32_16x16x32_bf16 v[88:91], a[88:91], v[184:187], v[88:91]
 s_add_u32 m0, s69, 36864
 ds_read_b64_tr_b16 a[84:85], v11 offset:49152
 buffer_load_dwordx4 v21, s[16:19], s78 offen  lds
 v_mfma_f32_16x16x32_bf16 v[92:95], a[88:91], v[188:191], v[92:95]
 s_waitcnt lgkmcnt(9)
 ds_read_b64_tr_b16 a[86:87], v11 offset:49664
 v_mfma_f32_16x16x32_bf16 v[96:99], a[92:95], v[184:187], v[96:99]
 ds_read_b64_tr_b16 a[88:89], v8 offset:53248
 v_mfma_f32_16x16x32_bf16 v[100:103], a[92:95], v[188:191], v[100:103]
 s_waitcnt lgkmcnt(9)
 ds_read_b64_tr_b16 a[90:91], v8 offset:53760
 v_mfma_f32_16x16x32_bf16 v[104:107], a[96:99], v[184:187], v[104:107]
 ds_read_b64_tr_b16 a[92:93], v9 offset:53248
 v_mfma_f32_16x16x32_bf16 v[108:111], a[96:99], v[188:191], v[108:111]
 s_waitcnt lgkmcnt(9)
 ds_read_b64_tr_b16 a[94:95], v9 offset:53760
 s_add_u32 s78, s74, 2949120
 v_mfma_f32_16x16x32_bf16 v[80:83], a[72:75], v[192:195], v[80:83]
 s_add_u32 m0, s69, 40960
 ds_read_b64_tr_b16 a[96:97], v10 offset:53248
 buffer_load_dwordx4 v21, s[16:19], s78 offen  lds
 v_mfma_f32_16x16x32_bf16 v[84:87], a[72:75], v[196:199], v[84:87]
 s_waitcnt lgkmcnt(9)
 ds_read_b64_tr_b16 a[98:99], v10 offset:53760
 v_mfma_f32_16x16x32_bf16 v[88:91], a[76:79], v[192:195], v[88:91]
 ds_read_b64_tr_b16 a[72:73], v11 offset:53248
 v_mfma_f32_16x16x32_bf16 v[92:95], a[76:79], v[196:199], v[92:95]
 s_waitcnt lgkmcnt(9)
 ds_read_b64_tr_b16 a[74:75], v11 offset:53760
 v_mfma_f32_16x16x32_bf16 v[96:99], a[80:83], v[192:195], v[96:99]
 s_waitcnt vmcnt(15)
 s_barrier
 ds_read_b64_tr_b16 a[76:77], v8 offset:57344
 v_mfma_f32_16x16x32_bf16 v[100:103], a[80:83], v[196:199], v[100:103]
 s_waitcnt lgkmcnt(9)
 ds_read_b64_tr_b16 a[78:79], v8 offset:57856
 s_add_u32 s78, s74, 3244032
 v_mfma_f32_16x16x32_bf16 v[104:107], a[84:87], v[192:195], v[104:107]
 s_add_u32 m0, s69, 45056
 ds_read_b64_tr_b16 a[80:81], v9 offset:57344
 buffer_load_dwordx4 v21, s[16:19], s78 offen  lds
 v_mfma_f32_16x16x32_bf16 v[108:111], a[84:87], v[196:199], v[108:111]
 s_waitcnt lgkmcnt(9)
 ds_read_b64_tr_b16 a[82:83], v9 offset:57856
 v_mfma_f32_16x16x32_bf16 v[80:83], a[88:91], v[200:203], v[80:83]
 ds_read_b64_tr_b16 a[84:85], v10 offset:57344
 v_mfma_f32_16x16x32_bf16 v[84:87], a[88:91], v[204:207], v[84:87]
 s_waitcnt lgkmcnt(9)
 ds_read_b64_tr_b16 a[86:87], v10 offset:57856
 v_mfma_f32_16x16x32_bf16 v[88:91], a[92:95], v[200:203], v[88:91]
 ds_read_b64_tr_b16 a[88:89], v11 offset:57344
 v_mfma_f32_16x16x32_bf16 v[92:95], a[92:95], v[204:207], v[92:95]
 s_waitcnt lgkmcnt(9)
 ds_read_b64_tr_b16 a[90:91], v11 offset:57856
 s_add_u32 s78, s74, 3538944
 v_mfma_f32_16x16x32_bf16 v[96:99], a[96:99], v[200:203], v[96:99]
 s_add_u32 m0, s69, 49152
 ds_read_b64_tr_b16 a[92:93], v8 offset:61440
 buffer_load_dwordx4 v21, s[16:19], s78 offen  lds
 v_mfma_f32_16x16x32_bf16 v[100:103], a[96:99], v[204:207], v[100:103]
 s_waitcnt lgkmcnt(9)
 ds_read_b64_tr_b16 a[94:95], v8 offset:61952
 v_mfma_f32_16x16x32_bf16 v[104:107], a[72:75], v[200:203], v[104:107]
 ds_read_b64_tr_b16 a[96:97], v9 offset:61440
 v_mfma_f32_16x16x32_bf16 v[108:111], a[72:75], v[204:207], v[108:111]
 s_waitcnt lgkmcnt(9)
 ds_read_b64_tr_b16 a[98:99], v9 offset:61952
 v_mfma_f32_16x16x32_bf16 v[80:83], a[76:79], v[208:211], v[80:83]
 ds_read_b64_tr_b16 a[72:73], v10 offset:61440
 v_mfma_f32_16x16x32_bf16 v[84:87], a[76:79], v[212:215], v[84:87]
 s_waitcnt lgkmcnt(9)
 ds_read_b64_tr_b16 a[74:75], v10 offset:61952
 s_add_u32 s78, s74, 3833856
 v_mfma_f32_16x16x32_bf16 v[88:91], a[80:83], v[208:211], v[88:91]
 s_add_u32 m0, s69, 53248
 ds_read_b64_tr_b16 a[76:77], v11 offset:61440
 buffer_load_dwordx4 v21, s[16:19], s78 offen  lds
 v_mfma_f32_16x16x32_bf16 v[92:95], a[80:83], v[212:215], v[92:95]
 s_waitcnt lgkmcnt(9)
 ds_read_b64_tr_b16 a[78:79], v11 offset:61952
 v_mfma_f32_16x16x32_bf16 v[96:99], a[84:87], v[208:211], v[96:99]
 ds_read_b64_tr_b16 a[80:81], v12 offset:0
 v_mfma_f32_16x16x32_bf16 v[100:103], a[84:87], v[212:215], v[100:103]
 s_waitcnt lgkmcnt(9)
 ds_read_b64_tr_b16 a[82:83], v12 offset:512
 v_mfma_f32_16x16x32_bf16 v[104:107], a[88:91], v[208:211], v[104:107]
 ds_read_b64_tr_b16 a[84:85], v13 offset:0
 v_mfma_f32_16x16x32_bf16 v[108:111], a[88:91], v[212:215], v[108:111]
 s_waitcnt lgkmcnt(9)
 ds_read_b64_tr_b16 a[86:87], v13 offset:512
 s_add_u32 s78, s74, 4128768
 v_mfma_f32_16x16x32_bf16 v[80:83], a[92:95], v[216:219], v[80:83]
 s_add_u32 m0, s69, 57344
 ds_read_b64_tr_b16 a[88:89], v14 offset:0
 buffer_load_dwordx4 v21, s[16:19], s78 offen  lds
 v_mfma_f32_16x16x32_bf16 v[84:87], a[92:95], v[220:223], v[84:87]
 s_waitcnt lgkmcnt(9)
 ds_read_b64_tr_b16 a[90:91], v14 offset:512
 v_mfma_f32_16x16x32_bf16 v[88:91], a[96:99], v[216:219], v[88:91]
 ds_read_b64_tr_b16 a[92:93], v15 offset:0
 v_mfma_f32_16x16x32_bf16 v[92:95], a[96:99], v[220:223], v[92:95]
 s_waitcnt lgkmcnt(9)
 ds_read_b64_tr_b16 a[94:95], v15 offset:512
 v_mfma_f32_16x16x32_bf16 v[96:99], a[72:75], v[216:219], v[96:99]
 ds_read_b64_tr_b16 a[96:97], v12 offset:4096
 v_mfma_f32_16x16x32_bf16 v[100:103], a[72:75], v[220:223], v[100:103]
 s_waitcnt lgkmcnt(9)
 ds_read_b64_tr_b16 a[98:99], v12 offset:4608
 s_add_u32 s78, s74, 4423680
 v_mfma_f32_16x16x32_bf16 v[104:107], a[76:79], v[216:219], v[104:107]
 s_add_u32 m0, s69, 61440
 ds_read_b64_tr_b16 a[72:73], v13 offset:4096
 buffer_load_dwordx4 v21, s[16:19], s78 offen  lds
 v_mfma_f32_16x16x32_bf16 v[108:111], a[76:79], v[220:223], v[108:111]
 s_waitcnt lgkmcnt(9)
 ds_read_b64_tr_b16 a[74:75], v13 offset:4608
 v_mfma_f32_16x16x32_bf16 v[80:83], a[80:83], v[224:227], v[80:83]
 ds_read_b64_tr_b16 a[76:77], v14 offset:4096
 v_mfma_f32_16x16x32_bf16 v[84:87], a[80:83], v[228:231], v[84:87]
 s_waitcnt lgkmcnt(9)
 ds_read_b64_tr_b16 a[78:79], v14 offset:4608
 v_mfma_f32_16x16x32_bf16 v[88:91], a[84:87], v[224:227], v[88:91]
 ds_read_b64_tr_b16 a[80:81], v15 offset:4096
 v_mfma_f32_16x16x32_bf16 v[92:95], a[84:87], v[228:231], v[92:95]
 s_waitcnt lgkmcnt(9)
 ds_read_b64_tr_b16 a[82:83], v15 offset:4608
 s_add_u32 s78, s74, 4718592
 v_mfma_f32_16x16x32_bf16 v[96:99], a[88:91], v[224:227], v[96:99]
 s_add_u32 m0, s69, 65536
 ds_read_b64_tr_b16 a[84:85], v12 offset:8192
 buffer_load_dwordx4 v21, s[16:19], s78 offen  lds
 v_mfma_f32_16x16x32_bf16 v[100:103], a[88:91], v[228:231], v[100:103]
 s_waitcnt lgkmcnt(9)
 ds_read_b64_tr_b16 a[86:87], v12 offset:8704
 v_mfma_f32_16x16x32_bf16 v[104:107], a[92:95], v[224:227], v[104:107]
 ds_read_b64_tr_b16 a[88:89], v13 offset:8192
 v_mfma_f32_16x16x32_bf16 v[108:111], a[92:95], v[228:231], v[108:111]
 s_waitcnt lgkmcnt(9)
 ds_read_b64_tr_b16 a[90:91], v13 offset:8704
 v_mfma_f32_16x16x32_bf16 v[80:83], a[96:99], v[232:235], v[80:83]
 ds_read_b64_tr_b16 a[92:93], v14 offset:8192
 v_mfma_f32_16x16x32_bf16 v[84:87], a[96:99], v[236:239], v[84:87]
 s_waitcnt lgkmcnt(9)
 ds_read_b64_tr_b16 a[94:95], v14 offset:8704
 s_add_u32 s78, s74, 5013504
 v_mfma_f32_16x16x32_bf16 v[88:91], a[72:75], v[232:235], v[88:91]
 s_add_u32 m0, s69, 69632
 ds_read_b64_tr_b16 a[96:97], v15 offset:8192
 buffer_load_dwordx4 v21, s[16:19], s78 offen  lds
 v_mfma_f32_16x16x32_bf16 v[92:95], a[72:75], v[236:239], v[92:95]
 s_waitcnt lgkmcnt(9)
 ds_read_b64_tr_b16 a[98:99], v15 offset:8704
 v_mfma_f32_16x16x32_bf16 v[96:99], a[76:79], v[232:235], v[96:99]
 ds_read_b64_tr_b16 a[72:73], v12 offset:12288
 v_mfma_f32_16x16x32_bf16 v[100:103], a[76:79], v[236:239], v[100:103]
 s_waitcnt lgkmcnt(9)
 ds_read_b64_tr_b16 a[74:75], v12 offset:12800
 v_mfma_f32_16x16x32_bf16 v[104:107], a[80:83], v[232:235], v[104:107]
 ds_read_b64_tr_b16 a[76:77], v13 offset:12288
 v_mfma_f32_16x16x32_bf16 v[108:111], a[80:83], v[236:239], v[108:111]
 s_waitcnt lgkmcnt(9)
 ds_read_b64_tr_b16 a[78:79], v13 offset:12800
 s_add_u32 s78, s74, 0
 v_mfma_f32_16x16x32_bf16 v[80:83], a[84:87], v[240:243], v[80:83]
 s_add_u32 m0, s69, 73728
 ds_read_b64_tr_b16 a[80:81], v14 offset:12288
 buffer_load_dwordx4 v21, s[20:23], s78 offen  lds
 v_mfma_f32_16x16x32_bf16 v[84:87], a[84:87], v[244:247], v[84:87]
 s_waitcnt lgkmcnt(9)
 ds_read_b64_tr_b16 a[82:83], v14 offset:12800
 v_mfma_f32_16x16x32_bf16 v[88:91], a[88:91], v[240:243], v[88:91]
 ds_read_b64_tr_b16 a[84:85], v15 offset:12288
 v_mfma_f32_16x16x32_bf16 v[92:95], a[88:91], v[244:247], v[92:95]
 s_waitcnt lgkmcnt(9)
 ds_read_b64_tr_b16 a[86:87], v15 offset:12800
 v_mfma_f32_16x16x32_bf16 v[96:99], a[92:95], v[240:243], v[96:99]
 s_waitcnt vmcnt(15)
 s_barrier
 ds_read_b64_tr_b16 a[88:89], v4 offset:0
 v_mfma_f32_16x16x32_bf16 v[100:103], a[92:95], v[244:247], v[100:103]
 s_waitcnt lgkmcnt(9)
 ds_read_b64_tr_b16 a[90:91], v4 offset:512
 s_add_u32 s78, s74, 294912
 v_mfma_f32_16x16x32_bf16 v[104:107], a[96:99], v[240:243], v[104:107]
 s_add_u32 m0, s69, 77824
 ds_read_b64_tr_b16 a[92:93], v5 offset:0
 buffer_load_dwordx4 v21, s[20:23], s78 offen  lds
 v_mfma_f32_16x16x32_bf16 v[108:111], a[96:99], v[244:247], v[108:111]
 s_waitcnt lgkmcnt(9)
 ds_read_b64_tr_b16 a[94:95], v5 offset:512
 v_mfma_f32_16x16x32_bf16 v[80:83], a[72:75], v[248:251], v[80:83]
 ds_read_b64_tr_b16 a[96:97], v6 offset:0
 v_mfma_f32_16x16x32_bf16 v[84:87], a[72:75], v[252:255], v[84:87]
 s_waitcnt lgkmcnt(9)
 ds_read_b64_tr_b16 a[98:99], v6 offset:512
 v_mfma_f32_16x16x32_bf16 v[88:91], a[76:79], v[248:251], v[88:91]
 ds_read_b64_tr_b16 a[72:73], v7 offset:0
 v_mfma_f32_16x16x32_bf16 v[92:95], a[76:79], v[252:255], v[92:95]
 s_waitcnt lgkmcnt(9)
 ds_read_b64_tr_b16 a[74:75], v7 offset:512
 s_add_u32 s78, s74, 589824
 v_mfma_f32_16x16x32_bf16 v[96:99], a[80:83], v[248:251], v[96:99]
 s_add_u32 m0, s69, 81920
 ds_read_b64_tr_b16 a[76:77], v4 offset:4096
 buffer_load_dwordx4 v21, s[20:23], s78 offen  lds
    s_branch L_s3_end
L_s3_V:
 s_add_u32 m0, s69, 12288
 s_add_u32 s78, s72, 331776
 buffer_load_dwordx4 v20, s[8:11], s78 offen  lds
 s_add_u32 m0, s69, 16384
 s_add_u32 s78, s72, 442368
 buffer_load_dwordx4 v20, s[8:11], s78 offen  lds
 s_add_u32 m0, s69, 20480
 s_add_u32 s78, s72, 552960
 buffer_load_dwordx4 v20, s[8:11], s78 offen  lds
 v_mfma_f32_16x16x32_bf16 v[52:55], v[40:43], v[244:247], v[52:55]
 v_mfma_f32_16x16x32_bf16 a[240:243], v[244:247], v[244:247], a[240:243]
 v_mfma_f32_16x16x32_bf16 v[52:55], v[40:43], v[252:255], v[52:55]
 v_mfma_f32_16x16x32_bf16 a[240:243], v[252:255], v[252:255], a[240:243]
 v_mfma_f32_16x16x32_bf16 v[68:71], a[148:151], v[240:243], v[64:67]
 v_cvt_pk_bf16_f32 v224, v84, v85
 v_cvt_pk_bf16_f32 v225, v86, v87
 v_mfma_f32_16x16x32_bf16 v[72:75], a[152:155], v[240:243], v[64:67]
 v_cvt_pk_bf16_f32 v226, v88, v89
 v_cvt_pk_bf16_f32 v227, v90, v91
 v_mfma_f32_16x16x32_bf16 v[76:79], a[148:151], v[248:251], v[64:67]
 v_cvt_pk_bf16_f32 v232, v92, v93
 v_cvt_pk_bf16_f32 v233, v94, v95
 v_mfma_f32_16x16x32_bf16 v[80:83], a[152:155], v[248:251], v[64:67]
 v_cvt_pk_bf16_f32 v234, v96, v97
 v_cvt_pk_bf16_f32 v235, v98, v99
 s_add_u32 m0, s69, 24576
 s_add_u32 s78, s72, 663552
 buffer_load_dwordx4 v20, s[8:11], s78 offen  lds
 v_cvt_pk_bf16_f32 v240, v68, v69
 v_cvt_pk_bf16_f32 v241, v70, v71
 v_cvt_pk_bf16_f32 v242, v72, v73
 v_cvt_pk_bf16_f32 v243, v74, v75
 v_cvt_pk_bf16_f32 v248, v76, v77
 v_cvt_pk_bf16_f32 v249, v78, v79
 v_cvt_pk_bf16_f32 v250, v80, v81
 v_cvt_pk_bf16_f32 v251, v82, v83
 v_mul_f32 v33, 0x3ae38e39, v52
 v_cvt_pk_bf16_f32 v39, v33, v33
 v_and_b32 v39, 0xffff0000, v39
 v_xor_b32 v104, 0x80000000, v39
 v_mov_b32 v105, v104
 v_mov_b32 v106, v104
 v_mov_b32 v107, v104
 s_nop 1
 v_mfma_f32_16x16x32_bf16 v[80:83], a[148:151], v[116:119], v[104:107]
 v_mfma_f32_16x16x32_bf16 v[84:87], a[152:155], v[116:119], v[104:107]
 s_add_u32 m0, s69, 28672
 s_add_u32 s78, s72, 774144
 buffer_load_dwordx4 v20, s[8:11], s78 offen  lds
 v_mfma_f32_16x16x32_bf16 v[88:91], a[148:151], v[124:127], v[104:107]
 v_mfma_f32_16x16x32_bf16 v[92:95], a[152:155], v[124:127], v[104:107]
 s_add_u32 m0, s69, 32768
 s_add_u32 s78, s72, 884736
 buffer_load_dwordx4 v20, s[8:11], s78 offen  lds
 v_mfma_f32_16x16x32_bf16 v[96:99], a[148:151], v[132:135], v[104:107]
 v_cvt_pk_bf16_f32 v116, v80, v81
 v_cvt_pk_bf16_f32 v117, v82, v83
 v_mfma_f32_16x16x32_bf16 v[100:103], a[152:155], v[132:135], v[104:107]
 s_nop 2
 v_cvt_pk_bf16_f32 v118, v84, v85
 v_cvt_pk_bf16_f32 v119, v86, v87
 v_cvt_pk_bf16_f32 v124, v88, v89
 v_cvt_pk_bf16_f32 v125, v90, v91
 s_nop 2
 v_cvt_pk_bf16_f32 v126, v92, v93
 v_cvt_pk_bf16_f32 v127, v94, v95
 v_cvt_pk_bf16_f32 v132, v96, v97
 v_cvt_pk_bf16_f32 v133, v98, v99
 s_nop 2
 v_cvt_pk_bf16_f32 v134, v100, v101
 v_cvt_pk_bf16_f32 v135, v102, v103
 s_waitcnt vmcnt(8)
 s_barrier
 ds_read_b64_tr_b16 a[72:73], v4 offset:0
 ds_read_b64_tr_b16 a[74:75], v4 offset:512
 ds_read_b64_tr_b16 a[76:77], v5 offset:0
 ds_read_b64_tr_b16 a[78:79], v5 offset:512
 ds_read_b64_tr_b16 a[80:81], v6 offset:0
 ds_read_b64_tr_b16 a[82:83], v6 offset:512
 ds_read_b64_tr_b16 a[84:85], v7 offset:0
 ds_read_b64_tr_b16 a[86:87], v7 offset:512
 ds_read_b64_tr_b16 a[88:89], v4 offset:4096
 ds_read_b64_tr_b16 a[90:91], v4 offset:4608
 ds_read_b64_tr_b16 a[92:93], v5 offset:4096
 ds_read_b64_tr_b16 a[94:95], v5 offset:4608
 s_waitcnt lgkmcnt(10)
 v_mfma_f32_16x16x32_bf16 v[48:51], v[112:115], a[72:75], 0
 s_add_u32 s78, s72, 995328
 ds_read_b64_tr_b16 a[96:97], v6 offset:4096
 v_accvgpr_read_b32 v34, a236
 v_mfma_f32_16x16x32_bf16 v[52:55], v[116:119], a[72:75], 0
 s_waitcnt lgkmcnt(9)
 ds_read_b64_tr_b16 a[98:99], v6 offset:4608
 v_accvgpr_read_b32 v35, a237
 v_mfma_f32_16x16x32_bf16 v[56:59], v[112:115], a[76:79], 0
 s_add_u32 m0, s69, 36864
 ds_read_b64_tr_b16 a[72:73], v7 offset:4096
 buffer_load_dwordx4 v20, s[8:11], s78 offen  lds
 v_mfma_f32_16x16x32_bf16 v[80:83], a[148:151], v[140:143], v[104:107]
 v_accvgpr_read_b32 v36, a238
 v_mfma_f32_16x16x32_bf16 v[60:63], v[116:119], a[76:79], 0
 s_waitcnt lgkmcnt(9)
 ds_read_b64_tr_b16 a[74:75], v7 offset:4608
 v_accvgpr_read_b32 v37, a239
 v_mfma_f32_16x16x32_bf16 v[64:67], v[112:115], a[80:83], 0
 ds_read_b64_tr_b16 a[76:77], v4 offset:8192
 s_mov_b32 vcc_lo, 0x22222222
 v_mfma_f32_16x16x32_bf16 v[84:87], a[152:155], v[140:143], v[104:107]
 v_mfma_f32_16x16x32_bf16 v[68:71], v[116:119], a[80:83], 0
 s_waitcnt lgkmcnt(9)
 ds_read_b64_tr_b16 a[78:79], v4 offset:8704
 s_mov_b32 vcc_hi, 0x22222222
 v_mfma_f32_16x16x32_bf16 v[72:75], v[112:115], a[84:87], 0
 s_add_u32 s78, s72, 1105920
 ds_read_b64_tr_b16 a[80:81], v5 offset:8192
 v_cvt_pk_bf16_f32 v140, v80, v81
 v_cndmask_b32 v34, v34, v35, vcc
 v_mfma_f32_16x16x32_bf16 v[76:79], v[116:119], a[84:87], 0
 s_waitcnt lgkmcnt(9)
 ds_read_b64_tr_b16 a[82:83], v5 offset:8704
 v_cvt_pk_bf16_f32 v141, v82, v83
 s_mov_b32 vcc_lo, 0x44444444
 v_mfma_f32_16x16x32_bf16 v[48:51], v[120:123], a[88:91], v[48:51]
 ds_read_b64_tr_b16 a[84:85], v6 offset:8192
 buffer_load_dword a214, v3, s[16:19], s74 offen offset:0
 v_cvt_pk_bf16_f32 v142, v84, v85
 v_mfma_f32_16x16x32_bf16 v[52:55], v[124:127], a[88:91], v[52:55]
 s_waitcnt lgkmcnt(9)
 ds_read_b64_tr_b16 a[86:87], v6 offset:8704
 v_cvt_pk_bf16_f32 v143, v86, v87
 s_mov_b32 vcc_hi, 0x44444444
 v_mfma_f32_16x16x32_bf16 v[56:59], v[120:123], a[92:95], v[56:59]
 s_add_u32 m0, s69, 40960
 ds_read_b64_tr_b16 a[88:89], v7 offset:8192
 buffer_load_dwordx4 v20, s[8:11], s78 offen  lds
 v_mfma_f32_16x16x32_bf16 v[88:91], a[148:151], v[148:151], v[104:107]
 v_cndmask_b32 v34, v34, v36, vcc
 v_mfma_f32_16x16x32_bf16 v[60:63], v[124:127], a[92:95], v[60:63]
 s_waitcnt lgkmcnt(9)
 ds_read_b64_tr_b16 a[90:91], v7 offset:8704
 s_mov_b32 vcc_lo, 0x88888888
 v_mfma_f32_16x16x32_bf16 v[64:67], v[120:123], a[96:99], v[64:67]
 s_waitcnt vmcnt(6)
 s_barrier
 ds_read_b64_tr_b16 a[92:93], v4 offset:12288
 s_add_u32 s78, s72, 1216512
 v_mfma_f32_16x16x32_bf16 v[92:95], a[152:155], v[148:151], v[104:107]
 s_mov_b32 vcc_hi, 0x88888888
 v_mfma_f32_16x16x32_bf16 v[68:71], v[124:127], a[96:99], v[68:71]
 s_waitcnt lgkmcnt(9)
 ds_read_b64_tr_b16 a[94:95], v4 offset:12800
 v_cndmask_b32 v34, v34, v37, vcc
 v_mfma_f32_16x16x32_bf16 v[72:75], v[120:123], a[72:75], v[72:75]
 s_add_u32 m0, s69, 45056
 ds_read_b64_tr_b16 a[96:97], v5 offset:12288
 buffer_load_dwordx4 v20, s[8:11], s78 offen  lds
 v_cvt_pk_bf16_f32 v148, v88, v89
 v_mfma_f32_16x16x32_bf16 v[76:79], v[124:127], a[72:75], v[76:79]
 s_waitcnt lgkmcnt(9)
 ds_read_b64_tr_b16 a[98:99], v5 offset:12800
 v_cvt_pk_bf16_f32 v149, v90, v91
 s_mov_b32 vcc_lo, 0xf0000f
 v_mfma_f32_16x16x32_bf16 v[48:51], v[128:131], a[76:79], v[48:51]
 ds_read_b64_tr_b16 a[72:73], v6 offset:12288
 v_cvt_pk_bf16_f32 v150, v92, v93
 s_mov_b32 vcc_hi, 0xf0000f00
 v_mfma_f32_16x16x32_bf16 v[52:55], v[132:135], a[76:79], v[52:55]
 s_waitcnt lgkmcnt(9)
 ds_read_b64_tr_b16 a[74:75], v6 offset:12800
 v_cvt_pk_bf16_f32 v151, v94, v95
 v_cndmask_b32 v28, 0, v34, vcc
 v_mfma_f32_16x16x32_bf16 v[56:59], v[128:131], a[80:83], v[56:59]
 s_add_u32 s78, s72, 1327104
 ds_read_b64_tr_b16 a[76:77], v7 offset:12288
 v_accvgpr_read_b32 v34, a240
 v_mfma_f32_16x16x32_bf16 v[96:99], a[148:151], v[156:159], v[104:107]
 v_mfma_f32_16x16x32_bf16 v[60:63], v[132:135], a[80:83], v[60:63]
 s_waitcnt lgkmcnt(9)
 ds_read_b64_tr_b16 a[78:79], v7 offset:12800
 v_accvgpr_read_b32 v35, a241
 v_mfma_f32_16x16x32_bf16 v[64:67], v[128:131], a[84:87], v[64:67]
 s_add_u32 m0, s69, 49152
 ds_read_b64_tr_b16 a[80:81], v4 offset:16384
 buffer_load_dwordx4 v20, s[8:11], s78 offen  lds
 v_mfma_f32_16x16x32_bf16 v[100:103], a[152:155], v[156:159], v[104:107]
 v_accvgpr_read_b32 v36, a242
 v_mfma_f32_16x16x32_bf16 v[68:71], v[132:135], a[84:87], v[68:71]
 s_waitcnt lgkmcnt(9)
 ds_read_b64_tr_b16 a[82:83], v4 offset:16896
 v_accvgpr_read_b32 v37, a243
 v_mfma_f32_16x16x32_bf16 v[72:75], v[128:131], a[88:91], v[72:75]
 ds_read_b64_tr_b16 a[84:85], v5 offset:16384
 v_cvt_pk_bf16_f32 v156, v96, v97
 s_mov_b32 vcc_lo, 0x22222222
 v_mfma_f32_16x16x32_bf16 v[76:79], v[132:135], a[88:91], v[76:79]
 s_waitcnt lgkmcnt(9)
 ds_read_b64_tr_b16 a[86:87], v5 offset:16896
 v_cvt_pk_bf16_f32 v157, v98, v99
 s_mov_b32 vcc_hi, 0x22222222
 v_mfma_f32_16x16x32_bf16 v[48:51], v[136:139], a[92:95], v[48:51]
 s_add_u32 s78, s72, 1437696
 ds_read_b64_tr_b16 a[88:89], v6 offset:16384
 v_cvt_pk_bf16_f32 v158, v100, v101
 v_cndmask_b32 v34, v34, v35, vcc
 v_mfma_f32_16x16x32_bf16 v[52:55], v[140:143], a[92:95], v[52:55]
 s_waitcnt lgkmcnt(9)
 ds_read_b64_tr_b16 a[90:91], v6 offset:16896
 v_cvt_pk_bf16_f32 v159, v102, v103
 s_mov_b32 vcc_lo, 0x44444444
 v_mfma_f32_16x16x32_bf16 v[56:59], v[136:139], a[96:99], v[56:59]
 s_add_u32 m0, s69, 53248
 ds_read_b64_tr_b16 a[92:93], v7 offset:16384
 buffer_load_dwordx4 v20, s[8:11], s78 offen  lds
 v_mfma_f32_16x16x32_bf16 v[80:83], a[148:151], v[164:167], v[104:107]
 s_mov_b32 vcc_hi, 0x44444444
 v_mfma_f32_16x16x32_bf16 v[60:63], v[140:143], a[96:99], v[60:63]
 s_waitcnt lgkmcnt(9)
 ds_read_b64_tr_b16 a[94:95], v7 offset:16896
 v_cndmask_b32 v34, v34, v36, vcc
 v_mfma_f32_16x16x32_bf16 v[64:67], v[136:139], a[72:75], v[64:67]
 ds_read_b64_tr_b16 a[96:97], v4 offset:20480
 s_mov_b32 vcc_lo, 0x88888888
 v_mfma_f32_16x16x32_bf16 v[84:87], a[152:155], v[164:167], v[104:107]
 v_mfma_f32_16x16x32_bf16 v[68:71], v[140:143], a[72:75], v[68:71]
 s_waitcnt lgkmcnt(9)
 ds_read_b64_tr_b16 a[98:99], v4 offset:20992
 s_mov_b32 vcc_hi, 0x88888888
 v_mfma_f32_16x16x32_bf16 v[72:75], v[136:139], a[76:79], v[72:75]
 s_add_u32 s78, s72, 1548288
 ds_read_b64_tr_b16 a[72:73], v5 offset:20480
 v_cvt_pk_bf16_f32 v164, v80, v81
 v_cndmask_b32 v34, v34, v37, vcc
 v_mfma_f32_16x16x32_bf16 v[76:79], v[140:143], a[76:79], v[76:79]
 s_waitcnt lgkmcnt(9)
 ds_read_b64_tr_b16 a[74:75], v5 offset:20992
 v_cvt_pk_bf16_f32 v165, v82, v83
 s_mov_b32 vcc_lo, 0xf0000f
 v_mfma_f32_16x16x32_bf16 v[48:51], v[144:147], a[80:83], v[48:51]
 s_add_u32 m0, s69, 57344
 ds_read_b64_tr_b16 a[76:77], v6 offset:20480
 buffer_load_dwordx4 v20, s[8:11], s78 offen  lds
 v_cvt_pk_bf16_f32 v166, v84, v85
 v_mfma_f32_16x16x32_bf16 v[52:55], v[148:151], a[80:83], v[52:55]
 s_waitcnt lgkmcnt(9)
 ds_read_b64_tr_b16 a[78:79], v6 offset:20992
 v_cvt_pk_bf16_f32 v167, v86, v87
 s_mov_b32 vcc_hi, 0xf0000f00
 v_mfma_f32_16x16x32_bf16 v[56:59], v[144:147], a[84:87], v[56:59]
 ds_read_b64_tr_b16 a[80:81], v7 offset:20480
 v_cndmask_b32 v29, 0, v34, vcc
 v_mfma_f32_16x16x32_bf16 v[88:91], a[148:151], v[172:175], v[104:107]
 v_mfma_f32_16x16x32_bf16 v[60:63], v[148:151], a[84:87], v[60:63]
 s_waitcnt lgkmcnt(9)
 ds_read_b64_tr_b16 a[82:83], v7 offset:20992
 v_mov_b32 v30, v28
 v_mfma_f32_16x16x32_bf16 v[64:67], v[144:147], a[88:91], v[64:67]
 s_waitcnt vmcnt(7)
 s_barrier
 ds_read_b64_tr_b16 a[84:85], v4 offset:24576
 s_add_u32 s78, s72, 1658880
 v_mfma_f32_16x16x32_bf16 v[92:95], a[152:155], v[172:175], v[104:107]
 v_mov_b32 v31, v29
 v_mfma_f32_16x16x32_bf16 v[68:71], v[148:151], a[88:91], v[68:71]
 s_waitcnt lgkmcnt(9)
 ds_read_b64_tr_b16 a[86:87], v4 offset:25088
 v_permlane16_swap_b32 v28, v30
 v_mfma_f32_16x16x32_bf16 v[72:75], v[144:147], a[92:95], v[72:75]
 s_add_u32 m0, s69, 61440
 ds_read_b64_tr_b16 a[88:89], v5 offset:24576
 buffer_load_dwordx4 v20, s[8:11], s78 offen  lds
 v_cvt_pk_bf16_f32 v172, v88, v89
 v_mfma_f32_16x16x32_bf16 v[76:79], v[148:151], a[92:95], v[76:79]
 s_waitcnt lgkmcnt(9)
 ds_read_b64_tr_b16 a[90:91], v5 offset:25088
 v_cvt_pk_bf16_f32 v173, v90, v91
 v_permlane16_swap_b32 v29, v31
 v_mfma_f32_16x16x32_bf16 v[48:51], v[152:155], a[96:99], v[48:51]
 ds_read_b64_tr_b16 a[92:93], v6 offset:24576
 v_cvt_pk_bf16_f32 v174, v92, v93
 v_add_f32 v28, v28, v30
 v_mfma_f32_16x16x32_bf16 v[52:55], v[156:159], a[96:99], v[52:55]
 s_waitcnt lgkmcnt(9)
 ds_read_b64_tr_b16 a[94:95], v6 offset:25088
 v_cvt_pk_bf16_f32 v175, v94, v95
 v_add_f32 v29, v29, v31
 v_mfma_f32_16x16x32_bf16 v[56:59], v[152:155], a[72:75], v[56:59]
 s_add_u32 s78, s72, 1769472
 ds_read_b64_tr_b16 a[96:97], v7 offset:24576
 v_mov_b32 v30, v28
 v_mfma_f32_16x16x32_bf16 v[96:99], a[148:151], v[180:183], v[104:107]
 v_mfma_f32_16x16x32_bf16 v[60:63], v[156:159], a[72:75], v[60:63]
 s_waitcnt lgkmcnt(9)
 ds_read_b64_tr_b16 a[98:99], v7 offset:25088
 v_mov_b32 v31, v29
 v_mfma_f32_16x16x32_bf16 v[64:67], v[152:155], a[76:79], v[64:67]
 s_add_u32 m0, s69, 65536
 ds_read_b64_tr_b16 a[72:73], v4 offset:28672
 buffer_load_dwordx4 v20, s[8:11], s78 offen  lds
 v_mfma_f32_16x16x32_bf16 v[100:103], a[152:155], v[180:183], v[104:107]
 v_permlane32_swap_b32 v28, v30
 v_mfma_f32_16x16x32_bf16 v[68:71], v[156:159], a[76:79], v[68:71]
 s_waitcnt lgkmcnt(9)
 ds_read_b64_tr_b16 a[74:75], v4 offset:29184
 v_permlane32_swap_b32 v29, v31
 v_mfma_f32_16x16x32_bf16 v[72:75], v[152:155], a[80:83], v[72:75]
 ds_read_b64_tr_b16 a[76:77], v5 offset:28672
 v_cvt_pk_bf16_f32 v180, v96, v97
 v_add_f32 v28, v28, v30
 v_mfma_f32_16x16x32_bf16 v[76:79], v[156:159], a[80:83], v[76:79]
 s_waitcnt lgkmcnt(9)
 ds_read_b64_tr_b16 a[78:79], v5 offset:29184
 v_cvt_pk_bf16_f32 v181, v98, v99
 v_add_f32 v29, v29, v31
 v_mfma_f32_16x16x32_bf16 v[48:51], v[160:163], a[84:87], v[48:51]
 s_add_u32 s78, s72, 1880064
 ds_read_b64_tr_b16 a[80:81], v6 offset:28672
 v_cvt_pk_bf16_f32 v182, v100, v101
 v_mul_f32 v28, 0x3ae38e39, v28
 v_mfma_f32_16x16x32_bf16 v[52:55], v[164:167], a[84:87], v[52:55]
 s_waitcnt lgkmcnt(9)
 ds_read_b64_tr_b16 a[82:83], v6 offset:29184
 v_cvt_pk_bf16_f32 v183, v102, v103
 v_fma_f32 v28, -v32, v32, v28
 v_mfma_f32_16x16x32_bf16 v[56:59], v[160:163], a[88:91], v[56:59]
 s_add_u32 m0, s69, 69632
 ds_read_b64_tr_b16 a[84:85], v7 offset:28672
 buffer_load_dwordx4 v20, s[8:11], s78 offen  lds
 v_mfma_f32_16x16x32_bf16 v[80:83], a[148:151], v[188:191], v[104:107]
 v_max_f32 v28, 0, v28
 v_mfma_f32_16x16x32_bf16 v[60:63], v[164:167], a[88:91], v[60:63]
 s_waitcnt lgkmcnt(9)
 ds_read_b64_tr_b16 a[86:87], v7 offset:29184
 v_cvt_pk_bf16_f32 v30, v28, v28
 v_mfma_f32_16x16x32_bf16 v[64:67], v[160:163], a[92:95], v[64:67]
 ds_read_b64_tr_b16 a[88:89], v4 offset:32768
 v_and_b32 v28, 0xffff0000, v30
 v_mfma_f32_16x16x32_bf16 v[84:87], a[152:155], v[188:191], v[104:107]
 v_mfma_f32_16x16x32_bf16 v[68:71], v[164:167], a[92:95], v[68:71]
 s_waitcnt lgkmcnt(9)
 ds_read_b64_tr_b16 a[90:91], v4 offset:33280
 v_add_f32 v28, 0x3727c5ac, v28
 v_mfma_f32_16x16x32_bf16 v[72:75], v[160:163], a[96:99], v[72:75]
 s_add_u32 s78, s73, 0
 ds_read_b64_tr_b16 a[92:93], v5 offset:32768
 v_cvt_pk_bf16_f32 v188, v80, v81
 v_cvt_pk_bf16_f32 v30, v28, v28
 v_mfma_f32_16x16x32_bf16 v[76:79], v[164:167], a[96:99], v[76:79]
 s_waitcnt lgkmcnt(9)
 ds_read_b64_tr_b16 a[94:95], v5 offset:33280
 v_cvt_pk_bf16_f32 v189, v82, v83
 v_lshlrev_b32 v28, 16, v30
 v_mfma_f32_16x16x32_bf16 v[48:51], v[168:171], a[72:75], v[48:51]
 s_add_u32 m0, s69, 73728
 ds_read_b64_tr_b16 a[96:97], v6 offset:32768
 buffer_load_dwordx4 v20, s[8:11], s78 offen  lds
 v_cvt_pk_bf16_f32 v190, v84, v85
 v_mfma_f32_16x16x32_bf16 v[52:55], v[172:175], a[72:75], v[52:55]
 s_waitcnt lgkmcnt(9)
 ds_read_b64_tr_b16 a[98:99], v6 offset:33280
 v_cvt_pk_bf16_f32 v191, v86, v87
 v_sqrt_f32 v28, v28
 v_mfma_f32_16x16x32_bf16 v[56:59], v[168:171], a[76:79], v[56:59]
 ds_read_b64_tr_b16 a[72:73], v7 offset:32768
 v_cvt_pk_bf16_f32 v30, v28, v28
 v_mfma_f32_16x16x32_bf16 v[88:91], a[148:151], v[196:199], v[104:107]
 v_mfma_f32_16x16x32_bf16 v[60:63], v[172:175], a[76:79], v[60:63]
 s_waitcnt lgkmcnt(9)
 ds_read_b64_tr_b16 a[74:75], v7 offset:33280
 v_lshlrev_b32 v28, 16, v30
 v_mfma_f32_16x16x32_bf16 v[64:67], v[168:171], a[80:83], v[64:67]
 s_waitcnt vmcnt(7)
 s_barrier
 ds_read_b64_tr_b16 a[76:77], v4 offset:36864
 s_add_u32 s78, s73, 110592
 v_mfma_f32_16x16x32_bf16 v[92:95], a[152:155], v[196:199], v[104:107]
 v_rcp_f32 v28, v28
 v_mfma_f32_16x16x32_bf16 v[68:71], v[172:175], a[80:83], v[68:71]
 s_waitcnt lgkmcnt(9)
 ds_read_b64_tr_b16 a[78:79], v4 offset:37376
 v_mul_f32 v30, v28, v28
 v_mfma_f32_16x16x32_bf16 v[72:75], v[168:171], a[84:87], v[72:75]
 s_add_u32 m0, s69, 77824
 ds_read_b64_tr_b16 a[80:81], v5 offset:36864
 buffer_load_dwordx4 v20, s[8:11], s78 offen  lds
 v_cvt_pk_bf16_f32 v196, v88, v89
 v_mfma_f32_16x16x32_bf16 v[76:79], v[172:175], a[84:87], v[76:79]
 s_waitcnt lgkmcnt(9)
 ds_read_b64_tr_b16 a[82:83], v5 offset:37376
 v_cvt_pk_bf16_f32 v197, v90, v91
 v_mul_f32 v32, s82, v28
 v_mfma_f32_16x16x32_bf16 v[48:51], v[176:179], a[88:91], v[48:51]
 ds_read_b64_tr_b16 a[84:85], v6 offset:36864
 v_cvt_pk_bf16_f32 v198, v92, v93
 v_mul_f32 v29, 0x3ae38e39, v29
 v_mfma_f32_16x16x32_bf16 v[52:55], v[180:183], a[88:91], v[52:55]
 s_waitcnt lgkmcnt(9)
 ds_read_b64_tr_b16 a[86:87], v6 offset:37376
 v_cvt_pk_bf16_f32 v199, v94, v95
 v_fma_f32 v29, -v33, v33, v29
 v_mfma_f32_16x16x32_bf16 v[56:59], v[176:179], a[92:95], v[56:59]
 s_add_u32 s78, s73, 221184
 ds_read_b64_tr_b16 a[88:89], v7 offset:36864
 v_max_f32 v29, 0, v29
 v_mfma_f32_16x16x32_bf16 v[96:99], a[148:151], v[204:207], v[104:107]
 v_mfma_f32_16x16x32_bf16 v[60:63], v[180:183], a[92:95], v[60:63]
 s_waitcnt lgkmcnt(9)
 ds_read_b64_tr_b16 a[90:91], v7 offset:37376
 v_cvt_pk_bf16_f32 v31, v29, v29
 v_mfma_f32_16x16x32_bf16 v[64:67], v[176:179], a[96:99], v[64:67]
 s_add_u32 m0, s69, 81920
 ds_read_b64_tr_b16 a[92:93], v4 offset:40960
 buffer_load_dwordx4 v20, s[8:11], s78 offen  lds
 v_mfma_f32_16x16x32_bf16 v[100:103], a[152:155], v[204:207], v[104:107]
 v_and_b32 v29, 0xffff0000, v31
 v_mfma_f32_16x16x32_bf16 v[68:71], v[180:183], a[96:99], v[68:71]
 s_waitcnt lgkmcnt(9)
 ds_read_b64_tr_b16 a[94:95], v4 offset:41472
 v_add_f32 v29, 0x3727c5ac, v29
 v_mfma_f32_16x16x32_bf16 v[72:75], v[176:179], a[72:75], v[72:75]
 ds_read_b64_tr_b16 a[96:97], v5 offset:40960
 v_cvt_pk_bf16_f32 v204, v96, v97
 v_cvt_pk_bf16_f32 v31, v29, v29
 v_mfma_f32_16x16x32_bf16 v[76:79], v[180:183], a[72:75], v[76:79]
 s_waitcnt lgkmcnt(9)
 ds_read_b64_tr_b16 a[98:99], v5 offset:41472
 v_cvt_pk_bf16_f32 v205, v98, v99
 v_lshlrev_b32 v29, 16, v31
 v_mfma_f32_16x16x32_bf16 v[48:51], v[184:187], a[76:79], v[48:51]
 s_add_u32 s78, s73, 331776
 ds_read_b64_tr_b16 a[72:73], v6 offset:40960
 buffer_load_dword a157, v3, s[20:23], s74 offen offset:0
 v_cvt_pk_bf16_f32 v206, v100, v101
 v_mfma_f32_16x16x32_bf16 v[52:55], v[188:191], a[76:79], v[52:55]
 s_waitcnt lgkmcnt(9)
 ds_read_b64_tr_b16 a[74:75], v6 offset:41472
 v_cvt_pk_bf16_f32 v207, v102, v103
 v_sqrt_f32 v29, v29
 v_mfma_f32_16x16x32_bf16 v[56:59], v[184:187], a[80:83], v[56:59]
 ds_read_b64_tr_b16 a[76:77], v7 offset:40960
 buffer_load_dword a158, v3, s[16:19], s74 offen offset:128
 v_mfma_f32_16x16x32_bf16 v[80:83], a[148:151], v[212:215], v[104:107]
 v_cvt_pk_bf16_f32 v31, v29, v29
 v_mfma_f32_16x16x32_bf16 v[60:63], v[188:191], a[80:83], v[60:63]
 s_waitcnt lgkmcnt(9)
 ds_read_b64_tr_b16 a[78:79], v7 offset:41472
 v_lshlrev_b32 v29, 16, v31
 v_mfma_f32_16x16x32_bf16 v[64:67], v[184:187], a[84:87], v[64:67]
 ds_read_b64_tr_b16 a[80:81], v4 offset:45056
 buffer_load_dword a159, v3, s[20:23], s74 offen offset:128
 v_mfma_f32_16x16x32_bf16 v[84:87], a[152:155], v[212:215], v[104:107]
 v_rcp_f32 v29, v29
 v_mfma_f32_16x16x32_bf16 v[68:71], v[188:191], a[84:87], v[68:71]
 s_waitcnt lgkmcnt(9)
 ds_read_b64_tr_b16 a[82:83], v4 offset:45568
 v_mul_f32 v31, v29, v29
 v_mfma_f32_16x16x32_bf16 v[72:75], v[184:187], a[88:91], v[72:75]
 s_add_u32 m0, s69, 86016
 ds_read_b64_tr_b16 a[84:85], v5 offset:45056
 buffer_load_dwordx4 v20, s[8:11], s78 offen  lds
 v_cvt_pk_bf16_f32 v212, v80, v81
 v_mfma_f32_16x16x32_bf16 v[76:79], v[188:191], a[88:91], v[76:79]
 s_waitcnt lgkmcnt(9)
 ds_read_b64_tr_b16 a[86:87], v5 offset:45568
 v_cvt_pk_bf16_f32 v213, v82, v83
 v_mul_f32 v33, s82, v29
 v_mfma_f32_16x16x32_bf16 v[48:51], v[192:195], a[92:95], v[48:51]
 s_add_u32 s78, s73, 442368
 ds_read_b64_tr_b16 a[88:89], v6 offset:45056
 v_cvt_pk_bf16_f32 v214, v84, v85
 s_mul_i32 s48, s70, 304128
 v_mfma_f32_16x16x32_bf16 v[52:55], v[196:199], a[92:95], v[52:55]
 s_waitcnt lgkmcnt(9)
 ds_read_b64_tr_b16 a[90:91], v6 offset:45568
 v_cvt_pk_bf16_f32 v215, v86, v87
 s_add_u32 s83, s48, 2424832
 v_mfma_f32_16x16x32_bf16 v[56:59], v[192:195], a[96:99], v[56:59]
 s_add_u32 m0, s69, 90112
 ds_read_b64_tr_b16 a[92:93], v7 offset:45056
 buffer_load_dwordx4 v20, s[8:11], s78 offen  lds
 v_mfma_f32_16x16x32_bf16 v[88:91], a[148:151], v[220:223], v[104:107]
 s_mul_i32 s49, s70, 147456
 v_mfma_f32_16x16x32_bf16 v[60:63], v[196:199], a[96:99], v[60:63]
 s_waitcnt lgkmcnt(9)
 ds_read_b64_tr_b16 a[94:95], v7 offset:45568
 s_add_u32 s90, s49, 65536
 v_lshlrev_b32 v45, 4, v2
 v_mfma_f32_16x16x32_bf16 v[64:67], v[192:195], a[72:75], v[64:67]
 s_waitcnt vmcnt(8)
 s_barrier
 ds_read_b64_tr_b16 a[96:97], v4 offset:49152
 ds_bpermute_b32 v34, v45, v28 offset:0
 v_mfma_f32_16x16x32_bf16 v[92:95], a[152:155], v[220:223], v[104:107]
 s_sub_u32 s50, s71, 9
 v_mfma_f32_16x16x32_bf16 v[68:71], v[196:199], a[72:75], v[68:71]
 s_waitcnt lgkmcnt(10)
 ds_read_b64_tr_b16 a[98:99], v4 offset:49664
 s_add_u32 s78, s73, 552960
 s_cmp_lt_u32 s71, 9
 s_cselect_b32 s84, s90, s83
 s_cselect_b32 s49, s71, s50
 v_mfma_f32_16x16x32_bf16 v[72:75], v[192:195], a[76:79], v[72:75]
 s_add_u32 m0, s69, 94208
 ds_read_b64_tr_b16 a[72:73], v5 offset:49152
 buffer_load_dwordx4 v20, s[8:11], s78 offen  lds
 v_cvt_pk_bf16_f32 v220, v88, v89
 v_mfma_f32_16x16x32_bf16 v[76:79], v[196:199], a[76:79], v[76:79]
 s_waitcnt lgkmcnt(10)
 ds_read_b64_tr_b16 a[74:75], v5 offset:49664
 v_cvt_pk_bf16_f32 v221, v90, v91
 s_lshl_b32 s49, s49, 12
 v_mfma_f32_16x16x32_bf16 v[48:51], v[200:203], a[80:83], v[48:51]
 ds_read_b64_tr_b16 a[76:77], v6 offset:49152
 v_cvt_pk_bf16_f32 v222, v92, v93
 s_mul_i32 s48, s68, 36864
 v_mfma_f32_16x16x32_bf16 v[52:55], v[204:207], a[80:83], v[52:55]
 s_waitcnt lgkmcnt(10)
 ds_read_b64_tr_b16 a[78:79], v6 offset:49664
 v_cvt_pk_bf16_f32 v223, v94, v95
 s_add_u32 s49, s49, s48
 v_mfma_f32_16x16x32_bf16 v[56:59], v[200:203], a[84:87], v[56:59]
 ds_read_b64_tr_b16 a[80:81], v7 offset:49152
 ds_bpermute_b32 v35, v45, v28 offset:4
 v_mfma_f32_16x16x32_bf16 v[96:99], a[148:151], v[228:231], v[104:107]
 v_lshlrev_b32 v42, 8, v2
 v_mfma_f32_16x16x32_bf16 v[60:63], v[204:207], a[84:87], v[60:63]
 s_waitcnt lgkmcnt(11)
 ds_read_b64_tr_b16 a[82:83], v7 offset:49664
 s_add_u32 s78, s73, 663552
 v_lshl_add_u32 v42, v1, 4, v42
 v_mfma_f32_16x16x32_bf16 v[64:67], v[200:203], a[88:91], v[64:67]
 s_add_u32 m0, s69, 98304
 ds_read_b64_tr_b16 a[84:85], v4 offset:53248
 buffer_load_dwordx4 v20, s[8:11], s78 offen  lds
 v_mfma_f32_16x16x32_bf16 v[100:103], a[152:155], v[228:231], v[104:107]
 v_add_u32 v27, s49, v42
 v_mfma_f32_16x16x32_bf16 v[68:71], v[204:207], a[88:91], v[68:71]
 s_waitcnt lgkmcnt(11)
 ds_read_b64_tr_b16 a[86:87], v4 offset:53760
 s_sub_u32 s49, s71, 2
 v_mfma_f32_16x16x32_bf16 v[72:75], v[200:203], a[92:95], v[72:75]
 ds_read_b64_tr_b16 a[88:89], v5 offset:53248
 v_cvt_pk_bf16_f32 v228, v96, v97
 s_lshl_b32 s49, s49, 12
 v_mfma_f32_16x16x32_bf16 v[76:79], v[204:207], a[92:95], v[76:79]
 s_waitcnt lgkmcnt(10)
 ds_read_b64_tr_b16 a[90:91], v5 offset:53760
 v_cvt_pk_bf16_f32 v229, v98, v99
 s_add_u32 s49, s49, s48
 v_mfma_f32_16x16x32_bf16 v[48:51], v[208:211], a[96:99], v[48:51]
 ds_read_b64_tr_b16 a[92:93], v6 offset:53248
 v_cvt_pk_bf16_f32 v230, v100, v101
 v_add_u32 v42, s49, v42
 v_mfma_f32_16x16x32_bf16 v[52:55], v[212:215], a[96:99], v[52:55]
 s_waitcnt lgkmcnt(10)
 ds_read_b64_tr_b16 a[94:95], v6 offset:53760
 v_cvt_pk_bf16_f32 v231, v102, v103
 s_lshl_b32 s49, s71, 10
 v_mfma_f32_16x16x32_bf16 v[56:59], v[208:211], a[72:75], v[56:59]
 s_add_u32 s78, s73, 774144
 ds_read_b64_tr_b16 a[96:97], v7 offset:53248
 ds_bpermute_b32 v36, v45, v28 offset:8
 v_mfma_f32_16x16x32_bf16 v[80:83], a[148:151], v[236:239], v[104:107]
 s_add_u32 s49, s49, s48
 v_mfma_f32_16x16x32_bf16 v[60:63], v[212:215], a[72:75], v[60:63]
 s_waitcnt lgkmcnt(11)
 ds_read_b64_tr_b16 a[98:99], v7 offset:53760
 s_add_u32 s49, s49, 147456
 v_mfma_f32_16x16x32_bf16 v[64:67], v[208:211], a[76:79], v[64:67]
 s_add_u32 m0, s69, 102400
 ds_read_b64_tr_b16 a[72:73], v4 offset:57344
 buffer_load_dwordx4 v20, s[8:11], s78 offen  lds
 v_mfma_f32_16x16x32_bf16 v[84:87], a[152:155], v[236:239], v[104:107]
 v_mul_u32_u24 v43, 9216, v2
 v_mfma_f32_16x16x32_bf16 v[68:71], v[212:215], a[76:79], v[68:71]
 s_waitcnt lgkmcnt(10)
 ds_read_b64_tr_b16 a[74:75], v4 offset:57856
 v_lshl_add_u32 v43, v1, 4, v43
 v_mfma_f32_16x16x32_bf16 v[72:75], v[208:211], a[80:83], v[72:75]
 ds_read_b64_tr_b16 a[76:77], v5 offset:57344
 v_cvt_pk_bf16_f32 v236, v80, v81
 v_add_u32 v43, s49, v43
 v_mfma_f32_16x16x32_bf16 v[76:79], v[212:215], a[80:83], v[76:79]
 s_waitcnt lgkmcnt(10)
 ds_read_b64_tr_b16 a[78:79], v5 offset:57856
 v_cvt_pk_bf16_f32 v237, v82, v83
 v_mov_b32 v44, s71
 v_mfma_f32_16x16x32_bf16 v[48:51], v[216:219], a[84:87], v[48:51]
 s_add_u32 s78, s73, 884736
 ds_read_b64_tr_b16 a[80:81], v6 offset:57344
 v_cvt_pk_bf16_f32 v238, v84, v85
 v_cmp_gt_u32 vcc, 9, v44
 v_mfma_f32_16x16x32_bf16 v[52:55], v[220:223], a[84:87], v[52:55]
 s_waitcnt lgkmcnt(10)
 ds_read_b64_tr_b16 a[82:83], v6 offset:57856
 v_cvt_pk_bf16_f32 v239, v86, v87
 v_cndmask_b32 v26, v42, v43, vcc
 v_mfma_f32_16x16x32_bf16 v[56:59], v[216:219], a[88:91], v[56:59]
 s_add_u32 m0, s69, 106496
 ds_read_b64_tr_b16 a[84:85], v7 offset:57344
 buffer_load_dwordx4 v20, s[8:11], s78 offen  lds
 v_mfma_f32_16x16x32_bf16 v[88:91], a[148:151], v[244:247], v[104:107]
 ds_bpermute_b32 v37, v45, v28 offset:12
 v_mfma_f32_16x16x32_bf16 v[60:63], v[220:223], a[88:91], v[60:63]
 s_waitcnt lgkmcnt(11)
 ds_read_b64_tr_b16 a[86:87], v7 offset:57856
 v_mfma_f32_16x16x32_bf16 v[64:67], v[216:219], a[92:95], v[64:67]
 ds_read_b64_tr_b16 a[88:89], v4 offset:61440
 v_mfma_f32_16x16x32_bf16 v[92:95], a[152:155], v[244:247], v[104:107]
 v_mfma_f32_16x16x32_bf16 v[68:71], v[220:223], a[92:95], v[68:71]
 s_waitcnt lgkmcnt(10)
 ds_read_b64_tr_b16 a[90:91], v4 offset:61952
 s_add_u32 s78, s73, 995328
 v_mfma_f32_16x16x32_bf16 v[72:75], v[216:219], a[96:99], v[72:75]
 s_add_u32 m0, s69, 110592
 ds_read_b64_tr_b16 a[92:93], v5 offset:61440
 buffer_load_dwordx4 v20, s[8:11], s78 offen  lds
 v_cvt_pk_bf16_f32 v244, v88, v89
 v_mfma_f32_16x16x32_bf16 v[76:79], v[220:223], a[96:99], v[76:79]
 s_waitcnt lgkmcnt(10)
 ds_read_b64_tr_b16 a[94:95], v5 offset:61952
 v_cvt_pk_bf16_f32 v245, v90, v91
 v_mfma_f32_16x16x32_bf16 v[48:51], v[224:227], a[72:75], v[48:51]
 ds_read_b64_tr_b16 a[96:97], v6 offset:61440
 ds_bpermute_b32 v38, v45, v29 offset:0
 v_cvt_pk_bf16_f32 v246, v92, v93
 v_mfma_f32_16x16x32_bf16 v[52:55], v[228:231], a[72:75], v[52:55]
 s_waitcnt lgkmcnt(11)
 ds_read_b64_tr_b16 a[98:99], v6 offset:61952
 v_cvt_pk_bf16_f32 v247, v94, v95
 v_mfma_f32_16x16x32_bf16 v[56:59], v[224:227], a[76:79], v[56:59]
 ds_read_b64_tr_b16 a[72:73], v7 offset:61440
 v_mfma_f32_16x16x32_bf16 v[96:99], a[148:151], v[252:255], v[104:107]
 v_mfma_f32_16x16x32_bf16 v[60:63], v[228:231], a[76:79], v[60:63]
 s_waitcnt lgkmcnt(11)
 ds_read_b64_tr_b16 a[74:75], v7 offset:61952
 s_add_u32 s78, s73, 1105920
 v_mfma_f32_16x16x32_bf16 v[64:67], v[224:227], a[80:83], v[64:67]
 s_add_u32 m0, s69, 114688
 ds_read_b64_tr_b16 a[76:77], v8 offset:0
 buffer_load_dwordx4 v20, s[8:11], s78 offen  lds
 v_mfma_f32_16x16x32_bf16 v[100:103], a[152:155], v[252:255], v[104:107]
 v_mfma_f32_16x16x32_bf16 v[68:71], v[228:231], a[80:83], v[68:71]
 s_waitcnt lgkmcnt(10)
 ds_read_b64_tr_b16 a[78:79], v8 offset:512
 v_mfma_f32_16x16x32_bf16 v[72:75], v[224:227], a[84:87], v[72:75]
 ds_read_b64_tr_b16 a[80:81], v9 offset:0
 ds_bpermute_b32 v39, v45, v29 offset:4
 v_cvt_pk_bf16_f32 v252, v96, v97
 v_mfma_f32_16x16x32_bf16 v[76:79], v[228:231], a[84:87], v[76:79]
 s_waitcnt lgkmcnt(11)
 ds_read_b64_tr_b16 a[82:83], v9 offset:512
 v_cvt_pk_bf16_f32 v253, v98, v99
 v_mfma_f32_16x16x32_bf16 v[48:51], v[232:235], a[88:91], v[48:51]
 ds_read_b64_tr_b16 a[84:85], v10 offset:0
 v_cvt_pk_bf16_f32 v254, v100, v101
 v_mfma_f32_16x16x32_bf16 v[52:55], v[236:239], a[88:91], v[52:55]
 s_waitcnt lgkmcnt(11)
 ds_read_b64_tr_b16 a[86:87], v10 offset:512
 v_cvt_pk_bf16_f32 v255, v102, v103
 v_mfma_f32_16x16x32_bf16 v[56:59], v[232:235], a[92:95], v[56:59]
 s_add_u32 s78, s73, 1216512
 ds_read_b64_tr_b16 a[88:89], v11 offset:0
 v_mfma_f32_16x16x32_bf16 v[60:63], v[236:239], a[92:95], v[60:63]
 s_waitcnt lgkmcnt(10)
 ds_read_b64_tr_b16 a[90:91], v11 offset:512
 v_mfma_f32_16x16x32_bf16 v[64:67], v[232:235], a[96:99], v[64:67]
 s_add_u32 m0, s69, 118784
 ds_read_b64_tr_b16 a[92:93], v8 offset:4096
 buffer_load_dwordx4 v20, s[8:11], s78 offen  lds
 ds_bpermute_b32 v40, v45, v29 offset:8
 v_mfma_f32_16x16x32_bf16 v[68:71], v[236:239], a[96:99], v[68:71]
 s_waitcnt lgkmcnt(11)
 ds_read_b64_tr_b16 a[94:95], v8 offset:4608
 v_mfma_f32_16x16x32_bf16 v[72:75], v[232:235], a[72:75], v[72:75]
 ds_read_b64_tr_b16 a[96:97], v9 offset:4096
 v_mfma_f32_16x16x32_bf16 v[76:79], v[236:239], a[72:75], v[76:79]
 s_waitcnt lgkmcnt(11)
 ds_read_b64_tr_b16 a[98:99], v9 offset:4608
 s_add_u32 s78, s73, 1327104
 v_mfma_f32_16x16x32_bf16 v[48:51], v[240:243], a[76:79], v[48:51]
 s_add_u32 m0, s69, 122880
 ds_read_b64_tr_b16 a[72:73], v10 offset:4096
 buffer_load_dwordx4 v20, s[8:11], s78 offen  lds
 v_mfma_f32_16x16x32_bf16 v[52:55], v[244:247], a[76:79], v[52:55]
 s_waitcnt lgkmcnt(10)
 ds_read_b64_tr_b16 a[74:75], v10 offset:4608
 v_mfma_f32_16x16x32_bf16 v[56:59], v[240:243], a[80:83], v[56:59]
 ds_read_b64_tr_b16 a[76:77], v11 offset:4096
 ds_bpermute_b32 v41, v45, v29 offset:12
 v_mfma_f32_16x16x32_bf16 v[60:63], v[244:247], a[80:83], v[60:63]
 s_waitcnt lgkmcnt(11)
 ds_read_b64_tr_b16 a[78:79], v11 offset:4608
 v_mfma_f32_16x16x32_bf16 v[64:67], v[240:243], a[84:87], v[64:67]
 s_waitcnt vmcnt(7)
 s_barrier
 ds_read_b64_tr_b16 a[80:81], v8 offset:8192
 v_mfma_f32_16x16x32_bf16 v[68:71], v[244:247], a[84:87], v[68:71]
 s_waitcnt lgkmcnt(11)
 ds_read_b64_tr_b16 a[82:83], v8 offset:8704
 s_add_u32 s78, s73, 1437696
 v_mfma_f32_16x16x32_bf16 v[72:75], v[240:243], a[88:91], v[72:75]
 s_add_u32 m0, s69, 126976
 ds_read_b64_tr_b16 a[84:85], v9 offset:8192
 buffer_load_dwordx4 v20, s[8:11], s78 offen  lds
 v_mfma_f32_16x16x32_bf16 v[76:79], v[244:247], a[88:91], v[76:79]
 s_waitcnt lgkmcnt(10)
 ds_read_b64_tr_b16 a[86:87], v9 offset:8704
 v_mfma_f32_16x16x32_bf16 v[48:51], v[248:251], a[92:95], v[48:51]
 ds_read_b64_tr_b16 a[88:89], v10 offset:8192
 v_mfma_f32_16x16x32_bf16 v[52:55], v[252:255], a[92:95], v[52:55]
 s_waitcnt lgkmcnt(10)
 ds_read_b64_tr_b16 a[90:91], v10 offset:8704
 v_mfma_f32_16x16x32_bf16 v[56:59], v[248:251], a[96:99], v[56:59]
 ds_read_b64_tr_b16 a[92:93], v11 offset:8192
 v_mfma_f32_16x16x32_bf16 v[60:63], v[252:255], a[96:99], v[60:63]
 s_waitcnt lgkmcnt(10)
 ds_read_b64_tr_b16 a[94:95], v11 offset:8704
 s_add_u32 s78, s73, 1548288
 v_mfma_f32_16x16x32_bf16 v[64:67], v[248:251], a[72:75], v[64:67]
 s_add_u32 m0, s69, 131072
 ds_read_b64_tr_b16 a[96:97], v8 offset:12288
 buffer_load_dwordx4 v20, s[8:11], s78 offen  lds
 v_mfma_f32_16x16x32_bf16 v[68:71], v[252:255], a[72:75], v[68:71]
 s_waitcnt lgkmcnt(9)
 ds_read_b64_tr_b16 a[98:99], v8 offset:12800
 v_mfma_f32_16x16x32_bf16 v[72:75], v[248:251], a[76:79], v[72:75]
 ds_read_b64_tr_b16 a[72:73], v9 offset:12288
 v_mfma_f32_16x16x32_bf16 v[76:79], v[252:255], a[76:79], v[76:79]
 s_waitcnt lgkmcnt(9)
 ds_read_b64_tr_b16 a[74:75], v9 offset:12800
 v_mfma_f32_16x16x32_bf16 v[80:83], a[80:83], v[112:115], 0
 ds_read_b64_tr_b16 a[76:77], v10 offset:12288
 v_mfma_f32_16x16x32_bf16 v[84:87], a[80:83], v[116:119], 0
 s_waitcnt lgkmcnt(9)
 ds_read_b64_tr_b16 a[78:79], v10 offset:12800
 s_add_u32 s78, s73, 1658880
 v_mfma_f32_16x16x32_bf16 v[88:91], a[84:87], v[112:115], 0
 s_add_u32 m0, s69, 135168
 ds_read_b64_tr_b16 a[80:81], v11 offset:12288
 buffer_load_dwordx4 v20, s[8:11], s78 offen  lds
 v_mfma_f32_16x16x32_bf16 v[92:95], a[84:87], v[116:119], 0
 s_waitcnt lgkmcnt(9)
 ds_read_b64_tr_b16 a[82:83], v11 offset:12800
 v_mfma_f32_16x16x32_bf16 v[96:99], a[88:91], v[112:115], 0
 ds_read_b64_tr_b16 a[84:85], v8 offset:16384
 v_mfma_f32_16x16x32_bf16 v[100:103], a[88:91], v[116:119], 0
 s_waitcnt lgkmcnt(9)
 ds_read_b64_tr_b16 a[86:87], v8 offset:16896
 v_mfma_f32_16x16x32_bf16 v[104:107], a[92:95], v[112:115], 0
 ds_read_b64_tr_b16 a[88:89], v9 offset:16384
 v_mul_f32 v48, v34, v48
 v_mfma_f32_16x16x32_bf16 v[108:111], a[92:95], v[116:119], 0
 s_waitcnt lgkmcnt(9)
 ds_read_b64_tr_b16 a[90:91], v9 offset:16896
 s_add_u32 s78, s73, 1769472
 v_mfma_f32_16x16x32_bf16 v[80:83], a[96:99], v[120:123], v[80:83]
 s_add_u32 m0, s69, 139264
 ds_read_b64_tr_b16 a[92:93], v10 offset:16384
 buffer_load_dwordx4 v20, s[8:11], s78 offen  lds
 v_mfma_f32_16x16x32_bf16 v[84:87], a[96:99], v[124:127], v[84:87]
 s_waitcnt lgkmcnt(9)
 ds_read_b64_tr_b16 a[94:95], v10 offset:16896
 v_mul_f32 v49, v35, v49
 v_mfma_f32_16x16x32_bf16 v[88:91], a[72:75], v[120:123], v[88:91]
 ds_read_b64_tr_b16 a[96:97], v11 offset:16384
 v_mul_f32 v50, v36, v50
 v_mfma_f32_16x16x32_bf16 v[92:95], a[72:75], v[124:127], v[92:95]
 s_waitcnt lgkmcnt(9)
 ds_read_b64_tr_b16 a[98:99], v11 offset:16896
 v_mul_f32 v51, v37, v51
 v_mfma_f32_16x16x32_bf16 v[96:99], a[76:79], v[120:123], v[96:99]
 ds_read_b64_tr_b16 a[72:73], v8 offset:20480
 v_mul_f32 v52, v38, v52
 v_mfma_f32_16x16x32_bf16 v[100:103], a[76:79], v[124:127], v[100:103]
 s_waitcnt lgkmcnt(9)
 ds_read_b64_tr_b16 a[74:75], v8 offset:20992
 s_add_u32 s78, s73, 1880064
 v_mfma_f32_16x16x32_bf16 v[104:107], a[80:83], v[120:123], v[104:107]
 s_add_u32 m0, s69, 143360
 ds_read_b64_tr_b16 a[76:77], v9 offset:20480
 buffer_load_dwordx4 v20, s[8:11], s78 offen  lds
 v_mfma_f32_16x16x32_bf16 v[108:111], a[80:83], v[124:127], v[108:111]
 s_waitcnt lgkmcnt(9)
 ds_read_b64_tr_b16 a[78:79], v9 offset:20992
 v_mul_f32 v53, v39, v53
 v_mfma_f32_16x16x32_bf16 v[80:83], a[84:87], v[128:131], v[80:83]
 ds_read_b64_tr_b16 a[80:81], v10 offset:20480
 v_mul_f32 v54, v40, v54
 v_mfma_f32_16x16x32_bf16 v[84:87], a[84:87], v[132:135], v[84:87]
 s_waitcnt lgkmcnt(9)
 ds_read_b64_tr_b16 a[82:83], v10 offset:20992
 v_mul_f32 v55, v41, v55
 v_mfma_f32_16x16x32_bf16 v[88:91], a[88:91], v[128:131], v[88:91]
 ds_read_b64_tr_b16 a[84:85], v11 offset:20480
 v_cvt_pk_bf16_f32 v44, v48, v52
 v_mfma_f32_16x16x32_bf16 v[92:95], a[88:91], v[132:135], v[92:95]
 s_waitcnt lgkmcnt(9)
 ds_read_b64_tr_b16 a[86:87], v11 offset:20992
 s_add_u32 s78, s74, 0
 v_mfma_f32_16x16x32_bf16 v[96:99], a[92:95], v[128:131], v[96:99]
 s_add_u32 m0, s69, 0
 ds_read_b64_tr_b16 a[88:89], v8 offset:24576
 buffer_load_dwordx4 v21, s[16:19], s78 offen  lds
 v_mfma_f32_16x16x32_bf16 v[100:103], a[92:95], v[132:135], v[100:103]
 s_waitcnt lgkmcnt(9)
 ds_read_b64_tr_b16 a[90:91], v8 offset:25088
 v_cvt_pk_bf16_f32 v45, v49, v53
 v_mfma_f32_16x16x32_bf16 v[104:107], a[96:99], v[128:131], v[104:107]
 ds_read_b64_tr_b16 a[92:93], v9 offset:24576
 v_cvt_pk_bf16_f32 v46, v50, v54
 v_mfma_f32_16x16x32_bf16 v[108:111], a[96:99], v[132:135], v[108:111]
 s_waitcnt lgkmcnt(9)
 ds_read_b64_tr_b16 a[94:95], v9 offset:25088
 v_cvt_pk_bf16_f32 v47, v51, v55
 v_mfma_f32_16x16x32_bf16 v[80:83], a[72:75], v[136:139], v[80:83]
 ds_read_b64_tr_b16 a[96:97], v10 offset:24576
 buffer_store_dwordx4 v[44:47], v26, s[36:39], s83 offen offset:0 sc1
 v_mfma_f32_16x16x32_bf16 v[84:87], a[72:75], v[140:143], v[84:87]
 s_waitcnt lgkmcnt(9)
 ds_read_b64_tr_b16 a[98:99], v10 offset:25088
 s_add_u32 s78, s74, 294912
 v_mfma_f32_16x16x32_bf16 v[88:91], a[76:79], v[136:139], v[88:91]
 s_add_u32 m0, s69, 4096
 ds_read_b64_tr_b16 a[72:73], v11 offset:24576
 buffer_load_dwordx4 v21, s[16:19], s78 offen  lds
 v_mfma_f32_16x16x32_bf16 v[92:95], a[76:79], v[140:143], v[92:95]
 s_waitcnt lgkmcnt(9)
 ds_read_b64_tr_b16 a[74:75], v11 offset:25088
 v_mul_f32 v56, v34, v56
 v_mfma_f32_16x16x32_bf16 v[96:99], a[80:83], v[136:139], v[96:99]
 ds_read_b64_tr_b16 a[76:77], v8 offset:28672
 v_mul_f32 v57, v35, v57
 v_mfma_f32_16x16x32_bf16 v[100:103], a[80:83], v[140:143], v[100:103]
 s_waitcnt lgkmcnt(9)
 ds_read_b64_tr_b16 a[78:79], v8 offset:29184
 v_mul_f32 v58, v36, v58
 v_mfma_f32_16x16x32_bf16 v[104:107], a[84:87], v[136:139], v[104:107]
 ds_read_b64_tr_b16 a[80:81], v9 offset:28672
 v_mul_f32 v59, v37, v59
 v_mfma_f32_16x16x32_bf16 v[108:111], a[84:87], v[140:143], v[108:111]
 s_waitcnt lgkmcnt(9)
 ds_read_b64_tr_b16 a[82:83], v9 offset:29184
 s_add_u32 s78, s74, 589824
 v_mfma_f32_16x16x32_bf16 v[80:83], a[88:91], v[144:147], v[80:83]
 s_add_u32 m0, s69, 8192
 ds_read_b64_tr_b16 a[84:85], v10 offset:28672
 buffer_load_dwordx4 v21, s[16:19], s78 offen  lds
 v_mfma_f32_16x16x32_bf16 v[84:87], a[88:91], v[148:151], v[84:87]
 s_waitcnt lgkmcnt(9)
 ds_read_b64_tr_b16 a[86:87], v10 offset:29184
 v_mul_f32 v60, v38, v60
 v_mfma_f32_16x16x32_bf16 v[88:91], a[92:95], v[144:147], v[88:91]
 ds_read_b64_tr_b16 a[88:89], v11 offset:28672
 v_mul_f32 v61, v39, v61
 v_mfma_f32_16x16x32_bf16 v[92:95], a[92:95], v[148:151], v[92:95]
 s_waitcnt lgkmcnt(9)
 ds_read_b64_tr_b16 a[90:91], v11 offset:29184
 v_mul_f32 v62, v40, v62
 v_mfma_f32_16x16x32_bf16 v[96:99], a[96:99], v[144:147], v[96:99]
 s_waitcnt vmcnt(10)
 s_barrier
 ds_read_b64_tr_b16 a[92:93], v8 offset:32768
 v_mul_f32 v63, v41, v63
 v_mfma_f32_16x16x32_bf16 v[100:103], a[96:99], v[148:151], v[100:103]
 s_waitcnt lgkmcnt(9)
 ds_read_b64_tr_b16 a[94:95], v8 offset:33280
 s_add_u32 s78, s74, 884736
 v_mfma_f32_16x16x32_bf16 v[104:107], a[72:75], v[144:147], v[104:107]
 s_add_u32 m0, s69, 12288
 ds_read_b64_tr_b16 a[96:97], v9 offset:32768
 buffer_load_dwordx4 v21, s[16:19], s78 offen  lds
 v_mfma_f32_16x16x32_bf16 v[108:111], a[72:75], v[148:151], v[108:111]
 s_waitcnt lgkmcnt(9)
 ds_read_b64_tr_b16 a[98:99], v9 offset:33280
 v_cvt_pk_bf16_f32 v44, v56, v60
 v_mfma_f32_16x16x32_bf16 v[80:83], a[76:79], v[152:155], v[80:83]
 ds_read_b64_tr_b16 a[72:73], v10 offset:32768
 v_cvt_pk_bf16_f32 v45, v57, v61
 v_mfma_f32_16x16x32_bf16 v[84:87], a[76:79], v[156:159], v[84:87]
 s_waitcnt lgkmcnt(9)
 ds_read_b64_tr_b16 a[74:75], v10 offset:33280
 v_cvt_pk_bf16_f32 v46, v58, v62
 v_mfma_f32_16x16x32_bf16 v[88:91], a[80:83], v[152:155], v[88:91]
 ds_read_b64_tr_b16 a[76:77], v11 offset:32768
 v_cvt_pk_bf16_f32 v47, v59, v63
 v_mfma_f32_16x16x32_bf16 v[92:95], a[80:83], v[156:159], v[92:95]
 s_waitcnt lgkmcnt(9)
 ds_read_b64_tr_b16 a[78:79], v11 offset:33280
 s_add_u32 s78, s74, 1179648
 v_mfma_f32_16x16x32_bf16 v[96:99], a[84:87], v[152:155], v[96:99]
 s_add_u32 m0, s69, 16384
 ds_read_b64_tr_b16 a[80:81], v8 offset:36864
 buffer_load_dwordx4 v21, s[16:19], s78 offen  lds
 v_mfma_f32_16x16x32_bf16 v[100:103], a[84:87], v[156:159], v[100:103]
 s_waitcnt lgkmcnt(9)
 ds_read_b64_tr_b16 a[82:83], v8 offset:37376
 buffer_store_dwordx4 v[44:47], v26, s[36:39], s83 offen offset:256 sc1
 v_mfma_f32_16x16x32_bf16 v[104:107], a[88:91], v[152:155], v[104:107]
 ds_read_b64_tr_b16 a[84:85], v9 offset:36864
 v_mul_f32 v64, v34, v64
 v_mfma_f32_16x16x32_bf16 v[108:111], a[88:91], v[156:159], v[108:111]
 s_waitcnt lgkmcnt(9)
 ds_read_b64_tr_b16 a[86:87], v9 offset:37376
 v_mul_f32 v65, v35, v65
 v_mfma_f32_16x16x32_bf16 v[80:83], a[92:95], v[160:163], v[80:83]
 ds_read_b64_tr_b16 a[88:89], v10 offset:36864
 v_mul_f32 v66, v36, v66
 v_mfma_f32_16x16x32_bf16 v[84:87], a[92:95], v[164:167], v[84:87]
 s_waitcnt lgkmcnt(9)
 ds_read_b64_tr_b16 a[90:91], v10 offset:37376
 s_add_u32 s78, s74, 1474560
 v_mfma_f32_16x16x32_bf16 v[88:91], a[96:99], v[160:163], v[88:91]
 s_add_u32 m0, s69, 20480
 ds_read_b64_tr_b16 a[92:93], v11 offset:36864
 buffer_load_dwordx4 v21, s[16:19], s78 offen  lds
 v_mfma_f32_16x16x32_bf16 v[92:95], a[96:99], v[164:167], v[92:95]
 s_waitcnt lgkmcnt(9)
 ds_read_b64_tr_b16 a[94:95], v11 offset:37376
 v_mul_f32 v67, v37, v67
 v_mfma_f32_16x16x32_bf16 v[96:99], a[72:75], v[160:163], v[96:99]
 ds_read_b64_tr_b16 a[96:97], v8 offset:40960
 v_mul_f32 v68, v38, v68
 v_mfma_f32_16x16x32_bf16 v[100:103], a[72:75], v[164:167], v[100:103]
 s_waitcnt lgkmcnt(9)
 ds_read_b64_tr_b16 a[98:99], v8 offset:41472
 v_mul_f32 v69, v39, v69
 v_mfma_f32_16x16x32_bf16 v[104:107], a[76:79], v[160:163], v[104:107]
 ds_read_b64_tr_b16 a[72:73], v9 offset:40960
 v_mul_f32 v70, v40, v70
 v_mfma_f32_16x16x32_bf16 v[108:111], a[76:79], v[164:167], v[108:111]
 s_waitcnt lgkmcnt(9)
 ds_read_b64_tr_b16 a[74:75], v9 offset:41472
 s_add_u32 s78, s74, 1769472
 v_mfma_f32_16x16x32_bf16 v[80:83], a[80:83], v[168:171], v[80:83]
 s_add_u32 m0, s69, 24576
 ds_read_b64_tr_b16 a[76:77], v10 offset:40960
 buffer_load_dwordx4 v21, s[16:19], s78 offen  lds
 v_mfma_f32_16x16x32_bf16 v[84:87], a[80:83], v[172:175], v[84:87]
 s_waitcnt lgkmcnt(9)
 ds_read_b64_tr_b16 a[78:79], v10 offset:41472
 v_mul_f32 v71, v41, v71
 v_mfma_f32_16x16x32_bf16 v[88:91], a[84:87], v[168:171], v[88:91]
 ds_read_b64_tr_b16 a[80:81], v11 offset:40960
 v_cvt_pk_bf16_f32 v44, v64, v68
 v_mfma_f32_16x16x32_bf16 v[92:95], a[84:87], v[172:175], v[92:95]
 s_waitcnt lgkmcnt(9)
 ds_read_b64_tr_b16 a[82:83], v11 offset:41472
 v_cvt_pk_bf16_f32 v45, v65, v69
 v_mfma_f32_16x16x32_bf16 v[96:99], a[88:91], v[168:171], v[96:99]
 ds_read_b64_tr_b16 a[84:85], v8 offset:45056
 v_cvt_pk_bf16_f32 v46, v66, v70
 v_mfma_f32_16x16x32_bf16 v[100:103], a[88:91], v[172:175], v[100:103]
 s_waitcnt lgkmcnt(9)
 ds_read_b64_tr_b16 a[86:87], v8 offset:45568
 s_add_u32 s78, s74, 2064384
 v_mfma_f32_16x16x32_bf16 v[104:107], a[92:95], v[168:171], v[104:107]
 s_add_u32 m0, s69, 28672
 ds_read_b64_tr_b16 a[88:89], v9 offset:45056
 buffer_load_dwordx4 v21, s[16:19], s78 offen  lds
 v_mfma_f32_16x16x32_bf16 v[108:111], a[92:95], v[172:175], v[108:111]
 s_waitcnt lgkmcnt(9)
 ds_read_b64_tr_b16 a[90:91], v9 offset:45568
 v_cvt_pk_bf16_f32 v47, v67, v71
 v_mfma_f32_16x16x32_bf16 v[80:83], a[96:99], v[176:179], v[80:83]
 ds_read_b64_tr_b16 a[92:93], v10 offset:45056
 buffer_store_dwordx4 v[44:47], v26, s[36:39], s83 offen offset:512 sc1
 v_mfma_f32_16x16x32_bf16 v[84:87], a[96:99], v[180:183], v[84:87]
 s_waitcnt lgkmcnt(9)
 ds_read_b64_tr_b16 a[94:95], v10 offset:45568
 v_mul_f32 v72, v34, v72
 v_mfma_f32_16x16x32_bf16 v[88:91], a[72:75], v[176:179], v[88:91]
 ds_read_b64_tr_b16 a[96:97], v11 offset:45056
 v_mul_f32 v73, v35, v73
 v_mfma_f32_16x16x32_bf16 v[92:95], a[72:75], v[180:183], v[92:95]
 s_waitcnt lgkmcnt(9)
 ds_read_b64_tr_b16 a[98:99], v11 offset:45568
 s_add_u32 s78, s74, 2359296
 v_mfma_f32_16x16x32_bf16 v[96:99], a[76:79], v[176:179], v[96:99]
 s_add_u32 m0, s69, 32768
 ds_read_b64_tr_b16 a[72:73], v8 offset:49152
 buffer_load_dwordx4 v21, s[16:19], s78 offen  lds
 v_mfma_f32_16x16x32_bf16 v[100:103], a[76:79], v[180:183], v[100:103]
 s_waitcnt lgkmcnt(9)
 ds_read_b64_tr_b16 a[74:75], v8 offset:49664
 v_mul_f32 v74, v36, v74
 v_mfma_f32_16x16x32_bf16 v[104:107], a[80:83], v[176:179], v[104:107]
 ds_read_b64_tr_b16 a[76:77], v9 offset:49152
 v_mul_f32 v75, v37, v75
 v_mfma_f32_16x16x32_bf16 v[108:111], a[80:83], v[180:183], v[108:111]
 s_waitcnt lgkmcnt(9)
 ds_read_b64_tr_b16 a[78:79], v9 offset:49664
 v_mul_f32 v76, v38, v76
 v_mfma_f32_16x16x32_bf16 v[80:83], a[84:87], v[184:187], v[80:83]
 ds_read_b64_tr_b16 a[80:81], v10 offset:49152
 v_mul_f32 v77, v39, v77
 v_mfma_f32_16x16x32_bf16 v[84:87], a[84:87], v[188:191], v[84:87]
 s_waitcnt lgkmcnt(9)
 ds_read_b64_tr_b16 a[82:83], v10 offset:49664
 s_add_u32 s78, s74, 2654208
 v_mfma_f32_16x16x32_bf16 v[88:91], a[88:91], v[184:187], v[88:91]
 s_add_u32 m0, s69, 36864
 ds_read_b64_tr_b16 a[84:85], v11 offset:49152
 buffer_load_dwordx4 v21, s[16:19], s78 offen  lds
 v_mfma_f32_16x16x32_bf16 v[92:95], a[88:91], v[188:191], v[92:95]
 s_waitcnt lgkmcnt(9)
 ds_read_b64_tr_b16 a[86:87], v11 offset:49664
 v_mul_f32 v78, v40, v78
 v_mfma_f32_16x16x32_bf16 v[96:99], a[92:95], v[184:187], v[96:99]
 ds_read_b64_tr_b16 a[88:89], v8 offset:53248
 v_mul_f32 v79, v41, v79
 v_mfma_f32_16x16x32_bf16 v[100:103], a[92:95], v[188:191], v[100:103]
 s_waitcnt lgkmcnt(9)
 ds_read_b64_tr_b16 a[90:91], v8 offset:53760
 v_cvt_pk_bf16_f32 v44, v72, v76
 v_mfma_f32_16x16x32_bf16 v[104:107], a[96:99], v[184:187], v[104:107]
 ds_read_b64_tr_b16 a[92:93], v9 offset:53248
 v_cvt_pk_bf16_f32 v45, v73, v77
 v_mfma_f32_16x16x32_bf16 v[108:111], a[96:99], v[188:191], v[108:111]
 s_waitcnt lgkmcnt(9)
 ds_read_b64_tr_b16 a[94:95], v9 offset:53760
 s_add_u32 s78, s74, 2949120
 v_mfma_f32_16x16x32_bf16 v[80:83], a[72:75], v[192:195], v[80:83]
 s_add_u32 m0, s69, 40960
 ds_read_b64_tr_b16 a[96:97], v10 offset:53248
 buffer_load_dwordx4 v21, s[16:19], s78 offen  lds
 v_mfma_f32_16x16x32_bf16 v[84:87], a[72:75], v[196:199], v[84:87]
 s_waitcnt lgkmcnt(9)
 ds_read_b64_tr_b16 a[98:99], v10 offset:53760
 v_cvt_pk_bf16_f32 v46, v74, v78
 v_mfma_f32_16x16x32_bf16 v[88:91], a[76:79], v[192:195], v[88:91]
 ds_read_b64_tr_b16 a[72:73], v11 offset:53248
 v_cvt_pk_bf16_f32 v47, v75, v79
 v_mfma_f32_16x16x32_bf16 v[92:95], a[76:79], v[196:199], v[92:95]
 s_waitcnt lgkmcnt(9)
 ds_read_b64_tr_b16 a[74:75], v11 offset:53760
 buffer_store_dwordx4 v[44:47], v26, s[36:39], s83 offen offset:768 sc1
 v_mfma_f32_16x16x32_bf16 v[96:99], a[80:83], v[192:195], v[96:99]
 s_waitcnt vmcnt(15)
 s_barrier
 ds_read_b64_tr_b16 a[76:77], v8 offset:57344
 v_mfma_f32_16x16x32_bf16 v[100:103], a[80:83], v[196:199], v[100:103]
 s_waitcnt lgkmcnt(9)
 ds_read_b64_tr_b16 a[78:79], v8 offset:57856
 s_add_u32 s78, s74, 3244032
 v_mfma_f32_16x16x32_bf16 v[104:107], a[84:87], v[192:195], v[104:107]
 s_add_u32 m0, s69, 45056
 ds_read_b64_tr_b16 a[80:81], v9 offset:57344
 buffer_load_dwordx4 v21, s[16:19], s78 offen  lds
 v_mfma_f32_16x16x32_bf16 v[108:111], a[84:87], v[196:199], v[108:111]
 s_waitcnt lgkmcnt(9)
 ds_read_b64_tr_b16 a[82:83], v9 offset:57856
 v_mfma_f32_16x16x32_bf16 v[80:83], a[88:91], v[200:203], v[80:83]
 ds_read_b64_tr_b16 a[84:85], v10 offset:57344
 v_mfma_f32_16x16x32_bf16 v[84:87], a[88:91], v[204:207], v[84:87]
 s_waitcnt lgkmcnt(9)
 ds_read_b64_tr_b16 a[86:87], v10 offset:57856
 v_mfma_f32_16x16x32_bf16 v[88:91], a[92:95], v[200:203], v[88:91]
 ds_read_b64_tr_b16 a[88:89], v11 offset:57344
 v_mfma_f32_16x16x32_bf16 v[92:95], a[92:95], v[204:207], v[92:95]
 s_waitcnt lgkmcnt(9)
 ds_read_b64_tr_b16 a[90:91], v11 offset:57856
 s_add_u32 s78, s74, 3538944
 v_mfma_f32_16x16x32_bf16 v[96:99], a[96:99], v[200:203], v[96:99]
 s_add_u32 m0, s69, 49152
 ds_read_b64_tr_b16 a[92:93], v8 offset:61440
 buffer_load_dwordx4 v21, s[16:19], s78 offen  lds
 v_mfma_f32_16x16x32_bf16 v[100:103], a[96:99], v[204:207], v[100:103]
 s_waitcnt lgkmcnt(9)
 ds_read_b64_tr_b16 a[94:95], v8 offset:61952
 v_mfma_f32_16x16x32_bf16 v[104:107], a[72:75], v[200:203], v[104:107]
 ds_read_b64_tr_b16 a[96:97], v9 offset:61440
 v_mfma_f32_16x16x32_bf16 v[108:111], a[72:75], v[204:207], v[108:111]
 s_waitcnt lgkmcnt(9)
 ds_read_b64_tr_b16 a[98:99], v9 offset:61952
 v_mfma_f32_16x16x32_bf16 v[80:83], a[76:79], v[208:211], v[80:83]
 ds_read_b64_tr_b16 a[72:73], v10 offset:61440
 v_mfma_f32_16x16x32_bf16 v[84:87], a[76:79], v[212:215], v[84:87]
 s_waitcnt lgkmcnt(9)
 ds_read_b64_tr_b16 a[74:75], v10 offset:61952
 s_add_u32 s78, s74, 3833856
 v_mfma_f32_16x16x32_bf16 v[88:91], a[80:83], v[208:211], v[88:91]
 s_add_u32 m0, s69, 53248
 ds_read_b64_tr_b16 a[76:77], v11 offset:61440
 buffer_load_dwordx4 v21, s[16:19], s78 offen  lds
 v_mfma_f32_16x16x32_bf16 v[92:95], a[80:83], v[212:215], v[92:95]
 s_waitcnt lgkmcnt(9)
 ds_read_b64_tr_b16 a[78:79], v11 offset:61952
 v_mfma_f32_16x16x32_bf16 v[96:99], a[84:87], v[208:211], v[96:99]
 ds_read_b64_tr_b16 a[80:81], v12 offset:0
 v_mfma_f32_16x16x32_bf16 v[100:103], a[84:87], v[212:215], v[100:103]
 s_waitcnt lgkmcnt(9)
 ds_read_b64_tr_b16 a[82:83], v12 offset:512
 v_mfma_f32_16x16x32_bf16 v[104:107], a[88:91], v[208:211], v[104:107]
 ds_read_b64_tr_b16 a[84:85], v13 offset:0
 v_mfma_f32_16x16x32_bf16 v[108:111], a[88:91], v[212:215], v[108:111]
 s_waitcnt lgkmcnt(9)
 ds_read_b64_tr_b16 a[86:87], v13 offset:512
 s_add_u32 s78, s74, 4128768
 v_mfma_f32_16x16x32_bf16 v[80:83], a[92:95], v[216:219], v[80:83]
 s_add_u32 m0, s69, 57344
 ds_read_b64_tr_b16 a[88:89], v14 offset:0
 buffer_load_dwordx4 v21, s[16:19], s78 offen  lds
 v_mfma_f32_16x16x32_bf16 v[84:87], a[92:95], v[220:223], v[84:87]
 s_waitcnt lgkmcnt(9)
 ds_read_b64_tr_b16 a[90:91], v14 offset:512
 v_mfma_f32_16x16x32_bf16 v[88:91], a[96:99], v[216:219], v[88:91]
 ds_read_b64_tr_b16 a[92:93], v15 offset:0
 v_mfma_f32_16x16x32_bf16 v[92:95], a[96:99], v[220:223], v[92:95]
 s_waitcnt lgkmcnt(9)
 ds_read_b64_tr_b16 a[94:95], v15 offset:512
 v_mfma_f32_16x16x32_bf16 v[96:99], a[72:75], v[216:219], v[96:99]
 ds_read_b64_tr_b16 a[96:97], v12 offset:4096
 v_mfma_f32_16x16x32_bf16 v[100:103], a[72:75], v[220:223], v[100:103]
 s_waitcnt lgkmcnt(9)
 ds_read_b64_tr_b16 a[98:99], v12 offset:4608
 s_add_u32 s78, s74, 4423680
 v_mfma_f32_16x16x32_bf16 v[104:107], a[76:79], v[216:219], v[104:107]
 s_add_u32 m0, s69, 61440
 ds_read_b64_tr_b16 a[72:73], v13 offset:4096
 buffer_load_dwordx4 v21, s[16:19], s78 offen  lds
 v_mfma_f32_16x16x32_bf16 v[108:111], a[76:79], v[220:223], v[108:111]
 s_waitcnt lgkmcnt(9)
 ds_read_b64_tr_b16 a[74:75], v13 offset:4608
 v_mfma_f32_16x16x32_bf16 v[80:83], a[80:83], v[224:227], v[80:83]
 ds_read_b64_tr_b16 a[76:77], v14 offset:4096
 v_mfma_f32_16x16x32_bf16 v[84:87], a[80:83], v[228:231], v[84:87]
 s_waitcnt lgkmcnt(9)
 ds_read_b64_tr_b16 a[78:79], v14 offset:4608
 v_mfma_f32_16x16x32_bf16 v[88:91], a[84:87], v[224:227], v[88:91]
 ds_read_b64_tr_b16 a[80:81], v15 offset:4096
 v_mfma_f32_16x16x32_bf16 v[92:95], a[84:87], v[228:231], v[92:95]
 s_waitcnt lgkmcnt(9)
 ds_read_b64_tr_b16 a[82:83], v15 offset:4608
 s_add_u32 s78, s74, 4718592
 v_mfma_f32_16x16x32_bf16 v[96:99], a[88:91], v[224:227], v[96:99]
 s_add_u32 m0, s69, 65536
 ds_read_b64_tr_b16 a[84:85], v12 offset:8192
 buffer_load_dwordx4 v21, s[16:19], s78 offen  lds
 v_mfma_f32_16x16x32_bf16 v[100:103], a[88:91], v[228:231], v[100:103]
 s_waitcnt lgkmcnt(9)
 ds_read_b64_tr_b16 a[86:87], v12 offset:8704
 v_mfma_f32_16x16x32_bf16 v[104:107], a[92:95], v[224:227], v[104:107]
 ds_read_b64_tr_b16 a[88:89], v13 offset:8192
 v_mfma_f32_16x16x32_bf16 v[108:111], a[92:95], v[228:231], v[108:111]
 s_waitcnt lgkmcnt(9)
 ds_read_b64_tr_b16 a[90:91], v13 offset:8704
 v_mfma_f32_16x16x32_bf16 v[80:83], a[96:99], v[232:235], v[80:83]
 ds_read_b64_tr_b16 a[92:93], v14 offset:8192
 v_mfma_f32_16x16x32_bf16 v[84:87], a[96:99], v[236:239], v[84:87]
 s_waitcnt lgkmcnt(9)
 ds_read_b64_tr_b16 a[94:95], v14 offset:8704
 s_add_u32 s78, s74, 5013504
 v_mfma_f32_16x16x32_bf16 v[88:91], a[72:75], v[232:235], v[88:91]
 s_add_u32 m0, s69, 69632
 ds_read_b64_tr_b16 a[96:97], v15 offset:8192
 buffer_load_dwordx4 v21, s[16:19], s78 offen  lds
 v_mfma_f32_16x16x32_bf16 v[92:95], a[72:75], v[236:239], v[92:95]
 s_waitcnt lgkmcnt(9)
 ds_read_b64_tr_b16 a[98:99], v15 offset:8704
 v_mfma_f32_16x16x32_bf16 v[96:99], a[76:79], v[232:235], v[96:99]
 ds_read_b64_tr_b16 a[72:73], v12 offset:12288
 v_mfma_f32_16x16x32_bf16 v[100:103], a[76:79], v[236:239], v[100:103]
 s_waitcnt lgkmcnt(9)
 ds_read_b64_tr_b16 a[74:75], v12 offset:12800
 v_mfma_f32_16x16x32_bf16 v[104:107], a[80:83], v[232:235], v[104:107]
 ds_read_b64_tr_b16 a[76:77], v13 offset:12288
 v_mfma_f32_16x16x32_bf16 v[108:111], a[80:83], v[236:239], v[108:111]
 s_waitcnt lgkmcnt(9)
 ds_read_b64_tr_b16 a[78:79], v13 offset:12800
 s_add_u32 s78, s74, 0
 v_mfma_f32_16x16x32_bf16 v[80:83], a[84:87], v[240:243], v[80:83]
 s_add_u32 m0, s69, 73728
 ds_read_b64_tr_b16 a[80:81], v14 offset:12288
 buffer_load_dwordx4 v21, s[20:23], s78 offen  lds
 v_mfma_f32_16x16x32_bf16 v[84:87], a[84:87], v[244:247], v[84:87]
 s_waitcnt lgkmcnt(9)
 ds_read_b64_tr_b16 a[82:83], v14 offset:12800
 v_mfma_f32_16x16x32_bf16 v[88:91], a[88:91], v[240:243], v[88:91]
 ds_read_b64_tr_b16 a[84:85], v15 offset:12288
 v_mfma_f32_16x16x32_bf16 v[92:95], a[88:91], v[244:247], v[92:95]
 s_waitcnt lgkmcnt(9)
 ds_read_b64_tr_b16 a[86:87], v15 offset:12800
 v_mfma_f32_16x16x32_bf16 v[96:99], a[92:95], v[240:243], v[96:99]
 s_waitcnt vmcnt(15)
 s_barrier
 ds_read_b64_tr_b16 a[88:89], v4 offset:0
 v_mfma_f32_16x16x32_bf16 v[100:103], a[92:95], v[244:247], v[100:103]
 s_waitcnt lgkmcnt(9)
 ds_read_b64_tr_b16 a[90:91], v4 offset:512
 s_add_u32 s78, s74, 294912
 v_mfma_f32_16x16x32_bf16 v[104:107], a[96:99], v[240:243], v[104:107]
 s_add_u32 m0, s69, 77824
 ds_read_b64_tr_b16 a[92:93], v5 offset:0
 buffer_load_dwordx4 v21, s[20:23], s78 offen  lds
 v_mfma_f32_16x16x32_bf16 v[108:111], a[96:99], v[244:247], v[108:111]
 s_waitcnt lgkmcnt(9)
 ds_read_b64_tr_b16 a[94:95], v5 offset:512
 v_mfma_f32_16x16x32_bf16 v[80:83], a[72:75], v[248:251], v[80:83]
 ds_read_b64_tr_b16 a[96:97], v6 offset:0
 v_mfma_f32_16x16x32_bf16 v[84:87], a[72:75], v[252:255], v[84:87]
 s_waitcnt lgkmcnt(9)
 ds_read_b64_tr_b16 a[98:99], v6 offset:512
 v_mfma_f32_16x16x32_bf16 v[88:91], a[76:79], v[248:251], v[88:91]
 ds_read_b64_tr_b16 a[72:73], v7 offset:0
 v_mfma_f32_16x16x32_bf16 v[92:95], a[76:79], v[252:255], v[92:95]
 s_waitcnt lgkmcnt(9)
 ds_read_b64_tr_b16 a[74:75], v7 offset:512
 s_add_u32 s78, s74, 589824
 v_mfma_f32_16x16x32_bf16 v[96:99], a[80:83], v[248:251], v[96:99]
 s_add_u32 m0, s69, 81920
 ds_read_b64_tr_b16 a[76:77], v4 offset:4096
 buffer_load_dwordx4 v21, s[20:23], s78 offen  lds
L_s3_end:
 v_mfma_f32_16x16x32_bf16 v[100:103], a[80:83], v[252:255], v[100:103]
 s_waitcnt lgkmcnt(9)
 ds_read_b64_tr_b16 a[78:79], v4 offset:4608
 v_mul_f32 v80, v32, v80
 v_mfma_f32_16x16x32_bf16 v[104:107], a[84:87], v[248:251], v[104:107]
 ds_read_b64_tr_b16 a[80:81], v5 offset:4096
 v_mul_f32 v81, v32, v81
 v_mfma_f32_16x16x32_bf16 v[108:111], a[84:87], v[252:255], v[108:111]
 s_waitcnt lgkmcnt(9)
 ds_read_b64_tr_b16 a[82:83], v5 offset:4608
 v_mul_f32 v82, v32, v82
 v_mfma_f32_16x16x32_bf16 v[48:51], a[88:91], v[112:115], 0
 ds_read_b64_tr_b16 a[84:85], v6 offset:4096
 v_mul_f32 v83, v32, v83
 v_mfma_f32_16x16x32_bf16 v[52:55], a[88:91], v[116:119], 0
 s_waitcnt lgkmcnt(9)
 ds_read_b64_tr_b16 a[86:87], v6 offset:4608
 s_add_u32 s78, s74, 884736
 v_mfma_f32_16x16x32_bf16 v[56:59], a[92:95], v[112:115], 0
 s_add_u32 m0, s69, 86016
 ds_read_b64_tr_b16 a[88:89], v7 offset:4096
 buffer_load_dwordx4 v21, s[20:23], s78 offen  lds
 v_mfma_f32_16x16x32_bf16 v[60:63], a[92:95], v[116:119], 0
 s_waitcnt lgkmcnt(9)
 ds_read_b64_tr_b16 a[90:91], v7 offset:4608
 v_cvt_pk_bf16_f32 v44, v80, v81
 v_mfma_f32_16x16x32_bf16 v[64:67], a[96:99], v[112:115], 0
 ds_read_b64_tr_b16 a[92:93], v4 offset:8192
 v_cvt_pk_bf16_f32 v45, v82, v83
 v_mfma_f32_16x16x32_bf16 v[68:71], a[96:99], v[116:119], 0
 s_waitcnt lgkmcnt(9)
 ds_read_b64_tr_b16 a[94:95], v4 offset:8704
 v_mul_f32 v84, v33, v84
 v_mfma_f32_16x16x32_bf16 v[72:75], a[72:75], v[112:115], 0
 ds_read_b64_tr_b16 a[96:97], v5 offset:8192
 v_mul_f32 v85, v33, v85
 v_mfma_f32_16x16x32_bf16 v[76:79], a[72:75], v[116:119], 0
 s_waitcnt lgkmcnt(9)
 ds_read_b64_tr_b16 a[98:99], v5 offset:8704
 s_add_u32 s78, s74, 1179648
 v_mfma_f32_16x16x32_bf16 v[48:51], a[76:79], v[120:123], v[48:51]
 s_add_u32 m0, s69, 90112
 ds_read_b64_tr_b16 a[72:73], v6 offset:8192
 buffer_load_dwordx4 v21, s[20:23], s78 offen  lds
 v_mfma_f32_16x16x32_bf16 v[52:55], a[76:79], v[124:127], v[52:55]
 s_waitcnt lgkmcnt(9)
 ds_read_b64_tr_b16 a[74:75], v6 offset:8704
 v_mul_f32 v86, v33, v86
 v_mfma_f32_16x16x32_bf16 v[56:59], a[80:83], v[120:123], v[56:59]
 ds_read_b64_tr_b16 a[76:77], v7 offset:8192
 v_mul_f32 v87, v33, v87
 v_mfma_f32_16x16x32_bf16 v[60:63], a[80:83], v[124:127], v[60:63]
 s_waitcnt lgkmcnt(9)
 ds_read_b64_tr_b16 a[78:79], v7 offset:8704
 v_cvt_pk_bf16_f32 v46, v84, v85
 v_mfma_f32_16x16x32_bf16 v[64:67], a[84:87], v[120:123], v[64:67]
 ds_read_b64_tr_b16 a[80:81], v4 offset:12288
 v_cvt_pk_bf16_f32 v47, v86, v87
 v_mfma_f32_16x16x32_bf16 v[68:71], a[84:87], v[124:127], v[68:71]
 s_waitcnt lgkmcnt(9)
 ds_read_b64_tr_b16 a[82:83], v4 offset:12800
 s_add_u32 s78, s74, 1474560
 v_mfma_f32_16x16x32_bf16 v[72:75], a[88:91], v[120:123], v[72:75]
 s_add_u32 m0, s69, 94208
 ds_read_b64_tr_b16 a[84:85], v5 offset:12288
 buffer_load_dwordx4 v21, s[20:23], s78 offen  lds
 v_mfma_f32_16x16x32_bf16 v[76:79], a[88:91], v[124:127], v[76:79]
 s_waitcnt lgkmcnt(9)
 ds_read_b64_tr_b16 a[86:87], v5 offset:12800
 buffer_store_dwordx4 v[44:47], v27, s[36:39], s84 offen offset:0 sc1
 v_mfma_f32_16x16x32_bf16 v[48:51], a[92:95], v[128:131], v[48:51]
 ds_read_b64_tr_b16 a[88:89], v6 offset:12288
 v_mul_f32 v88, v32, v88
 v_mfma_f32_16x16x32_bf16 v[52:55], a[92:95], v[132:135], v[52:55]
 s_waitcnt lgkmcnt(9)
 ds_read_b64_tr_b16 a[90:91], v6 offset:12800
 v_mul_f32 v89, v32, v89
 v_mfma_f32_16x16x32_bf16 v[56:59], a[96:99], v[128:131], v[56:59]
 ds_read_b64_tr_b16 a[92:93], v7 offset:12288
 v_mul_f32 v90, v32, v90
 v_mfma_f32_16x16x32_bf16 v[60:63], a[96:99], v[132:135], v[60:63]
 s_waitcnt lgkmcnt(9)
 ds_read_b64_tr_b16 a[94:95], v7 offset:12800
 s_add_u32 s78, s74, 1769472
 v_mfma_f32_16x16x32_bf16 v[64:67], a[72:75], v[128:131], v[64:67]
 s_add_u32 m0, s69, 98304
 ds_read_b64_tr_b16 a[96:97], v4 offset:16384
 buffer_load_dwordx4 v21, s[20:23], s78 offen  lds
 v_mfma_f32_16x16x32_bf16 v[68:71], a[72:75], v[132:135], v[68:71]
 s_waitcnt lgkmcnt(9)
 ds_read_b64_tr_b16 a[98:99], v4 offset:16896
 v_mul_f32 v91, v32, v91
 v_mfma_f32_16x16x32_bf16 v[72:75], a[76:79], v[128:131], v[72:75]
 ds_read_b64_tr_b16 a[72:73], v5 offset:16384
 v_cvt_pk_bf16_f32 v40, v88, v89
 v_mfma_f32_16x16x32_bf16 v[76:79], a[76:79], v[132:135], v[76:79]
 s_waitcnt lgkmcnt(9)
 ds_read_b64_tr_b16 a[74:75], v5 offset:16896
 v_cvt_pk_bf16_f32 v41, v90, v91
 v_mfma_f32_16x16x32_bf16 v[48:51], a[80:83], v[136:139], v[48:51]
 ds_read_b64_tr_b16 a[76:77], v6 offset:16384
 v_mul_f32 v92, v33, v92
 v_mfma_f32_16x16x32_bf16 v[52:55], a[80:83], v[140:143], v[52:55]
 s_waitcnt lgkmcnt(9)
 ds_read_b64_tr_b16 a[78:79], v6 offset:16896
 s_add_u32 s78, s74, 2064384
 v_mfma_f32_16x16x32_bf16 v[56:59], a[84:87], v[136:139], v[56:59]
 s_add_u32 m0, s69, 102400
 ds_read_b64_tr_b16 a[80:81], v7 offset:16384
 buffer_load_dwordx4 v21, s[20:23], s78 offen  lds
 v_mfma_f32_16x16x32_bf16 v[60:63], a[84:87], v[140:143], v[60:63]
 s_waitcnt lgkmcnt(9)
 ds_read_b64_tr_b16 a[82:83], v7 offset:16896
 v_mul_f32 v93, v33, v93
 v_mfma_f32_16x16x32_bf16 v[64:67], a[88:91], v[136:139], v[64:67]
 ds_read_b64_tr_b16 a[84:85], v4 offset:20480
 v_mul_f32 v94, v33, v94
 v_mfma_f32_16x16x32_bf16 v[68:71], a[88:91], v[140:143], v[68:71]
 s_waitcnt lgkmcnt(9)
 ds_read_b64_tr_b16 a[86:87], v4 offset:20992
 v_mul_f32 v95, v33, v95
 v_mfma_f32_16x16x32_bf16 v[72:75], a[92:95], v[136:139], v[72:75]
 ds_read_b64_tr_b16 a[88:89], v5 offset:20480
 v_cvt_pk_bf16_f32 v42, v92, v93
 v_mfma_f32_16x16x32_bf16 v[76:79], a[92:95], v[140:143], v[76:79]
 s_waitcnt lgkmcnt(9)
 ds_read_b64_tr_b16 a[90:91], v5 offset:20992
 s_add_u32 s78, s74, 2359296
 v_mfma_f32_16x16x32_bf16 v[48:51], a[96:99], v[144:147], v[48:51]
 s_add_u32 m0, s69, 106496
 ds_read_b64_tr_b16 a[92:93], v6 offset:20480
 buffer_load_dwordx4 v21, s[20:23], s78 offen  lds
 v_mfma_f32_16x16x32_bf16 v[52:55], a[96:99], v[148:151], v[52:55]
 s_waitcnt lgkmcnt(9)
 ds_read_b64_tr_b16 a[94:95], v6 offset:20992
 v_cvt_pk_bf16_f32 v43, v94, v95
 v_mfma_f32_16x16x32_bf16 v[56:59], a[72:75], v[144:147], v[56:59]
 ds_read_b64_tr_b16 a[96:97], v7 offset:20480
 buffer_store_dwordx4 v[40:43], v27, s[36:39], s84 offen offset:1024 sc1
 v_mfma_f32_16x16x32_bf16 v[60:63], a[72:75], v[148:151], v[60:63]
 s_waitcnt lgkmcnt(9)
 ds_read_b64_tr_b16 a[98:99], v7 offset:20992
 v_mul_f32 v96, v32, v96
 v_mfma_f32_16x16x32_bf16 v[64:67], a[76:79], v[144:147], v[64:67]
 s_waitcnt vmcnt(17)
 s_barrier
 ds_read_b64_tr_b16 a[72:73], v4 offset:24576
 v_mul_f32 v97, v32, v97
 v_mfma_f32_16x16x32_bf16 v[68:71], a[76:79], v[148:151], v[68:71]
 s_waitcnt lgkmcnt(9)
 ds_read_b64_tr_b16 a[74:75], v4 offset:25088
 s_add_u32 s78, s74, 2654208
 v_mfma_f32_16x16x32_bf16 v[72:75], a[80:83], v[144:147], v[72:75]
 s_add_u32 m0, s69, 110592
 ds_read_b64_tr_b16 a[76:77], v5 offset:24576
 buffer_load_dwordx4 v21, s[20:23], s78 offen  lds
 v_mfma_f32_16x16x32_bf16 v[76:79], a[80:83], v[148:151], v[76:79]
 s_waitcnt lgkmcnt(9)
 ds_read_b64_tr_b16 a[78:79], v5 offset:25088
 v_mul_f32 v98, v32, v98
 v_mfma_f32_16x16x32_bf16 v[48:51], a[84:87], v[152:155], v[48:51]
 ds_read_b64_tr_b16 a[80:81], v6 offset:24576
 v_mul_f32 v99, v32, v99
 v_mfma_f32_16x16x32_bf16 v[52:55], a[84:87], v[156:159], v[52:55]
 s_waitcnt lgkmcnt(9)
 ds_read_b64_tr_b16 a[82:83], v6 offset:25088
 v_cvt_pk_bf16_f32 v44, v96, v97
 v_mfma_f32_16x16x32_bf16 v[56:59], a[88:91], v[152:155], v[56:59]
 ds_read_b64_tr_b16 a[84:85], v7 offset:24576
 v_cvt_pk_bf16_f32 v45, v98, v99
 v_mfma_f32_16x16x32_bf16 v[60:63], a[88:91], v[156:159], v[60:63]
 s_waitcnt lgkmcnt(9)
 ds_read_b64_tr_b16 a[86:87], v7 offset:25088
 s_add_u32 s78, s74, 2949120
 v_mfma_f32_16x16x32_bf16 v[64:67], a[92:95], v[152:155], v[64:67]
 s_add_u32 m0, s69, 114688
 ds_read_b64_tr_b16 a[88:89], v4 offset:28672
 buffer_load_dwordx4 v21, s[20:23], s78 offen  lds
 v_mfma_f32_16x16x32_bf16 v[68:71], a[92:95], v[156:159], v[68:71]
 s_waitcnt lgkmcnt(9)
 ds_read_b64_tr_b16 a[90:91], v4 offset:29184
 v_mul_f32 v100, v33, v100
 v_mfma_f32_16x16x32_bf16 v[72:75], a[96:99], v[152:155], v[72:75]
 ds_read_b64_tr_b16 a[92:93], v5 offset:28672
 v_mul_f32 v101, v33, v101
 v_mfma_f32_16x16x32_bf16 v[76:79], a[96:99], v[156:159], v[76:79]
 s_waitcnt lgkmcnt(9)
 ds_read_b64_tr_b16 a[94:95], v5 offset:29184
 v_mul_f32 v102, v33, v102
 v_mfma_f32_16x16x32_bf16 v[48:51], a[72:75], v[160:163], v[48:51]
 ds_read_b64_tr_b16 a[96:97], v6 offset:28672
 v_mul_f32 v103, v33, v103
 v_mfma_f32_16x16x32_bf16 v[52:55], a[72:75], v[164:167], v[52:55]
 s_waitcnt lgkmcnt(9)
 ds_read_b64_tr_b16 a[98:99], v6 offset:29184
 s_add_u32 s78, s74, 3244032
 v_mfma_f32_16x16x32_bf16 v[56:59], a[76:79], v[160:163], v[56:59]
 s_add_u32 m0, s69, 118784
 ds_read_b64_tr_b16 a[72:73], v7 offset:28672
 buffer_load_dwordx4 v21, s[20:23], s78 offen  lds
 v_mfma_f32_16x16x32_bf16 v[60:63], a[76:79], v[164:167], v[60:63]
 s_waitcnt lgkmcnt(9)
 ds_read_b64_tr_b16 a[74:75], v7 offset:29184
 v_cvt_pk_bf16_f32 v46, v100, v101
 v_mfma_f32_16x16x32_bf16 v[64:67], a[80:83], v[160:163], v[64:67]
 ds_read_b64_tr_b16 a[76:77], v4 offset:32768
 v_cvt_pk_bf16_f32 v47, v102, v103
 v_mfma_f32_16x16x32_bf16 v[68:71], a[80:83], v[164:167], v[68:71]
 s_waitcnt lgkmcnt(9)
 ds_read_b64_tr_b16 a[78:79], v4 offset:33280
 buffer_store_dwordx4 v[44:47], v27, s[36:39], s84 offen offset:2048 sc1
 v_mfma_f32_16x16x32_bf16 v[72:75], a[84:87], v[160:163], v[72:75]
 ds_read_b64_tr_b16 a[80:81], v5 offset:32768
 v_mul_f32 v104, v32, v104
 v_mfma_f32_16x16x32_bf16 v[76:79], a[84:87], v[164:167], v[76:79]
 s_waitcnt lgkmcnt(9)
 ds_read_b64_tr_b16 a[82:83], v5 offset:33280
 s_add_u32 s78, s74, 3538944
 v_mfma_f32_16x16x32_bf16 v[48:51], a[88:91], v[168:171], v[48:51]
 s_add_u32 m0, s69, 122880
 ds_read_b64_tr_b16 a[84:85], v6 offset:32768
 buffer_load_dwordx4 v21, s[20:23], s78 offen  lds
 v_mfma_f32_16x16x32_bf16 v[52:55], a[88:91], v[172:175], v[52:55]
 s_waitcnt lgkmcnt(9)
 ds_read_b64_tr_b16 a[86:87], v6 offset:33280
 v_mul_f32 v105, v32, v105
 v_mfma_f32_16x16x32_bf16 v[56:59], a[92:95], v[168:171], v[56:59]
 ds_read_b64_tr_b16 a[88:89], v7 offset:32768
 v_mul_f32 v106, v32, v106
 v_mfma_f32_16x16x32_bf16 v[60:63], a[92:95], v[172:175], v[60:63]
 s_waitcnt lgkmcnt(9)
 ds_read_b64_tr_b16 a[90:91], v7 offset:33280
 v_mul_f32 v107, v32, v107
 v_mfma_f32_16x16x32_bf16 v[64:67], a[96:99], v[168:171], v[64:67]
 ds_read_b64_tr_b16 a[92:93], v4 offset:36864
 v_cvt_pk_bf16_f32 v40, v104, v105
 v_mfma_f32_16x16x32_bf16 v[68:71], a[96:99], v[172:175], v[68:71]
 s_waitcnt lgkmcnt(9)
 ds_read_b64_tr_b16 a[94:95], v4 offset:37376
 s_add_u32 s78, s74, 3833856
 v_mfma_f32_16x16x32_bf16 v[72:75], a[72:75], v[168:171], v[72:75]
 s_add_u32 m0, s69, 126976
 ds_read_b64_tr_b16 a[96:97], v5 offset:36864
 buffer_load_dwordx4 v21, s[20:23], s78 offen  lds
 v_mfma_f32_16x16x32_bf16 v[76:79], a[72:75], v[172:175], v[76:79]
 s_waitcnt lgkmcnt(9)
 ds_read_b64_tr_b16 a[98:99], v5 offset:37376
 v_cvt_pk_bf16_f32 v41, v106, v107
 v_mfma_f32_16x16x32_bf16 v[48:51], a[76:79], v[176:179], v[48:51]
 ds_read_b64_tr_b16 a[72:73], v6 offset:36864
 v_mul_f32 v108, v33, v108
 v_mfma_f32_16x16x32_bf16 v[52:55], a[76:79], v[180:183], v[52:55]
 s_waitcnt lgkmcnt(9)
 ds_read_b64_tr_b16 a[74:75], v6 offset:37376
 v_mul_f32 v109, v33, v109
 v_mfma_f32_16x16x32_bf16 v[56:59], a[80:83], v[176:179], v[56:59]
 ds_read_b64_tr_b16 a[76:77], v7 offset:36864
 v_mul_f32 v110, v33, v110
 v_mfma_f32_16x16x32_bf16 v[60:63], a[80:83], v[180:183], v[60:63]
 s_waitcnt lgkmcnt(9)
 ds_read_b64_tr_b16 a[78:79], v7 offset:37376
 s_add_u32 s78, s74, 4128768
 v_mfma_f32_16x16x32_bf16 v[64:67], a[84:87], v[176:179], v[64:67]
 s_add_u32 m0, s69, 131072
 ds_read_b64_tr_b16 a[80:81], v4 offset:40960
 buffer_load_dwordx4 v21, s[20:23], s78 offen  lds
 v_mfma_f32_16x16x32_bf16 v[68:71], a[84:87], v[180:183], v[68:71]
 s_waitcnt lgkmcnt(9)
 ds_read_b64_tr_b16 a[82:83], v4 offset:41472
 v_mul_f32 v111, v33, v111
 v_mfma_f32_16x16x32_bf16 v[72:75], a[88:91], v[176:179], v[72:75]
 ds_read_b64_tr_b16 a[84:85], v5 offset:40960
 v_cvt_pk_bf16_f32 v42, v108, v109
 v_mfma_f32_16x16x32_bf16 v[76:79], a[88:91], v[180:183], v[76:79]
 s_waitcnt lgkmcnt(9)
 ds_read_b64_tr_b16 a[86:87], v5 offset:41472
 v_cvt_pk_bf16_f32 v43, v110, v111
 v_mfma_f32_16x16x32_bf16 v[48:51], a[92:95], v[184:187], v[48:51]
 ds_read_b64_tr_b16 a[88:89], v6 offset:40960
 buffer_store_dwordx4 v[40:43], v27, s[36:39], s84 offen offset:3072 sc1
 v_mfma_f32_16x16x32_bf16 v[52:55], a[92:95], v[188:191], v[52:55]
 s_waitcnt lgkmcnt(9)
 ds_read_b64_tr_b16 a[90:91], v6 offset:41472
 s_add_u32 s78, s74, 4423680
 v_mfma_f32_16x16x32_bf16 v[56:59], a[96:99], v[184:187], v[56:59]
 s_add_u32 m0, s69, 135168
 ds_read_b64_tr_b16 a[92:93], v7 offset:40960
 buffer_load_dwordx4 v21, s[20:23], s78 offen  lds
 v_mfma_f32_16x16x32_bf16 v[60:63], a[96:99], v[188:191], v[60:63]
 s_waitcnt lgkmcnt(9)
 ds_read_b64_tr_b16 a[94:95], v7 offset:41472
 s_lshr_b32 s50, s71, 3
 v_mfma_f32_16x16x32_bf16 v[64:67], a[72:75], v[184:187], v[64:67]
 s_lshl_b32 s48, s70, 1
 ds_read_b64_tr_b16 a[96:97], v4 offset:45056
 s_add_u32 s49, s48, s50
 v_mfma_f32_16x16x32_bf16 v[68:71], a[72:75], v[188:191], v[68:71]
 s_waitcnt lgkmcnt(9)
 ds_read_b64_tr_b16 a[98:99], v4 offset:45568
 s_lshl_b32 s97, s49, 11
 v_mfma_f32_16x16x32_bf16 v[72:75], a[76:79], v[184:187], v[72:75]
 s_lshr_b32 s49, s68, 1
 ds_read_b64_tr_b16 a[72:73], v5 offset:45056
 s_add_u32 s48, s48, s49
 v_mfma_f32_16x16x32_bf16 v[76:79], a[76:79], v[188:191], v[76:79]
 s_waitcnt lgkmcnt(9)
 ds_read_b64_tr_b16 a[74:75], v5 offset:45568
 s_add_u32 s78, s74, 4718592
 v_mfma_f32_16x16x32_bf16 v[48:51], a[80:83], v[192:195], v[48:51]
 s_add_u32 m0, s69, 139264
 ds_read_b64_tr_b16 a[76:77], v6 offset:45056
 buffer_load_dwordx4 v21, s[20:23], s78 offen  lds
 v_mfma_f32_16x16x32_bf16 v[52:55], a[80:83], v[196:199], v[52:55]
 s_waitcnt lgkmcnt(9)
 ds_read_b64_tr_b16 a[78:79], v6 offset:45568
 s_lshl_b32 s48, s48, 9
 v_mfma_f32_16x16x32_bf16 v[56:59], a[84:87], v[192:195], v[56:59]
 s_lshl_b32 s49, s71, 5
 ds_read_b64_tr_b16 a[80:81], v7 offset:45056
 s_add_u32 s48, s48, s49
 v_mfma_f32_16x16x32_bf16 v[60:63], a[84:87], v[196:199], v[60:63]
 s_waitcnt lgkmcnt(9)
 ds_read_b64_tr_b16 a[82:83], v7 offset:45568
 s_and_b32 s49, s68, 1
 v_mfma_f32_16x16x32_bf16 v[64:67], a[88:91], v[192:195], v[64:67]
 s_waitcnt vmcnt(21)
 s_barrier
 ds_read_b64_tr_b16 a[84:85], v4 offset:49152
 s_add_u32 s48, s48, s49
 v_mfma_f32_16x16x32_bf16 v[68:71], a[88:91], v[196:199], v[68:71]
 s_waitcnt lgkmcnt(9)
 ds_read_b64_tr_b16 a[86:87], v4 offset:49664
 s_add_u32 s78, s74, 5013504
 v_mfma_f32_16x16x32_bf16 v[72:75], a[92:95], v[192:195], v[72:75]
 s_add_u32 m0, s69, 143360
 ds_read_b64_tr_b16 a[88:89], v5 offset:49152
 buffer_load_dwordx4 v21, s[20:23], s78 offen  lds
 v_mfma_f32_16x16x32_bf16 v[76:79], a[92:95], v[196:199], v[76:79]
 s_waitcnt lgkmcnt(9)
 ds_read_b64_tr_b16 a[90:91], v5 offset:49664
 s_lshl_b32 s98, s48, 2
 v_mfma_f32_16x16x32_bf16 v[48:51], a[96:99], v[200:203], v[48:51]
 s_lshl_b32 s95, s70, 4
 ds_read_b64_tr_b16 a[92:93], v6 offset:49152
 s_add_u32 s95, s95, s71
 v_mfma_f32_16x16x32_bf16 v[52:55], a[96:99], v[204:207], v[52:55]
 s_waitcnt lgkmcnt(9)
 ds_read_b64_tr_b16 a[94:95], v6 offset:49664
 s_lshl_b32 s48, s95, 2
 v_mfma_f32_16x16x32_bf16 v[56:59], a[72:75], v[200:203], v[56:59]
 s_add_u32 s48, s48, s68
 ds_read_b64_tr_b16 a[96:97], v7 offset:49152
 s_lshl_b32 s48, s48, 8
 v_mfma_f32_16x16x32_bf16 v[60:63], a[72:75], v[204:207], v[60:63]
 s_waitcnt lgkmcnt(9)
 ds_read_b64_tr_b16 a[98:99], v7 offset:49664
 s_add_u32 s78, s74, 128
 v_mfma_f32_16x16x32_bf16 v[64:67], a[76:79], v[200:203], v[64:67]
 s_add_u32 m0, s69, 0
 ds_read_b64_tr_b16 a[72:73], v4 offset:53248
 buffer_load_dwordx4 v21, s[16:19], s78 offen  lds
 v_mfma_f32_16x16x32_bf16 v[68:71], a[76:79], v[204:207], v[68:71]
 s_waitcnt lgkmcnt(9)
 ds_read_b64_tr_b16 a[74:75], v4 offset:53760
 s_add_u32 s48, s48, 10485760
 v_mfma_f32_16x16x32_bf16 v[72:75], a[80:83], v[200:203], v[72:75]
 s_mul_i32 s49, s71, 576
 ds_read_b64_tr_b16 a[76:77], v5 offset:53248
 s_and_b32 s49, s49, 0xffffff80
 v_mfma_f32_16x16x32_bf16 v[76:79], a[80:83], v[204:207], v[76:79]
 s_waitcnt lgkmcnt(9)
 ds_read_b64_tr_b16 a[78:79], v5 offset:53760
 s_add_u32 s49, s49, s83
 v_mfma_f32_16x16x32_bf16 v[48:51], a[84:87], v[208:211], v[48:51]
 s_add_u32 s49, s49, 294912
 ds_read_b64_tr_b16 a[80:81], v6 offset:53248
 v_bfe_u32 v38, v0, 1, 4
 v_mfma_f32_16x16x32_bf16 v[52:55], a[84:87], v[212:215], v[52:55]
 s_waitcnt lgkmcnt(9)
 ds_read_b64_tr_b16 a[82:83], v6 offset:53760
 s_add_u32 s78, s74, 295040
 v_mfma_f32_16x16x32_bf16 v[56:59], a[88:91], v[208:211], v[56:59]
 s_add_u32 m0, s69, 4096
 ds_read_b64_tr_b16 a[84:85], v7 offset:53248
 buffer_load_dwordx4 v21, s[16:19], s78 offen  lds
 v_mfma_f32_16x16x32_bf16 v[60:63], a[88:91], v[212:215], v[60:63]
 s_waitcnt lgkmcnt(9)
 ds_read_b64_tr_b16 a[86:87], v7 offset:53760
 v_and_b32 v39, 1, v0
 v_mfma_f32_16x16x32_bf16 v[64:67], a[92:95], v[208:211], v[64:67]
 ds_read_b64_tr_b16 a[88:89], v4 offset:57344
 v_lshlrev_b32 v38, 7, v38
 v_mfma_f32_16x16x32_bf16 v[68:71], a[92:95], v[212:215], v[68:71]
 s_waitcnt lgkmcnt(9)
 ds_read_b64_tr_b16 a[90:91], v4 offset:57856
 v_lshl_add_u32 v38, v39, 2, v38
 v_mfma_f32_16x16x32_bf16 v[72:75], a[96:99], v[208:211], v[72:75]
 ds_read_b64_tr_b16 a[92:93], v5 offset:57344
 v_lshlrev_b32 v44, 4, v0
 v_mfma_f32_16x16x32_bf16 v[76:79], a[96:99], v[212:215], v[76:79]
 s_waitcnt lgkmcnt(9)
 ds_read_b64_tr_b16 a[94:95], v5 offset:57856
 s_add_u32 s78, s74, 589952
 v_mfma_f32_16x16x32_bf16 v[48:51], a[72:75], v[216:219], v[48:51]
 s_add_u32 m0, s69, 8192
 ds_read_b64_tr_b16 a[96:97], v6 offset:57344
 buffer_load_dwordx4 v21, s[16:19], s78 offen  lds
 v_mfma_f32_16x16x32_bf16 v[52:55], a[72:75], v[220:223], v[52:55]
 s_waitcnt lgkmcnt(9)
 ds_read_b64_tr_b16 a[98:99], v6 offset:57856
 v_mov_b32 v46, 2147483648
 v_mfma_f32_16x16x32_bf16 v[56:59], a[76:79], v[216:219], v[56:59]
 ds_read_b64_tr_b16 a[72:73], v7 offset:57344
 v_lshl_add_u32 v45, s68, 7, v44
 v_mfma_f32_16x16x32_bf16 v[60:63], a[76:79], v[220:223], v[60:63]
 s_waitcnt lgkmcnt(9)
 ds_read_b64_tr_b16 a[74:75], v7 offset:57856
 v_cmp_gt_u32 vcc, 0x80, v45
 v_mfma_f32_16x16x32_bf16 v[64:67], a[80:83], v[216:219], v[64:67]
 ds_read_b64_tr_b16 a[76:77], v4 offset:61440
 v_cndmask_b32 v45, v46, v45, vcc
 v_mfma_f32_16x16x32_bf16 v[68:71], a[80:83], v[220:223], v[68:71]
 s_waitcnt lgkmcnt(9)
 ds_read_b64_tr_b16 a[78:79], v4 offset:61952
 s_add_u32 s78, s74, 884864
 v_mfma_f32_16x16x32_bf16 v[72:75], a[84:87], v[216:219], v[72:75]
 s_add_u32 m0, s69, 12288
 ds_read_b64_tr_b16 a[80:81], v5 offset:61440
 buffer_load_dwordx4 v21, s[16:19], s78 offen  lds
 v_mfma_f32_16x16x32_bf16 v[76:79], a[84:87], v[220:223], v[76:79]
 s_waitcnt lgkmcnt(9)
 ds_read_b64_tr_b16 a[82:83], v5 offset:61952
 v_cmp_gt_u32 vcc, 16, v0
 v_mfma_f32_16x16x32_bf16 v[48:51], a[88:91], v[224:227], v[48:51]
 ds_read_b64_tr_b16 a[84:85], v6 offset:61440
 v_cndmask_b32 v44, v46, v44, vcc
 v_mfma_f32_16x16x32_bf16 v[52:55], a[88:91], v[228:231], v[52:55]
 s_waitcnt lgkmcnt(9)
 ds_read_b64_tr_b16 a[86:87], v6 offset:61952
 v_mov_b32 v40, 0x3f803f80
 v_mfma_f32_16x16x32_bf16 v[56:59], a[92:95], v[224:227], v[56:59]
 ds_read_b64_tr_b16 a[88:89], v7 offset:61440
 v_mov_b32 v41, v40
 v_mfma_f32_16x16x32_bf16 v[60:63], a[92:95], v[228:231], v[60:63]
 s_waitcnt lgkmcnt(9)
 ds_read_b64_tr_b16 a[90:91], v7 offset:61952
 s_add_u32 s78, s74, 1179776
 v_mfma_f32_16x16x32_bf16 v[64:67], a[96:99], v[224:227], v[64:67]
 s_add_u32 m0, s69, 16384
 ds_read_b64_tr_b16 a[92:93], v8 offset:0
 buffer_load_dwordx4 v21, s[16:19], s78 offen  lds
 v_mfma_f32_16x16x32_bf16 v[68:71], a[96:99], v[228:231], v[68:71]
 s_waitcnt lgkmcnt(9)
 ds_read_b64_tr_b16 a[94:95], v8 offset:512
 v_mov_b32 v42, v40
 v_mfma_f32_16x16x32_bf16 v[72:75], a[72:75], v[224:227], v[72:75]
 ds_read_b64_tr_b16 a[96:97], v9 offset:0
 v_mov_b32 v43, v40
 v_mfma_f32_16x16x32_bf16 v[76:79], a[72:75], v[228:231], v[76:79]
 s_waitcnt lgkmcnt(9)
 ds_read_b64_tr_b16 a[98:99], v9 offset:512
 v_mov_b32 v36, 1
 v_mfma_f32_16x16x32_bf16 v[48:51], a[76:79], v[232:235], v[48:51]
 s_and_b32 s50, s68, 1
 ds_read_b64_tr_b16 a[72:73], v10 offset:0
 s_lshl_b32 s51, s95, 1
 v_mfma_f32_16x16x32_bf16 v[52:55], a[76:79], v[236:239], v[52:55]
 s_waitcnt lgkmcnt(9)
 ds_read_b64_tr_b16 a[74:75], v10 offset:512
 s_add_u32 s78, s74, 1474688
 v_mfma_f32_16x16x32_bf16 v[56:59], a[80:83], v[232:235], v[56:59]
 s_add_u32 m0, s69, 20480
 ds_read_b64_tr_b16 a[76:77], v11 offset:0
 buffer_load_dwordx4 v21, s[16:19], s78 offen  lds
 v_mfma_f32_16x16x32_bf16 v[60:63], a[80:83], v[236:239], v[60:63]
 s_waitcnt lgkmcnt(9)
 ds_read_b64_tr_b16 a[78:79], v11 offset:512
 s_add_u32 s51, s51, s50
 v_mfma_f32_16x16x32_bf16 v[64:67], a[84:87], v[232:235], v[64:67]
 s_lshl_b32 s51, s51, 2
 ds_read_b64_tr_b16 a[80:81], v8 offset:4096
 s_lshr_b32 s50, s68, 1
 v_mfma_f32_16x16x32_bf16 v[68:71], a[84:87], v[236:239], v[68:71]
 s_waitcnt lgkmcnt(9)
 ds_read_b64_tr_b16 a[82:83], v8 offset:4608
 s_add_u32 s51, s51, s50
 v_mfma_f32_16x16x32_bf16 v[72:75], a[88:91], v[232:235], v[72:75]
 s_lshl_b32 s51, s51, 10
 ds_read_b64_tr_b16 a[84:85], v9 offset:4096
 s_add_u32 s72, s51, 8388608
 v_mfma_f32_16x16x32_bf16 v[76:79], a[88:91], v[236:239], v[76:79]
 s_waitcnt lgkmcnt(9)
 ds_read_b64_tr_b16 a[86:87], v9 offset:4608
 s_add_u32 s78, s74, 1769600
 v_mfma_f32_16x16x32_bf16 v[48:51], a[92:95], v[240:243], v[48:51]
 s_add_u32 m0, s69, 24576
 ds_read_b64_tr_b16 a[88:89], v10 offset:4096
 buffer_load_dwordx4 v21, s[16:19], s78 offen  lds
 v_mfma_f32_16x16x32_bf16 v[52:55], a[92:95], v[244:247], v[52:55]
 s_waitcnt lgkmcnt(9)
 ds_read_b64_tr_b16 a[90:91], v10 offset:4608
 v_lshlrev_b32 v39, 4, v0
 v_mfma_f32_16x16x32_bf16 v[56:59], a[96:99], v[240:243], v[56:59]
 s_and_b32 s94, s71, 3
 ds_read_b64_tr_b16 a[92:93], v11 offset:4096
 s_lshl_b32 s94, s94, 6
 v_mfma_f32_16x16x32_bf16 v[60:63], a[96:99], v[244:247], v[60:63]
 s_waitcnt lgkmcnt(9)
 ds_read_b64_tr_b16 a[94:95], v11 offset:4608
 buffer_load_dword a130, v38, s[36:39], s97 offen sc1
 v_mfma_f32_16x16x32_bf16 v[64:67], a[72:75], v[240:243], v[64:67]
 s_waitcnt vmcnt(24)
 s_barrier
 ds_read_b64_tr_b16 a[96:97], v8 offset:8192
 buffer_load_dword a131, off, s[36:39], s98 sc1
 v_mfma_f32_16x16x32_bf16 v[68:71], a[72:75], v[244:247], v[68:71]
 s_waitcnt lgkmcnt(9)
 ds_read_b64_tr_b16 a[98:99], v8 offset:8704
 s_add_u32 s78, s74, 2064512
 v_mfma_f32_16x16x32_bf16 v[72:75], a[76:79], v[240:243], v[72:75]
 s_add_u32 m0, s69, 28672
 ds_read_b64_tr_b16 a[72:73], v9 offset:8192
 buffer_load_dwordx4 v21, s[16:19], s78 offen  lds
 v_mfma_f32_16x16x32_bf16 v[76:79], a[76:79], v[244:247], v[76:79]
 s_waitcnt lgkmcnt(9)
 ds_read_b64_tr_b16 a[74:75], v9 offset:8704
 buffer_store_dwordx4 v[40:43], v45, s[36:39], s49 offen sc1
 v_mfma_f32_16x16x32_bf16 v[48:51], a[80:83], v[248:251], v[48:51]
 ds_read_b64_tr_b16 a[76:77], v10 offset:8192
 v_mfma_f32_16x16x32_bf16 v[52:55], a[80:83], v[252:255], v[52:55]
 s_waitcnt lgkmcnt(9)
 ds_read_b64_tr_b16 a[78:79], v10 offset:8704
 v_mov_b32 v40, -1
 v_mfma_f32_16x16x32_bf16 v[56:59], a[84:87], v[248:251], v[56:59]
 ds_read_b64_tr_b16 a[80:81], v11 offset:8192
 v_mov_b32 v41, -1
 v_mfma_f32_16x16x32_bf16 v[60:63], a[84:87], v[252:255], v[60:63]
 s_waitcnt lgkmcnt(9)
 ds_read_b64_tr_b16 a[82:83], v11 offset:8704
 s_add_u32 s78, s74, 2359424
 v_mfma_f32_16x16x32_bf16 v[64:67], a[88:91], v[248:251], v[64:67]
 s_add_u32 m0, s69, 32768
 ds_read_b64_tr_b16 a[84:85], v8 offset:12288
 buffer_load_dwordx4 v21, s[16:19], s78 offen  lds
 v_mfma_f32_16x16x32_bf16 v[68:71], a[88:91], v[252:255], v[68:71]
 s_waitcnt lgkmcnt(9)
 ds_read_b64_tr_b16 a[86:87], v8 offset:12800
 v_mov_b32 v42, -1
 v_mfma_f32_16x16x32_bf16 v[72:75], a[92:95], v[248:251], v[72:75]
 ds_read_b64_tr_b16 a[88:89], v9 offset:12288
 v_mov_b32 v43, -1
 v_mfma_f32_16x16x32_bf16 v[76:79], a[92:95], v[252:255], v[76:79]
 s_waitcnt lgkmcnt(9)
 ds_read_b64_tr_b16 a[90:91], v9 offset:12800
 buffer_store_dwordx4 v[40:43], v44, s[36:39], s48 offen sc1
 v_mfma_f32_16x16x32_bf16 v[80:83], a[96:99], v[112:115], 0
 ds_read_b64_tr_b16 a[92:93], v10 offset:12288
 buffer_store_dwordx4 v[40:43], v39, s[36:39], s72 offen sc1
 v_mfma_f32_16x16x32_bf16 v[84:87], a[96:99], v[116:119], 0
 s_waitcnt lgkmcnt(9)
 ds_read_b64_tr_b16 a[94:95], v10 offset:12800
 s_add_u32 s78, s74, 2654336
 v_mfma_f32_16x16x32_bf16 v[88:91], a[72:75], v[112:115], 0
 s_add_u32 m0, s69, 36864
 ds_read_b64_tr_b16 a[96:97], v11 offset:12288
 buffer_load_dwordx4 v21, s[16:19], s78 offen  lds
 v_mfma_f32_16x16x32_bf16 v[92:95], a[72:75], v[116:119], 0
 s_waitcnt lgkmcnt(9)
 ds_read_b64_tr_b16 a[98:99], v11 offset:12800
 buffer_store_dwordx4 v[40:43], v39, s[36:39], s72 offen offset:2048 sc1
 v_mfma_f32_16x16x32_bf16 v[96:99], a[76:79], v[112:115], 0
 ds_read_b64_tr_b16 a[72:73], v8 offset:16384
 v_lshlrev_b32 v46, 4, v0
 v_mfma_f32_16x16x32_bf16 v[100:103], a[76:79], v[116:119], 0
 s_waitcnt lgkmcnt(9)
 ds_read_b64_tr_b16 a[74:75], v8 offset:16896
 s_mul_i32 s51, s68, 5120
 v_mfma_f32_16x16x32_bf16 v[104:107], a[80:83], v[112:115], 0
 s_add_u32 s51, s51, L_tab_wave-parallel_sum__mha_block__glu_gated_bilinear__prompt_kernel
 ds_read_b64_tr_b16 a[76:77], v9 offset:16384
 s_mov_b32 s50, L_tab-parallel_sum__mha_block__glu_gated_bilinear__prompt_kernel
 v_mfma_f32_16x16x32_bf16 v[108:111], a[80:83], v[116:119], 0
 s_waitcnt lgkmcnt(9)
 ds_read_b64_tr_b16 a[78:79], v9 offset:16896
 s_add_u32 s78, s74, 2949248
 v_mfma_f32_16x16x32_bf16 v[80:83], a[84:87], v[120:123], v[80:83]
 s_add_u32 m0, s69, 40960
 ds_read_b64_tr_b16 a[80:81], v10 offset:16384
 buffer_load_dwordx4 v21, s[16:19], s78 offen  lds
 v_mfma_f32_16x16x32_bf16 v[84:87], a[84:87], v[124:127], v[84:87]
 s_waitcnt lgkmcnt(9)
 ds_read_b64_tr_b16 a[82:83], v10 offset:16896
 v_mul_f32 v48, v30, v48
 v_mfma_f32_16x16x32_bf16 v[88:91], a[88:91], v[120:123], v[88:91]
 ds_read_b64_tr_b16 a[84:85], v11 offset:16384
 v_mul_f32 v49, v30, v49
 v_mfma_f32_16x16x32_bf16 v[92:95], a[88:91], v[124:127], v[92:95]
 s_waitcnt lgkmcnt(9)
 ds_read_b64_tr_b16 a[86:87], v11 offset:16896
 v_mul_f32 v50, v30, v50
 v_mfma_f32_16x16x32_bf16 v[96:99], a[92:95], v[120:123], v[96:99]
 ds_read_b64_tr_b16 a[88:89], v8 offset:20480
 v_mul_f32 v51, v30, v51
 v_mfma_f32_16x16x32_bf16 v[100:103], a[92:95], v[124:127], v[100:103]
 s_waitcnt lgkmcnt(9)
 ds_read_b64_tr_b16 a[90:91], v8 offset:20992
 s_add_u32 s78, s74, 3244160
 v_mfma_f32_16x16x32_bf16 v[104:107], a[96:99], v[120:123], v[104:107]
 s_add_u32 m0, s69, 45056
 ds_read_b64_tr_b16 a[92:93], v9 offset:20480
 buffer_load_dwordx4 v21, s[16:19], s78 offen  lds
 v_mfma_f32_16x16x32_bf16 v[108:111], a[96:99], v[124:127], v[108:111]
 s_waitcnt lgkmcnt(9)
 ds_read_b64_tr_b16 a[94:95], v9 offset:20992
 v_mul_f32 v52, v31, v52
 v_mfma_f32_16x16x32_bf16 v[80:83], a[72:75], v[128:131], v[80:83]
 ds_read_b64_tr_b16 a[96:97], v10 offset:20480
 v_mul_f32 v53, v31, v53
 v_mfma_f32_16x16x32_bf16 v[84:87], a[72:75], v[132:135], v[84:87]
 s_waitcnt lgkmcnt(9)
 ds_read_b64_tr_b16 a[98:99], v10 offset:20992
 v_mul_f32 v54, v31, v54
 v_mfma_f32_16x16x32_bf16 v[88:91], a[76:79], v[128:131], v[88:91]
 ds_read_b64_tr_b16 a[72:73], v11 offset:20480
 v_mul_f32 v55, v31, v55
 v_mfma_f32_16x16x32_bf16 v[92:95], a[76:79], v[132:135], v[92:95]
 s_waitcnt lgkmcnt(9)
 ds_read_b64_tr_b16 a[74:75], v11 offset:20992
 s_add_u32 s78, s74, 3539072
 v_mfma_f32_16x16x32_bf16 v[96:99], a[80:83], v[128:131], v[96:99]
 s_add_u32 m0, s69, 49152
 ds_read_b64_tr_b16 a[76:77], v8 offset:24576
 buffer_load_dwordx4 v21, s[16:19], s78 offen  lds
 v_mfma_f32_16x16x32_bf16 v[100:103], a[80:83], v[132:135], v[100:103]
 s_waitcnt lgkmcnt(9)
 ds_read_b64_tr_b16 a[78:79], v8 offset:25088
 v_mul_f32 v56, v30, v56
 v_mfma_f32_16x16x32_bf16 v[104:107], a[84:87], v[128:131], v[104:107]
 ds_read_b64_tr_b16 a[80:81], v9 offset:24576
 v_mul_f32 v57, v30, v57
 v_mfma_f32_16x16x32_bf16 v[108:111], a[84:87], v[132:135], v[108:111]
 s_waitcnt lgkmcnt(9)
 ds_read_b64_tr_b16 a[82:83], v9 offset:25088
 v_mul_f32 v58, v30, v58
 v_mfma_f32_16x16x32_bf16 v[80:83], a[88:91], v[136:139], v[80:83]
 ds_read_b64_tr_b16 a[84:85], v10 offset:24576
 v_mul_f32 v59, v30, v59
 v_mfma_f32_16x16x32_bf16 v[84:87], a[88:91], v[140:143], v[84:87]
 s_waitcnt lgkmcnt(9)
 ds_read_b64_tr_b16 a[86:87], v10 offset:25088
 s_add_u32 s78, s74, 3833984
 v_mfma_f32_16x16x32_bf16 v[88:91], a[92:95], v[136:139], v[88:91]
 s_add_u32 m0, s69, 53248
 ds_read_b64_tr_b16 a[88:89], v11 offset:24576
 buffer_load_dwordx4 v21, s[16:19], s78 offen  lds
 v_mfma_f32_16x16x32_bf16 v[92:95], a[92:95], v[140:143], v[92:95]
 s_waitcnt lgkmcnt(9)
 ds_read_b64_tr_b16 a[90:91], v11 offset:25088
 v_mul_f32 v60, v31, v60
 v_mfma_f32_16x16x32_bf16 v[96:99], a[96:99], v[136:139], v[96:99]
 ds_read_b64_tr_b16 a[92:93], v8 offset:28672
 v_mul_f32 v61, v31, v61
 v_mfma_f32_16x16x32_bf16 v[100:103], a[96:99], v[140:143], v[100:103]
 s_waitcnt lgkmcnt(9)
 ds_read_b64_tr_b16 a[94:95], v8 offset:29184
 v_mul_f32 v62, v31, v62
 v_mfma_f32_16x16x32_bf16 v[104:107], a[72:75], v[136:139], v[104:107]
 ds_read_b64_tr_b16 a[96:97], v9 offset:28672
 v_mul_f32 v63, v31, v63
 v_mfma_f32_16x16x32_bf16 v[108:111], a[72:75], v[140:143], v[108:111]
 s_waitcnt lgkmcnt(9)
 ds_read_b64_tr_b16 a[98:99], v9 offset:29184
 s_add_u32 s78, s74, 4128896
 v_mfma_f32_16x16x32_bf16 v[80:83], a[76:79], v[144:147], v[80:83]
 s_add_u32 m0, s69, 57344
 ds_read_b64_tr_b16 a[72:73], v10 offset:28672
 buffer_load_dwordx4 v21, s[16:19], s78 offen  lds
 v_mfma_f32_16x16x32_bf16 v[84:87], a[76:79], v[148:151], v[84:87]
 s_waitcnt lgkmcnt(9)
 ds_read_b64_tr_b16 a[74:75], v10 offset:29184
 v_mul_f32 v64, v30, v64
 v_mfma_f32_16x16x32_bf16 v[88:91], a[80:83], v[144:147], v[88:91]
 ds_read_b64_tr_b16 a[76:77], v11 offset:28672
 v_mul_f32 v65, v30, v65
 v_mfma_f32_16x16x32_bf16 v[92:95], a[80:83], v[148:151], v[92:95]
 s_waitcnt lgkmcnt(9)
 ds_read_b64_tr_b16 a[78:79], v11 offset:29184
 v_mul_f32 v66, v30, v66
 v_mfma_f32_16x16x32_bf16 v[96:99], a[84:87], v[144:147], v[96:99]
 s_waitcnt vmcnt(29)
 s_barrier
 ds_read_b64_tr_b16 a[80:81], v8 offset:32768
 v_mul_f32 v67, v30, v67
 v_mfma_f32_16x16x32_bf16 v[100:103], a[84:87], v[148:151], v[100:103]
 s_waitcnt lgkmcnt(9)
 ds_read_b64_tr_b16 a[82:83], v8 offset:33280
 s_add_u32 s78, s74, 4423808
 v_mfma_f32_16x16x32_bf16 v[104:107], a[88:91], v[144:147], v[104:107]
 s_add_u32 m0, s69, 61440
 ds_read_b64_tr_b16 a[84:85], v9 offset:32768
 buffer_load_dwordx4 v21, s[16:19], s78 offen  lds
 v_mfma_f32_16x16x32_bf16 v[108:111], a[88:91], v[148:151], v[108:111]
 s_waitcnt lgkmcnt(9)
 ds_read_b64_tr_b16 a[86:87], v9 offset:33280
 v_mul_f32 v68, v31, v68
 v_mfma_f32_16x16x32_bf16 v[80:83], a[92:95], v[152:155], v[80:83]
 ds_read_b64_tr_b16 a[88:89], v10 offset:32768
 v_mul_f32 v69, v31, v69
 v_mfma_f32_16x16x32_bf16 v[84:87], a[92:95], v[156:159], v[84:87]
 s_waitcnt lgkmcnt(9)
 ds_read_b64_tr_b16 a[90:91], v10 offset:33280
 v_mul_f32 v70, v31, v70
 v_mfma_f32_16x16x32_bf16 v[88:91], a[96:99], v[152:155], v[88:91]
 ds_read_b64_tr_b16 a[92:93], v11 offset:32768
 v_mul_f32 v71, v31, v71
 v_mfma_f32_16x16x32_bf16 v[92:95], a[96:99], v[156:159], v[92:95]
 s_waitcnt lgkmcnt(9)
 ds_read_b64_tr_b16 a[94:95], v11 offset:33280
 s_add_u32 s78, s74, 4718720
 v_mfma_f32_16x16x32_bf16 v[96:99], a[72:75], v[152:155], v[96:99]
 s_add_u32 m0, s69, 65536
 ds_read_b64_tr_b16 a[96:97], v8 offset:36864
 buffer_load_dwordx4 v21, s[16:19], s78 offen  lds
 v_mfma_f32_16x16x32_bf16 v[100:103], a[72:75], v[156:159], v[100:103]
 s_waitcnt lgkmcnt(9)
 ds_read_b64_tr_b16 a[98:99], v8 offset:37376
 v_mul_f32 v72, v30, v72
 v_mfma_f32_16x16x32_bf16 v[104:107], a[76:79], v[152:155], v[104:107]
 ds_read_b64_tr_b16 a[72:73], v9 offset:36864
 v_mul_f32 v73, v30, v73
 v_mfma_f32_16x16x32_bf16 v[108:111], a[76:79], v[156:159], v[108:111]
 s_waitcnt lgkmcnt(9)
 ds_read_b64_tr_b16 a[74:75], v9 offset:37376
 v_mul_f32 v74, v30, v74
 v_mfma_f32_16x16x32_bf16 v[80:83], a[80:83], v[160:163], v[80:83]
 ds_read_b64_tr_b16 a[76:77], v10 offset:36864
 v_mul_f32 v75, v30, v75
 v_mfma_f32_16x16x32_bf16 v[84:87], a[80:83], v[164:167], v[84:87]
 s_waitcnt lgkmcnt(9)
 ds_read_b64_tr_b16 a[78:79], v10 offset:37376
 s_add_u32 s78, s74, 5013632
 v_mfma_f32_16x16x32_bf16 v[88:91], a[84:87], v[160:163], v[88:91]
 s_add_u32 m0, s69, 69632
 ds_read_b64_tr_b16 a[80:81], v11 offset:36864
 buffer_load_dwordx4 v21, s[16:19], s78 offen  lds
 v_mfma_f32_16x16x32_bf16 v[92:95], a[84:87], v[164:167], v[92:95]
 s_waitcnt lgkmcnt(9)
 ds_read_b64_tr_b16 a[82:83], v11 offset:37376
 v_mul_f32 v76, v31, v76
 v_mfma_f32_16x16x32_bf16 v[96:99], a[88:91], v[160:163], v[96:99]
 ds_read_b64_tr_b16 a[84:85], v8 offset:40960
 v_mul_f32 v77, v31, v77
 v_mfma_f32_16x16x32_bf16 v[100:103], a[88:91], v[164:167], v[100:103]
 s_waitcnt lgkmcnt(9)
 ds_read_b64_tr_b16 a[86:87], v8 offset:41472
 v_mul_f32 v78, v31, v78
 v_mfma_f32_16x16x32_bf16 v[104:107], a[92:95], v[160:163], v[104:107]
 ds_read_b64_tr_b16 a[88:89], v9 offset:40960
 v_mul_f32 v79, v31, v79
 v_mfma_f32_16x16x32_bf16 v[108:111], a[92:95], v[164:167], v[108:111]
 s_waitcnt lgkmcnt(9)
 ds_read_b64_tr_b16 a[90:91], v9 offset:41472
 s_add_u32 s78, s74, 128
 v_mfma_f32_16x16x32_bf16 v[80:83], a[96:99], v[168:171], v[80:83]
 s_add_u32 m0, s69, 73728
 ds_read_b64_tr_b16 a[92:93], v10 offset:40960
 buffer_load_dwordx4 v21, s[20:23], s78 offen  lds
 v_mfma_f32_16x16x32_bf16 v[84:87], a[96:99], v[172:175], v[84:87]
 s_waitcnt lgkmcnt(9)
 ds_read_b64_tr_b16 a[94:95], v10 offset:41472
 buffer_load_dwordx4 v[22:25], v46, s[44:47], s51 offen offset:0
 v_mfma_f32_16x16x32_bf16 v[88:91], a[72:75], v[168:171], v[88:91]
 s_mov_b32 s51, 2304
 ds_read_b64_tr_b16 a[96:97], v11 offset:40960
 s_cmp_ge_u32 s68, 2
 s_cselect_b32 s40, s20, s16
 s_cselect_b32 s41, s21, s17
 s_cselect_b32 s50, 576, s51
 v_mfma_f32_16x16x32_bf16 v[92:95], a[72:75], v[172:175], v[92:95]
 s_waitcnt lgkmcnt(9)
 ds_read_b64_tr_b16 a[98:99], v11 offset:41472
 s_mov_b32 s42, 5308416
 v_mfma_f32_16x16x32_bf16 v[96:99], a[76:79], v[168:171], v[96:99]
 s_mov_b32 s43, 0x20000
 ds_read_b64_tr_b16 a[72:73], v8 offset:45056
 s_mul_i32 s86, s71, s50
 v_mfma_f32_16x16x32_bf16 v[100:103], a[76:79], v[172:175], v[100:103]
 s_waitcnt lgkmcnt(9)
 ds_read_b64_tr_b16 a[74:75], v8 offset:45568
 s_add_u32 s78, s74, 295040
 v_mfma_f32_16x16x32_bf16 v[104:107], a[80:83], v[168:171], v[104:107]
 s_add_u32 m0, s69, 77824
 ds_read_b64_tr_b16 a[76:77], v9 offset:45056
 buffer_load_dwordx4 v21, s[20:23], s78 offen  lds
 v_mfma_f32_16x16x32_bf16 v[108:111], a[80:83], v[172:175], v[108:111]
 s_waitcnt lgkmcnt(9)
 ds_read_b64_tr_b16 a[78:79], v9 offset:45568
 s_add_u32 s86, s86, 2424832
 v_mfma_f32_16x16x32_bf16 v[80:83], a[84:87], v[176:179], v[80:83]
 s_lshr_b32 s48, s71, 1
 ds_read_b64_tr_b16 a[80:81], v10 offset:45056
 s_mul_i32 s48, s48, 1152
 v_mfma_f32_16x16x32_bf16 v[84:87], a[84:87], v[180:183], v[84:87]
 s_waitcnt lgkmcnt(9)
 ds_read_b64_tr_b16 a[82:83], v10 offset:45568
 s_and_b32 s49, s71, 1
 v_mfma_f32_16x16x32_bf16 v[88:91], a[88:91], v[176:179], v[88:91]
 s_lshl_b32 s75, s49, 6
 ds_read_b64_tr_b16 a[84:85], v11 offset:45056
 s_add_u32 s75, s75, s48
 v_mfma_f32_16x16x32_bf16 v[92:95], a[88:91], v[180:183], v[92:95]
 s_waitcnt lgkmcnt(9)
 ds_read_b64_tr_b16 a[86:87], v11 offset:45568
 s_add_u32 s78, s74, 589952
 v_mfma_f32_16x16x32_bf16 v[96:99], a[92:95], v[176:179], v[96:99]
 s_add_u32 m0, s69, 81920
 ds_read_b64_tr_b16 a[88:89], v8 offset:49152
 buffer_load_dwordx4 v21, s[20:23], s78 offen  lds
 v_mfma_f32_16x16x32_bf16 v[100:103], a[92:95], v[180:183], v[100:103]
 s_waitcnt lgkmcnt(9)
 ds_read_b64_tr_b16 a[90:91], v8 offset:49664
 s_add_u32 s75, s75, 512
 v_mfma_f32_16x16x32_bf16 v[104:107], a[96:99], v[176:179], v[104:107]
 s_mul_i32 s76, s74, 576
 ds_read_b64_tr_b16 a[92:93], v9 offset:49152
 s_mul_i32 s77, s75, 576
 v_mfma_f32_16x16x32_bf16 v[108:111], a[96:99], v[180:183], v[108:111]
 s_waitcnt lgkmcnt(9)
 ds_read_b64_tr_b16 a[94:95], v9 offset:49664
 v_min_u32 v39, 8, v0
 v_mfma_f32_16x16x32_bf16 v[80:83], a[72:75], v[184:187], v[80:83]
 ds_read_b64_tr_b16 a[96:97], v10 offset:49152
 buffer_load_dword a160, v3, s[16:19], s74 offen offset:256
 v_mfma_f32_16x16x32_bf16 v[84:87], a[72:75], v[188:191], v[84:87]
 s_waitcnt lgkmcnt(9)
 ds_read_b64_tr_b16 a[98:99], v10 offset:49664
 v_add_u32 v39, s81, v39
 v_mfma_f32_16x16x32_bf16 v[88:91], a[76:79], v[184:187], v[88:91]
 ds_read_b64_tr_b16 a[72:73], v11 offset:49152
 v_lshrrev_b32 v38, 1, v39
 v_mfma_f32_16x16x32_bf16 v[92:95], a[76:79], v[188:191], v[92:95]
 s_waitcnt lgkmcnt(9)
 ds_read_b64_tr_b16 a[74:75], v11 offset:49664
 v_and_b32 v39, 1, v39
 v_mfma_f32_16x16x32_bf16 v[96:99], a[80:83], v[184:187], v[96:99]
 ds_read_b64_tr_b16 a[76:77], v8 offset:53248
 v_mul_u32_u24 v40, 1152, v38
 v_mfma_f32_16x16x32_bf16 v[100:103], a[80:83], v[188:191], v[100:103]
 s_waitcnt lgkmcnt(9)
 ds_read_b64_tr_b16 a[78:79], v8 offset:53760
 v_lshl_add_u32 v40, v39, 7, v40
 v_mfma_f32_16x16x32_bf16 v[104:107], a[84:87], v[184:187], v[104:107]
 s_sub_u32 s48, s77, 294912
 ds_read_b64_tr_b16 a[80:81], v9 offset:53248
 v_add_u32 v41, s76, v40
 v_mfma_f32_16x16x32_bf16 v[108:111], a[84:87], v[188:191], v[108:111]
 s_waitcnt lgkmcnt(9)
 ds_read_b64_tr_b16 a[82:83], v9 offset:53760
 v_add_u32 v40, s48, v40
 v_mfma_f32_16x16x32_bf16 v[80:83], a[88:91], v[192:195], v[80:83]
 ds_read_b64_tr_b16 a[84:85], v10 offset:53248
 v_cmp_gt_u32 vcc, 0x100, v38
 v_mfma_f32_16x16x32_bf16 v[84:87], a[88:91], v[196:199], v[84:87]
 s_waitcnt lgkmcnt(9)
 ds_read_b64_tr_b16 a[86:87], v10 offset:53760
 v_cndmask_b32 v34, v40, v41, vcc
 v_mfma_f32_16x16x32_bf16 v[88:91], a[92:95], v[192:195], v[88:91]
 s_lshr_b32 s48, s2, 3
 ds_read_b64_tr_b16 a[88:89], v11 offset:53248
 s_lshl_b32 s48, s48, 2
 v_mfma_f32_16x16x32_bf16 v[92:95], a[92:95], v[196:199], v[92:95]
 s_waitcnt lgkmcnt(9)
 ds_read_b64_tr_b16 a[90:91], v11 offset:53760
 s_add_u32 s48, s48, s68
 v_mfma_f32_16x16x32_bf16 v[96:99], a[96:99], v[192:195], v[96:99]
 s_waitcnt vmcnt(29)
 s_barrier
 ds_read_b64_tr_b16 a[92:93], v8 offset:57344
 s_mul_i32 s48, s48, 41
 v_mfma_f32_16x16x32_bf16 v[100:103], a[96:99], v[196:199], v[100:103]
 s_waitcnt lgkmcnt(9)
 ds_read_b64_tr_b16 a[94:95], v8 offset:57856
 s_add_u32 s78, s74, 884864
 v_mfma_f32_16x16x32_bf16 v[104:107], a[72:75], v[192:195], v[104:107]
 s_add_u32 m0, s69, 86016
 ds_read_b64_tr_b16 a[96:97], v9 offset:57344
 buffer_load_dwordx4 v21, s[20:23], s78 offen  lds
 v_mfma_f32_16x16x32_bf16 v[108:111], a[72:75], v[196:199], v[108:111]
 s_waitcnt lgkmcnt(9)
 ds_read_b64_tr_b16 a[98:99], v9 offset:57856
 v_min_u32 v38, 40, v0
 v_mfma_f32_16x16x32_bf16 v[80:83], a[76:79], v[200:203], v[80:83]
 ds_read_b64_tr_b16 a[72:73], v10 offset:57344
 v_add_u32 v38, s48, v38
 v_mfma_f32_16x16x32_bf16 v[84:87], a[76:79], v[204:207], v[84:87]
 s_waitcnt lgkmcnt(9)
 ds_read_b64_tr_b16 a[74:75], v10 offset:57856
 v_lshlrev_b32 v35, 7, v38
 v_mfma_f32_16x16x32_bf16 v[88:91], a[80:83], v[200:203], v[88:91]
 s_lshl_b32 s48, s70, 3
 ds_read_b64_tr_b16 a[76:77], v11 offset:57344
 s_lshl_b32 s49, s68, 1
 v_mfma_f32_16x16x32_bf16 v[92:95], a[80:83], v[204:207], v[92:95]
 s_waitcnt lgkmcnt(9)
 ds_read_b64_tr_b16 a[78:79], v11 offset:57856
 s_add_u32 s48, s48, s49
 v_mfma_f32_16x16x32_bf16 v[96:99], a[84:87], v[200:203], v[96:99]
 s_lshl_b32 s48, s48, 4
 ds_read_b64_tr_b16 a[80:81], v8 offset:61440
 s_add_u32 s48, s48, s71
 v_mfma_f32_16x16x32_bf16 v[100:103], a[84:87], v[204:207], v[100:103]
 s_waitcnt lgkmcnt(9)
 ds_read_b64_tr_b16 a[82:83], v8 offset:61952
 s_mul_i32 s85, s48, 18432
 v_mfma_f32_16x16x32_bf16 v[104:107], a[88:91], v[200:203], v[104:107]
 s_add_u32 s85, s85, 12582912
 ds_read_b64_tr_b16 a[84:85], v9 offset:61440
 s_mul_i32 s48, s71, 2304
 v_mfma_f32_16x16x32_bf16 v[108:111], a[88:91], v[204:207], v[108:111]
 s_waitcnt lgkmcnt(9)
 ds_read_b64_tr_b16 a[86:87], v9 offset:61952
 s_add_u32 s90, s90, s48
 v_mfma_f32_16x16x32_bf16 v[80:83], a[92:95], v[208:211], v[80:83]
 s_mul_i32 s87, s68, 5120
 ds_read_b64_tr_b16 a[88:89], v10 offset:61440
 s_lshr_b32 s49, s71, 3
 v_mfma_f32_16x16x32_bf16 v[84:87], a[92:95], v[212:215], v[84:87]
 s_waitcnt lgkmcnt(9)
 ds_read_b64_tr_b16 a[90:91], v10 offset:61952
 s_add_u32 s78, s74, 1179776
 v_mfma_f32_16x16x32_bf16 v[88:91], a[96:99], v[208:211], v[88:91]
 s_add_u32 m0, s69, 90112
 ds_read_b64_tr_b16 a[92:93], v11 offset:61440
 buffer_load_dwordx4 v21, s[20:23], s78 offen  lds
 v_mfma_f32_16x16x32_bf16 v[92:95], a[96:99], v[212:215], v[92:95]
 s_waitcnt lgkmcnt(9)
 ds_read_b64_tr_b16 a[94:95], v11 offset:61952
 s_lshl_b32 s49, s49, 2
 v_mfma_f32_16x16x32_bf16 v[96:99], a[72:75], v[208:211], v[96:99]
 s_add_u32 s49, s49, s68
 ds_read_b64_tr_b16 a[96:97], v12 offset:0
 s_and_b32 s48, s71, 7
 v_mfma_f32_16x16x32_bf16 v[100:103], a[72:75], v[212:215], v[100:103]
 s_waitcnt lgkmcnt(9)
 ds_read_b64_tr_b16 a[98:99], v12 offset:512
 s_lshl_b32 s50, s70, 3
 v_mfma_f32_16x16x32_bf16 v[104:107], a[76:79], v[208:211], v[104:107]
 s_add_u32 s50, s50, s49
 ds_read_b64_tr_b16 a[72:73], v13 offset:0
 s_mul_i32 s91, s50, 294912
 v_mfma_f32_16x16x32_bf16 v[108:111], a[76:79], v[212:215], v[108:111]
 s_waitcnt lgkmcnt(9)
 ds_read_b64_tr_b16 a[74:75], v13 offset:512
 s_mul_i32 s51, s48, 2304
 v_mfma_f32_16x16x32_bf16 v[80:83], a[80:83], v[216:219], v[80:83]
 s_add_u32 s91, s91, s51
 ds_read_b64_tr_b16 a[76:77], v14 offset:0
 s_add_u32 s91, s91, 12582912
 v_mfma_f32_16x16x32_bf16 v[84:87], a[80:83], v[220:223], v[84:87]
 s_waitcnt lgkmcnt(9)
 ds_read_b64_tr_b16 a[78:79], v14 offset:512
 s_mul_i32 s92, s50, 18432
 v_mfma_f32_16x16x32_bf16 v[88:91], a[84:87], v[216:219], v[88:91]
 s_mul_i32 s51, s48, 144
 ds_read_b64_tr_b16 a[80:81], v15 offset:0
 s_add_u32 s92, s92, s51
 v_mfma_f32_16x16x32_bf16 v[92:95], a[84:87], v[220:223], v[92:95]
 s_waitcnt lgkmcnt(9)
 ds_read_b64_tr_b16 a[82:83], v15 offset:512
 s_mov_b32 s93, s51
 v_mfma_f32_16x16x32_bf16 v[96:99], a[88:91], v[216:219], v[96:99]
 s_mul_i32 s73, s48, 2
 ds_read_b64_tr_b16 a[84:85], v12 offset:4096
 s_lshl_b32 s96, s49, 4
 v_mfma_f32_16x16x32_bf16 v[100:103], a[88:91], v[220:223], v[100:103]
 s_waitcnt lgkmcnt(9)
 ds_read_b64_tr_b16 a[86:87], v12 offset:4608
 s_add_u32 s78, s74, 1474688
 v_mfma_f32_16x16x32_bf16 v[104:107], a[92:95], v[216:219], v[104:107]
 s_add_u32 m0, s69, 94208
 ds_read_b64_tr_b16 a[88:89], v12 offset:8192
 buffer_load_dwordx4 v21, s[20:23], s78 offen  lds
 v_mfma_f32_16x16x32_bf16 v[108:111], a[92:95], v[220:223], v[108:111]
 s_waitcnt lgkmcnt(9)
 ds_read_b64_tr_b16 a[90:91], v12 offset:8704
 v_lshlrev_b32 v46, 4, v0
 v_mfma_f32_16x16x32_bf16 v[80:83], a[96:99], v[224:227], v[80:83]
 s_mul_i32 s51, s68, 5120
 ds_read_b64_tr_b16 a[92:93], v12 offset:12288
 v_mfma_f32_16x16x32_bf16 v[84:87], a[96:99], v[228:231], v[84:87]
 s_waitcnt lgkmcnt(9)
 ds_read_b64_tr_b16 a[94:95], v12 offset:12800
 v_mfma_f32_16x16x32_bf16 v[88:91], a[72:75], v[224:227], v[88:91]
 s_add_u32 s51, s51, L_tab_wave-parallel_sum__mha_block__glu_gated_bilinear__prompt_kernel
 ds_read_b64_tr_b16 a[96:97], v13 offset:4096
 v_mfma_f32_16x16x32_bf16 v[92:95], a[72:75], v[228:231], v[92:95]
 s_waitcnt lgkmcnt(9)
 ds_read_b64_tr_b16 a[98:99], v13 offset:4608
 v_mfma_f32_16x16x32_bf16 v[96:99], a[76:79], v[224:227], v[96:99]
 s_mov_b32 s50, L_tab-parallel_sum__mha_block__glu_gated_bilinear__prompt_kernel
 ds_read_b64_tr_b16 a[72:73], v13 offset:8192
 buffer_load_dwordx4 a[132:135], v46, s[44:47], s51 offen offset:1024
 v_mfma_f32_16x16x32_bf16 v[100:103], a[76:79], v[228:231], v[100:103]
 s_waitcnt lgkmcnt(9)
 ds_read_b64_tr_b16 a[74:75], v13 offset:8704
 v_mfma_f32_16x16x32_bf16 v[104:107], a[80:83], v[224:227], v[104:107]
 ds_read_b64_tr_b16 a[76:77], v13 offset:12288
 v_mfma_f32_16x16x32_bf16 v[108:111], a[80:83], v[228:231], v[108:111]
 s_waitcnt lgkmcnt(9)
 ds_read_b64_tr_b16 a[78:79], v13 offset:12800
 v_mfma_f32_16x16x32_bf16 v[80:83], a[84:87], v[232:235], v[80:83]
 ds_read_b64_tr_b16 a[80:81], v14 offset:4096
 v_mfma_f32_16x16x32_bf16 v[84:87], a[84:87], v[236:239], v[84:87]
 s_waitcnt lgkmcnt(9)
 ds_read_b64_tr_b16 a[82:83], v14 offset:4608
 s_add_u32 s78, s74, 1769600
 v_mfma_f32_16x16x32_bf16 v[80:83], a[88:91], v[240:243], v[80:83]
 s_add_u32 m0, s69, 98304
 ds_read_b64_tr_b16 a[84:85], v14 offset:8192
 buffer_load_dwordx4 v21, s[20:23], s78 offen  lds
 v_mfma_f32_16x16x32_bf16 v[84:87], a[88:91], v[244:247], v[84:87]
 s_waitcnt lgkmcnt(9)
 ds_read_b64_tr_b16 a[86:87], v14 offset:8704
 v_mfma_f32_16x16x32_bf16 v[80:83], a[92:95], v[248:251], v[80:83]
 ds_read_b64_tr_b16 a[88:89], v14 offset:12288
 v_mfma_f32_16x16x32_bf16 v[84:87], a[92:95], v[252:255], v[84:87]
 s_waitcnt lgkmcnt(9)
 ds_read_b64_tr_b16 a[90:91], v14 offset:12800
 v_mfma_f32_16x16x32_bf16 v[88:91], a[96:99], v[232:235], v[88:91]
 ds_read_b64_tr_b16 a[92:93], v15 offset:4096
 v_mfma_f32_16x16x32_bf16 v[92:95], a[96:99], v[236:239], v[92:95]
 s_waitcnt lgkmcnt(9)
 ds_read_b64_tr_b16 a[94:95], v15 offset:4608
 buffer_load_dwordx4 a[136:139], v46, s[44:47], s51 offen offset:2048
 v_mfma_f32_16x16x32_bf16 v[88:91], a[72:75], v[240:243], v[88:91]
 ds_read_b64_tr_b16 a[96:97], v15 offset:8192
 v_mfma_f32_16x16x32_bf16 v[92:95], a[72:75], v[244:247], v[92:95]
 s_waitcnt lgkmcnt(9)
 ds_read_b64_tr_b16 a[98:99], v15 offset:8704
 v_mul_f32 v80, v48, v80
 v_mfma_f32_16x16x32_bf16 v[88:91], a[76:79], v[248:251], v[88:91]
 ds_read_b64_tr_b16 a[72:73], v15 offset:12288
 v_mul_f32 v81, v49, v81
 v_mfma_f32_16x16x32_bf16 v[92:95], a[76:79], v[252:255], v[92:95]
 s_waitcnt lgkmcnt(9)
 ds_read_b64_tr_b16 a[74:75], v15 offset:12800
 v_mul_f32 v82, v50, v82
 v_mfma_f32_16x16x32_bf16 v[96:99], a[80:83], v[232:235], v[96:99]
 s_waitcnt vmcnt(29)
 s_barrier
 ds_read_b64_tr_b16 a[76:77], v4 offset:0
 v_mul_f32 v83, v51, v83
 v_mfma_f32_16x16x32_bf16 v[100:103], a[80:83], v[236:239], v[100:103]
 s_waitcnt lgkmcnt(9)
 ds_read_b64_tr_b16 a[78:79], v4 offset:512
 s_add_u32 s78, s74, 2064512
 v_mfma_f32_16x16x32_bf16 v[96:99], a[84:87], v[240:243], v[96:99]
 s_add_u32 m0, s69, 102400
 ds_read_b64_tr_b16 a[80:81], v4 offset:4096
 buffer_load_dwordx4 v21, s[20:23], s78 offen  lds
 v_mfma_f32_16x16x32_bf16 v[100:103], a[84:87], v[244:247], v[100:103]
 s_waitcnt lgkmcnt(9)
 ds_read_b64_tr_b16 a[82:83], v4 offset:4608
 v_mul_f32 v84, v52, v84
 v_mfma_f32_16x16x32_bf16 v[96:99], a[88:91], v[248:251], v[96:99]
 ds_read_b64_tr_b16 a[84:85], v4 offset:8192
 v_mul_f32 v85, v53, v85
 v_mfma_f32_16x16x32_bf16 v[100:103], a[88:91], v[252:255], v[100:103]
 s_waitcnt lgkmcnt(9)
 ds_read_b64_tr_b16 a[86:87], v4 offset:8704
 v_mul_f32 v86, v54, v86
 v_mfma_f32_16x16x32_bf16 v[104:107], a[92:95], v[232:235], v[104:107]
 ds_read_b64_tr_b16 a[88:89], v5 offset:0
 v_mul_f32 v87, v55, v87
 v_mfma_f32_16x16x32_bf16 v[108:111], a[92:95], v[236:239], v[108:111]
 s_waitcnt lgkmcnt(9)
 ds_read_b64_tr_b16 a[90:91], v5 offset:512
 v_mul_f32 v88, v56, v88
 v_mul_f32 v89, v57, v89
 v_mfma_f32_16x16x32_bf16 v[104:107], a[96:99], v[240:243], v[104:107]
 ds_read_b64_tr_b16 a[92:93], v5 offset:4096
 v_mul_f32 v90, v58, v90
 v_mul_f32 v91, v59, v91
 v_mfma_f32_16x16x32_bf16 v[108:111], a[96:99], v[244:247], v[108:111]
 s_waitcnt lgkmcnt(9)
 ds_read_b64_tr_b16 a[94:95], v5 offset:4608
 v_mul_f32 v92, v60, v92
 v_mul_f32 v93, v61, v93
 v_mfma_f32_16x16x32_bf16 v[104:107], a[72:75], v[248:251], v[104:107]
 ds_read_b64_tr_b16 a[96:97], v5 offset:8192
 v_mul_f32 v94, v62, v94
 v_mul_f32 v95, v63, v95
 v_mfma_f32_16x16x32_bf16 v[108:111], a[72:75], v[252:255], v[108:111]
 s_waitcnt lgkmcnt(9)
 ds_read_b64_tr_b16 a[98:99], v5 offset:8704
 v_mul_f32 v96, v64, v96
 v_mfma_f32_16x16x32_bf16 v[48:51], a[76:79], v[112:115], 0
 ds_read_b64_tr_b16 a[72:73], v6 offset:0
 v_mul_f32 v97, v65, v97
 v_mfma_f32_16x16x32_bf16 v[52:55], a[76:79], v[116:119], 0
 s_waitcnt lgkmcnt(9)
 ds_read_b64_tr_b16 a[74:75], v6 offset:512
 s_add_u32 s78, s74, 2359424
 v_mfma_f32_16x16x32_bf16 v[48:51], a[80:83], v[120:123], v[48:51]
 s_add_u32 m0, s69, 106496
 ds_read_b64_tr_b16 a[76:77], v6 offset:4096
 buffer_load_dwordx4 v21, s[20:23], s78 offen  lds
 v_mfma_f32_16x16x32_bf16 v[52:55], a[80:83], v[124:127], v[52:55]
 s_waitcnt lgkmcnt(9)
 ds_read_b64_tr_b16 a[78:79], v6 offset:4608
 v_mul_f32 v98, v66, v98
 v_mfma_f32_16x16x32_bf16 v[48:51], a[84:87], v[128:131], v[48:51]
 ds_read_b64_tr_b16 a[80:81], v6 offset:8192
 v_mul_f32 v99, v67, v99
 v_mfma_f32_16x16x32_bf16 v[52:55], a[84:87], v[132:135], v[52:55]
 s_waitcnt lgkmcnt(9)
 ds_read_b64_tr_b16 a[82:83], v6 offset:8704
 v_mul_f32 v100, v68, v100
 v_mul_f32 v101, v69, v101
 v_mfma_f32_16x16x32_bf16 v[56:59], a[88:91], v[112:115], 0
 ds_read_b64_tr_b16 a[84:85], v7 offset:0
 v_mul_f32 v102, v70, v102
 v_mul_f32 v103, v71, v103
 v_mfma_f32_16x16x32_bf16 v[60:63], a[88:91], v[116:119], 0
 s_waitcnt lgkmcnt(9)
 ds_read_b64_tr_b16 a[86:87], v7 offset:512
 v_mul_f32 v104, v72, v104
 v_mul_f32 v105, v73, v105
 v_mfma_f32_16x16x32_bf16 v[56:59], a[92:95], v[120:123], v[56:59]
 ds_read_b64_tr_b16 a[88:89], v7 offset:4096
 v_mul_f32 v106, v74, v106
 v_mul_f32 v107, v75, v107
 v_mfma_f32_16x16x32_bf16 v[60:63], a[92:95], v[124:127], v[60:63]
 s_waitcnt lgkmcnt(9)
 ds_read_b64_tr_b16 a[90:91], v7 offset:4608
 v_mul_f32 v108, v76, v108
 v_mul_f32 v109, v77, v109
 v_mfma_f32_16x16x32_bf16 v[56:59], a[96:99], v[128:131], v[56:59]
 ds_read_b64_tr_b16 a[92:93], v7 offset:8192
 v_mul_f32 v110, v78, v110
 v_mul_f32 v111, v79, v111
 v_mfma_f32_16x16x32_bf16 v[60:63], a[96:99], v[132:135], v[60:63]
 s_waitcnt lgkmcnt(9)
 ds_read_b64_tr_b16 a[94:95], v7 offset:8704
 v_cvt_pk_bf16_f32 v32, v80, v81
 v_mfma_f32_16x16x32_bf16 v[64:67], a[72:75], v[112:115], 0
 ds_read_b64_tr_b16 a[96:97], v4 offset:12288
 v_accvgpr_write_b32 a0, v32
 v_mfma_f32_16x16x32_bf16 v[68:71], a[72:75], v[116:119], 0
 s_waitcnt lgkmcnt(9)
 ds_read_b64_tr_b16 a[98:99], v4 offset:12800
 s_add_u32 s78, s74, 2654336
 v_mfma_f32_16x16x32_bf16 v[64:67], a[76:79], v[120:123], v[64:67]
 s_add_u32 m0, s69, 110592
 ds_read_b64_tr_b16 a[72:73], v5 offset:12288
 buffer_load_dwordx4 v21, s[20:23], s78 offen  lds
 v_mfma_f32_16x16x32_bf16 v[68:71], a[76:79], v[124:127], v[68:71]
 s_waitcnt lgkmcnt(9)
 ds_read_b64_tr_b16 a[74:75], v5 offset:12800
 v_cvt_pk_bf16_f32 v33, v82, v83
 v_mfma_f32_16x16x32_bf16 v[64:67], a[80:83], v[128:131], v[64:67]
 ds_read_b64_tr_b16 a[76:77], v6 offset:12288
 v_accvgpr_write_b32 a1, v33
 v_mfma_f32_16x16x32_bf16 v[68:71], a[80:83], v[132:135], v[68:71]
 s_waitcnt lgkmcnt(9)
 ds_read_b64_tr_b16 a[78:79], v6 offset:12800
 v_cvt_pk_bf16_f32 v32, v84, v85
 v_mfma_f32_16x16x32_bf16 v[72:75], a[84:87], v[112:115], 0
 ds_read_b64_tr_b16 a[80:81], v7 offset:12288
 v_accvgpr_write_b32 a4, v32
 v_mfma_f32_16x16x32_bf16 v[76:79], a[84:87], v[116:119], 0
 s_waitcnt lgkmcnt(9)
 ds_read_b64_tr_b16 a[82:83], v7 offset:12800
 s_add_u32 s78, s74, 2949248
 v_mfma_f32_16x16x32_bf16 v[72:75], a[88:91], v[120:123], v[72:75]
 s_add_u32 m0, s69, 114688
 ds_read_b64_tr_b16 a[84:85], v4 offset:16384
 buffer_load_dwordx4 v21, s[20:23], s78 offen  lds
 v_mfma_f32_16x16x32_bf16 v[76:79], a[88:91], v[124:127], v[76:79]
 s_waitcnt lgkmcnt(9)
 ds_read_b64_tr_b16 a[86:87], v4 offset:16896
 v_cvt_pk_bf16_f32 v33, v86, v87
 v_mfma_f32_16x16x32_bf16 v[72:75], a[92:95], v[128:131], v[72:75]
 ds_read_b64_tr_b16 a[88:89], v5 offset:16384
 v_accvgpr_write_b32 a5, v33
 v_mfma_f32_16x16x32_bf16 v[76:79], a[92:95], v[132:135], v[76:79]
 s_waitcnt lgkmcnt(9)
 ds_read_b64_tr_b16 a[90:91], v5 offset:16896
 v_cvt_pk_bf16_f32 v32, v88, v89
 v_mfma_f32_16x16x32_bf16 v[48:51], a[96:99], v[136:139], v[48:51]
 ds_read_b64_tr_b16 a[92:93], v6 offset:16384
 v_accvgpr_write_b32 a2, v32
 v_mfma_f32_16x16x32_bf16 v[52:55], a[96:99], v[140:143], v[52:55]
 s_waitcnt lgkmcnt(9)
 ds_read_b64_tr_b16 a[94:95], v6 offset:16896
 s_add_u32 s78, s74, 3244160
 v_mfma_f32_16x16x32_bf16 v[56:59], a[72:75], v[136:139], v[56:59]
 s_add_u32 m0, s69, 118784
 ds_read_b64_tr_b16 a[96:97], v7 offset:16384
 buffer_load_dwordx4 v21, s[20:23], s78 offen  lds
 v_mfma_f32_16x16x32_bf16 v[60:63], a[72:75], v[140:143], v[60:63]
 s_waitcnt lgkmcnt(9)
 ds_read_b64_tr_b16 a[98:99], v7 offset:16896
 v_cvt_pk_bf16_f32 v33, v90, v91
 v_mfma_f32_16x16x32_bf16 v[64:67], a[76:79], v[136:139], v[64:67]
 ds_read_b64_tr_b16 a[72:73], v4 offset:20480
 v_accvgpr_write_b32 a3, v33
 v_mfma_f32_16x16x32_bf16 v[68:71], a[76:79], v[140:143], v[68:71]
 s_waitcnt lgkmcnt(9)
 ds_read_b64_tr_b16 a[74:75], v4 offset:20992
 v_cvt_pk_bf16_f32 v32, v92, v93
 v_mfma_f32_16x16x32_bf16 v[72:75], a[80:83], v[136:139], v[72:75]
 ds_read_b64_tr_b16 a[76:77], v5 offset:20480
 v_accvgpr_write_b32 a6, v32
 v_mfma_f32_16x16x32_bf16 v[76:79], a[80:83], v[140:143], v[76:79]
 s_waitcnt lgkmcnt(9)
 ds_read_b64_tr_b16 a[78:79], v5 offset:20992
 s_add_u32 s78, s74, 3539072
 v_mfma_f32_16x16x32_bf16 v[48:51], a[84:87], v[144:147], v[48:51]
 s_add_u32 m0, s69, 122880
 ds_read_b64_tr_b16 a[80:81], v6 offset:20480
 buffer_load_dwordx4 v21, s[20:23], s78 offen  lds
 v_mfma_f32_16x16x32_bf16 v[52:55], a[84:87], v[148:151], v[52:55]
 s_waitcnt lgkmcnt(9)
 ds_read_b64_tr_b16 a[82:83], v6 offset:20992
 v_cvt_pk_bf16_f32 v33, v94, v95
 v_mfma_f32_16x16x32_bf16 v[56:59], a[88:91], v[144:147], v[56:59]
 ds_read_b64_tr_b16 a[84:85], v7 offset:20480
 v_accvgpr_write_b32 a7, v33
 v_mfma_f32_16x16x32_bf16 v[60:63], a[88:91], v[148:151], v[60:63]
 s_waitcnt lgkmcnt(9)
 ds_read_b64_tr_b16 a[86:87], v7 offset:20992
 v_cvt_pk_bf16_f32 v32, v96, v97
 v_mfma_f32_16x16x32_bf16 v[64:67], a[92:95], v[144:147], v[64:67]
 s_waitcnt vmcnt(15)
 s_barrier
 ds_read_b64_tr_b16 a[88:89], v4 offset:24576
 v_accvgpr_write_b32 a8, v32
 v_mfma_f32_16x16x32_bf16 v[68:71], a[92:95], v[148:151], v[68:71]
 s_waitcnt lgkmcnt(9)
 ds_read_b64_tr_b16 a[90:91], v4 offset:25088
 s_add_u32 s78, s74, 3833984
 v_mfma_f32_16x16x32_bf16 v[72:75], a[96:99], v[144:147], v[72:75]
 s_add_u32 m0, s69, 126976
 ds_read_b64_tr_b16 a[92:93], v5 offset:24576
 buffer_load_dwordx4 v21, s[20:23], s78 offen  lds
 v_mfma_f32_16x16x32_bf16 v[76:79], a[96:99], v[148:151], v[76:79]
 s_waitcnt lgkmcnt(9)
 ds_read_b64_tr_b16 a[94:95], v5 offset:25088
 v_cvt_pk_bf16_f32 v33, v98, v99
 v_mfma_f32_16x16x32_bf16 v[48:51], a[72:75], v[152:155], v[48:51]
 ds_read_b64_tr_b16 a[96:97], v6 offset:24576
 v_accvgpr_write_b32 a9, v33
 v_mfma_f32_16x16x32_bf16 v[52:55], a[72:75], v[156:159], v[52:55]
 s_waitcnt lgkmcnt(9)
 ds_read_b64_tr_b16 a[98:99], v6 offset:25088
 v_cvt_pk_bf16_f32 v32, v100, v101
 v_mfma_f32_16x16x32_bf16 v[56:59], a[76:79], v[152:155], v[56:59]
 s_and_b32 s99, s70, 15
 ds_read_b64_tr_b16 a[72:73], v7 offset:24576
 v_accvgpr_write_b32 a12, v32
 v_mfma_f32_16x16x32_bf16 v[60:63], a[76:79], v[156:159], v[60:63]
 s_waitcnt lgkmcnt(9)
 ds_read_b64_tr_b16 a[74:75], v7 offset:25088
 s_add_u32 s78, s74, 4128896
 v_mfma_f32_16x16x32_bf16 v[64:67], a[80:83], v[152:155], v[64:67]
 s_add_u32 m0, s69, 131072
 ds_read_b64_tr_b16 a[76:77], v4 offset:28672
 buffer_load_dwordx4 v21, s[20:23], s78 offen  lds
 v_mfma_f32_16x16x32_bf16 v[68:71], a[80:83], v[156:159], v[68:71]
 s_waitcnt lgkmcnt(9)
 ds_read_b64_tr_b16 a[78:79], v4 offset:29184
 v_cvt_pk_bf16_f32 v33, v102, v103
 v_mfma_f32_16x16x32_bf16 v[72:75], a[84:87], v[152:155], v[72:75]
 s_cmp_eq_u32 s99, 0
 s_cselect_b32 s99, s94, 0x40000000
 ds_read_b64_tr_b16 a[80:81], v5 offset:28672
 v_accvgpr_write_b32 a13, v33
 v_mfma_f32_16x16x32_bf16 v[76:79], a[84:87], v[156:159], v[76:79]
 s_waitcnt lgkmcnt(9)
 ds_read_b64_tr_b16 a[82:83], v5 offset:29184
 v_cvt_pk_bf16_f32 v32, v104, v105
 v_mfma_f32_16x16x32_bf16 v[48:51], a[88:91], v[160:163], v[48:51]
 ds_read_b64_tr_b16 a[84:85], v6 offset:28672
 v_accvgpr_write_b32 a10, v32
 v_mfma_f32_16x16x32_bf16 v[52:55], a[88:91], v[164:167], v[52:55]
 s_waitcnt lgkmcnt(9)
 ds_read_b64_tr_b16 a[86:87], v6 offset:29184
 s_add_u32 s78, s74, 4423808
 v_mfma_f32_16x16x32_bf16 v[56:59], a[92:95], v[160:163], v[56:59]
 s_add_u32 m0, s69, 135168
 ds_read_b64_tr_b16 a[88:89], v7 offset:28672
 buffer_load_dwordx4 v21, s[20:23], s78 offen  lds
 v_mfma_f32_16x16x32_bf16 v[60:63], a[92:95], v[164:167], v[60:63]
 s_waitcnt lgkmcnt(9)
 ds_read_b64_tr_b16 a[90:91], v7 offset:29184
 v_cvt_pk_bf16_f32 v33, v106, v107
 v_mfma_f32_16x16x32_bf16 v[64:67], a[96:99], v[160:163], v[64:67]
 ds_read_b64_tr_b16 a[92:93], v4 offset:32768
 v_accvgpr_write_b32 a11, v33
 v_mfma_f32_16x16x32_bf16 v[68:71], a[96:99], v[164:167], v[68:71]
 s_waitcnt lgkmcnt(9)
 ds_read_b64_tr_b16 a[94:95], v4 offset:33280
 v_cvt_pk_bf16_f32 v32, v108, v109
 v_mfma_f32_16x16x32_bf16 v[72:75], a[72:75], v[160:163], v[72:75]
 ds_read_b64_tr_b16 a[96:97], v5 offset:32768
 v_accvgpr_write_b32 a14, v32
 v_mfma_f32_16x16x32_bf16 v[76:79], a[72:75], v[164:167], v[76:79]
 s_waitcnt lgkmcnt(9)
 ds_read_b64_tr_b16 a[98:99], v5 offset:33280
 s_add_u32 s78, s74, 4718720
 v_mfma_f32_16x16x32_bf16 v[48:51], a[76:79], v[168:171], v[48:51]
 s_add_u32 m0, s69, 139264
 ds_read_b64_tr_b16 a[72:73], v6 offset:32768
 buffer_load_dwordx4 v21, s[20:23], s78 offen  lds
 v_mfma_f32_16x16x32_bf16 v[52:55], a[76:79], v[172:175], v[52:55]
 s_waitcnt lgkmcnt(9)
 ds_read_b64_tr_b16 a[74:75], v6 offset:33280
 v_cvt_pk_bf16_f32 v33, v110, v111
 v_mfma_f32_16x16x32_bf16 v[56:59], a[80:83], v[168:171], v[56:59]
 ds_read_b64_tr_b16 a[76:77], v7 offset:32768
 v_accvgpr_write_b32 a15, v33
 v_mfma_f32_16x16x32_bf16 v[60:63], a[80:83], v[172:175], v[60:63]
 s_waitcnt lgkmcnt(9)
 ds_read_b64_tr_b16 a[78:79], v7 offset:33280
 buffer_atomic_add v36, v25, s[32:35], s99 offen sc1
 v_mfma_f32_16x16x32_bf16 v[64:67], a[84:87], v[168:171], v[64:67]
 ds_read_b64_tr_b16 a[80:81], v4 offset:36864
 buffer_load_dwordx4 a[140:143], v46, s[44:47], s51 offen offset:3072
 v_mfma_f32_16x16x32_bf16 v[68:71], a[84:87], v[172:175], v[68:71]
 s_waitcnt lgkmcnt(9)
 ds_read_b64_tr_b16 a[82:83], v4 offset:37376
 s_add_u32 s78, s74, 5013632
 v_mfma_f32_16x16x32_bf16 v[72:75], a[88:91], v[168:171], v[72:75]
 s_add_u32 m0, s69, 143360
 ds_read_b64_tr_b16 a[84:85], v5 offset:36864
 buffer_load_dwordx4 v21, s[20:23], s78 offen  lds
 v_mfma_f32_16x16x32_bf16 v[76:79], a[88:91], v[172:175], v[76:79]
 s_waitcnt lgkmcnt(9)
 ds_read_b64_tr_b16 a[86:87], v5 offset:37376
 v_mfma_f32_16x16x32_bf16 v[48:51], a[92:95], v[176:179], v[48:51]
 s_and_b32 s99, s70, 15
 ds_read_b64_tr_b16 a[88:89], v6 offset:36864
 v_mfma_f32_16x16x32_bf16 v[52:55], a[92:95], v[180:183], v[52:55]
 s_waitcnt lgkmcnt(9)
 ds_read_b64_tr_b16 a[90:91], v6 offset:37376
 v_mfma_f32_16x16x32_bf16 v[56:59], a[96:99], v[176:179], v[56:59]
 s_cmp_eq_u32 s99, 1
 s_cselect_b32 s99, s94, 0x40000000
 ds_read_b64_tr_b16 a[92:93], v7 offset:36864
 buffer_atomic_add v36, v25, s[32:35], s99 offen sc1
 v_mfma_f32_16x16x32_bf16 v[60:63], a[96:99], v[180:183], v[60:63]
 s_waitcnt lgkmcnt(9)
 ds_read_b64_tr_b16 a[94:95], v7 offset:37376
 s_add_u32 s78, s74, 256
 v_mfma_f32_16x16x32_bf16 v[64:67], a[72:75], v[176:179], v[64:67]
 s_add_u32 m0, s69, 0
 ds_read_b64_tr_b16 a[96:97], v4 offset:40960
 buffer_load_dwordx4 v21, s[16:19], s78 offen  lds
 v_mfma_f32_16x16x32_bf16 v[68:71], a[72:75], v[180:183], v[68:71]
 s_waitcnt lgkmcnt(9)
 ds_read_b64_tr_b16 a[98:99], v4 offset:41472
 v_mfma_f32_16x16x32_bf16 v[72:75], a[76:79], v[176:179], v[72:75]
 ds_read_b64_tr_b16 a[72:73], v5 offset:40960
 v_mfma_f32_16x16x32_bf16 v[76:79], a[76:79], v[180:183], v[76:79]
 s_waitcnt lgkmcnt(9)
 ds_read_b64_tr_b16 a[74:75], v5 offset:41472
 v_mfma_f32_16x16x32_bf16 v[48:51], a[80:83], v[184:187], v[48:51]
 s_add_u32 s51, s51, 4096
 ds_read_b64_tr_b16 a[76:77], v6 offset:40960
 buffer_load_dword a161, v3, s[20:23], s74 offen offset:256
 v_mfma_f32_16x16x32_bf16 v[52:55], a[80:83], v[188:191], v[52:55]
 s_waitcnt lgkmcnt(9)
 ds_read_b64_tr_b16 a[78:79], v6 offset:41472
 s_add_u32 s78, s74, 295168
 v_mfma_f32_16x16x32_bf16 v[56:59], a[84:87], v[184:187], v[56:59]
 s_add_u32 m0, s69, 4096
 ds_read_b64_tr_b16 a[80:81], v7 offset:40960
 buffer_load_dwordx4 v21, s[16:19], s78 offen  lds
 v_mfma_f32_16x16x32_bf16 v[60:63], a[84:87], v[188:191], v[60:63]
 s_waitcnt lgkmcnt(9)
 ds_read_b64_tr_b16 a[82:83], v7 offset:41472
 buffer_load_dwordx4 a[144:147], v46, s[44:47], s51 offen offset:0
 v_mfma_f32_16x16x32_bf16 v[64:67], a[88:91], v[184:187], v[64:67]
 ds_read_b64_tr_b16 a[84:85], v4 offset:45056
 v_mfma_f32_16x16x32_bf16 v[68:71], a[88:91], v[188:191], v[68:71]
 s_waitcnt lgkmcnt(9)
 ds_read_b64_tr_b16 a[86:87], v4 offset:45568
 v_mfma_f32_16x16x32_bf16 v[72:75], a[92:95], v[184:187], v[72:75]
 ds_read_b64_tr_b16 a[88:89], v5 offset:45056
 v_mfma_f32_16x16x32_bf16 v[76:79], a[92:95], v[188:191], v[76:79]
 s_waitcnt lgkmcnt(9)
 ds_read_b64_tr_b16 a[90:91], v5 offset:45568
 v_mfma_f32_16x16x32_bf16 v[48:51], a[96:99], v[192:195], v[48:51]
 ds_read_b64_tr_b16 a[92:93], v6 offset:45056
 v_mfma_f32_16x16x32_bf16 v[52:55], a[96:99], v[196:199], v[52:55]
 s_waitcnt lgkmcnt(9)
 ds_read_b64_tr_b16 a[94:95], v6 offset:45568
 v_mfma_f32_16x16x32_bf16 v[56:59], a[72:75], v[192:195], v[56:59]
 s_and_b32 s99, s70, 15
 ds_read_b64_tr_b16 a[96:97], v7 offset:45056
 v_mfma_f32_16x16x32_bf16 v[60:63], a[72:75], v[196:199], v[60:63]
 s_waitcnt lgkmcnt(9)
 ds_read_b64_tr_b16 a[98:99], v7 offset:45568
 v_mfma_f32_16x16x32_bf16 v[64:67], a[76:79], v[192:195], v[64:67]
 s_barrier
 ds_read_b64_tr_b16 a[72:73], v4 offset:49152
 v_mfma_f32_16x16x32_bf16 v[68:71], a[76:79], v[196:199], v[68:71]
 s_waitcnt lgkmcnt(9)
 ds_read_b64_tr_b16 a[74:75], v4 offset:49664
 s_add_u32 s78, s74, 590080
 v_mfma_f32_16x16x32_bf16 v[72:75], a[80:83], v[192:195], v[72:75]
 s_add_u32 m0, s69, 8192
 ds_read_b64_tr_b16 a[76:77], v5 offset:49152
 buffer_load_dwordx4 v21, s[16:19], s78 offen  lds
 v_mfma_f32_16x16x32_bf16 v[76:79], a[80:83], v[196:199], v[76:79]
 s_waitcnt lgkmcnt(9)
 ds_read_b64_tr_b16 a[78:79], v5 offset:49664
 buffer_load_dwordx4 v[16:19], v46, s[44:47], s50 offen offset:0
 v_mfma_f32_16x16x32_bf16 v[48:51], a[84:87], v[200:203], v[48:51]
 s_cmp_eq_u32 s99, 2
 s_cselect_b32 s99, s94, 0x40000000
 ds_read_b64_tr_b16 a[80:81], v6 offset:49152
 buffer_atomic_add v36, v25, s[32:35], s99 offen sc1
 v_mfma_f32_16x16x32_bf16 v[52:55], a[84:87], v[204:207], v[52:55]
 s_waitcnt lgkmcnt(9)
 ds_read_b64_tr_b16 a[82:83], v6 offset:49664
 v_mfma_f32_16x16x32_bf16 v[56:59], a[88:91], v[200:203], v[56:59]
 ds_read_b64_tr_b16 a[84:85], v7 offset:49152
 v_mfma_f32_16x16x32_bf16 v[60:63], a[88:91], v[204:207], v[60:63]
 s_waitcnt lgkmcnt(9)
 ds_read_b64_tr_b16 a[86:87], v7 offset:49664
 v_mfma_f32_16x16x32_bf16 v[64:67], a[92:95], v[200:203], v[64:67]
 ds_read_b64_tr_b16 a[88:89], v4 offset:53248
 v_mfma_f32_16x16x32_bf16 v[68:71], a[92:95], v[204:207], v[68:71]
 s_waitcnt lgkmcnt(9)
 ds_read_b64_tr_b16 a[90:91], v4 offset:53760
 v_mfma_f32_16x16x32_bf16 v[72:75], a[96:99], v[200:203], v[72:75]
 ds_read_b64_tr_b16 a[92:93], v5 offset:53248
 v_mfma_f32_16x16x32_bf16 v[76:79], a[96:99], v[204:207], v[76:79]
 s_waitcnt lgkmcnt(9)
 ds_read_b64_tr_b16 a[94:95], v5 offset:53760
 v_mfma_f32_16x16x32_bf16 v[48:51], a[72:75], v[208:211], v[48:51]
 ds_read_b64_tr_b16 a[96:97], v6 offset:53248
 v_mfma_f32_16x16x32_bf16 v[52:55], a[72:75], v[212:215], v[52:55]
 s_waitcnt lgkmcnt(9)
 ds_read_b64_tr_b16 a[98:99], v6 offset:53760
 s_add_u32 s78, s74, 884992
 v_mfma_f32_16x16x32_bf16 v[56:59], a[76:79], v[208:211], v[56:59]
 s_add_u32 m0, s69, 12288
 ds_read_b64_tr_b16 a[72:73], v7 offset:53248
 buffer_load_dwordx4 v21, s[16:19], s78 offen  lds
 v_mfma_f32_16x16x32_bf16 v[60:63], a[76:79], v[212:215], v[60:63]
 s_waitcnt lgkmcnt(9)
 ds_read_b64_tr_b16 a[74:75], v7 offset:53760
 buffer_load_dwordx4 a[100:103], v46, s[44:47], s50 offen offset:1024
 v_mfma_f32_16x16x32_bf16 v[64:67], a[80:83], v[208:211], v[64:67]
 ds_read_b64_tr_b16 a[76:77], v4 offset:57344
 v_mfma_f32_16x16x32_bf16 v[68:71], a[80:83], v[212:215], v[68:71]
 s_waitcnt lgkmcnt(9)
 ds_read_b64_tr_b16 a[78:79], v4 offset:57856
 v_mfma_f32_16x16x32_bf16 v[72:75], a[84:87], v[208:211], v[72:75]
 s_and_b32 s99, s70, 15
 ds_read_b64_tr_b16 a[80:81], v5 offset:57344
 v_mfma_f32_16x16x32_bf16 v[76:79], a[84:87], v[212:215], v[76:79]
 s_waitcnt lgkmcnt(9)
 ds_read_b64_tr_b16 a[82:83], v5 offset:57856
 v_mfma_f32_16x16x32_bf16 v[48:51], a[88:91], v[216:219], v[48:51]
 s_cmp_eq_u32 s99, 3
 s_cselect_b32 s99, s94, 0x40000000
 ds_read_b64_tr_b16 a[84:85], v6 offset:57344
 buffer_atomic_add v36, v25, s[32:35], s99 offen sc1
 v_mfma_f32_16x16x32_bf16 v[52:55], a[88:91], v[220:223], v[52:55]
 s_waitcnt lgkmcnt(9)
 ds_read_b64_tr_b16 a[86:87], v6 offset:57856
 v_mfma_f32_16x16x32_bf16 v[56:59], a[92:95], v[216:219], v[56:59]
 ds_read_b64_tr_b16 a[88:89], v7 offset:57344
 v_mfma_f32_16x16x32_bf16 v[60:63], a[92:95], v[220:223], v[60:63]
 s_waitcnt lgkmcnt(9)
 ds_read_b64_tr_b16 a[90:91], v7 offset:57856
 v_mfma_f32_16x16x32_bf16 v[64:67], a[96:99], v[216:219], v[64:67]
 ds_read_b64_tr_b16 a[92:93], v4 offset:61440
 v_mfma_f32_16x16x32_bf16 v[68:71], a[96:99], v[220:223], v[68:71]
 s_waitcnt lgkmcnt(9)
 ds_read_b64_tr_b16 a[94:95], v4 offset:61952
 s_add_u32 s78, s74, 1179904
 v_mfma_f32_16x16x32_bf16 v[72:75], a[72:75], v[216:219], v[72:75]
 s_add_u32 m0, s69, 16384
 ds_read_b64_tr_b16 a[96:97], v5 offset:61440
 buffer_load_dwordx4 v21, s[16:19], s78 offen  lds
 v_mfma_f32_16x16x32_bf16 v[76:79], a[72:75], v[220:223], v[76:79]
 s_waitcnt lgkmcnt(9)
 ds_read_b64_tr_b16 a[98:99], v5 offset:61952
 buffer_load_dwordx4 a[104:107], v46, s[44:47], s50 offen offset:2048
 v_mfma_f32_16x16x32_bf16 v[48:51], a[76:79], v[224:227], v[48:51]
 ds_read_b64_tr_b16 a[72:73], v6 offset:61440
 v_mfma_f32_16x16x32_bf16 v[52:55], a[76:79], v[228:231], v[52:55]
 s_waitcnt lgkmcnt(9)
 ds_read_b64_tr_b16 a[74:75], v6 offset:61952
 v_mfma_f32_16x16x32_bf16 v[56:59], a[80:83], v[224:227], v[56:59]
 ds_read_b64_tr_b16 a[76:77], v7 offset:61440
 v_mfma_f32_16x16x32_bf16 v[60:63], a[80:83], v[228:231], v[60:63]
 s_waitcnt lgkmcnt(9)
 ds_read_b64_tr_b16 a[78:79], v7 offset:61952
 v_mfma_f32_16x16x32_bf16 v[64:67], a[84:87], v[224:227], v[64:67]
 ds_read_b64_tr_b16 a[80:81], v8 offset:0
 v_mfma_f32_16x16x32_bf16 v[68:71], a[84:87], v[228:231], v[68:71]
 s_waitcnt lgkmcnt(9)
 ds_read_b64_tr_b16 a[82:83], v8 offset:512
 v_mfma_f32_16x16x32_bf16 v[72:75], a[88:91], v[224:227], v[72:75]
 ds_read_b64_tr_b16 a[84:85], v9 offset:0
 v_mfma_f32_16x16x32_bf16 v[76:79], a[88:91], v[228:231], v[76:79]
 s_waitcnt lgkmcnt(9)
 ds_read_b64_tr_b16 a[86:87], v9 offset:512
 v_mfma_f32_16x16x32_bf16 v[48:51], a[92:95], v[232:235], v[48:51]
 ds_read_b64_tr_b16 a[88:89], v10 offset:0
 v_mfma_f32_16x16x32_bf16 v[52:55], a[92:95], v[236:239], v[52:55]
 s_waitcnt lgkmcnt(9)
 ds_read_b64_tr_b16 a[90:91], v10 offset:512
 s_add_u32 s78, s74, 1474816
 v_mfma_f32_16x16x32_bf16 v[56:59], a[96:99], v[232:235], v[56:59]
 s_add_u32 m0, s69, 20480
 ds_read_b64_tr_b16 a[92:93], v11 offset:0
 buffer_load_dwordx4 v21, s[16:19], s78 offen  lds
 v_mfma_f32_16x16x32_bf16 v[60:63], a[96:99], v[236:239], v[60:63]
 s_waitcnt lgkmcnt(9)
 ds_read_b64_tr_b16 a[94:95], v11 offset:512
 buffer_load_dwordx4 a[108:111], v46, s[44:47], s50 offen offset:3072
 v_mfma_f32_16x16x32_bf16 v[64:67], a[72:75], v[232:235], v[64:67]
 s_and_b32 s99, s70, 15
 ds_read_b64_tr_b16 a[96:97], v8 offset:4096
 v_mfma_f32_16x16x32_bf16 v[68:71], a[72:75], v[236:239], v[68:71]
 s_waitcnt lgkmcnt(9)
 ds_read_b64_tr_b16 a[98:99], v8 offset:4608
 v_mfma_f32_16x16x32_bf16 v[72:75], a[76:79], v[232:235], v[72:75]
 s_cmp_eq_u32 s99, 4
 s_cselect_b32 s99, s94, 0x40000000
 ds_read_b64_tr_b16 a[72:73], v9 offset:4096
 buffer_atomic_add v36, v25, s[32:35], s99 offen sc1
 v_mfma_f32_16x16x32_bf16 v[76:79], a[76:79], v[236:239], v[76:79]
 s_waitcnt lgkmcnt(9)
 ds_read_b64_tr_b16 a[74:75], v9 offset:4608
 v_mfma_f32_16x16x32_bf16 v[48:51], a[80:83], v[240:243], v[48:51]
 ds_read_b64_tr_b16 a[76:77], v10 offset:4096
 v_mfma_f32_16x16x32_bf16 v[52:55], a[80:83], v[244:247], v[52:55]
 s_waitcnt lgkmcnt(9)
 ds_read_b64_tr_b16 a[78:79], v10 offset:4608
 v_mfma_f32_16x16x32_bf16 v[56:59], a[84:87], v[240:243], v[56:59]
 ds_read_b64_tr_b16 a[80:81], v11 offset:4096
 v_mfma_f32_16x16x32_bf16 v[60:63], a[84:87], v[244:247], v[60:63]
 s_waitcnt lgkmcnt(9)
 ds_read_b64_tr_b16 a[82:83], v11 offset:4608
 v_mfma_f32_16x16x32_bf16 v[64:67], a[88:91], v[240:243], v[64:67]
 s_waitcnt vmcnt(32)
 s_barrier
 ds_read_b64_tr_b16 a[84:85], v8 offset:8192
 v_mfma_f32_16x16x32_bf16 v[68:71], a[88:91], v[244:247], v[68:71]
 s_waitcnt lgkmcnt(9)
 ds_read_b64_tr_b16 a[86:87], v8 offset:8704
 s_add_u32 s78, s74, 1769728
 v_mfma_f32_16x16x32_bf16 v[72:75], a[92:95], v[240:243], v[72:75]
 s_add_u32 m0, s69, 24576
 ds_read_b64_tr_b16 a[88:89], v9 offset:8192
 buffer_load_dwordx4 v21, s[16:19], s78 offen  lds
 v_mfma_f32_16x16x32_bf16 v[76:79], a[92:95], v[244:247], v[76:79]
 s_waitcnt lgkmcnt(9)
 ds_read_b64_tr_b16 a[90:91], v9 offset:8704
 v_mfma_f32_16x16x32_bf16 v[48:51], a[96:99], v[248:251], v[48:51]
 s_add_u32 s50, s50, 4096
 ds_read_b64_tr_b16 a[92:93], v10 offset:8192
 buffer_load_dwordx4 a[112:115], v46, s[44:47], s50 offen offset:0
 v_mfma_f32_16x16x32_bf16 v[52:55], a[96:99], v[252:255], v[52:55]
 s_waitcnt lgkmcnt(9)
 ds_read_b64_tr_b16 a[94:95], v10 offset:8704
 v_mfma_f32_16x16x32_bf16 v[56:59], a[72:75], v[248:251], v[56:59]
 ds_read_b64_tr_b16 a[96:97], v11 offset:8192
 v_mfma_f32_16x16x32_bf16 v[60:63], a[72:75], v[252:255], v[60:63]
 s_waitcnt lgkmcnt(9)
 ds_read_b64_tr_b16 a[98:99], v11 offset:8704
 v_mfma_f32_16x16x32_bf16 v[64:67], a[76:79], v[248:251], v[64:67]
 ds_read_b64_tr_b16 a[72:73], v8 offset:12288
 v_mfma_f32_16x16x32_bf16 v[68:71], a[76:79], v[252:255], v[68:71]
 s_waitcnt lgkmcnt(9)
 ds_read_b64_tr_b16 a[74:75], v8 offset:12800
 v_mfma_f32_16x16x32_bf16 v[72:75], a[80:83], v[248:251], v[72:75]
 s_and_b32 s99, s70, 15
 ds_read_b64_tr_b16 a[76:77], v9 offset:12288
 v_mfma_f32_16x16x32_bf16 v[76:79], a[80:83], v[252:255], v[76:79]
 s_waitcnt lgkmcnt(9)
 ds_read_b64_tr_b16 a[78:79], v9 offset:12800
 v_mfma_f32_16x16x32_bf16 v[80:83], a[84:87], v[112:115], 0
 s_cmp_eq_u32 s99, 5
 s_cselect_b32 s99, s94, 0x40000000
 ds_read_b64_tr_b16 a[80:81], v10 offset:12288
 buffer_atomic_add v36, v25, s[32:35], s99 offen sc1
 v_mfma_f32_16x16x32_bf16 v[84:87], a[84:87], v[116:119], 0
 s_waitcnt lgkmcnt(9)
 ds_read_b64_tr_b16 a[82:83], v10 offset:12800
 s_add_u32 s78, s74, 2064640
 v_mfma_f32_16x16x32_bf16 v[88:91], a[88:91], v[112:115], 0
 s_add_u32 m0, s69, 28672
 ds_read_b64_tr_b16 a[84:85], v11 offset:12288
 buffer_load_dwordx4 v21, s[16:19], s78 offen  lds
 v_mfma_f32_16x16x32_bf16 v[92:95], a[88:91], v[116:119], 0
 s_waitcnt lgkmcnt(9)
 ds_read_b64_tr_b16 a[86:87], v11 offset:12800
 buffer_load_dwordx4 a[116:119], v46, s[44:47], s50 offen offset:1024
 v_mfma_f32_16x16x32_bf16 v[96:99], a[92:95], v[112:115], 0
 ds_read_b64_tr_b16 a[88:89], v8 offset:16384
 v_mfma_f32_16x16x32_bf16 v[100:103], a[92:95], v[116:119], 0
 s_waitcnt lgkmcnt(9)
 ds_read_b64_tr_b16 a[90:91], v8 offset:16896
 v_mfma_f32_16x16x32_bf16 v[104:107], a[96:99], v[112:115], 0
 ds_read_b64_tr_b16 a[92:93], v9 offset:16384
 v_mfma_f32_16x16x32_bf16 v[108:111], a[96:99], v[116:119], 0
 s_waitcnt lgkmcnt(9)
 ds_read_b64_tr_b16 a[94:95], v9 offset:16896
 v_mfma_f32_16x16x32_bf16 v[80:83], a[72:75], v[120:123], v[80:83]
 ds_read_b64_tr_b16 a[96:97], v10 offset:16384
 v_mul_f32 v48, v30, v48
 v_mfma_f32_16x16x32_bf16 v[84:87], a[72:75], v[124:127], v[84:87]
 s_waitcnt lgkmcnt(9)
 ds_read_b64_tr_b16 a[98:99], v10 offset:16896
 v_mul_f32 v49, v30, v49
 v_mfma_f32_16x16x32_bf16 v[88:91], a[76:79], v[120:123], v[88:91]
 ds_read_b64_tr_b16 a[72:73], v11 offset:16384
 v_mul_f32 v50, v30, v50
 v_mfma_f32_16x16x32_bf16 v[92:95], a[76:79], v[124:127], v[92:95]
 s_waitcnt lgkmcnt(9)
 ds_read_b64_tr_b16 a[74:75], v11 offset:16896
 v_mul_f32 v51, v30, v51
 v_mfma_f32_16x16x32_bf16 v[96:99], a[80:83], v[120:123], v[96:99]
 ds_read_b64_tr_b16 a[76:77], v8 offset:20480
 v_mul_f32 v52, v31, v52
 v_mfma_f32_16x16x32_bf16 v[100:103], a[80:83], v[124:127], v[100:103]
 s_waitcnt lgkmcnt(9)
 ds_read_b64_tr_b16 a[78:79], v8 offset:20992
 s_add_u32 s78, s74, 2359552
 v_mfma_f32_16x16x32_bf16 v[104:107], a[84:87], v[120:123], v[104:107]
 s_add_u32 m0, s69, 32768
 ds_read_b64_tr_b16 a[80:81], v9 offset:20480
 buffer_load_dwordx4 v21, s[16:19], s78 offen  lds
 v_mfma_f32_16x16x32_bf16 v[108:111], a[84:87], v[124:127], v[108:111]
 s_waitcnt lgkmcnt(9)
 ds_read_b64_tr_b16 a[82:83], v9 offset:20992
 v_mul_f32 v53, v31, v53
 v_mfma_f32_16x16x32_bf16 v[80:83], a[88:91], v[128:131], v[80:83]
 ds_read_b64_tr_b16 a[84:85], v10 offset:20480
 v_mul_f32 v54, v31, v54
 v_mfma_f32_16x16x32_bf16 v[84:87], a[88:91], v[132:135], v[84:87]
 s_waitcnt lgkmcnt(9)
 ds_read_b64_tr_b16 a[86:87], v10 offset:20992
 v_mul_f32 v55, v31, v55
 v_mfma_f32_16x16x32_bf16 v[88:91], a[92:95], v[128:131], v[88:91]
 s_and_b32 s99, s70, 15
 ds_read_b64_tr_b16 a[88:89], v11 offset:20480
 v_mul_f32 v56, v30, v56
 v_mfma_f32_16x16x32_bf16 v[92:95], a[92:95], v[132:135], v[92:95]
 s_waitcnt lgkmcnt(9)
 ds_read_b64_tr_b16 a[90:91], v11 offset:20992
 s_add_u32 s78, s74, 2654464
 v_mfma_f32_16x16x32_bf16 v[96:99], a[96:99], v[128:131], v[96:99]
 s_add_u32 m0, s69, 36864
 ds_read_b64_tr_b16 a[92:93], v8 offset:24576
 buffer_load_dwordx4 v21, s[16:19], s78 offen  lds
 v_mfma_f32_16x16x32_bf16 v[100:103], a[96:99], v[132:135], v[100:103]
 s_waitcnt lgkmcnt(9)
 ds_read_b64_tr_b16 a[94:95], v8 offset:25088
 v_mul_f32 v57, v30, v57
 v_mfma_f32_16x16x32_bf16 v[104:107], a[72:75], v[128:131], v[104:107]
 s_cmp_eq_u32 s99, 6
 s_cselect_b32 s99, s94, 0x40000000
 ds_read_b64_tr_b16 a[96:97], v9 offset:24576
 v_mul_f32 v58, v30, v58
 v_mfma_f32_16x16x32_bf16 v[108:111], a[72:75], v[132:135], v[108:111]
 s_waitcnt lgkmcnt(9)
 ds_read_b64_tr_b16 a[98:99], v9 offset:25088
 v_mul_f32 v59, v30, v59
 v_mfma_f32_16x16x32_bf16 v[80:83], a[76:79], v[136:139], v[80:83]
 ds_read_b64_tr_b16 a[72:73], v10 offset:24576
 v_mul_f32 v60, v31, v60
 v_mfma_f32_16x16x32_bf16 v[84:87], a[76:79], v[140:143], v[84:87]
 s_waitcnt lgkmcnt(9)
 ds_read_b64_tr_b16 a[74:75], v10 offset:25088
 s_add_u32 s78, s74, 2949376
 v_mfma_f32_16x16x32_bf16 v[88:91], a[80:83], v[136:139], v[88:91]
 s_add_u32 m0, s69, 40960
 ds_read_b64_tr_b16 a[76:77], v11 offset:24576
 buffer_load_dwordx4 v21, s[16:19], s78 offen  lds
 v_mfma_f32_16x16x32_bf16 v[92:95], a[80:83], v[140:143], v[92:95]
 s_waitcnt lgkmcnt(9)
 ds_read_b64_tr_b16 a[78:79], v11 offset:25088
 v_mul_f32 v61, v31, v61
 v_mfma_f32_16x16x32_bf16 v[96:99], a[84:87], v[136:139], v[96:99]
 ds_read_b64_tr_b16 a[80:81], v8 offset:28672
 v_mul_f32 v62, v31, v62
 v_mfma_f32_16x16x32_bf16 v[100:103], a[84:87], v[140:143], v[100:103]
 s_waitcnt lgkmcnt(9)
 ds_read_b64_tr_b16 a[82:83], v8 offset:29184
 v_mul_f32 v63, v31, v63
 v_mfma_f32_16x16x32_bf16 v[104:107], a[88:91], v[136:139], v[104:107]
 ds_read_b64_tr_b16 a[84:85], v9 offset:28672
 v_mul_f32 v64, v30, v64
 v_mfma_f32_16x16x32_bf16 v[108:111], a[88:91], v[140:143], v[108:111]
 s_waitcnt lgkmcnt(9)
 ds_read_b64_tr_b16 a[86:87], v9 offset:29184
 s_add_u32 s78, s74, 3244288
 v_mfma_f32_16x16x32_bf16 v[80:83], a[92:95], v[144:147], v[80:83]
 s_add_u32 m0, s69, 45056
 ds_read_b64_tr_b16 a[88:89], v10 offset:28672
 buffer_load_dwordx4 v21, s[16:19], s78 offen  lds
 v_mfma_f32_16x16x32_bf16 v[84:87], a[92:95], v[148:151], v[84:87]
 s_waitcnt lgkmcnt(9)
 ds_read_b64_tr_b16 a[90:91], v10 offset:29184
 v_mul_f32 v65, v30, v65
 v_mfma_f32_16x16x32_bf16 v[88:91], a[96:99], v[144:147], v[88:91]
 ds_read_b64_tr_b16 a[92:93], v11 offset:28672
 v_mul_f32 v66, v30, v66
 v_mfma_f32_16x16x32_bf16 v[92:95], a[96:99], v[148:151], v[92:95]
 s_waitcnt lgkmcnt(9)
 ds_read_b64_tr_b16 a[94:95], v11 offset:29184
 v_mul_f32 v67, v30, v67
 v_mfma_f32_16x16x32_bf16 v[96:99], a[72:75], v[144:147], v[96:99]
 s_waitcnt vmcnt(33)
 s_barrier
 ds_read_b64_tr_b16 a[96:97], v8 offset:32768
 v_mul_f32 v68, v31, v68
 v_mfma_f32_16x16x32_bf16 v[100:103], a[72:75], v[148:151], v[100:103]
 s_waitcnt lgkmcnt(9)
 ds_read_b64_tr_b16 a[98:99], v8 offset:33280
 s_add_u32 s78, s74, 3539200
 v_mfma_f32_16x16x32_bf16 v[104:107], a[76:79], v[144:147], v[104:107]
 s_add_u32 m0, s69, 49152
 ds_read_b64_tr_b16 a[72:73], v9 offset:32768
 buffer_load_dwordx4 v21, s[16:19], s78 offen  lds
 v_mfma_f32_16x16x32_bf16 v[108:111], a[76:79], v[148:151], v[108:111]
 s_waitcnt lgkmcnt(9)
 ds_read_b64_tr_b16 a[74:75], v9 offset:33280
 v_mul_f32 v69, v31, v69
 v_mfma_f32_16x16x32_bf16 v[80:83], a[80:83], v[152:155], v[80:83]
 ds_read_b64_tr_b16 a[76:77], v10 offset:32768
 v_mul_f32 v70, v31, v70
 v_mfma_f32_16x16x32_bf16 v[84:87], a[80:83], v[156:159], v[84:87]
 s_waitcnt lgkmcnt(9)
 ds_read_b64_tr_b16 a[78:79], v10 offset:33280
 v_mul_f32 v71, v31, v71
 v_mfma_f32_16x16x32_bf16 v[88:91], a[84:87], v[152:155], v[88:91]
 ds_read_b64_tr_b16 a[80:81], v11 offset:32768
 v_mul_f32 v72, v30, v72
 v_mfma_f32_16x16x32_bf16 v[92:95], a[84:87], v[156:159], v[92:95]
 s_waitcnt lgkmcnt(9)
 ds_read_b64_tr_b16 a[82:83], v11 offset:33280
 s_add_u32 s78, s74, 3834112
 v_mfma_f32_16x16x32_bf16 v[96:99], a[88:91], v[152:155], v[96:99]
 s_add_u32 m0, s69, 53248
 ds_read_b64_tr_b16 a[84:85], v8 offset:36864
 buffer_load_dwordx4 v21, s[16:19], s78 offen  lds
 v_mfma_f32_16x16x32_bf16 v[100:103], a[88:91], v[156:159], v[100:103]
 s_waitcnt lgkmcnt(9)
 ds_read_b64_tr_b16 a[86:87], v8 offset:37376
 v_mul_f32 v73, v30, v73
 v_mfma_f32_16x16x32_bf16 v[104:107], a[92:95], v[152:155], v[104:107]
 ds_read_b64_tr_b16 a[88:89], v9 offset:36864
 v_mul_f32 v74, v30, v74
 v_mfma_f32_16x16x32_bf16 v[108:111], a[92:95], v[156:159], v[108:111]
 s_waitcnt lgkmcnt(9)
 ds_read_b64_tr_b16 a[90:91], v9 offset:37376
 v_mul_f32 v75, v30, v75
 v_mfma_f32_16x16x32_bf16 v[80:83], a[96:99], v[160:163], v[80:83]
 ds_read_b64_tr_b16 a[92:93], v10 offset:36864
 v_mul_f32 v76, v31, v76
 v_mfma_f32_16x16x32_bf16 v[84:87], a[96:99], v[164:167], v[84:87]
 s_waitcnt lgkmcnt(9)
 ds_read_b64_tr_b16 a[94:95], v10 offset:37376
 s_add_u32 s78, s74, 4129024
 v_mfma_f32_16x16x32_bf16 v[88:91], a[72:75], v[160:163], v[88:91]
 s_add_u32 m0, s69, 57344
 ds_read_b64_tr_b16 a[96:97], v11 offset:36864
 buffer_load_dwordx4 v21, s[16:19], s78 offen  lds
 v_mfma_f32_16x16x32_bf16 v[92:95], a[72:75], v[164:167], v[92:95]
 s_waitcnt lgkmcnt(9)
 ds_read_b64_tr_b16 a[98:99], v11 offset:37376
 v_mul_f32 v77, v31, v77
 v_mfma_f32_16x16x32_bf16 v[96:99], a[76:79], v[160:163], v[96:99]
 ds_read_b64_tr_b16 a[72:73], v8 offset:40960
 v_mul_f32 v78, v31, v78
 v_mfma_f32_16x16x32_bf16 v[100:103], a[76:79], v[164:167], v[100:103]
 s_waitcnt lgkmcnt(9)
 ds_read_b64_tr_b16 a[74:75], v8 offset:41472
 v_mul_f32 v79, v31, v79
 v_mfma_f32_16x16x32_bf16 v[104:107], a[80:83], v[160:163], v[104:107]
 ds_read_b64_tr_b16 a[76:77], v9 offset:40960
 buffer_atomic_add v36, v25, s[32:35], s99 offen sc1
 v_mfma_f32_16x16x32_bf16 v[108:111], a[80:83], v[164:167], v[108:111]
 s_waitcnt lgkmcnt(9)
 ds_read_b64_tr_b16 a[78:79], v9 offset:41472
 s_add_u32 s78, s74, 4423936
 v_mfma_f32_16x16x32_bf16 v[80:83], a[84:87], v[168:171], v[80:83]
 s_add_u32 m0, s69, 61440
 ds_read_b64_tr_b16 a[80:81], v10 offset:40960
 buffer_load_dwordx4 v21, s[16:19], s78 offen  lds
 v_mfma_f32_16x16x32_bf16 v[84:87], a[84:87], v[172:175], v[84:87]
 s_waitcnt lgkmcnt(9)
 ds_read_b64_tr_b16 a[82:83], v10 offset:41472
 buffer_load_dwordx4 a[120:123], v46, s[44:47], s50 offen offset:2048
 v_mfma_f32_16x16x32_bf16 v[88:91], a[88:91], v[168:171], v[88:91]
 s_and_b32 s99, s70, 15
 ds_read_b64_tr_b16 a[84:85], v11 offset:40960
 v_mfma_f32_16x16x32_bf16 v[92:95], a[88:91], v[172:175], v[92:95]
 s_waitcnt lgkmcnt(9)
 ds_read_b64_tr_b16 a[86:87], v11 offset:41472
 v_mfma_f32_16x16x32_bf16 v[96:99], a[92:95], v[168:171], v[96:99]
 s_cmp_eq_u32 s99, 7
 s_cselect_b32 s99, s94, 0x40000000
 ds_read_b64_tr_b16 a[88:89], v8 offset:45056
 buffer_atomic_add v36, v25, s[32:35], s99 offen sc1
 v_mfma_f32_16x16x32_bf16 v[100:103], a[92:95], v[172:175], v[100:103]
 s_waitcnt lgkmcnt(9)
 ds_read_b64_tr_b16 a[90:91], v8 offset:45568
 s_add_u32 s78, s74, 4718848
 v_mfma_f32_16x16x32_bf16 v[104:107], a[96:99], v[168:171], v[104:107]
 s_add_u32 m0, s69, 65536
 ds_read_b64_tr_b16 a[92:93], v9 offset:45056
 buffer_load_dwordx4 v21, s[16:19], s78 offen  lds
 v_mfma_f32_16x16x32_bf16 v[108:111], a[96:99], v[172:175], v[108:111]
 s_waitcnt lgkmcnt(9)
 ds_read_b64_tr_b16 a[94:95], v9 offset:45568
 v_mfma_f32_16x16x32_bf16 v[80:83], a[72:75], v[176:179], v[80:83]
 s_and_b32 s99, s70, 15
 ds_read_b64_tr_b16 a[96:97], v10 offset:45056
 v_mfma_f32_16x16x32_bf16 v[84:87], a[72:75], v[180:183], v[84:87]
 s_waitcnt lgkmcnt(9)
 ds_read_b64_tr_b16 a[98:99], v10 offset:45568
 v_mfma_f32_16x16x32_bf16 v[88:91], a[76:79], v[176:179], v[88:91]
 s_cmp_eq_u32 s99, 8
 s_cselect_b32 s99, s94, 0x40000000
 ds_read_b64_tr_b16 a[72:73], v11 offset:45056
 buffer_atomic_add v36, v25, s[32:35], s99 offen sc1
 v_mfma_f32_16x16x32_bf16 v[92:95], a[76:79], v[180:183], v[92:95]
 s_waitcnt lgkmcnt(9)
 ds_read_b64_tr_b16 a[74:75], v11 offset:45568
 s_add_u32 s78, s74, 5013760
 v_mfma_f32_16x16x32_bf16 v[96:99], a[80:83], v[176:179], v[96:99]
 s_add_u32 m0, s69, 69632
 ds_read_b64_tr_b16 a[76:77], v8 offset:49152
 buffer_load_dwordx4 v21, s[16:19], s78 offen  lds
 v_mfma_f32_16x16x32_bf16 v[100:103], a[80:83], v[180:183], v[100:103]
 s_waitcnt lgkmcnt(9)
 ds_read_b64_tr_b16 a[78:79], v8 offset:49664
 buffer_load_dwordx4 a[124:127], v46, s[44:47], s50 offen offset:3072
 v_mfma_f32_16x16x32_bf16 v[104:107], a[84:87], v[176:179], v[104:107]
 ds_read_b64_tr_b16 a[80:81], v9 offset:49152
 v_mfma_f32_16x16x32_bf16 v[108:111], a[84:87], v[180:183], v[108:111]
 s_waitcnt lgkmcnt(9)
 ds_read_b64_tr_b16 a[82:83], v9 offset:49664
 v_mfma_f32_16x16x32_bf16 v[80:83], a[88:91], v[184:187], v[80:83]
 ds_read_b64_tr_b16 a[84:85], v10 offset:49152
 buffer_load_dword a162, v3, s[16:19], s74 offen offset:384
 v_mfma_f32_16x16x32_bf16 v[84:87], a[88:91], v[188:191], v[84:87]
 s_waitcnt lgkmcnt(9)
 ds_read_b64_tr_b16 a[86:87], v10 offset:49664
 buffer_load_dword a166, v34, s[24:27], 0 offen offset:0
 v_mfma_f32_16x16x32_bf16 v[88:91], a[92:95], v[184:187], v[88:91]
 s_add_u32 s78, s74, 256
 ds_read_b64_tr_b16 a[88:89], v11 offset:49152
 v_mfma_f32_16x16x32_bf16 v[92:95], a[92:95], v[188:191], v[92:95]
 s_waitcnt lgkmcnt(9)
 ds_read_b64_tr_b16 a[90:91], v11 offset:49664
 v_mfma_f32_16x16x32_bf16 v[96:99], a[96:99], v[184:187], v[96:99]
 s_add_u32 m0, s69, 73728
 ds_read_b64_tr_b16 a[92:93], v8 offset:53248
 buffer_load_dwordx4 v21, s[20:23], s78 offen  lds
 v_mfma_f32_16x16x32_bf16 v[100:103], a[96:99], v[188:191], v[100:103]
 s_waitcnt lgkmcnt(9)
 ds_read_b64_tr_b16 a[94:95], v8 offset:53760
 v_mfma_f32_16x16x32_bf16 v[104:107], a[72:75], v[184:187], v[104:107]
 s_and_b32 s99, s70, 15
 ds_read_b64_tr_b16 a[96:97], v9 offset:53248
 v_mfma_f32_16x16x32_bf16 v[108:111], a[72:75], v[188:191], v[108:111]
 s_waitcnt lgkmcnt(9)
 ds_read_b64_tr_b16 a[98:99], v9 offset:53760
 v_mfma_f32_16x16x32_bf16 v[80:83], a[76:79], v[192:195], v[80:83]
 s_cmp_eq_u32 s99, 9
 s_cselect_b32 s99, s94, 0x40000000
 ds_read_b64_tr_b16 a[72:73], v10 offset:53248
 buffer_atomic_add v36, v25, s[32:35], s99 offen sc1
 v_mfma_f32_16x16x32_bf16 v[84:87], a[76:79], v[196:199], v[84:87]
 s_waitcnt lgkmcnt(9)
 ds_read_b64_tr_b16 a[74:75], v10 offset:53760
 v_mfma_f32_16x16x32_bf16 v[88:91], a[80:83], v[192:195], v[88:91]
 s_add_u32 s50, s50, 4096
 ds_read_b64_tr_b16 a[76:77], v11 offset:53248
 buffer_load_dwordx2 a[128:129], v46, s[44:47], s50 offen
 v_mfma_f32_16x16x32_bf16 v[92:95], a[80:83], v[196:199], v[92:95]
 s_waitcnt lgkmcnt(9)
 ds_read_b64_tr_b16 a[78:79], v11 offset:53760
 v_mfma_f32_16x16x32_bf16 v[96:99], a[84:87], v[192:195], v[96:99]
 s_waitcnt vmcnt(41)
 s_barrier
 ds_read_b64_tr_b16 a[80:81], v8 offset:57344
 v_mfma_f32_16x16x32_bf16 v[100:103], a[84:87], v[196:199], v[100:103]
 s_waitcnt lgkmcnt(9)
 ds_read_b64_tr_b16 a[82:83], v8 offset:57856
 s_add_u32 s78, s74, 295168
 v_mfma_f32_16x16x32_bf16 v[104:107], a[88:91], v[192:195], v[104:107]
 s_add_u32 m0, s69, 77824
 ds_read_b64_tr_b16 a[84:85], v9 offset:57344
 buffer_load_dwordx4 v21, s[20:23], s78 offen  lds
 v_mfma_f32_16x16x32_bf16 v[108:111], a[88:91], v[196:199], v[108:111]
 s_waitcnt lgkmcnt(9)
 ds_read_b64_tr_b16 a[86:87], v9 offset:57856
 v_mfma_f32_16x16x32_bf16 v[80:83], a[92:95], v[200:203], v[80:83]
 ds_read_b64_tr_b16 a[88:89], v10 offset:57344
 v_mfma_f32_16x16x32_bf16 v[84:87], a[92:95], v[204:207], v[84:87]
 s_waitcnt lgkmcnt(9)
 ds_read_b64_tr_b16 a[90:91], v10 offset:57856
 v_mfma_f32_16x16x32_bf16 v[88:91], a[96:99], v[200:203], v[88:91]
 ds_read_b64_tr_b16 a[92:93], v11 offset:57344
 v_mfma_f32_16x16x32_bf16 v[92:95], a[96:99], v[204:207], v[92:95]
 s_waitcnt lgkmcnt(9)
 ds_read_b64_tr_b16 a[94:95], v11 offset:57856
 v_mfma_f32_16x16x32_bf16 v[96:99], a[72:75], v[200:203], v[96:99]
 ds_read_b64_tr_b16 a[96:97], v8 offset:61440
 v_mfma_f32_16x16x32_bf16 v[100:103], a[72:75], v[204:207], v[100:103]
 s_waitcnt lgkmcnt(9)
 ds_read_b64_tr_b16 a[98:99], v8 offset:61952
 s_lshr_b32 s82, s2, 3
 v_mfma_f32_16x16x32_bf16 v[104:107], a[76:79], v[200:203], v[104:107]
 s_lshl_b32 s82, s82, 2
 ds_read_b64_tr_b16 a[72:73], v9 offset:61440
 s_add_u32 s82, s82, s68
 v_mfma_f32_16x16x32_bf16 v[108:111], a[76:79], v[204:207], v[108:111]
 s_waitcnt lgkmcnt(9)
 ds_read_b64_tr_b16 a[74:75], v9 offset:61952
 s_lshl_b32 s82, s82, 7
 v_mfma_f32_16x16x32_bf16 v[80:83], a[80:83], v[208:211], v[80:83]
L_cp1:
 s_add_u32 s84, s82, L_cp1-parallel_sum__mha_block__glu_gated_bilinear__prompt_kernel+8192
 ds_read_b64_tr_b16 a[76:77], v10 offset:61440
 buffer_load_dword a245, off, s[44:47], s84
 v_mfma_f32_16x16x32_bf16 v[84:87], a[80:83], v[212:215], v[84:87]
 s_waitcnt lgkmcnt(9)
 ds_read_b64_tr_b16 a[78:79], v10 offset:61952
 s_add_u32 s78, s74, 590080
 v_mfma_f32_16x16x32_bf16 v[88:91], a[84:87], v[208:211], v[88:91]
 s_add_u32 m0, s69, 81920
 ds_read_b64_tr_b16 a[80:81], v11 offset:61440
 buffer_load_dwordx4 v21, s[20:23], s78 offen  lds
 v_mfma_f32_16x16x32_bf16 v[92:95], a[84:87], v[212:215], v[92:95]
 s_waitcnt lgkmcnt(9)
 ds_read_b64_tr_b16 a[82:83], v11 offset:61952
 v_mfma_f32_16x16x32_bf16 v[96:99], a[88:91], v[208:211], v[96:99]
 s_and_b32 s99, s70, 15
 ds_read_b64_tr_b16 a[84:85], v12 offset:0
 v_mfma_f32_16x16x32_bf16 v[100:103], a[88:91], v[212:215], v[100:103]
 s_waitcnt lgkmcnt(9)
 ds_read_b64_tr_b16 a[86:87], v12 offset:512
 v_mfma_f32_16x16x32_bf16 v[104:107], a[92:95], v[208:211], v[104:107]
 s_cmp_eq_u32 s99, 10
 s_cselect_b32 s99, s94, 0x40000000
 ds_read_b64_tr_b16 a[88:89], v13 offset:0
 buffer_atomic_add v36, v25, s[32:35], s99 offen sc1
 v_mfma_f32_16x16x32_bf16 v[108:111], a[92:95], v[212:215], v[108:111]
 s_waitcnt lgkmcnt(9)
 ds_read_b64_tr_b16 a[90:91], v13 offset:512
 v_mfma_f32_16x16x32_bf16 v[80:83], a[96:99], v[216:219], v[80:83]
 ds_read_b64_tr_b16 a[92:93], v14 offset:0
 v_mfma_f32_16x16x32_bf16 v[84:87], a[96:99], v[220:223], v[84:87]
 s_waitcnt lgkmcnt(9)
 ds_read_b64_tr_b16 a[94:95], v14 offset:512
 v_mfma_f32_16x16x32_bf16 v[88:91], a[72:75], v[216:219], v[88:91]
 ds_read_b64_tr_b16 a[96:97], v15 offset:0
 v_mfma_f32_16x16x32_bf16 v[92:95], a[72:75], v[220:223], v[92:95]
 s_waitcnt lgkmcnt(9)
 ds_read_b64_tr_b16 a[98:99], v15 offset:512
 v_mfma_f32_16x16x32_bf16 v[96:99], a[76:79], v[216:219], v[96:99]
 ds_read_b64_tr_b16 a[72:73], v12 offset:4096
 v_mfma_f32_16x16x32_bf16 v[100:103], a[76:79], v[220:223], v[100:103]
 s_waitcnt lgkmcnt(9)
 ds_read_b64_tr_b16 a[74:75], v12 offset:4608
 s_add_u32 s78, s74, 884992
 v_mfma_f32_16x16x32_bf16 v[104:107], a[80:83], v[216:219], v[104:107]
 s_add_u32 m0, s69, 86016
 ds_read_b64_tr_b16 a[76:77], v12 offset:8192
 buffer_load_dwordx4 v21, s[20:23], s78 offen  lds
 v_mfma_f32_16x16x32_bf16 v[108:111], a[80:83], v[220:223], v[108:111]
 s_waitcnt lgkmcnt(9)
 ds_read_b64_tr_b16 a[78:79], v12 offset:8704
 v_mfma_f32_16x16x32_bf16 v[80:83], a[84:87], v[224:227], v[80:83]
 ds_read_b64_tr_b16 a[80:81], v12 offset:12288
 v_mfma_f32_16x16x32_bf16 v[84:87], a[84:87], v[228:231], v[84:87]
 s_waitcnt lgkmcnt(9)
 ds_read_b64_tr_b16 a[82:83], v12 offset:12800
 v_mfma_f32_16x16x32_bf16 v[88:91], a[88:91], v[224:227], v[88:91]
 ds_read_b64_tr_b16 a[84:85], v13 offset:4096
 v_mfma_f32_16x16x32_bf16 v[92:95], a[88:91], v[228:231], v[92:95]
 s_waitcnt lgkmcnt(9)
 ds_read_b64_tr_b16 a[86:87], v13 offset:4608
 v_mfma_f32_16x16x32_bf16 v[96:99], a[92:95], v[224:227], v[96:99]
 ds_read_b64_tr_b16 a[88:89], v13 offset:8192
 v_mfma_f32_16x16x32_bf16 v[100:103], a[92:95], v[228:231], v[100:103]
 s_waitcnt lgkmcnt(9)
 ds_read_b64_tr_b16 a[90:91], v13 offset:8704
 v_mfma_f32_16x16x32_bf16 v[104:107], a[96:99], v[224:227], v[104:107]
 s_and_b32 s99, s70, 15
 ds_read_b64_tr_b16 a[92:93], v13 offset:12288
 v_mfma_f32_16x16x32_bf16 v[108:111], a[96:99], v[228:231], v[108:111]
 s_waitcnt lgkmcnt(9)
 ds_read_b64_tr_b16 a[94:95], v13 offset:12800
 v_mfma_f32_16x16x32_bf16 v[80:83], a[72:75], v[232:235], v[80:83]
 s_cmp_eq_u32 s99, 11
 s_cselect_b32 s99, s94, 0x40000000
 ds_read_b64_tr_b16 a[96:97], v14 offset:4096
 buffer_atomic_add v36, v25, s[32:35], s99 offen sc1
 v_mfma_f32_16x16x32_bf16 v[84:87], a[72:75], v[236:239], v[84:87]
 s_waitcnt lgkmcnt(9)
 ds_read_b64_tr_b16 a[98:99], v14 offset:4608
 s_add_u32 s78, s74, 1179904
 v_mfma_f32_16x16x32_bf16 v[80:83], a[76:79], v[240:243], v[80:83]
 s_add_u32 m0, s69, 90112
 ds_read_b64_tr_b16 a[72:73], v14 offset:8192
 buffer_load_dwordx4 v21, s[20:23], s78 offen  lds
 v_mfma_f32_16x16x32_bf16 v[84:87], a[76:79], v[244:247], v[84:87]
 s_waitcnt lgkmcnt(9)
 ds_read_b64_tr_b16 a[74:75], v14 offset:8704
 v_mfma_f32_16x16x32_bf16 v[80:83], a[80:83], v[248:251], v[80:83]
 ds_read_b64_tr_b16 a[76:77], v14 offset:12288
 v_mfma_f32_16x16x32_bf16 v[84:87], a[80:83], v[252:255], v[84:87]
 s_waitcnt lgkmcnt(9)
 ds_read_b64_tr_b16 a[78:79], v14 offset:12800
 v_mfma_f32_16x16x32_bf16 v[88:91], a[84:87], v[232:235], v[88:91]
 ds_read_b64_tr_b16 a[80:81], v15 offset:4096
 v_mfma_f32_16x16x32_bf16 v[92:95], a[84:87], v[236:239], v[92:95]
 s_waitcnt lgkmcnt(9)
 ds_read_b64_tr_b16 a[82:83], v15 offset:4608
 v_mfma_f32_16x16x32_bf16 v[88:91], a[88:91], v[240:243], v[88:91]
 ds_read_b64_tr_b16 a[84:85], v15 offset:8192
 v_mfma_f32_16x16x32_bf16 v[92:95], a[88:91], v[244:247], v[92:95]
 s_waitcnt lgkmcnt(9)
 ds_read_b64_tr_b16 a[86:87], v15 offset:8704
 v_mul_f32 v80, v48, v80
 v_mfma_f32_16x16x32_bf16 v[88:91], a[92:95], v[248:251], v[88:91]
 ds_read_b64_tr_b16 a[88:89], v15 offset:12288
 v_mul_f32 v81, v49, v81
 v_mfma_f32_16x16x32_bf16 v[92:95], a[92:95], v[252:255], v[92:95]
 s_waitcnt lgkmcnt(9)
 ds_read_b64_tr_b16 a[90:91], v15 offset:12800
 v_mul_f32 v82, v50, v82
 v_mfma_f32_16x16x32_bf16 v[96:99], a[96:99], v[232:235], v[96:99]
 s_waitcnt vmcnt(34)
 s_barrier
 ds_read_b64_tr_b16 a[92:93], v4 offset:0
 v_mul_f32 v83, v51, v83
 v_mfma_f32_16x16x32_bf16 v[100:103], a[96:99], v[236:239], v[100:103]
 s_waitcnt lgkmcnt(9)
 ds_read_b64_tr_b16 a[94:95], v4 offset:512
 s_add_u32 s78, s74, 1474816
 v_mfma_f32_16x16x32_bf16 v[96:99], a[72:75], v[240:243], v[96:99]
 s_add_u32 m0, s69, 94208
 ds_read_b64_tr_b16 a[96:97], v4 offset:4096
 buffer_load_dwordx4 v21, s[20:23], s78 offen  lds
 v_mfma_f32_16x16x32_bf16 v[100:103], a[72:75], v[244:247], v[100:103]
 s_waitcnt lgkmcnt(9)
 ds_read_b64_tr_b16 a[98:99], v4 offset:4608
 v_mul_f32 v84, v52, v84
 v_mfma_f32_16x16x32_bf16 v[96:99], a[76:79], v[248:251], v[96:99]
 ds_read_b64_tr_b16 a[72:73], v4 offset:8192
 v_mul_f32 v85, v53, v85
 v_mfma_f32_16x16x32_bf16 v[100:103], a[76:79], v[252:255], v[100:103]
 s_waitcnt lgkmcnt(9)
 ds_read_b64_tr_b16 a[74:75], v4 offset:8704
 v_mul_f32 v86, v54, v86
 v_mfma_f32_16x16x32_bf16 v[104:107], a[80:83], v[232:235], v[104:107]
 s_and_b32 s99, s70, 15
 ds_read_b64_tr_b16 a[76:77], v5 offset:0
 v_mul_f32 v87, v55, v87
 v_mfma_f32_16x16x32_bf16 v[108:111], a[80:83], v[236:239], v[108:111]
 s_waitcnt lgkmcnt(9)
 ds_read_b64_tr_b16 a[78:79], v5 offset:512
 v_mul_f32 v88, v56, v88
 v_mul_f32 v89, v57, v89
 v_mfma_f32_16x16x32_bf16 v[104:107], a[84:87], v[240:243], v[104:107]
 s_cmp_eq_u32 s99, 12
 s_cselect_b32 s99, s94, 0x40000000
 ds_read_b64_tr_b16 a[80:81], v5 offset:4096
 v_mul_f32 v90, v58, v90
 v_mul_f32 v91, v59, v91
 v_mfma_f32_16x16x32_bf16 v[108:111], a[84:87], v[244:247], v[108:111]
 s_waitcnt lgkmcnt(9)
 ds_read_b64_tr_b16 a[82:83], v5 offset:4608
 v_mul_f32 v92, v60, v92
 v_mul_f32 v93, v61, v93
 v_mfma_f32_16x16x32_bf16 v[104:107], a[88:91], v[248:251], v[104:107]
 ds_read_b64_tr_b16 a[84:85], v5 offset:8192
 v_mul_f32 v94, v62, v94
 v_mul_f32 v95, v63, v95
 v_mfma_f32_16x16x32_bf16 v[108:111], a[88:91], v[252:255], v[108:111]
 s_waitcnt lgkmcnt(9)
 ds_read_b64_tr_b16 a[86:87], v5 offset:8704
 v_mul_f32 v96, v64, v96
 v_mfma_f32_16x16x32_bf16 v[48:51], a[92:95], v[112:115], 0
 ds_read_b64_tr_b16 a[88:89], v6 offset:0
 v_mul_f32 v97, v65, v97
 v_mfma_f32_16x16x32_bf16 v[52:55], a[92:95], v[116:119], 0
 s_waitcnt lgkmcnt(9)
 ds_read_b64_tr_b16 a[90:91], v6 offset:512
 s_add_u32 s78, s74, 1769728
 v_mfma_f32_16x16x32_bf16 v[48:51], a[96:99], v[120:123], v[48:51]
 s_add_u32 m0, s69, 98304
 ds_read_b64_tr_b16 a[92:93], v6 offset:4096
 buffer_load_dwordx4 v21, s[20:23], s78 offen  lds
 v_mfma_f32_16x16x32_bf16 v[52:55], a[96:99], v[124:127], v[52:55]
 s_waitcnt lgkmcnt(9)
 ds_read_b64_tr_b16 a[94:95], v6 offset:4608
 v_mul_f32 v98, v66, v98
 v_mfma_f32_16x16x32_bf16 v[48:51], a[72:75], v[128:131], v[48:51]
 ds_read_b64_tr_b16 a[96:97], v6 offset:8192
 v_mul_f32 v99, v67, v99
 v_mfma_f32_16x16x32_bf16 v[52:55], a[72:75], v[132:135], v[52:55]
 s_waitcnt lgkmcnt(9)
 ds_read_b64_tr_b16 a[98:99], v6 offset:8704
 v_mul_f32 v100, v68, v100
 v_mul_f32 v101, v69, v101
 v_mfma_f32_16x16x32_bf16 v[56:59], a[76:79], v[112:115], 0
 ds_read_b64_tr_b16 a[72:73], v7 offset:0
 v_mul_f32 v102, v70, v102
 v_mul_f32 v103, v71, v103
 v_mfma_f32_16x16x32_bf16 v[60:63], a[76:79], v[116:119], 0
 s_waitcnt lgkmcnt(9)
 ds_read_b64_tr_b16 a[74:75], v7 offset:512
 v_mul_f32 v104, v72, v104
 v_mul_f32 v105, v73, v105
 v_mfma_f32_16x16x32_bf16 v[56:59], a[80:83], v[120:123], v[56:59]
 ds_read_b64_tr_b16 a[76:77], v7 offset:4096
 v_mul_f32 v106, v74, v106
 v_mul_f32 v107, v75, v107
 v_mfma_f32_16x16x32_bf16 v[60:63], a[80:83], v[124:127], v[60:63]
 s_waitcnt lgkmcnt(9)
 ds_read_b64_tr_b16 a[78:79], v7 offset:4608
 v_mul_f32 v108, v76, v108
 v_mul_f32 v109, v77, v109
 v_mfma_f32_16x16x32_bf16 v[56:59], a[84:87], v[128:131], v[56:59]
 ds_read_b64_tr_b16 a[80:81], v7 offset:8192
 v_mul_f32 v110, v78, v110
 v_mul_f32 v111, v79, v111
 v_mfma_f32_16x16x32_bf16 v[60:63], a[84:87], v[132:135], v[60:63]
 s_waitcnt lgkmcnt(9)
 ds_read_b64_tr_b16 a[82:83], v7 offset:8704
 v_cvt_pk_bf16_f32 v32, v80, v81
 v_mfma_f32_16x16x32_bf16 v[64:67], a[88:91], v[112:115], 0
 ds_read_b64_tr_b16 a[84:85], v4 offset:12288
 v_accvgpr_write_b32 a16, v32
 v_mfma_f32_16x16x32_bf16 v[68:71], a[88:91], v[116:119], 0
 s_waitcnt lgkmcnt(9)
 ds_read_b64_tr_b16 a[86:87], v4 offset:12800
 s_add_u32 s78, s74, 2064640
 v_mfma_f32_16x16x32_bf16 v[64:67], a[92:95], v[120:123], v[64:67]
 s_add_u32 m0, s69, 102400
 ds_read_b64_tr_b16 a[88:89], v5 offset:12288
 buffer_load_dwordx4 v21, s[20:23], s78 offen  lds
 v_mfma_f32_16x16x32_bf16 v[68:71], a[92:95], v[124:127], v[68:71]
 s_waitcnt lgkmcnt(9)
 ds_read_b64_tr_b16 a[90:91], v5 offset:12800
 v_cvt_pk_bf16_f32 v33, v82, v83
 v_mfma_f32_16x16x32_bf16 v[64:67], a[96:99], v[128:131], v[64:67]
 ds_read_b64_tr_b16 a[92:93], v6 offset:12288
 v_accvgpr_write_b32 a17, v33
 v_mfma_f32_16x16x32_bf16 v[68:71], a[96:99], v[132:135], v[68:71]
 s_waitcnt lgkmcnt(9)
 ds_read_b64_tr_b16 a[94:95], v6 offset:12800
 v_cvt_pk_bf16_f32 v32, v84, v85
 v_mfma_f32_16x16x32_bf16 v[72:75], a[72:75], v[112:115], 0
 ds_read_b64_tr_b16 a[96:97], v7 offset:12288
 v_accvgpr_write_b32 a20, v32
 v_mfma_f32_16x16x32_bf16 v[76:79], a[72:75], v[116:119], 0
 s_waitcnt lgkmcnt(9)
 ds_read_b64_tr_b16 a[98:99], v7 offset:12800
 s_add_u32 s78, s74, 2359552
 v_mfma_f32_16x16x32_bf16 v[72:75], a[76:79], v[120:123], v[72:75]
 s_add_u32 m0, s69, 106496
 ds_read_b64_tr_b16 a[72:73], v4 offset:16384
 buffer_load_dwordx4 v21, s[20:23], s78 offen  lds
 v_mfma_f32_16x16x32_bf16 v[76:79], a[76:79], v[124:127], v[76:79]
 s_waitcnt lgkmcnt(9)
 ds_read_b64_tr_b16 a[74:75], v4 offset:16896
 v_cvt_pk_bf16_f32 v33, v86, v87
 v_mfma_f32_16x16x32_bf16 v[72:75], a[80:83], v[128:131], v[72:75]
 ds_read_b64_tr_b16 a[76:77], v5 offset:16384
 v_accvgpr_write_b32 a21, v33
 v_mfma_f32_16x16x32_bf16 v[76:79], a[80:83], v[132:135], v[76:79]
 s_waitcnt lgkmcnt(9)
 ds_read_b64_tr_b16 a[78:79], v5 offset:16896
 v_cvt_pk_bf16_f32 v32, v88, v89
 v_mfma_f32_16x16x32_bf16 v[48:51], a[84:87], v[136:139], v[48:51]
 ds_read_b64_tr_b16 a[80:81], v6 offset:16384
 v_accvgpr_write_b32 a18, v32
 v_mfma_f32_16x16x32_bf16 v[52:55], a[84:87], v[140:143], v[52:55]
 s_waitcnt lgkmcnt(9)
 ds_read_b64_tr_b16 a[82:83], v6 offset:16896
 s_add_u32 s78, s74, 2654464
 v_mfma_f32_16x16x32_bf16 v[56:59], a[88:91], v[136:139], v[56:59]
 s_add_u32 m0, s69, 110592
 ds_read_b64_tr_b16 a[84:85], v7 offset:16384
 buffer_load_dwordx4 v21, s[20:23], s78 offen  lds
 v_mfma_f32_16x16x32_bf16 v[60:63], a[88:91], v[140:143], v[60:63]
 s_waitcnt lgkmcnt(9)
 ds_read_b64_tr_b16 a[86:87], v7 offset:16896
 v_cvt_pk_bf16_f32 v33, v90, v91
 v_mfma_f32_16x16x32_bf16 v[64:67], a[92:95], v[136:139], v[64:67]
 ds_read_b64_tr_b16 a[88:89], v4 offset:20480
 v_accvgpr_write_b32 a19, v33
 v_mfma_f32_16x16x32_bf16 v[68:71], a[92:95], v[140:143], v[68:71]
 s_waitcnt lgkmcnt(9)
 ds_read_b64_tr_b16 a[90:91], v4 offset:20992
 v_cvt_pk_bf16_f32 v32, v92, v93
 v_mfma_f32_16x16x32_bf16 v[72:75], a[96:99], v[136:139], v[72:75]
 ds_read_b64_tr_b16 a[92:93], v5 offset:20480
 v_accvgpr_write_b32 a22, v32
 v_mfma_f32_16x16x32_bf16 v[76:79], a[96:99], v[140:143], v[76:79]
 s_waitcnt lgkmcnt(9)
 ds_read_b64_tr_b16 a[94:95], v5 offset:20992
 s_add_u32 s78, s74, 2949376
 v_mfma_f32_16x16x32_bf16 v[48:51], a[72:75], v[144:147], v[48:51]
 s_add_u32 m0, s69, 114688
 ds_read_b64_tr_b16 a[96:97], v6 offset:20480
 buffer_load_dwordx4 v21, s[20:23], s78 offen  lds
 v_mfma_f32_16x16x32_bf16 v[52:55], a[72:75], v[148:151], v[52:55]
 s_waitcnt lgkmcnt(9)
 ds_read_b64_tr_b16 a[98:99], v6 offset:20992
 v_cvt_pk_bf16_f32 v33, v94, v95
 v_mfma_f32_16x16x32_bf16 v[56:59], a[76:79], v[144:147], v[56:59]
 ds_read_b64_tr_b16 a[72:73], v7 offset:20480
 v_accvgpr_write_b32 a23, v33
 v_mfma_f32_16x16x32_bf16 v[60:63], a[76:79], v[148:151], v[60:63]
 s_waitcnt lgkmcnt(9)
 ds_read_b64_tr_b16 a[74:75], v7 offset:20992
 v_cvt_pk_bf16_f32 v32, v96, v97
 v_mfma_f32_16x16x32_bf16 v[64:67], a[80:83], v[144:147], v[64:67]
 s_waitcnt vmcnt(29)
 s_barrier
 ds_read_b64_tr_b16 a[76:77], v4 offset:24576
 v_accvgpr_write_b32 a24, v32
 v_mfma_f32_16x16x32_bf16 v[68:71], a[80:83], v[148:151], v[68:71]
 s_waitcnt lgkmcnt(9)
 ds_read_b64_tr_b16 a[78:79], v4 offset:25088
 s_add_u32 s78, s74, 3244288
 v_mfma_f32_16x16x32_bf16 v[72:75], a[84:87], v[144:147], v[72:75]
 s_add_u32 m0, s69, 118784
 ds_read_b64_tr_b16 a[80:81], v5 offset:24576
 buffer_load_dwordx4 v21, s[20:23], s78 offen  lds
 v_mfma_f32_16x16x32_bf16 v[76:79], a[84:87], v[148:151], v[76:79]
 s_waitcnt lgkmcnt(9)
 ds_read_b64_tr_b16 a[82:83], v5 offset:25088
 v_cvt_pk_bf16_f32 v33, v98, v99
 v_mfma_f32_16x16x32_bf16 v[48:51], a[88:91], v[152:155], v[48:51]
 ds_read_b64_tr_b16 a[84:85], v6 offset:24576
 v_accvgpr_write_b32 a25, v33
 v_mfma_f32_16x16x32_bf16 v[52:55], a[88:91], v[156:159], v[52:55]
 s_waitcnt lgkmcnt(9)
 ds_read_b64_tr_b16 a[86:87], v6 offset:25088
 v_cvt_pk_bf16_f32 v32, v100, v101
 v_mfma_f32_16x16x32_bf16 v[56:59], a[92:95], v[152:155], v[56:59]
 ds_read_b64_tr_b16 a[88:89], v7 offset:24576
 v_accvgpr_write_b32 a28, v32
 v_mfma_f32_16x16x32_bf16 v[60:63], a[92:95], v[156:159], v[60:63]
 s_waitcnt lgkmcnt(9)
 ds_read_b64_tr_b16 a[90:91], v7 offset:25088
 s_add_u32 s78, s74, 3539200
 v_mfma_f32_16x16x32_bf16 v[64:67], a[96:99], v[152:155], v[64:67]
 s_add_u32 m0, s69, 122880
 ds_read_b64_tr_b16 a[92:93], v4 offset:28672
 buffer_load_dwordx4 v21, s[20:23], s78 offen  lds
 v_mfma_f32_16x16x32_bf16 v[68:71], a[96:99], v[156:159], v[68:71]
 s_waitcnt lgkmcnt(9)
 ds_read_b64_tr_b16 a[94:95], v4 offset:29184
 v_cvt_pk_bf16_f32 v33, v102, v103
 v_mfma_f32_16x16x32_bf16 v[72:75], a[72:75], v[152:155], v[72:75]
 ds_read_b64_tr_b16 a[96:97], v5 offset:28672
 v_accvgpr_write_b32 a29, v33
 v_mfma_f32_16x16x32_bf16 v[76:79], a[72:75], v[156:159], v[76:79]
 s_waitcnt lgkmcnt(9)
 ds_read_b64_tr_b16 a[98:99], v5 offset:29184
 v_cvt_pk_bf16_f32 v32, v104, v105
 v_mfma_f32_16x16x32_bf16 v[48:51], a[76:79], v[160:163], v[48:51]
 ds_read_b64_tr_b16 a[72:73], v6 offset:28672
 v_accvgpr_write_b32 a26, v32
 v_mfma_f32_16x16x32_bf16 v[52:55], a[76:79], v[164:167], v[52:55]
 s_waitcnt lgkmcnt(9)
 ds_read_b64_tr_b16 a[74:75], v6 offset:29184
 s_add_u32 s78, s74, 3834112
 v_mfma_f32_16x16x32_bf16 v[56:59], a[80:83], v[160:163], v[56:59]
 s_add_u32 m0, s69, 126976
 ds_read_b64_tr_b16 a[76:77], v7 offset:28672
 buffer_load_dwordx4 v21, s[20:23], s78 offen  lds
 v_mfma_f32_16x16x32_bf16 v[60:63], a[80:83], v[164:167], v[60:63]
 s_waitcnt lgkmcnt(9)
 ds_read_b64_tr_b16 a[78:79], v7 offset:29184
 v_cvt_pk_bf16_f32 v33, v106, v107
 v_mfma_f32_16x16x32_bf16 v[64:67], a[84:87], v[160:163], v[64:67]
 ds_read_b64_tr_b16 a[80:81], v4 offset:32768
 v_accvgpr_write_b32 a27, v33
 v_mfma_f32_16x16x32_bf16 v[68:71], a[84:87], v[164:167], v[68:71]
 s_waitcnt lgkmcnt(9)
 ds_read_b64_tr_b16 a[82:83], v4 offset:33280
 v_cvt_pk_bf16_f32 v32, v108, v109
 v_mfma_f32_16x16x32_bf16 v[72:75], a[88:91], v[160:163], v[72:75]
 ds_read_b64_tr_b16 a[84:85], v5 offset:32768
 v_accvgpr_write_b32 a30, v32
 v_mfma_f32_16x16x32_bf16 v[76:79], a[88:91], v[164:167], v[76:79]
 s_waitcnt lgkmcnt(9)
 ds_read_b64_tr_b16 a[86:87], v5 offset:33280
 s_add_u32 s78, s74, 4129024
 v_mfma_f32_16x16x32_bf16 v[48:51], a[92:95], v[168:171], v[48:51]
 s_add_u32 m0, s69, 131072
 ds_read_b64_tr_b16 a[88:89], v6 offset:32768
 buffer_load_dwordx4 v21, s[20:23], s78 offen  lds
 v_mfma_f32_16x16x32_bf16 v[52:55], a[92:95], v[172:175], v[52:55]
 s_waitcnt lgkmcnt(9)
 ds_read_b64_tr_b16 a[90:91], v6 offset:33280
 v_cvt_pk_bf16_f32 v33, v110, v111
 v_mfma_f32_16x16x32_bf16 v[56:59], a[96:99], v[168:171], v[56:59]
 ds_read_b64_tr_b16 a[92:93], v7 offset:32768
 v_accvgpr_write_b32 a31, v33
 v_mfma_f32_16x16x32_bf16 v[60:63], a[96:99], v[172:175], v[60:63]
 s_waitcnt lgkmcnt(9)
 ds_read_b64_tr_b16 a[94:95], v7 offset:33280
 buffer_atomic_add v36, v25, s[32:35], s99 offen sc1
 v_mfma_f32_16x16x32_bf16 v[64:67], a[72:75], v[168:171], v[64:67]
 s_and_b32 s99, s70, 15
 ds_read_b64_tr_b16 a[96:97], v4 offset:36864
 v_mfma_f32_16x16x32_bf16 v[68:71], a[72:75], v[172:175], v[68:71]
 s_waitcnt lgkmcnt(9)
 ds_read_b64_tr_b16 a[98:99], v4 offset:37376
 s_add_u32 s78, s74, 4423936
 v_mfma_f32_16x16x32_bf16 v[72:75], a[76:79], v[168:171], v[72:75]
 s_add_u32 m0, s69, 135168
 ds_read_b64_tr_b16 a[72:73], v5 offset:36864
 buffer_load_dwordx4 v21, s[20:23], s78 offen  lds
 v_mfma_f32_16x16x32_bf16 v[76:79], a[76:79], v[172:175], v[76:79]
 s_waitcnt lgkmcnt(9)
 ds_read_b64_tr_b16 a[74:75], v5 offset:37376
 v_mfma_f32_16x16x32_bf16 v[48:51], a[80:83], v[176:179], v[48:51]
 s_cmp_eq_u32 s99, 13
 s_cselect_b32 s99, s94, 0x40000000
 ds_read_b64_tr_b16 a[76:77], v6 offset:36864
 buffer_atomic_add v36, v25, s[32:35], s99 offen sc1
 v_mfma_f32_16x16x32_bf16 v[52:55], a[80:83], v[180:183], v[52:55]
 s_waitcnt lgkmcnt(9)
 ds_read_b64_tr_b16 a[78:79], v6 offset:37376
 v_mfma_f32_16x16x32_bf16 v[56:59], a[84:87], v[176:179], v[56:59]
 s_and_b32 s99, s70, 15
 ds_read_b64_tr_b16 a[80:81], v7 offset:36864
 v_mfma_f32_16x16x32_bf16 v[60:63], a[84:87], v[180:183], v[60:63]
 s_waitcnt lgkmcnt(9)
 ds_read_b64_tr_b16 a[82:83], v7 offset:37376
 s_add_u32 s78, s74, 4718848
 v_mfma_f32_16x16x32_bf16 v[64:67], a[88:91], v[176:179], v[64:67]
 s_add_u32 m0, s69, 139264
 ds_read_b64_tr_b16 a[84:85], v4 offset:40960
 buffer_load_dwordx4 v21, s[20:23], s78 offen  lds
 v_mfma_f32_16x16x32_bf16 v[68:71], a[88:91], v[180:183], v[68:71]
 s_waitcnt lgkmcnt(9)
 ds_read_b64_tr_b16 a[86:87], v4 offset:41472
 v_mfma_f32_16x16x32_bf16 v[72:75], a[92:95], v[176:179], v[72:75]
 s_cmp_eq_u32 s99, 14
 s_cselect_b32 s99, s94, 0x40000000
 ds_read_b64_tr_b16 a[88:89], v5 offset:40960
 buffer_atomic_add v36, v25, s[32:35], s99 offen sc1
 v_mfma_f32_16x16x32_bf16 v[76:79], a[92:95], v[180:183], v[76:79]
 s_waitcnt lgkmcnt(9)
 ds_read_b64_tr_b16 a[90:91], v5 offset:41472
 v_mfma_f32_16x16x32_bf16 v[48:51], a[96:99], v[184:187], v[48:51]
 s_and_b32 s99, s70, 15
 ds_read_b64_tr_b16 a[92:93], v6 offset:40960
 buffer_load_dword a163, v3, s[20:23], s74 offen offset:384
 v_mfma_f32_16x16x32_bf16 v[52:55], a[96:99], v[188:191], v[52:55]
 s_waitcnt lgkmcnt(9)
 ds_read_b64_tr_b16 a[94:95], v6 offset:41472
 buffer_load_dword a167, v34, s[24:27], 0 offen offset:256
 v_mfma_f32_16x16x32_bf16 v[56:59], a[72:75], v[184:187], v[56:59]
 s_add_u32 s78, s74, 5013760
 ds_read_b64_tr_b16 a[96:97], v7 offset:40960
 v_mfma_f32_16x16x32_bf16 v[60:63], a[72:75], v[188:191], v[60:63]
 s_waitcnt lgkmcnt(9)
 ds_read_b64_tr_b16 a[98:99], v7 offset:41472
 v_mfma_f32_16x16x32_bf16 v[64:67], a[76:79], v[184:187], v[64:67]
 s_add_u32 m0, s69, 143360
 ds_read_b64_tr_b16 a[72:73], v4 offset:45056
 buffer_load_dwordx4 v21, s[20:23], s78 offen  lds
 v_mfma_f32_16x16x32_bf16 v[68:71], a[76:79], v[188:191], v[68:71]
 s_waitcnt lgkmcnt(9)
 ds_read_b64_tr_b16 a[74:75], v4 offset:45568
 v_mfma_f32_16x16x32_bf16 v[72:75], a[80:83], v[184:187], v[72:75]
 s_cmp_eq_u32 s99, 15
 s_cselect_b32 s99, s94, 0x40000000
 ds_read_b64_tr_b16 a[76:77], v5 offset:45056
 buffer_atomic_add v36, v25, s[32:35], s99 offen sc1
 v_mfma_f32_16x16x32_bf16 v[76:79], a[80:83], v[188:191], v[76:79]
 s_waitcnt lgkmcnt(9)
 ds_read_b64_tr_b16 a[78:79], v5 offset:45568
 v_mfma_f32_16x16x32_bf16 v[48:51], a[84:87], v[192:195], v[48:51]
 ds_read_b64_tr_b16 a[80:81], v6 offset:45056
 v_mfma_f32_16x16x32_bf16 v[52:55], a[84:87], v[196:199], v[52:55]
 s_waitcnt lgkmcnt(9)
 ds_read_b64_tr_b16 a[82:83], v6 offset:45568
 v_mfma_f32_16x16x32_bf16 v[56:59], a[88:91], v[192:195], v[56:59]
 ds_read_b64_tr_b16 a[84:85], v7 offset:45056
 v_mfma_f32_16x16x32_bf16 v[60:63], a[88:91], v[196:199], v[60:63]
 s_waitcnt lgkmcnt(9)
 ds_read_b64_tr_b16 a[86:87], v7 offset:45568
 v_mfma_f32_16x16x32_bf16 v[64:67], a[92:95], v[192:195], v[64:67]
 s_waitcnt vmcnt(26)
 s_barrier
 ds_read_b64_tr_b16 a[88:89], v4 offset:49152
 v_mfma_f32_16x16x32_bf16 v[68:71], a[92:95], v[196:199], v[68:71]
 s_waitcnt lgkmcnt(9)
 ds_read_b64_tr_b16 a[90:91], v4 offset:49664
 s_add_u32 s78, s74, 384
 v_mfma_f32_16x16x32_bf16 v[72:75], a[96:99], v[192:195], v[72:75]
 s_add_u32 m0, s69, 0
 ds_read_b64_tr_b16 a[92:93], v5 offset:49152
 buffer_load_dwordx4 v21, s[16:19], s78 offen  lds
 v_mfma_f32_16x16x32_bf16 v[76:79], a[96:99], v[196:199], v[76:79]
 s_waitcnt lgkmcnt(9)
 ds_read_b64_tr_b16 a[94:95], v5 offset:49664
 v_mfma_f32_16x16x32_bf16 v[48:51], a[72:75], v[200:203], v[48:51]
 ds_read_b64_tr_b16 a[96:97], v6 offset:49152
 v_mfma_f32_16x16x32_bf16 v[52:55], a[72:75], v[204:207], v[52:55]
 s_waitcnt lgkmcnt(9)
 ds_read_b64_tr_b16 a[98:99], v6 offset:49664
 v_mfma_f32_16x16x32_bf16 v[56:59], a[76:79], v[200:203], v[56:59]
 ds_read_b64_tr_b16 a[72:73], v7 offset:49152
 v_mfma_f32_16x16x32_bf16 v[60:63], a[76:79], v[204:207], v[60:63]
 s_waitcnt lgkmcnt(9)
 ds_read_b64_tr_b16 a[74:75], v7 offset:49664
 v_mfma_f32_16x16x32_bf16 v[64:67], a[80:83], v[200:203], v[64:67]
 ds_read_b64_tr_b16 a[76:77], v4 offset:53248
 v_mfma_f32_16x16x32_bf16 v[68:71], a[80:83], v[204:207], v[68:71]
 s_waitcnt lgkmcnt(9)
 ds_read_b64_tr_b16 a[78:79], v4 offset:53760
 v_mfma_f32_16x16x32_bf16 v[72:75], a[84:87], v[200:203], v[72:75]
 ds_read_b64_tr_b16 a[80:81], v5 offset:53248
 v_mfma_f32_16x16x32_bf16 v[76:79], a[84:87], v[204:207], v[76:79]
 s_waitcnt lgkmcnt(9)
 ds_read_b64_tr_b16 a[82:83], v5 offset:53760
 v_mfma_f32_16x16x32_bf16 v[48:51], a[88:91], v[208:211], v[48:51]
 ds_read_b64_tr_b16 a[84:85], v6 offset:53248
 v_mfma_f32_16x16x32_bf16 v[52:55], a[88:91], v[212:215], v[52:55]
 s_waitcnt lgkmcnt(9)
 ds_read_b64_tr_b16 a[86:87], v6 offset:53760
 s_add_u32 s78, s74, 295296
 v_mfma_f32_16x16x32_bf16 v[56:59], a[92:95], v[208:211], v[56:59]
 s_add_u32 m0, s69, 4096
 ds_read_b64_tr_b16 a[88:89], v7 offset:53248
 buffer_load_dwordx4 v21, s[16:19], s78 offen  lds
 v_mfma_f32_16x16x32_bf16 v[60:63], a[92:95], v[212:215], v[60:63]
 s_waitcnt lgkmcnt(9)
 ds_read_b64_tr_b16 a[90:91], v7 offset:53760
 v_mfma_f32_16x16x32_bf16 v[64:67], a[96:99], v[208:211], v[64:67]
 ds_read_b64_tr_b16 a[92:93], v4 offset:57344
 v_mfma_f32_16x16x32_bf16 v[68:71], a[96:99], v[212:215], v[68:71]
 s_waitcnt lgkmcnt(9)
 ds_read_b64_tr_b16 a[94:95], v4 offset:57856
 v_mfma_f32_16x16x32_bf16 v[72:75], a[72:75], v[208:211], v[72:75]
 ds_read_b64_tr_b16 a[96:97], v5 offset:57344
 v_mfma_f32_16x16x32_bf16 v[76:79], a[72:75], v[212:215], v[76:79]
 s_waitcnt lgkmcnt(9)
 ds_read_b64_tr_b16 a[98:99], v5 offset:57856
 v_mfma_f32_16x16x32_bf16 v[48:51], a[76:79], v[216:219], v[48:51]
 ds_read_b64_tr_b16 a[72:73], v6 offset:57344
 v_mfma_f32_16x16x32_bf16 v[52:55], a[76:79], v[220:223], v[52:55]
 s_waitcnt lgkmcnt(9)
 ds_read_b64_tr_b16 a[74:75], v6 offset:57856
 v_mfma_f32_16x16x32_bf16 v[56:59], a[80:83], v[216:219], v[56:59]
 ds_read_b64_tr_b16 a[76:77], v7 offset:57344
 v_mfma_f32_16x16x32_bf16 v[60:63], a[80:83], v[220:223], v[60:63]
 s_waitcnt lgkmcnt(9)
 ds_read_b64_tr_b16 a[78:79], v7 offset:57856
 v_mfma_f32_16x16x32_bf16 v[64:67], a[84:87], v[216:219], v[64:67]
 ds_read_b64_tr_b16 a[80:81], v4 offset:61440
 v_mfma_f32_16x16x32_bf16 v[68:71], a[84:87], v[220:223], v[68:71]
 s_waitcnt lgkmcnt(9)
 ds_read_b64_tr_b16 a[82:83], v4 offset:61952
 s_add_u32 s78, s74, 590208
 v_mfma_f32_16x16x32_bf16 v[72:75], a[88:91], v[216:219], v[72:75]
 s_add_u32 m0, s69, 8192
 ds_read_b64_tr_b16 a[84:85], v5 offset:61440
 buffer_load_dwordx4 v21, s[16:19], s78 offen  lds
 v_mfma_f32_16x16x32_bf16 v[76:79], a[88:91], v[220:223], v[76:79]
 s_waitcnt lgkmcnt(9)
 ds_read_b64_tr_b16 a[86:87], v5 offset:61952
 v_mfma_f32_16x16x32_bf16 v[48:51], a[92:95], v[224:227], v[48:51]
 ds_read_b64_tr_b16 a[88:89], v6 offset:61440
 v_mfma_f32_16x16x32_bf16 v[52:55], a[92:95], v[228:231], v[52:55]
 s_waitcnt lgkmcnt(9)
 ds_read_b64_tr_b16 a[90:91], v6 offset:61952
 v_mfma_f32_16x16x32_bf16 v[56:59], a[96:99], v[224:227], v[56:59]
 ds_read_b64_tr_b16 a[92:93], v7 offset:61440
 v_mfma_f32_16x16x32_bf16 v[60:63], a[96:99], v[228:231], v[60:63]
 s_waitcnt lgkmcnt(9)
 ds_read_b64_tr_b16 a[94:95], v7 offset:61952
 v_mfma_f32_16x16x32_bf16 v[64:67], a[72:75], v[224:227], v[64:67]
 ds_read_b64_tr_b16 a[96:97], v8 offset:0
 v_mfma_f32_16x16x32_bf16 v[68:71], a[72:75], v[228:231], v[68:71]
 s_waitcnt lgkmcnt(9)
 ds_read_b64_tr_b16 a[98:99], v8 offset:512
 v_mfma_f32_16x16x32_bf16 v[72:75], a[76:79], v[224:227], v[72:75]
 ds_read_b64_tr_b16 a[72:73], v9 offset:0
 v_mfma_f32_16x16x32_bf16 v[76:79], a[76:79], v[228:231], v[76:79]
 s_waitcnt lgkmcnt(9)
 ds_read_b64_tr_b16 a[74:75], v9 offset:512
 v_mfma_f32_16x16x32_bf16 v[48:51], a[80:83], v[232:235], v[48:51]
 ds_read_b64_tr_b16 a[76:77], v10 offset:0
 v_mfma_f32_16x16x32_bf16 v[52:55], a[80:83], v[236:239], v[52:55]
 s_waitcnt lgkmcnt(9)
 ds_read_b64_tr_b16 a[78:79], v10 offset:512
 s_add_u32 s78, s74, 885120
 v_mfma_f32_16x16x32_bf16 v[56:59], a[84:87], v[232:235], v[56:59]
 s_add_u32 m0, s69, 12288
 ds_read_b64_tr_b16 a[80:81], v11 offset:0
 buffer_load_dwordx4 v21, s[16:19], s78 offen  lds
 v_mfma_f32_16x16x32_bf16 v[60:63], a[84:87], v[236:239], v[60:63]
 s_waitcnt lgkmcnt(9)
 ds_read_b64_tr_b16 a[82:83], v11 offset:512
 v_mfma_f32_16x16x32_bf16 v[64:67], a[88:91], v[232:235], v[64:67]
 ds_read_b64_tr_b16 a[84:85], v8 offset:4096
 v_mfma_f32_16x16x32_bf16 v[68:71], a[88:91], v[236:239], v[68:71]
 s_waitcnt lgkmcnt(9)
 ds_read_b64_tr_b16 a[86:87], v8 offset:4608
 v_mfma_f32_16x16x32_bf16 v[72:75], a[92:95], v[232:235], v[72:75]
 ds_read_b64_tr_b16 a[88:89], v9 offset:4096
 v_mfma_f32_16x16x32_bf16 v[76:79], a[92:95], v[236:239], v[76:79]
 s_waitcnt lgkmcnt(9)
 ds_read_b64_tr_b16 a[90:91], v9 offset:4608
 v_mfma_f32_16x16x32_bf16 v[48:51], a[96:99], v[240:243], v[48:51]
 ds_read_b64_tr_b16 a[92:93], v10 offset:4096
 v_mfma_f32_16x16x32_bf16 v[52:55], a[96:99], v[244:247], v[52:55]
 s_waitcnt lgkmcnt(9)
 ds_read_b64_tr_b16 a[94:95], v10 offset:4608
 v_mfma_f32_16x16x32_bf16 v[56:59], a[72:75], v[240:243], v[56:59]
 ds_read_b64_tr_b16 a[96:97], v11 offset:4096
 v_mfma_f32_16x16x32_bf16 v[60:63], a[72:75], v[244:247], v[60:63]
 s_waitcnt lgkmcnt(9)
 ds_read_b64_tr_b16 a[98:99], v11 offset:4608
 v_mfma_f32_16x16x32_bf16 v[64:67], a[76:79], v[240:243], v[64:67]
 s_waitcnt vmcnt(22)
 s_barrier
 ds_read_b64_tr_b16 a[72:73], v8 offset:8192
 v_mfma_f32_16x16x32_bf16 v[68:71], a[76:79], v[244:247], v[68:71]
 s_waitcnt lgkmcnt(9)
 ds_read_b64_tr_b16 a[74:75], v8 offset:8704
 s_add_u32 s78, s74, 1180032
 v_mfma_f32_16x16x32_bf16 v[72:75], a[80:83], v[240:243], v[72:75]
 s_add_u32 m0, s69, 16384
 ds_read_b64_tr_b16 a[76:77], v9 offset:8192
 buffer_load_dwordx4 v21, s[16:19], s78 offen  lds
 v_mfma_f32_16x16x32_bf16 v[76:79], a[80:83], v[244:247], v[76:79]
 s_waitcnt lgkmcnt(9)
 ds_read_b64_tr_b16 a[78:79], v9 offset:8704
 v_mfma_f32_16x16x32_bf16 v[48:51], a[84:87], v[248:251], v[48:51]
 ds_read_b64_tr_b16 a[80:81], v10 offset:8192
 v_mfma_f32_16x16x32_bf16 v[52:55], a[84:87], v[252:255], v[52:55]
 s_waitcnt lgkmcnt(9)
 ds_read_b64_tr_b16 a[82:83], v10 offset:8704
 v_mfma_f32_16x16x32_bf16 v[56:59], a[88:91], v[248:251], v[56:59]
 ds_read_b64_tr_b16 a[84:85], v11 offset:8192
 v_mfma_f32_16x16x32_bf16 v[60:63], a[88:91], v[252:255], v[60:63]
 s_waitcnt lgkmcnt(9)
 ds_read_b64_tr_b16 a[86:87], v11 offset:8704
 v_mfma_f32_16x16x32_bf16 v[64:67], a[92:95], v[248:251], v[64:67]
 ds_read_b64_tr_b16 a[88:89], v8 offset:12288
 v_mfma_f32_16x16x32_bf16 v[68:71], a[92:95], v[252:255], v[68:71]
 s_waitcnt lgkmcnt(9)
 ds_read_b64_tr_b16 a[90:91], v8 offset:12800
 v_mfma_f32_16x16x32_bf16 v[72:75], a[96:99], v[248:251], v[72:75]
 ds_read_b64_tr_b16 a[92:93], v9 offset:12288
 v_mfma_f32_16x16x32_bf16 v[76:79], a[96:99], v[252:255], v[76:79]
 s_waitcnt lgkmcnt(9)
 ds_read_b64_tr_b16 a[94:95], v9 offset:12800
 v_mfma_f32_16x16x32_bf16 v[80:83], a[72:75], v[112:115], 0
 ds_read_b64_tr_b16 a[96:97], v10 offset:12288
 v_mfma_f32_16x16x32_bf16 v[84:87], a[72:75], v[116:119], 0
 s_waitcnt lgkmcnt(9)
 ds_read_b64_tr_b16 a[98:99], v10 offset:12800
 s_add_u32 s78, s74, 1474944
 v_mfma_f32_16x16x32_bf16 v[88:91], a[76:79], v[112:115], 0
 s_add_u32 m0, s69, 20480
 ds_read_b64_tr_b16 a[72:73], v11 offset:12288
 buffer_load_dwordx4 v21, s[16:19], s78 offen  lds
 v_mfma_f32_16x16x32_bf16 v[92:95], a[76:79], v[116:119], 0
 s_waitcnt lgkmcnt(9)
 ds_read_b64_tr_b16 a[74:75], v11 offset:12800
 v_mfma_f32_16x16x32_bf16 v[96:99], a[80:83], v[112:115], 0
 ds_read_b64_tr_b16 a[76:77], v8 offset:16384
 v_mfma_f32_16x16x32_bf16 v[100:103], a[80:83], v[116:119], 0
 s_waitcnt lgkmcnt(9)
 ds_read_b64_tr_b16 a[78:79], v8 offset:16896
 v_mfma_f32_16x16x32_bf16 v[104:107], a[84:87], v[112:115], 0
 ds_read_b64_tr_b16 a[80:81], v9 offset:16384
 v_mfma_f32_16x16x32_bf16 v[108:111], a[84:87], v[116:119], 0
 s_waitcnt lgkmcnt(9)
 ds_read_b64_tr_b16 a[82:83], v9 offset:16896
 v_mfma_f32_16x16x32_bf16 v[80:83], a[88:91], v[120:123], v[80:83]
 ds_read_b64_tr_b16 a[84:85], v10 offset:16384
 v_mul_f32 v48, v30, v48
 v_mfma_f32_16x16x32_bf16 v[84:87], a[88:91], v[124:127], v[84:87]
 s_waitcnt lgkmcnt(9)
 ds_read_b64_tr_b16 a[86:87], v10 offset:16896
 v_mul_f32 v49, v30, v49
 v_mfma_f32_16x16x32_bf16 v[88:91], a[92:95], v[120:123], v[88:91]
 ds_read_b64_tr_b16 a[88:89], v11 offset:16384
 v_mul_f32 v50, v30, v50
 v_mfma_f32_16x16x32_bf16 v[92:95], a[92:95], v[124:127], v[92:95]
 s_waitcnt lgkmcnt(9)
 ds_read_b64_tr_b16 a[90:91], v11 offset:16896
 v_mul_f32 v51, v30, v51
 v_mfma_f32_16x16x32_bf16 v[96:99], a[96:99], v[120:123], v[96:99]
 ds_read_b64_tr_b16 a[92:93], v8 offset:20480
 v_mul_f32 v52, v31, v52
 v_mfma_f32_16x16x32_bf16 v[100:103], a[96:99], v[124:127], v[100:103]
 s_waitcnt lgkmcnt(9)
 ds_read_b64_tr_b16 a[94:95], v8 offset:20992
 s_add_u32 s78, s74, 1769856
 v_mfma_f32_16x16x32_bf16 v[104:107], a[72:75], v[120:123], v[104:107]
 s_add_u32 m0, s69, 24576
 ds_read_b64_tr_b16 a[96:97], v9 offset:20480
 buffer_load_dwordx4 v21, s[16:19], s78 offen  lds
 v_mfma_f32_16x16x32_bf16 v[108:111], a[72:75], v[124:127], v[108:111]
 s_waitcnt lgkmcnt(9)
 ds_read_b64_tr_b16 a[98:99], v9 offset:20992
 v_mul_f32 v53, v31, v53
 v_mfma_f32_16x16x32_bf16 v[80:83], a[76:79], v[128:131], v[80:83]
 ds_read_b64_tr_b16 a[72:73], v10 offset:20480
 v_mul_f32 v54, v31, v54
 v_mfma_f32_16x16x32_bf16 v[84:87], a[76:79], v[132:135], v[84:87]
 s_waitcnt lgkmcnt(9)
 ds_read_b64_tr_b16 a[74:75], v10 offset:20992
 v_mul_f32 v55, v31, v55
 v_mfma_f32_16x16x32_bf16 v[88:91], a[80:83], v[128:131], v[88:91]
 ds_read_b64_tr_b16 a[76:77], v11 offset:20480
 v_mul_f32 v56, v30, v56
 v_mfma_f32_16x16x32_bf16 v[92:95], a[80:83], v[132:135], v[92:95]
 s_waitcnt lgkmcnt(9)
 ds_read_b64_tr_b16 a[78:79], v11 offset:20992
 s_add_u32 s78, s74, 2064768
 v_mfma_f32_16x16x32_bf16 v[96:99], a[84:87], v[128:131], v[96:99]
 s_add_u32 m0, s69, 28672
 ds_read_b64_tr_b16 a[80:81], v8 offset:24576
 buffer_load_dwordx4 v21, s[16:19], s78 offen  lds
 v_mfma_f32_16x16x32_bf16 v[100:103], a[84:87], v[132:135], v[100:103]
 s_waitcnt lgkmcnt(9)
 ds_read_b64_tr_b16 a[82:83], v8 offset:25088
 v_mul_f32 v57, v30, v57
 v_mfma_f32_16x16x32_bf16 v[104:107], a[88:91], v[128:131], v[104:107]
 ds_read_b64_tr_b16 a[84:85], v9 offset:24576
 v_mul_f32 v58, v30, v58
 v_mfma_f32_16x16x32_bf16 v[108:111], a[88:91], v[132:135], v[108:111]
 s_waitcnt lgkmcnt(9)
 ds_read_b64_tr_b16 a[86:87], v9 offset:25088
 v_mul_f32 v59, v30, v59
 v_mfma_f32_16x16x32_bf16 v[80:83], a[92:95], v[136:139], v[80:83]
 ds_read_b64_tr_b16 a[88:89], v10 offset:24576
 v_mul_f32 v60, v31, v60
 v_mfma_f32_16x16x32_bf16 v[84:87], a[92:95], v[140:143], v[84:87]
 s_waitcnt lgkmcnt(9)
 ds_read_b64_tr_b16 a[90:91], v10 offset:25088
 s_add_u32 s78, s74, 2359680
 v_mfma_f32_16x16x32_bf16 v[88:91], a[96:99], v[136:139], v[88:91]
 s_add_u32 m0, s69, 32768
 ds_read_b64_tr_b16 a[92:93], v11 offset:24576
 buffer_load_dwordx4 v21, s[16:19], s78 offen  lds
 v_mfma_f32_16x16x32_bf16 v[92:95], a[96:99], v[140:143], v[92:95]
 s_waitcnt lgkmcnt(9)
 ds_read_b64_tr_b16 a[94:95], v11 offset:25088
 v_mul_f32 v61, v31, v61
 v_mfma_f32_16x16x32_bf16 v[96:99], a[72:75], v[136:139], v[96:99]
 ds_read_b64_tr_b16 a[96:97], v8 offset:28672
 v_mul_f32 v62, v31, v62
 v_mfma_f32_16x16x32_bf16 v[100:103], a[72:75], v[140:143], v[100:103]
 s_waitcnt lgkmcnt(9)
 ds_read_b64_tr_b16 a[98:99], v8 offset:29184
 v_mul_f32 v63, v31, v63
 v_mfma_f32_16x16x32_bf16 v[104:107], a[76:79], v[136:139], v[104:107]
 ds_read_b64_tr_b16 a[72:73], v9 offset:28672
 v_mul_f32 v64, v30, v64
 v_mfma_f32_16x16x32_bf16 v[108:111], a[76:79], v[140:143], v[108:111]
 s_waitcnt lgkmcnt(9)
 ds_read_b64_tr_b16 a[74:75], v9 offset:29184
 s_add_u32 s78, s74, 2654592
 v_mfma_f32_16x16x32_bf16 v[80:83], a[80:83], v[144:147], v[80:83]
 s_add_u32 m0, s69, 36864
 ds_read_b64_tr_b16 a[76:77], v10 offset:28672
 buffer_load_dwordx4 v21, s[16:19], s78 offen  lds
 v_mfma_f32_16x16x32_bf16 v[84:87], a[80:83], v[148:151], v[84:87]
 s_waitcnt lgkmcnt(9)
 ds_read_b64_tr_b16 a[78:79], v10 offset:29184
 v_mul_f32 v65, v30, v65
 v_mfma_f32_16x16x32_bf16 v[88:91], a[84:87], v[144:147], v[88:91]
 ds_read_b64_tr_b16 a[80:81], v11 offset:28672
 v_mul_f32 v66, v30, v66
 v_mfma_f32_16x16x32_bf16 v[92:95], a[84:87], v[148:151], v[92:95]
 s_waitcnt lgkmcnt(9)
 ds_read_b64_tr_b16 a[82:83], v11 offset:29184
 v_mul_f32 v67, v30, v67
 v_mfma_f32_16x16x32_bf16 v[96:99], a[88:91], v[144:147], v[96:99]
 s_waitcnt vmcnt(22)
 s_barrier
 ds_read_b64_tr_b16 a[84:85], v8 offset:32768
 v_mul_f32 v68, v31, v68
 v_mfma_f32_16x16x32_bf16 v[100:103], a[88:91], v[148:151], v[100:103]
 s_waitcnt lgkmcnt(9)
 ds_read_b64_tr_b16 a[86:87], v8 offset:33280
 s_add_u32 s78, s74, 2949504
 v_mfma_f32_16x16x32_bf16 v[104:107], a[92:95], v[144:147], v[104:107]
 s_add_u32 m0, s69, 40960
 ds_read_b64_tr_b16 a[88:89], v9 offset:32768
 buffer_load_dwordx4 v21, s[16:19], s78 offen  lds
 v_mfma_f32_16x16x32_bf16 v[108:111], a[92:95], v[148:151], v[108:111]
 s_waitcnt lgkmcnt(9)
 ds_read_b64_tr_b16 a[90:91], v9 offset:33280
 v_mul_f32 v69, v31, v69
 v_mfma_f32_16x16x32_bf16 v[80:83], a[96:99], v[152:155], v[80:83]
 ds_read_b64_tr_b16 a[92:93], v10 offset:32768
 v_mul_f32 v70, v31, v70
 v_mfma_f32_16x16x32_bf16 v[84:87], a[96:99], v[156:159], v[84:87]
 s_waitcnt lgkmcnt(9)
 ds_read_b64_tr_b16 a[94:95], v10 offset:33280
 v_mul_f32 v71, v31, v71
 v_mfma_f32_16x16x32_bf16 v[88:91], a[72:75], v[152:155], v[88:91]
 ds_read_b64_tr_b16 a[96:97], v11 offset:32768
 v_mul_f32 v72, v30, v72
 v_mfma_f32_16x16x32_bf16 v[92:95], a[72:75], v[156:159], v[92:95]
 s_waitcnt lgkmcnt(9)
 ds_read_b64_tr_b16 a[98:99], v11 offset:33280
 s_add_u32 s78, s74, 3244416
 v_mfma_f32_16x16x32_bf16 v[96:99], a[76:79], v[152:155], v[96:99]
 s_add_u32 m0, s69, 45056
 ds_read_b64_tr_b16 a[72:73], v8 offset:36864
 buffer_load_dwordx4 v21, s[16:19], s78 offen  lds
 v_mfma_f32_16x16x32_bf16 v[100:103], a[76:79], v[156:159], v[100:103]
 s_waitcnt lgkmcnt(9)
 ds_read_b64_tr_b16 a[74:75], v8 offset:37376
 v_mul_f32 v73, v30, v73
 v_mfma_f32_16x16x32_bf16 v[104:107], a[80:83], v[152:155], v[104:107]
 ds_read_b64_tr_b16 a[76:77], v9 offset:36864
 v_mul_f32 v74, v30, v74
 v_mfma_f32_16x16x32_bf16 v[108:111], a[80:83], v[156:159], v[108:111]
 s_waitcnt lgkmcnt(9)
 ds_read_b64_tr_b16 a[78:79], v9 offset:37376
 v_mul_f32 v75, v30, v75
 v_mfma_f32_16x16x32_bf16 v[80:83], a[84:87], v[160:163], v[80:83]
 ds_read_b64_tr_b16 a[80:81], v10 offset:36864
 v_mul_f32 v76, v31, v76
 v_mfma_f32_16x16x32_bf16 v[84:87], a[84:87], v[164:167], v[84:87]
 s_waitcnt lgkmcnt(9)
 ds_read_b64_tr_b16 a[82:83], v10 offset:37376
 s_add_u32 s78, s74, 3539328
 v_mfma_f32_16x16x32_bf16 v[88:91], a[88:91], v[160:163], v[88:91]
 s_add_u32 m0, s69, 49152
 ds_read_b64_tr_b16 a[84:85], v11 offset:36864
 buffer_load_dwordx4 v21, s[16:19], s78 offen  lds
 v_mfma_f32_16x16x32_bf16 v[92:95], a[88:91], v[164:167], v[92:95]
 s_waitcnt lgkmcnt(9)
 ds_read_b64_tr_b16 a[86:87], v11 offset:37376
 v_mul_f32 v77, v31, v77
 v_mfma_f32_16x16x32_bf16 v[96:99], a[92:95], v[160:163], v[96:99]
 ds_read_b64_tr_b16 a[88:89], v8 offset:40960
 v_mul_f32 v78, v31, v78
 v_mfma_f32_16x16x32_bf16 v[100:103], a[92:95], v[164:167], v[100:103]
 s_waitcnt lgkmcnt(9)
 ds_read_b64_tr_b16 a[90:91], v8 offset:41472
 v_mul_f32 v79, v31, v79
 v_mfma_f32_16x16x32_bf16 v[104:107], a[96:99], v[160:163], v[104:107]
 ds_read_b64_tr_b16 a[92:93], v9 offset:40960
 v_mfma_f32_16x16x32_bf16 v[108:111], a[96:99], v[164:167], v[108:111]
 s_waitcnt lgkmcnt(9)
 ds_read_b64_tr_b16 a[94:95], v9 offset:41472
 s_add_u32 s78, s74, 3834240
 v_mfma_f32_16x16x32_bf16 v[80:83], a[72:75], v[168:171], v[80:83]
 s_add_u32 m0, s69, 53248
 ds_read_b64_tr_b16 a[96:97], v10 offset:40960
 buffer_load_dwordx4 v21, s[16:19], s78 offen  lds
 v_mfma_f32_16x16x32_bf16 v[84:87], a[72:75], v[172:175], v[84:87]
 s_waitcnt lgkmcnt(9)
 ds_read_b64_tr_b16 a[98:99], v10 offset:41472
 v_mfma_f32_16x16x32_bf16 v[88:91], a[76:79], v[168:171], v[88:91]
 ds_read_b64_tr_b16 a[72:73], v11 offset:40960
 v_mfma_f32_16x16x32_bf16 v[92:95], a[76:79], v[172:175], v[92:95]
 s_waitcnt lgkmcnt(9)
 ds_read_b64_tr_b16 a[74:75], v11 offset:41472
 v_mfma_f32_16x16x32_bf16 v[96:99], a[80:83], v[168:171], v[96:99]
 ds_read_b64_tr_b16 a[76:77], v8 offset:45056
 v_mfma_f32_16x16x32_bf16 v[100:103], a[80:83], v[172:175], v[100:103]
 s_waitcnt lgkmcnt(9)
 ds_read_b64_tr_b16 a[78:79], v8 offset:45568
 s_add_u32 s78, s74, 4129152
 v_mfma_f32_16x16x32_bf16 v[104:107], a[84:87], v[168:171], v[104:107]
 s_add_u32 m0, s69, 57344
 ds_read_b64_tr_b16 a[80:81], v9 offset:45056
 buffer_load_dwordx4 v21, s[16:19], s78 offen  lds
 v_mfma_f32_16x16x32_bf16 v[108:111], a[84:87], v[172:175], v[108:111]
 s_waitcnt lgkmcnt(9)
 ds_read_b64_tr_b16 a[82:83], v9 offset:45568
 v_mfma_f32_16x16x32_bf16 v[80:83], a[88:91], v[176:179], v[80:83]
 ds_read_b64_tr_b16 a[84:85], v10 offset:45056
 v_mfma_f32_16x16x32_bf16 v[84:87], a[88:91], v[180:183], v[84:87]
 s_waitcnt lgkmcnt(9)
 ds_read_b64_tr_b16 a[86:87], v10 offset:45568
 v_mfma_f32_16x16x32_bf16 v[88:91], a[92:95], v[176:179], v[88:91]
 ds_read_b64_tr_b16 a[88:89], v11 offset:45056
 v_mfma_f32_16x16x32_bf16 v[92:95], a[92:95], v[180:183], v[92:95]
 s_waitcnt lgkmcnt(9)
 ds_read_b64_tr_b16 a[90:91], v11 offset:45568
 s_add_u32 s78, s74, 4424064
 v_mfma_f32_16x16x32_bf16 v[96:99], a[96:99], v[176:179], v[96:99]
 s_add_u32 m0, s69, 61440
 ds_read_b64_tr_b16 a[92:93], v8 offset:49152
 buffer_load_dwordx4 v21, s[16:19], s78 offen  lds
 v_mfma_f32_16x16x32_bf16 v[100:103], a[96:99], v[180:183], v[100:103]
 s_waitcnt lgkmcnt(9)
 ds_read_b64_tr_b16 a[94:95], v8 offset:49664
 v_mfma_f32_16x16x32_bf16 v[104:107], a[72:75], v[176:179], v[104:107]
 ds_read_b64_tr_b16 a[96:97], v9 offset:49152
 v_mfma_f32_16x16x32_bf16 v[108:111], a[72:75], v[180:183], v[108:111]
 s_waitcnt lgkmcnt(9)
 ds_read_b64_tr_b16 a[98:99], v9 offset:49664
 v_mfma_f32_16x16x32_bf16 v[80:83], a[76:79], v[184:187], v[80:83]
 ds_read_b64_tr_b16 a[72:73], v10 offset:49152
 buffer_load_dword a164, v3, s[16:19], s75 offen offset:0
 v_mfma_f32_16x16x32_bf16 v[84:87], a[76:79], v[188:191], v[84:87]
 s_waitcnt lgkmcnt(9)
 ds_read_b64_tr_b16 a[74:75], v10 offset:49664
 buffer_load_dword a165, v3, s[20:23], s75 offen offset:0
 v_mfma_f32_16x16x32_bf16 v[88:91], a[80:83], v[184:187], v[88:91]
 s_add_u32 s78, s74, 4718976
 ds_read_b64_tr_b16 a[76:77], v11 offset:49152
 buffer_load_dword a168, v34, s[24:27], 0 offen offset:512
 v_mfma_f32_16x16x32_bf16 v[92:95], a[80:83], v[188:191], v[92:95]
 s_waitcnt lgkmcnt(9)
 ds_read_b64_tr_b16 a[78:79], v11 offset:49664
 v_mfma_f32_16x16x32_bf16 v[96:99], a[84:87], v[184:187], v[96:99]
 s_add_u32 m0, s69, 65536
 ds_read_b64_tr_b16 a[80:81], v8 offset:53248
 buffer_load_dwordx4 v21, s[16:19], s78 offen  lds
 v_mfma_f32_16x16x32_bf16 v[100:103], a[84:87], v[188:191], v[100:103]
 s_waitcnt lgkmcnt(9)
 ds_read_b64_tr_b16 a[82:83], v8 offset:53760
 v_mfma_f32_16x16x32_bf16 v[104:107], a[88:91], v[184:187], v[104:107]
 ds_read_b64_tr_b16 a[84:85], v9 offset:53248
 v_mfma_f32_16x16x32_bf16 v[108:111], a[88:91], v[188:191], v[108:111]
 s_waitcnt lgkmcnt(9)
 ds_read_b64_tr_b16 a[86:87], v9 offset:53760
 v_mfma_f32_16x16x32_bf16 v[80:83], a[92:95], v[192:195], v[80:83]
 ds_read_b64_tr_b16 a[88:89], v10 offset:53248
 v_mfma_f32_16x16x32_bf16 v[84:87], a[92:95], v[196:199], v[84:87]
 s_waitcnt lgkmcnt(9)
 ds_read_b64_tr_b16 a[90:91], v10 offset:53760
 v_mfma_f32_16x16x32_bf16 v[88:91], a[96:99], v[192:195], v[88:91]
 ds_read_b64_tr_b16 a[92:93], v11 offset:53248
 v_mfma_f32_16x16x32_bf16 v[92:95], a[96:99], v[196:199], v[92:95]
 s_waitcnt lgkmcnt(9)
 ds_read_b64_tr_b16 a[94:95], v11 offset:53760
 v_mfma_f32_16x16x32_bf16 v[96:99], a[72:75], v[192:195], v[96:99]
 s_waitcnt vmcnt(21)
 s_barrier
 ds_read_b64_tr_b16 a[96:97], v8 offset:57344
 v_mfma_f32_16x16x32_bf16 v[100:103], a[72:75], v[196:199], v[100:103]
 s_waitcnt lgkmcnt(9)
 ds_read_b64_tr_b16 a[98:99], v8 offset:57856
 s_add_u32 s78, s74, 5013888
 v_mfma_f32_16x16x32_bf16 v[104:107], a[76:79], v[192:195], v[104:107]
 s_add_u32 m0, s69, 69632
 ds_read_b64_tr_b16 a[72:73], v9 offset:57344
 buffer_load_dwordx4 v21, s[16:19], s78 offen  lds
 v_mfma_f32_16x16x32_bf16 v[108:111], a[76:79], v[196:199], v[108:111]
 s_waitcnt lgkmcnt(9)
 ds_read_b64_tr_b16 a[74:75], v9 offset:57856
 v_mfma_f32_16x16x32_bf16 v[80:83], a[80:83], v[200:203], v[80:83]
 ds_read_b64_tr_b16 a[76:77], v10 offset:57344
 v_mfma_f32_16x16x32_bf16 v[84:87], a[80:83], v[204:207], v[84:87]
 s_waitcnt lgkmcnt(9)
 ds_read_b64_tr_b16 a[78:79], v10 offset:57856
 v_mfma_f32_16x16x32_bf16 v[88:91], a[84:87], v[200:203], v[88:91]
 ds_read_b64_tr_b16 a[80:81], v11 offset:57344
 v_mfma_f32_16x16x32_bf16 v[92:95], a[84:87], v[204:207], v[92:95]
 s_waitcnt lgkmcnt(9)
 ds_read_b64_tr_b16 a[82:83], v11 offset:57856
 v_mfma_f32_16x16x32_bf16 v[96:99], a[88:91], v[200:203], v[96:99]
 ds_read_b64_tr_b16 a[84:85], v8 offset:61440
 v_mfma_f32_16x16x32_bf16 v[100:103], a[88:91], v[204:207], v[100:103]
 s_waitcnt lgkmcnt(9)
 ds_read_b64_tr_b16 a[86:87], v8 offset:61952
 v_mfma_f32_16x16x32_bf16 v[104:107], a[92:95], v[200:203], v[104:107]
 ds_read_b64_tr_b16 a[88:89], v9 offset:61440
 v_mfma_f32_16x16x32_bf16 v[108:111], a[92:95], v[204:207], v[108:111]
 s_waitcnt lgkmcnt(9)
 ds_read_b64_tr_b16 a[90:91], v9 offset:61952
 v_mfma_f32_16x16x32_bf16 v[80:83], a[96:99], v[208:211], v[80:83]
 ds_read_b64_tr_b16 a[92:93], v10 offset:61440
 v_mfma_f32_16x16x32_bf16 v[84:87], a[96:99], v[212:215], v[84:87]
 s_waitcnt lgkmcnt(9)
 ds_read_b64_tr_b16 a[94:95], v10 offset:61952
 s_add_u32 s78, s74, 384
 v_mfma_f32_16x16x32_bf16 v[88:91], a[72:75], v[208:211], v[88:91]
 s_add_u32 m0, s69, 73728
 ds_read_b64_tr_b16 a[96:97], v11 offset:61440
 buffer_load_dwordx4 v21, s[20:23], s78 offen  lds
 v_mfma_f32_16x16x32_bf16 v[92:95], a[72:75], v[212:215], v[92:95]
 s_waitcnt lgkmcnt(9)
 ds_read_b64_tr_b16 a[98:99], v11 offset:61952
 v_mfma_f32_16x16x32_bf16 v[96:99], a[76:79], v[208:211], v[96:99]
 ds_read_b64_tr_b16 a[72:73], v12 offset:0
 v_mfma_f32_16x16x32_bf16 v[100:103], a[76:79], v[212:215], v[100:103]
 s_waitcnt lgkmcnt(9)
 ds_read_b64_tr_b16 a[74:75], v12 offset:512
 v_mfma_f32_16x16x32_bf16 v[104:107], a[80:83], v[208:211], v[104:107]
 ds_read_b64_tr_b16 a[76:77], v13 offset:0
 v_mfma_f32_16x16x32_bf16 v[108:111], a[80:83], v[212:215], v[108:111]
 s_waitcnt lgkmcnt(9)
 ds_read_b64_tr_b16 a[78:79], v13 offset:512
 v_mfma_f32_16x16x32_bf16 v[80:83], a[84:87], v[216:219], v[80:83]
 ds_read_b64_tr_b16 a[80:81], v14 offset:0
 v_mfma_f32_16x16x32_bf16 v[84:87], a[84:87], v[220:223], v[84:87]
 s_waitcnt lgkmcnt(9)
 ds_read_b64_tr_b16 a[82:83], v14 offset:512
 v_mfma_f32_16x16x32_bf16 v[88:91], a[88:91], v[216:219], v[88:91]
 ds_read_b64_tr_b16 a[84:85], v15 offset:0
 v_mfma_f32_16x16x32_bf16 v[92:95], a[88:91], v[220:223], v[92:95]
 s_waitcnt lgkmcnt(9)
 ds_read_b64_tr_b16 a[86:87], v15 offset:512
 v_mfma_f32_16x16x32_bf16 v[96:99], a[92:95], v[216:219], v[96:99]
 ds_read_b64_tr_b16 a[88:89], v12 offset:4096
 v_mfma_f32_16x16x32_bf16 v[100:103], a[92:95], v[220:223], v[100:103]
 s_waitcnt lgkmcnt(9)
 ds_read_b64_tr_b16 a[90:91], v12 offset:4608
 s_add_u32 s78, s74, 295296
 v_mfma_f32_16x16x32_bf16 v[104:107], a[96:99], v[216:219], v[104:107]
 s_add_u32 m0, s69, 77824
 ds_read_b64_tr_b16 a[92:93], v12 offset:8192
 buffer_load_dwordx4 v21, s[20:23], s78 offen  lds
 v_mfma_f32_16x16x32_bf16 v[108:111], a[96:99], v[220:223], v[108:111]
 s_waitcnt lgkmcnt(9)
 ds_read_b64_tr_b16 a[94:95], v12 offset:8704
 v_mfma_f32_16x16x32_bf16 v[80:83], a[72:75], v[224:227], v[80:83]
 ds_read_b64_tr_b16 a[96:97], v12 offset:12288
 v_mfma_f32_16x16x32_bf16 v[84:87], a[72:75], v[228:231], v[84:87]
 s_waitcnt lgkmcnt(9)
 ds_read_b64_tr_b16 a[98:99], v12 offset:12800
 v_mfma_f32_16x16x32_bf16 v[88:91], a[76:79], v[224:227], v[88:91]
 ds_read_b64_tr_b16 a[72:73], v13 offset:4096
 v_mfma_f32_16x16x32_bf16 v[92:95], a[76:79], v[228:231], v[92:95]
 s_waitcnt lgkmcnt(9)
 ds_read_b64_tr_b16 a[74:75], v13 offset:4608
 v_mfma_f32_16x16x32_bf16 v[96:99], a[80:83], v[224:227], v[96:99]
 ds_read_b64_tr_b16 a[76:77], v13 offset:8192
 v_mfma_f32_16x16x32_bf16 v[100:103], a[80:83], v[228:231], v[100:103]
 s_waitcnt lgkmcnt(9)
 ds_read_b64_tr_b16 a[78:79], v13 offset:8704
 v_mfma_f32_16x16x32_bf16 v[104:107], a[84:87], v[224:227], v[104:107]
 ds_read_b64_tr_b16 a[80:81], v13 offset:12288
 v_mfma_f32_16x16x32_bf16 v[108:111], a[84:87], v[228:231], v[108:111]
 s_waitcnt lgkmcnt(9)
 ds_read_b64_tr_b16 a[82:83], v13 offset:12800
 v_mfma_f32_16x16x32_bf16 v[80:83], a[88:91], v[232:235], v[80:83]
 ds_read_b64_tr_b16 a[84:85], v14 offset:4096
 v_mfma_f32_16x16x32_bf16 v[84:87], a[88:91], v[236:239], v[84:87]
 s_waitcnt lgkmcnt(9)
 ds_read_b64_tr_b16 a[86:87], v14 offset:4608
 s_add_u32 s78, s74, 590208
 v_mfma_f32_16x16x32_bf16 v[80:83], a[92:95], v[240:243], v[80:83]
 s_add_u32 m0, s69, 81920
 ds_read_b64_tr_b16 a[88:89], v14 offset:8192
 buffer_load_dwordx4 v21, s[20:23], s78 offen  lds
 v_mfma_f32_16x16x32_bf16 v[84:87], a[92:95], v[244:247], v[84:87]
 s_waitcnt lgkmcnt(9)
 ds_read_b64_tr_b16 a[90:91], v14 offset:8704
 v_mfma_f32_16x16x32_bf16 v[80:83], a[96:99], v[248:251], v[80:83]
 ds_read_b64_tr_b16 a[92:93], v14 offset:12288
 v_mfma_f32_16x16x32_bf16 v[84:87], a[96:99], v[252:255], v[84:87]
 s_waitcnt lgkmcnt(9)
 ds_read_b64_tr_b16 a[94:95], v14 offset:12800
 v_mfma_f32_16x16x32_bf16 v[88:91], a[72:75], v[232:235], v[88:91]
 ds_read_b64_tr_b16 a[96:97], v15 offset:4096
 v_mfma_f32_16x16x32_bf16 v[92:95], a[72:75], v[236:239], v[92:95]
 s_waitcnt lgkmcnt(9)
 ds_read_b64_tr_b16 a[98:99], v15 offset:4608
 v_mfma_f32_16x16x32_bf16 v[88:91], a[76:79], v[240:243], v[88:91]
 ds_read_b64_tr_b16 a[72:73], v15 offset:8192
 v_mfma_f32_16x16x32_bf16 v[92:95], a[76:79], v[244:247], v[92:95]
 s_waitcnt lgkmcnt(9)
 ds_read_b64_tr_b16 a[74:75], v15 offset:8704
 v_mul_f32 v80, v48, v80
 v_mfma_f32_16x16x32_bf16 v[88:91], a[80:83], v[248:251], v[88:91]
 ds_read_b64_tr_b16 a[76:77], v15 offset:12288
 v_mul_f32 v81, v49, v81
 v_mfma_f32_16x16x32_bf16 v[92:95], a[80:83], v[252:255], v[92:95]
 s_waitcnt lgkmcnt(9)
 ds_read_b64_tr_b16 a[78:79], v15 offset:12800
 v_mul_f32 v82, v50, v82
 v_mfma_f32_16x16x32_bf16 v[96:99], a[84:87], v[232:235], v[96:99]
 s_waitcnt vmcnt(18)
 s_barrier
 ds_read_b64_tr_b16 a[80:81], v4 offset:0
 v_mul_f32 v83, v51, v83
 v_mfma_f32_16x16x32_bf16 v[100:103], a[84:87], v[236:239], v[100:103]
 s_waitcnt lgkmcnt(9)
 ds_read_b64_tr_b16 a[82:83], v4 offset:512
 s_add_u32 s78, s74, 885120
 v_mfma_f32_16x16x32_bf16 v[96:99], a[88:91], v[240:243], v[96:99]
 s_add_u32 m0, s69, 86016
 ds_read_b64_tr_b16 a[84:85], v4 offset:4096
 buffer_load_dwordx4 v21, s[20:23], s78 offen  lds
 v_mfma_f32_16x16x32_bf16 v[100:103], a[88:91], v[244:247], v[100:103]
 s_waitcnt lgkmcnt(9)
 ds_read_b64_tr_b16 a[86:87], v4 offset:4608
 v_mul_f32 v84, v52, v84
 v_mfma_f32_16x16x32_bf16 v[96:99], a[92:95], v[248:251], v[96:99]
 ds_read_b64_tr_b16 a[88:89], v4 offset:8192
 v_mul_f32 v85, v53, v85
 v_mfma_f32_16x16x32_bf16 v[100:103], a[92:95], v[252:255], v[100:103]
 s_waitcnt lgkmcnt(9)
 ds_read_b64_tr_b16 a[90:91], v4 offset:8704
 v_mul_f32 v86, v54, v86
 v_mfma_f32_16x16x32_bf16 v[104:107], a[96:99], v[232:235], v[104:107]
 ds_read_b64_tr_b16 a[92:93], v5 offset:0
 v_mul_f32 v87, v55, v87
 v_mfma_f32_16x16x32_bf16 v[108:111], a[96:99], v[236:239], v[108:111]
 s_waitcnt lgkmcnt(9)
 ds_read_b64_tr_b16 a[94:95], v5 offset:512
 v_mul_f32 v88, v56, v88
 v_mul_f32 v89, v57, v89
 v_mfma_f32_16x16x32_bf16 v[104:107], a[72:75], v[240:243], v[104:107]
 ds_read_b64_tr_b16 a[96:97], v5 offset:4096
 v_mul_f32 v90, v58, v90
 v_mul_f32 v91, v59, v91
 v_mfma_f32_16x16x32_bf16 v[108:111], a[72:75], v[244:247], v[108:111]
 s_waitcnt lgkmcnt(9)
 ds_read_b64_tr_b16 a[98:99], v5 offset:4608
 v_mul_f32 v92, v60, v92
 v_mul_f32 v93, v61, v93
 v_mfma_f32_16x16x32_bf16 v[104:107], a[76:79], v[248:251], v[104:107]
 ds_read_b64_tr_b16 a[72:73], v5 offset:8192
 v_mul_f32 v94, v62, v94
 v_mul_f32 v95, v63, v95
 v_mfma_f32_16x16x32_bf16 v[108:111], a[76:79], v[252:255], v[108:111]
 s_waitcnt lgkmcnt(9)
 ds_read_b64_tr_b16 a[74:75], v5 offset:8704
 v_mul_f32 v96, v64, v96
 v_mfma_f32_16x16x32_bf16 v[48:51], a[80:83], v[112:115], 0
 ds_read_b64_tr_b16 a[76:77], v6 offset:0
 v_mul_f32 v97, v65, v97
 v_mfma_f32_16x16x32_bf16 v[52:55], a[80:83], v[116:119], 0
 s_waitcnt lgkmcnt(9)
 ds_read_b64_tr_b16 a[78:79], v6 offset:512
 s_add_u32 s78, s74, 1180032
 v_mfma_f32_16x16x32_bf16 v[48:51], a[84:87], v[120:123], v[48:51]
 s_add_u32 m0, s69, 90112
 ds_read_b64_tr_b16 a[80:81], v6 offset:4096
 buffer_load_dwordx4 v21, s[20:23], s78 offen  lds
 v_mfma_f32_16x16x32_bf16 v[52:55], a[84:87], v[124:127], v[52:55]
 s_waitcnt lgkmcnt(9)
 ds_read_b64_tr_b16 a[82:83], v6 offset:4608
 v_mul_f32 v98, v66, v98
 v_mfma_f32_16x16x32_bf16 v[48:51], a[88:91], v[128:131], v[48:51]
 ds_read_b64_tr_b16 a[84:85], v6 offset:8192
 v_mul_f32 v99, v67, v99
 v_mfma_f32_16x16x32_bf16 v[52:55], a[88:91], v[132:135], v[52:55]
 s_waitcnt lgkmcnt(9)
 ds_read_b64_tr_b16 a[86:87], v6 offset:8704
 v_mul_f32 v100, v68, v100
 v_mul_f32 v101, v69, v101
 v_mfma_f32_16x16x32_bf16 v[56:59], a[92:95], v[112:115], 0
 ds_read_b64_tr_b16 a[88:89], v7 offset:0
 v_mul_f32 v102, v70, v102
 v_mul_f32 v103, v71, v103
 v_mfma_f32_16x16x32_bf16 v[60:63], a[92:95], v[116:119], 0
 s_waitcnt lgkmcnt(9)
 ds_read_b64_tr_b16 a[90:91], v7 offset:512
 v_mul_f32 v104, v72, v104
 v_mul_f32 v105, v73, v105
 v_mfma_f32_16x16x32_bf16 v[56:59], a[96:99], v[120:123], v[56:59]
 ds_read_b64_tr_b16 a[92:93], v7 offset:4096
 v_mul_f32 v106, v74, v106
 v_mul_f32 v107, v75, v107
 v_mfma_f32_16x16x32_bf16 v[60:63], a[96:99], v[124:127], v[60:63]
 s_waitcnt lgkmcnt(9)
 ds_read_b64_tr_b16 a[94:95], v7 offset:4608
 v_mul_f32 v108, v76, v108
 v_mul_f32 v109, v77, v109
 v_mfma_f32_16x16x32_bf16 v[56:59], a[72:75], v[128:131], v[56:59]
 ds_read_b64_tr_b16 a[96:97], v7 offset:8192
 v_mul_f32 v110, v78, v110
 v_mul_f32 v111, v79, v111
 v_mfma_f32_16x16x32_bf16 v[60:63], a[72:75], v[132:135], v[60:63]
 s_waitcnt lgkmcnt(9)
 ds_read_b64_tr_b16 a[98:99], v7 offset:8704
 v_cvt_pk_bf16_f32 v32, v80, v81
 v_mfma_f32_16x16x32_bf16 v[64:67], a[76:79], v[112:115], 0
 ds_read_b64_tr_b16 a[72:73], v4 offset:12288
 v_accvgpr_write_b32 a32, v32
 v_mfma_f32_16x16x32_bf16 v[68:71], a[76:79], v[116:119], 0
 s_waitcnt lgkmcnt(9)
 ds_read_b64_tr_b16 a[74:75], v4 offset:12800
 s_add_u32 s78, s74, 1474944
 v_mfma_f32_16x16x32_bf16 v[64:67], a[80:83], v[120:123], v[64:67]
 s_add_u32 m0, s69, 94208
 ds_read_b64_tr_b16 a[76:77], v5 offset:12288
 buffer_load_dwordx4 v21, s[20:23], s78 offen  lds
 v_mfma_f32_16x16x32_bf16 v[68:71], a[80:83], v[124:127], v[68:71]
 s_waitcnt lgkmcnt(9)
 ds_read_b64_tr_b16 a[78:79], v5 offset:12800
 v_cvt_pk_bf16_f32 v33, v82, v83
 v_mfma_f32_16x16x32_bf16 v[64:67], a[84:87], v[128:131], v[64:67]
 ds_read_b64_tr_b16 a[80:81], v6 offset:12288
 v_accvgpr_write_b32 a33, v33
 v_mfma_f32_16x16x32_bf16 v[68:71], a[84:87], v[132:135], v[68:71]
 s_waitcnt lgkmcnt(9)
 ds_read_b64_tr_b16 a[82:83], v6 offset:12800
 v_cvt_pk_bf16_f32 v32, v84, v85
 v_mfma_f32_16x16x32_bf16 v[72:75], a[88:91], v[112:115], 0
 ds_read_b64_tr_b16 a[84:85], v7 offset:12288
 v_accvgpr_write_b32 a36, v32
 v_mfma_f32_16x16x32_bf16 v[76:79], a[88:91], v[116:119], 0
 s_waitcnt lgkmcnt(9)
 ds_read_b64_tr_b16 a[86:87], v7 offset:12800
 s_add_u32 s78, s74, 1769856
 v_mfma_f32_16x16x32_bf16 v[72:75], a[92:95], v[120:123], v[72:75]
 s_add_u32 m0, s69, 98304
 ds_read_b64_tr_b16 a[88:89], v4 offset:16384
 buffer_load_dwordx4 v21, s[20:23], s78 offen  lds
 v_mfma_f32_16x16x32_bf16 v[76:79], a[92:95], v[124:127], v[76:79]
 s_waitcnt lgkmcnt(9)
 ds_read_b64_tr_b16 a[90:91], v4 offset:16896
 v_cvt_pk_bf16_f32 v33, v86, v87
 v_mfma_f32_16x16x32_bf16 v[72:75], a[96:99], v[128:131], v[72:75]
 ds_read_b64_tr_b16 a[92:93], v5 offset:16384
 v_accvgpr_write_b32 a37, v33
 v_mfma_f32_16x16x32_bf16 v[76:79], a[96:99], v[132:135], v[76:79]
 s_waitcnt lgkmcnt(9)
 ds_read_b64_tr_b16 a[94:95], v5 offset:16896
 v_cvt_pk_bf16_f32 v32, v88, v89
 v_mfma_f32_16x16x32_bf16 v[48:51], a[72:75], v[136:139], v[48:51]
 ds_read_b64_tr_b16 a[96:97], v6 offset:16384
 v_accvgpr_write_b32 a34, v32
 v_mfma_f32_16x16x32_bf16 v[52:55], a[72:75], v[140:143], v[52:55]
 s_waitcnt lgkmcnt(9)
 ds_read_b64_tr_b16 a[98:99], v6 offset:16896
 s_add_u32 s78, s74, 2064768
 v_mfma_f32_16x16x32_bf16 v[56:59], a[76:79], v[136:139], v[56:59]
 s_add_u32 m0, s69, 102400
 ds_read_b64_tr_b16 a[72:73], v7 offset:16384
 buffer_load_dwordx4 v21, s[20:23], s78 offen  lds
 v_mfma_f32_16x16x32_bf16 v[60:63], a[76:79], v[140:143], v[60:63]
 s_waitcnt lgkmcnt(9)
 ds_read_b64_tr_b16 a[74:75], v7 offset:16896
 v_cvt_pk_bf16_f32 v33, v90, v91
 v_mfma_f32_16x16x32_bf16 v[64:67], a[80:83], v[136:139], v[64:67]
 ds_read_b64_tr_b16 a[76:77], v4 offset:20480
 v_accvgpr_write_b32 a35, v33
 v_mfma_f32_16x16x32_bf16 v[68:71], a[80:83], v[140:143], v[68:71]
 s_waitcnt lgkmcnt(9)
 ds_read_b64_tr_b16 a[78:79], v4 offset:20992
 v_cvt_pk_bf16_f32 v32, v92, v93
 v_mfma_f32_16x16x32_bf16 v[72:75], a[84:87], v[136:139], v[72:75]
 ds_read_b64_tr_b16 a[80:81], v5 offset:20480
 v_accvgpr_write_b32 a38, v32
 v_mfma_f32_16x16x32_bf16 v[76:79], a[84:87], v[140:143], v[76:79]
 s_waitcnt lgkmcnt(9)
 ds_read_b64_tr_b16 a[82:83], v5 offset:20992
 s_add_u32 s78, s74, 2359680
 v_mfma_f32_16x16x32_bf16 v[48:51], a[88:91], v[144:147], v[48:51]
 s_add_u32 m0, s69, 106496
 ds_read_b64_tr_b16 a[84:85], v6 offset:20480
 buffer_load_dwordx4 v21, s[20:23], s78 offen  lds
 v_mfma_f32_16x16x32_bf16 v[52:55], a[88:91], v[148:151], v[52:55]
 s_waitcnt lgkmcnt(9)
 ds_read_b64_tr_b16 a[86:87], v6 offset:20992
 v_cvt_pk_bf16_f32 v33, v94, v95
 v_mfma_f32_16x16x32_bf16 v[56:59], a[92:95], v[144:147], v[56:59]
 ds_read_b64_tr_b16 a[88:89], v7 offset:20480
 v_accvgpr_write_b32 a39, v33
 v_mfma_f32_16x16x32_bf16 v[60:63], a[92:95], v[148:151], v[60:63]
 s_waitcnt lgkmcnt(9)
 ds_read_b64_tr_b16 a[90:91], v7 offset:20992
 v_cvt_pk_bf16_f32 v32, v96, v97
 v_mfma_f32_16x16x32_bf16 v[64:67], a[96:99], v[144:147], v[64:67]
 s_waitcnt vmcnt(18)
 s_barrier
 ds_read_b64_tr_b16 a[92:93], v4 offset:24576
 v_accvgpr_write_b32 a40, v32
 v_mfma_f32_16x16x32_bf16 v[68:71], a[96:99], v[148:151], v[68:71]
 s_waitcnt lgkmcnt(9)
 ds_read_b64_tr_b16 a[94:95], v4 offset:25088
 s_add_u32 s78, s74, 2654592
 v_mfma_f32_16x16x32_bf16 v[72:75], a[72:75], v[144:147], v[72:75]
 s_add_u32 m0, s69, 110592
 ds_read_b64_tr_b16 a[96:97], v5 offset:24576
 buffer_load_dwordx4 v21, s[20:23], s78 offen  lds
 v_mfma_f32_16x16x32_bf16 v[76:79], a[72:75], v[148:151], v[76:79]
 s_waitcnt lgkmcnt(9)
 ds_read_b64_tr_b16 a[98:99], v5 offset:25088
 v_cvt_pk_bf16_f32 v33, v98, v99
 v_mfma_f32_16x16x32_bf16 v[48:51], a[76:79], v[152:155], v[48:51]
 ds_read_b64_tr_b16 a[72:73], v6 offset:24576
 v_accvgpr_write_b32 a41, v33
 v_mfma_f32_16x16x32_bf16 v[52:55], a[76:79], v[156:159], v[52:55]
 s_waitcnt lgkmcnt(9)
 ds_read_b64_tr_b16 a[74:75], v6 offset:25088
 v_cvt_pk_bf16_f32 v32, v100, v101
 v_mfma_f32_16x16x32_bf16 v[56:59], a[80:83], v[152:155], v[56:59]
 ds_read_b64_tr_b16 a[76:77], v7 offset:24576
 v_accvgpr_write_b32 a44, v32
 v_mfma_f32_16x16x32_bf16 v[60:63], a[80:83], v[156:159], v[60:63]
 s_waitcnt lgkmcnt(9)
 ds_read_b64_tr_b16 a[78:79], v7 offset:25088
 s_add_u32 s78, s74, 2949504
 v_mfma_f32_16x16x32_bf16 v[64:67], a[84:87], v[152:155], v[64:67]
 s_add_u32 m0, s69, 114688
 ds_read_b64_tr_b16 a[80:81], v4 offset:28672
 buffer_load_dwordx4 v21, s[20:23], s78 offen  lds
 v_mfma_f32_16x16x32_bf16 v[68:71], a[84:87], v[156:159], v[68:71]
 s_waitcnt lgkmcnt(9)
 ds_read_b64_tr_b16 a[82:83], v4 offset:29184
 v_cvt_pk_bf16_f32 v33, v102, v103
 v_mfma_f32_16x16x32_bf16 v[72:75], a[88:91], v[152:155], v[72:75]
 ds_read_b64_tr_b16 a[84:85], v5 offset:28672
 v_accvgpr_write_b32 a45, v33
 v_mfma_f32_16x16x32_bf16 v[76:79], a[88:91], v[156:159], v[76:79]
 s_waitcnt lgkmcnt(9)
 ds_read_b64_tr_b16 a[86:87], v5 offset:29184
 v_cvt_pk_bf16_f32 v32, v104, v105
 v_mfma_f32_16x16x32_bf16 v[48:51], a[92:95], v[160:163], v[48:51]
 ds_read_b64_tr_b16 a[88:89], v6 offset:28672
 v_accvgpr_write_b32 a42, v32
 v_mfma_f32_16x16x32_bf16 v[52:55], a[92:95], v[164:167], v[52:55]
 s_waitcnt lgkmcnt(9)
 ds_read_b64_tr_b16 a[90:91], v6 offset:29184
 s_add_u32 s78, s74, 3244416
 v_mfma_f32_16x16x32_bf16 v[56:59], a[96:99], v[160:163], v[56:59]
 s_add_u32 m0, s69, 118784
 ds_read_b64_tr_b16 a[92:93], v7 offset:28672
 buffer_load_dwordx4 v21, s[20:23], s78 offen  lds
 v_mfma_f32_16x16x32_bf16 v[60:63], a[96:99], v[164:167], v[60:63]
 s_waitcnt lgkmcnt(9)
 ds_read_b64_tr_b16 a[94:95], v7 offset:29184
 v_cvt_pk_bf16_f32 v33, v106, v107
 v_mfma_f32_16x16x32_bf16 v[64:67], a[72:75], v[160:163], v[64:67]
 ds_read_b64_tr_b16 a[96:97], v4 offset:32768
 v_accvgpr_write_b32 a43, v33
 v_mfma_f32_16x16x32_bf16 v[68:71], a[72:75], v[164:167], v[68:71]
 s_waitcnt lgkmcnt(9)
 ds_read_b64_tr_b16 a[98:99], v4 offset:33280
 v_cvt_pk_bf16_f32 v32, v108, v109
 v_mfma_f32_16x16x32_bf16 v[72:75], a[76:79], v[160:163], v[72:75]
 ds_read_b64_tr_b16 a[72:73], v5 offset:32768
 v_accvgpr_write_b32 a46, v32
 v_mfma_f32_16x16x32_bf16 v[76:79], a[76:79], v[164:167], v[76:79]
 s_waitcnt lgkmcnt(9)
 ds_read_b64_tr_b16 a[74:75], v5 offset:33280
 s_add_u32 s78, s74, 3539328
 v_mfma_f32_16x16x32_bf16 v[48:51], a[80:83], v[168:171], v[48:51]
 s_add_u32 m0, s69, 122880
 ds_read_b64_tr_b16 a[76:77], v6 offset:32768
 buffer_load_dwordx4 v21, s[20:23], s78 offen  lds
 v_mfma_f32_16x16x32_bf16 v[52:55], a[80:83], v[172:175], v[52:55]
 s_waitcnt lgkmcnt(9)
 ds_read_b64_tr_b16 a[78:79], v6 offset:33280
 v_cvt_pk_bf16_f32 v33, v110, v111
 v_mfma_f32_16x16x32_bf16 v[56:59], a[84:87], v[168:171], v[56:59]
 ds_read_b64_tr_b16 a[80:81], v7 offset:32768
 v_accvgpr_write_b32 a47, v33
 v_mfma_f32_16x16x32_bf16 v[60:63], a[84:87], v[172:175], v[60:63]
 s_waitcnt lgkmcnt(9)
 ds_read_b64_tr_b16 a[82:83], v7 offset:33280
 v_mfma_f32_16x16x32_bf16 v[64:67], a[88:91], v[168:171], v[64:67]
 ds_read_b64_tr_b16 a[84:85], v4 offset:36864
 v_mfma_f32_16x16x32_bf16 v[68:71], a[88:91], v[172:175], v[68:71]
 s_waitcnt lgkmcnt(9)
 ds_read_b64_tr_b16 a[86:87], v4 offset:37376
 s_add_u32 s78, s74, 3834240
 v_mfma_f32_16x16x32_bf16 v[72:75], a[92:95], v[168:171], v[72:75]
 s_add_u32 m0, s69, 126976
 ds_read_b64_tr_b16 a[88:89], v5 offset:36864
 buffer_load_dwordx4 v21, s[20:23], s78 offen  lds
 v_mfma_f32_16x16x32_bf16 v[76:79], a[92:95], v[172:175], v[76:79]
 s_waitcnt lgkmcnt(9)
 ds_read_b64_tr_b16 a[90:91], v5 offset:37376
 v_mfma_f32_16x16x32_bf16 v[48:51], a[96:99], v[176:179], v[48:51]
 ds_read_b64_tr_b16 a[92:93], v6 offset:36864
 v_mfma_f32_16x16x32_bf16 v[52:55], a[96:99], v[180:183], v[52:55]
 s_waitcnt lgkmcnt(9)
 ds_read_b64_tr_b16 a[94:95], v6 offset:37376
 v_mfma_f32_16x16x32_bf16 v[56:59], a[72:75], v[176:179], v[56:59]
 ds_read_b64_tr_b16 a[96:97], v7 offset:36864
 v_mfma_f32_16x16x32_bf16 v[60:63], a[72:75], v[180:183], v[60:63]
 s_waitcnt lgkmcnt(9)
 ds_read_b64_tr_b16 a[98:99], v7 offset:37376
 s_add_u32 s78, s74, 4129152
 v_mfma_f32_16x16x32_bf16 v[64:67], a[76:79], v[176:179], v[64:67]
 s_add_u32 m0, s69, 131072
 ds_read_b64_tr_b16 a[72:73], v4 offset:40960
 buffer_load_dwordx4 v21, s[20:23], s78 offen  lds
 v_mfma_f32_16x16x32_bf16 v[68:71], a[76:79], v[180:183], v[68:71]
 s_waitcnt lgkmcnt(9)
 ds_read_b64_tr_b16 a[74:75], v4 offset:41472
 v_mfma_f32_16x16x32_bf16 v[72:75], a[80:83], v[176:179], v[72:75]
 ds_read_b64_tr_b16 a[76:77], v5 offset:40960
 v_mfma_f32_16x16x32_bf16 v[76:79], a[80:83], v[180:183], v[76:79]
 s_waitcnt lgkmcnt(9)
 ds_read_b64_tr_b16 a[78:79], v5 offset:41472
 v_mfma_f32_16x16x32_bf16 v[48:51], a[84:87], v[184:187], v[48:51]
 ds_read_b64_tr_b16 a[80:81], v6 offset:40960
 buffer_load_dword a169, v34, s[24:27], 0 offen offset:768
 v_mfma_f32_16x16x32_bf16 v[52:55], a[84:87], v[188:191], v[52:55]
 s_waitcnt lgkmcnt(9)
 ds_read_b64_tr_b16 a[82:83], v6 offset:41472
 s_add_u32 s78, s74, 4424064
 v_mfma_f32_16x16x32_bf16 v[56:59], a[88:91], v[184:187], v[56:59]
 s_add_u32 m0, s69, 135168
 ds_read_b64_tr_b16 a[84:85], v7 offset:40960
 buffer_load_dwordx4 v21, s[20:23], s78 offen  lds
 v_mfma_f32_16x16x32_bf16 v[60:63], a[88:91], v[188:191], v[60:63]
 s_waitcnt lgkmcnt(9)
 ds_read_b64_tr_b16 a[86:87], v7 offset:41472
 v_mfma_f32_16x16x32_bf16 v[64:67], a[92:95], v[184:187], v[64:67]
 ds_read_b64_tr_b16 a[88:89], v4 offset:45056
 v_mfma_f32_16x16x32_bf16 v[68:71], a[92:95], v[188:191], v[68:71]
 s_waitcnt lgkmcnt(9)
 ds_read_b64_tr_b16 a[90:91], v4 offset:45568
 v_mfma_f32_16x16x32_bf16 v[72:75], a[96:99], v[184:187], v[72:75]
 ds_read_b64_tr_b16 a[92:93], v5 offset:45056
 v_mfma_f32_16x16x32_bf16 v[76:79], a[96:99], v[188:191], v[76:79]
 s_waitcnt lgkmcnt(9)
 ds_read_b64_tr_b16 a[94:95], v5 offset:45568
 v_mfma_f32_16x16x32_bf16 v[48:51], a[72:75], v[192:195], v[48:51]
 ds_read_b64_tr_b16 a[96:97], v6 offset:45056
 v_mfma_f32_16x16x32_bf16 v[52:55], a[72:75], v[196:199], v[52:55]
 s_waitcnt lgkmcnt(9)
 ds_read_b64_tr_b16 a[98:99], v6 offset:45568
 v_mfma_f32_16x16x32_bf16 v[56:59], a[76:79], v[192:195], v[56:59]
 ds_read_b64_tr_b16 a[72:73], v7 offset:45056
 v_mfma_f32_16x16x32_bf16 v[60:63], a[76:79], v[196:199], v[60:63]
 s_waitcnt lgkmcnt(9)
 ds_read_b64_tr_b16 a[74:75], v7 offset:45568
 v_mfma_f32_16x16x32_bf16 v[64:67], a[80:83], v[192:195], v[64:67]
 s_waitcnt vmcnt(17)
 s_barrier
 ds_read_b64_tr_b16 a[76:77], v4 offset:49152
 v_mfma_f32_16x16x32_bf16 v[68:71], a[80:83], v[196:199], v[68:71]
 s_waitcnt lgkmcnt(9)
 ds_read_b64_tr_b16 a[78:79], v4 offset:49664
 s_add_u32 s78, s74, 4718976
 v_mfma_f32_16x16x32_bf16 v[72:75], a[84:87], v[192:195], v[72:75]
 s_add_u32 m0, s69, 139264
 ds_read_b64_tr_b16 a[80:81], v5 offset:49152
 buffer_load_dwordx4 v21, s[20:23], s78 offen  lds
 v_mfma_f32_16x16x32_bf16 v[76:79], a[84:87], v[196:199], v[76:79]
 s_waitcnt lgkmcnt(9)
 ds_read_b64_tr_b16 a[82:83], v5 offset:49664
 v_mfma_f32_16x16x32_bf16 v[48:51], a[88:91], v[200:203], v[48:51]
 ds_read_b64_tr_b16 a[84:85], v6 offset:49152
 v_mfma_f32_16x16x32_bf16 v[52:55], a[88:91], v[204:207], v[52:55]
 s_waitcnt lgkmcnt(9)
 ds_read_b64_tr_b16 a[86:87], v6 offset:49664
 v_mfma_f32_16x16x32_bf16 v[56:59], a[92:95], v[200:203], v[56:59]
 ds_read_b64_tr_b16 a[88:89], v7 offset:49152
 v_mfma_f32_16x16x32_bf16 v[60:63], a[92:95], v[204:207], v[60:63]
 s_waitcnt lgkmcnt(9)
 ds_read_b64_tr_b16 a[90:91], v7 offset:49664
 v_mfma_f32_16x16x32_bf16 v[64:67], a[96:99], v[200:203], v[64:67]
 ds_read_b64_tr_b16 a[92:93], v4 offset:53248
 v_mfma_f32_16x16x32_bf16 v[68:71], a[96:99], v[204:207], v[68:71]
 s_waitcnt lgkmcnt(9)
 ds_read_b64_tr_b16 a[94:95], v4 offset:53760
 v_mfma_f32_16x16x32_bf16 v[72:75], a[72:75], v[200:203], v[72:75]
 ds_read_b64_tr_b16 a[96:97], v5 offset:53248
 v_mfma_f32_16x16x32_bf16 v[76:79], a[72:75], v[204:207], v[76:79]
 s_waitcnt lgkmcnt(9)
 ds_read_b64_tr_b16 a[98:99], v5 offset:53760
 v_mfma_f32_16x16x32_bf16 v[48:51], a[76:79], v[208:211], v[48:51]
 ds_read_b64_tr_b16 a[72:73], v6 offset:53248
 v_mfma_f32_16x16x32_bf16 v[52:55], a[76:79], v[212:215], v[52:55]
 s_waitcnt lgkmcnt(9)
 ds_read_b64_tr_b16 a[74:75], v6 offset:53760
 s_add_u32 s78, s74, 5013888
 v_mfma_f32_16x16x32_bf16 v[56:59], a[80:83], v[208:211], v[56:59]
 s_add_u32 m0, s69, 143360
 ds_read_b64_tr_b16 a[76:77], v7 offset:53248
 buffer_load_dwordx4 v21, s[20:23], s78 offen  lds
 v_mfma_f32_16x16x32_bf16 v[60:63], a[80:83], v[212:215], v[60:63]
 s_waitcnt lgkmcnt(9)
 ds_read_b64_tr_b16 a[78:79], v7 offset:53760
 v_mfma_f32_16x16x32_bf16 v[64:67], a[84:87], v[208:211], v[64:67]
 ds_read_b64_tr_b16 a[80:81], v4 offset:57344
 v_mfma_f32_16x16x32_bf16 v[68:71], a[84:87], v[212:215], v[68:71]
 s_waitcnt lgkmcnt(9)
 ds_read_b64_tr_b16 a[82:83], v4 offset:57856
 v_mfma_f32_16x16x32_bf16 v[72:75], a[88:91], v[208:211], v[72:75]
 ds_read_b64_tr_b16 a[84:85], v5 offset:57344
 v_mfma_f32_16x16x32_bf16 v[76:79], a[88:91], v[212:215], v[76:79]
 s_waitcnt lgkmcnt(9)
 ds_read_b64_tr_b16 a[86:87], v5 offset:57856
 v_mfma_f32_16x16x32_bf16 v[48:51], a[92:95], v[216:219], v[48:51]
 ds_read_b64_tr_b16 a[88:89], v6 offset:57344
 v_mfma_f32_16x16x32_bf16 v[52:55], a[92:95], v[220:223], v[52:55]
 s_waitcnt lgkmcnt(9)
 ds_read_b64_tr_b16 a[90:91], v6 offset:57856
 v_mfma_f32_16x16x32_bf16 v[56:59], a[96:99], v[216:219], v[56:59]
 ds_read_b64_tr_b16 a[92:93], v7 offset:57344
 v_mfma_f32_16x16x32_bf16 v[60:63], a[96:99], v[220:223], v[60:63]
 s_waitcnt lgkmcnt(9)
 ds_read_b64_tr_b16 a[94:95], v7 offset:57856
 v_mfma_f32_16x16x32_bf16 v[64:67], a[72:75], v[216:219], v[64:67]
 ds_read_b64_tr_b16 a[96:97], v4 offset:61440
 v_mfma_f32_16x16x32_bf16 v[68:71], a[72:75], v[220:223], v[68:71]
 s_waitcnt lgkmcnt(9)
 ds_read_b64_tr_b16 a[98:99], v4 offset:61952
 s_add_u32 s78, s75, 0
 v_mfma_f32_16x16x32_bf16 v[72:75], a[76:79], v[216:219], v[72:75]
 s_add_u32 m0, s69, 0
 ds_read_b64_tr_b16 a[72:73], v5 offset:61440
 buffer_load_dwordx4 v22, s[40:43], s78 offen  lds
 v_mfma_f32_16x16x32_bf16 v[76:79], a[76:79], v[220:223], v[76:79]
 s_waitcnt lgkmcnt(9)
 ds_read_b64_tr_b16 a[74:75], v5 offset:61952
 v_mfma_f32_16x16x32_bf16 v[48:51], a[80:83], v[224:227], v[48:51]
 ds_read_b64_tr_b16 a[76:77], v6 offset:61440
 v_mfma_f32_16x16x32_bf16 v[52:55], a[80:83], v[228:231], v[52:55]
 s_waitcnt lgkmcnt(9)
 ds_read_b64_tr_b16 a[78:79], v6 offset:61952
 v_mfma_f32_16x16x32_bf16 v[56:59], a[84:87], v[224:227], v[56:59]
 ds_read_b64_tr_b16 a[80:81], v7 offset:61440
 v_mfma_f32_16x16x32_bf16 v[60:63], a[84:87], v[228:231], v[60:63]
 s_waitcnt lgkmcnt(9)
 ds_read_b64_tr_b16 a[82:83], v7 offset:61952
 v_mfma_f32_16x16x32_bf16 v[64:67], a[88:91], v[224:227], v[64:67]
 ds_read_b64_tr_b16 a[84:85], v8 offset:0
 v_mfma_f32_16x16x32_bf16 v[68:71], a[88:91], v[228:231], v[68:71]
 s_waitcnt lgkmcnt(9)
 ds_read_b64_tr_b16 a[86:87], v8 offset:512
 v_mfma_f32_16x16x32_bf16 v[72:75], a[92:95], v[224:227], v[72:75]
 ds_read_b64_tr_b16 a[88:89], v9 offset:0
 v_mfma_f32_16x16x32_bf16 v[76:79], a[92:95], v[228:231], v[76:79]
 s_waitcnt lgkmcnt(9)
 ds_read_b64_tr_b16 a[90:91], v9 offset:512
 v_mfma_f32_16x16x32_bf16 v[48:51], a[96:99], v[232:235], v[48:51]
 ds_read_b64_tr_b16 a[92:93], v10 offset:0
 v_mfma_f32_16x16x32_bf16 v[52:55], a[96:99], v[236:239], v[52:55]
 s_waitcnt lgkmcnt(9)
 ds_read_b64_tr_b16 a[94:95], v10 offset:512
 s_add_u32 s78, s75, 294912
 v_mfma_f32_16x16x32_bf16 v[56:59], a[72:75], v[232:235], v[56:59]
 s_add_u32 m0, s69, 4096
 ds_read_b64_tr_b16 a[96:97], v11 offset:0
 buffer_load_dwordx4 v22, s[40:43], s78 offen  lds
 v_mfma_f32_16x16x32_bf16 v[60:63], a[72:75], v[236:239], v[60:63]
 s_waitcnt lgkmcnt(9)
 ds_read_b64_tr_b16 a[98:99], v11 offset:512
 v_mfma_f32_16x16x32_bf16 v[64:67], a[76:79], v[232:235], v[64:67]
 ds_read_b64_tr_b16 a[72:73], v8 offset:4096
 v_mfma_f32_16x16x32_bf16 v[68:71], a[76:79], v[236:239], v[68:71]
 s_waitcnt lgkmcnt(9)
 ds_read_b64_tr_b16 a[74:75], v8 offset:4608
 v_mfma_f32_16x16x32_bf16 v[72:75], a[80:83], v[232:235], v[72:75]
 ds_read_b64_tr_b16 a[76:77], v9 offset:4096
 v_mfma_f32_16x16x32_bf16 v[76:79], a[80:83], v[236:239], v[76:79]
 s_waitcnt lgkmcnt(9)
 ds_read_b64_tr_b16 a[78:79], v9 offset:4608
 v_mfma_f32_16x16x32_bf16 v[48:51], a[84:87], v[240:243], v[48:51]
 ds_read_b64_tr_b16 a[80:81], v10 offset:4096
 v_mfma_f32_16x16x32_bf16 v[52:55], a[84:87], v[244:247], v[52:55]
 s_waitcnt lgkmcnt(9)
 ds_read_b64_tr_b16 a[82:83], v10 offset:4608
 v_mfma_f32_16x16x32_bf16 v[56:59], a[88:91], v[240:243], v[56:59]
 ds_read_b64_tr_b16 a[84:85], v11 offset:4096
 v_mfma_f32_16x16x32_bf16 v[60:63], a[88:91], v[244:247], v[60:63]
 s_waitcnt lgkmcnt(9)
 ds_read_b64_tr_b16 a[86:87], v11 offset:4608
 v_mfma_f32_16x16x32_bf16 v[64:67], a[92:95], v[240:243], v[64:67]
 s_waitcnt vmcnt(15)
 s_barrier
 ds_read_b64_tr_b16 a[88:89], v8 offset:8192
 v_mfma_f32_16x16x32_bf16 v[68:71], a[92:95], v[244:247], v[68:71]
 s_waitcnt lgkmcnt(9)
 ds_read_b64_tr_b16 a[90:91], v8 offset:8704
 s_add_u32 s78, s75, 589824
 v_mfma_f32_16x16x32_bf16 v[72:75], a[96:99], v[240:243], v[72:75]
 s_add_u32 m0, s69, 8192
 ds_read_b64_tr_b16 a[92:93], v9 offset:8192
 buffer_load_dwordx4 v22, s[40:43], s78 offen  lds
 v_mfma_f32_16x16x32_bf16 v[76:79], a[96:99], v[244:247], v[76:79]
 s_waitcnt lgkmcnt(9)
 ds_read_b64_tr_b16 a[94:95], v9 offset:8704
 v_mfma_f32_16x16x32_bf16 v[48:51], a[72:75], v[248:251], v[48:51]
 ds_read_b64_tr_b16 a[96:97], v10 offset:8192
 v_mfma_f32_16x16x32_bf16 v[52:55], a[72:75], v[252:255], v[52:55]
 s_waitcnt lgkmcnt(9)
 ds_read_b64_tr_b16 a[98:99], v10 offset:8704
 v_mfma_f32_16x16x32_bf16 v[56:59], a[76:79], v[248:251], v[56:59]
 ds_read_b64_tr_b16 a[72:73], v11 offset:8192
 v_mfma_f32_16x16x32_bf16 v[60:63], a[76:79], v[252:255], v[60:63]
 s_waitcnt lgkmcnt(9)
 ds_read_b64_tr_b16 a[74:75], v11 offset:8704
 v_mfma_f32_16x16x32_bf16 v[64:67], a[80:83], v[248:251], v[64:67]
 ds_read_b64_tr_b16 a[76:77], v8 offset:12288
 v_mfma_f32_16x16x32_bf16 v[68:71], a[80:83], v[252:255], v[68:71]
 s_waitcnt lgkmcnt(9)
 ds_read_b64_tr_b16 a[78:79], v8 offset:12800
 v_mfma_f32_16x16x32_bf16 v[72:75], a[84:87], v[248:251], v[72:75]
 ds_read_b64_tr_b16 a[80:81], v9 offset:12288
 v_mfma_f32_16x16x32_bf16 v[76:79], a[84:87], v[252:255], v[76:79]
 s_waitcnt lgkmcnt(9)
 ds_read_b64_tr_b16 a[82:83], v9 offset:12800
 v_mfma_f32_16x16x32_bf16 v[80:83], a[88:91], v[112:115], 0
 ds_read_b64_tr_b16 a[84:85], v10 offset:12288
 v_mfma_f32_16x16x32_bf16 v[84:87], a[88:91], v[116:119], 0
 s_waitcnt lgkmcnt(9)
 ds_read_b64_tr_b16 a[86:87], v10 offset:12800
 s_add_u32 s78, s75, 884736
 v_mfma_f32_16x16x32_bf16 v[88:91], a[92:95], v[112:115], 0
 s_add_u32 m0, s69, 12288
 ds_read_b64_tr_b16 a[88:89], v11 offset:12288
 buffer_load_dwordx4 v22, s[40:43], s78 offen  lds
 v_mfma_f32_16x16x32_bf16 v[92:95], a[92:95], v[116:119], 0
 s_waitcnt lgkmcnt(9)
 ds_read_b64_tr_b16 a[90:91], v11 offset:12800
 v_mfma_f32_16x16x32_bf16 v[96:99], a[96:99], v[112:115], 0
 ds_read_b64_tr_b16 a[92:93], v8 offset:16384
 v_mfma_f32_16x16x32_bf16 v[100:103], a[96:99], v[116:119], 0
 s_waitcnt lgkmcnt(9)
 ds_read_b64_tr_b16 a[94:95], v8 offset:16896
 v_mfma_f32_16x16x32_bf16 v[104:107], a[72:75], v[112:115], 0
 ds_read_b64_tr_b16 a[96:97], v9 offset:16384
 v_mfma_f32_16x16x32_bf16 v[108:111], a[72:75], v[116:119], 0
 s_waitcnt lgkmcnt(9)
 ds_read_b64_tr_b16 a[98:99], v9 offset:16896
 v_mfma_f32_16x16x32_bf16 v[80:83], a[76:79], v[120:123], v[80:83]
 ds_read_b64_tr_b16 a[72:73], v10 offset:16384
 v_mul_f32 v48, v30, v48
 v_mfma_f32_16x16x32_bf16 v[84:87], a[76:79], v[124:127], v[84:87]
 s_waitcnt lgkmcnt(9)
 ds_read_b64_tr_b16 a[74:75], v10 offset:16896
 v_mul_f32 v49, v30, v49
 v_mfma_f32_16x16x32_bf16 v[88:91], a[80:83], v[120:123], v[88:91]
 ds_read_b64_tr_b16 a[76:77], v11 offset:16384
 v_mul_f32 v50, v30, v50
 v_mfma_f32_16x16x32_bf16 v[92:95], a[80:83], v[124:127], v[92:95]
 s_waitcnt lgkmcnt(9)
 ds_read_b64_tr_b16 a[78:79], v11 offset:16896
 v_mul_f32 v51, v30, v51
 v_mfma_f32_16x16x32_bf16 v[96:99], a[84:87], v[120:123], v[96:99]
 ds_read_b64_tr_b16 a[80:81], v8 offset:20480
 v_mul_f32 v52, v31, v52
 v_mfma_f32_16x16x32_bf16 v[100:103], a[84:87], v[124:127], v[100:103]
 s_waitcnt lgkmcnt(9)
 ds_read_b64_tr_b16 a[82:83], v8 offset:20992
 s_add_u32 s78, s75, 1179648
 v_mfma_f32_16x16x32_bf16 v[104:107], a[88:91], v[120:123], v[104:107]
 s_add_u32 m0, s69, 16384
 ds_read_b64_tr_b16 a[84:85], v9 offset:20480
 buffer_load_dwordx4 v22, s[40:43], s78 offen  lds
 v_mfma_f32_16x16x32_bf16 v[108:111], a[88:91], v[124:127], v[108:111]
 s_waitcnt lgkmcnt(9)
 ds_read_b64_tr_b16 a[86:87], v9 offset:20992
 v_mul_f32 v53, v31, v53
 v_mfma_f32_16x16x32_bf16 v[80:83], a[92:95], v[128:131], v[80:83]
 ds_read_b64_tr_b16 a[88:89], v10 offset:20480
 v_mul_f32 v54, v31, v54
 v_mfma_f32_16x16x32_bf16 v[84:87], a[92:95], v[132:135], v[84:87]
 s_waitcnt lgkmcnt(9)
 ds_read_b64_tr_b16 a[90:91], v10 offset:20992
 v_mul_f32 v55, v31, v55
 v_mfma_f32_16x16x32_bf16 v[88:91], a[96:99], v[128:131], v[88:91]
 ds_read_b64_tr_b16 a[92:93], v11 offset:20480
 v_mul_f32 v56, v30, v56
 v_mfma_f32_16x16x32_bf16 v[92:95], a[96:99], v[132:135], v[92:95]
 s_waitcnt lgkmcnt(9)
 ds_read_b64_tr_b16 a[94:95], v11 offset:20992
 s_add_u32 s78, s75, 1474560
 v_mfma_f32_16x16x32_bf16 v[96:99], a[72:75], v[128:131], v[96:99]
 s_add_u32 m0, s69, 20480
 ds_read_b64_tr_b16 a[96:97], v8 offset:24576
 buffer_load_dwordx4 v22, s[40:43], s78 offen  lds
 v_mfma_f32_16x16x32_bf16 v[100:103], a[72:75], v[132:135], v[100:103]
 s_waitcnt lgkmcnt(9)
 ds_read_b64_tr_b16 a[98:99], v8 offset:25088
 v_mul_f32 v57, v30, v57
 v_mfma_f32_16x16x32_bf16 v[104:107], a[76:79], v[128:131], v[104:107]
 ds_read_b64_tr_b16 a[72:73], v9 offset:24576
 v_mul_f32 v58, v30, v58
 v_mfma_f32_16x16x32_bf16 v[108:111], a[76:79], v[132:135], v[108:111]
 s_waitcnt lgkmcnt(9)
 ds_read_b64_tr_b16 a[74:75], v9 offset:25088
 v_mul_f32 v59, v30, v59
 v_mfma_f32_16x16x32_bf16 v[80:83], a[80:83], v[136:139], v[80:83]
 ds_read_b64_tr_b16 a[76:77], v10 offset:24576
 v_mul_f32 v60, v31, v60
 v_mfma_f32_16x16x32_bf16 v[84:87], a[80:83], v[140:143], v[84:87]
 s_waitcnt lgkmcnt(9)
 ds_read_b64_tr_b16 a[78:79], v10 offset:25088
 s_add_u32 s78, s75, 1769472
 v_mfma_f32_16x16x32_bf16 v[88:91], a[84:87], v[136:139], v[88:91]
 s_add_u32 m0, s69, 24576
 ds_read_b64_tr_b16 a[80:81], v11 offset:24576
 buffer_load_dwordx4 v22, s[40:43], s78 offen  lds
 v_mfma_f32_16x16x32_bf16 v[92:95], a[84:87], v[140:143], v[92:95]
 s_waitcnt lgkmcnt(9)
 ds_read_b64_tr_b16 a[82:83], v11 offset:25088
 v_mul_f32 v61, v31, v61
 v_mfma_f32_16x16x32_bf16 v[96:99], a[88:91], v[136:139], v[96:99]
 ds_read_b64_tr_b16 a[84:85], v8 offset:28672
 v_mul_f32 v62, v31, v62
 v_mfma_f32_16x16x32_bf16 v[100:103], a[88:91], v[140:143], v[100:103]
 s_waitcnt lgkmcnt(9)
 ds_read_b64_tr_b16 a[86:87], v8 offset:29184
 v_mul_f32 v63, v31, v63
 v_mfma_f32_16x16x32_bf16 v[104:107], a[92:95], v[136:139], v[104:107]
 ds_read_b64_tr_b16 a[88:89], v9 offset:28672
 v_mul_f32 v64, v30, v64
 v_mfma_f32_16x16x32_bf16 v[108:111], a[92:95], v[140:143], v[108:111]
 s_waitcnt lgkmcnt(9)
 ds_read_b64_tr_b16 a[90:91], v9 offset:29184
 s_add_u32 s78, s75, 2064384
 v_mfma_f32_16x16x32_bf16 v[80:83], a[96:99], v[144:147], v[80:83]
 s_add_u32 m0, s69, 28672
 ds_read_b64_tr_b16 a[92:93], v10 offset:28672
 buffer_load_dwordx4 v22, s[40:43], s78 offen  lds
 v_mfma_f32_16x16x32_bf16 v[84:87], a[96:99], v[148:151], v[84:87]
 s_waitcnt lgkmcnt(9)
 ds_read_b64_tr_b16 a[94:95], v10 offset:29184
 v_mul_f32 v65, v30, v65
 v_mfma_f32_16x16x32_bf16 v[88:91], a[72:75], v[144:147], v[88:91]
 ds_read_b64_tr_b16 a[96:97], v11 offset:28672
 v_mul_f32 v66, v30, v66
 v_mfma_f32_16x16x32_bf16 v[92:95], a[72:75], v[148:151], v[92:95]
 s_waitcnt lgkmcnt(9)
 ds_read_b64_tr_b16 a[98:99], v11 offset:29184
 v_mul_f32 v67, v30, v67
 v_mfma_f32_16x16x32_bf16 v[96:99], a[76:79], v[144:147], v[96:99]
 s_waitcnt vmcnt(15)
 s_barrier
 ds_read_b64_tr_b16 a[72:73], v8 offset:32768
 v_mul_f32 v68, v31, v68
 v_mfma_f32_16x16x32_bf16 v[100:103], a[76:79], v[148:151], v[100:103]
 s_waitcnt lgkmcnt(9)
 ds_read_b64_tr_b16 a[74:75], v8 offset:33280
 s_add_u32 s78, s75, 2359296
 v_mfma_f32_16x16x32_bf16 v[104:107], a[80:83], v[144:147], v[104:107]
 s_add_u32 m0, s69, 32768
 ds_read_b64_tr_b16 a[76:77], v9 offset:32768
 buffer_load_dwordx4 v22, s[40:43], s78 offen  lds
 v_mfma_f32_16x16x32_bf16 v[108:111], a[80:83], v[148:151], v[108:111]
 s_waitcnt lgkmcnt(9)
 ds_read_b64_tr_b16 a[78:79], v9 offset:33280
 v_mul_f32 v69, v31, v69
 v_mfma_f32_16x16x32_bf16 v[80:83], a[84:87], v[152:155], v[80:83]
 ds_read_b64_tr_b16 a[80:81], v10 offset:32768
 v_mul_f32 v70, v31, v70
 v_mfma_f32_16x16x32_bf16 v[84:87], a[84:87], v[156:159], v[84:87]
 s_waitcnt lgkmcnt(9)
 ds_read_b64_tr_b16 a[82:83], v10 offset:33280
 v_mul_f32 v71, v31, v71
 v_mfma_f32_16x16x32_bf16 v[88:91], a[88:91], v[152:155], v[88:91]
 ds_read_b64_tr_b16 a[84:85], v11 offset:32768
 v_mul_f32 v72, v30, v72
 v_mfma_f32_16x16x32_bf16 v[92:95], a[88:91], v[156:159], v[92:95]
 s_waitcnt lgkmcnt(9)
 ds_read_b64_tr_b16 a[86:87], v11 offset:33280
 s_add_u32 s78, s75, 2654208
 v_mfma_f32_16x16x32_bf16 v[96:99], a[92:95], v[152:155], v[96:99]
 s_add_u32 m0, s69, 36864
 ds_read_b64_tr_b16 a[88:89], v8 offset:36864
 buffer_load_dwordx4 v22, s[40:43], s78 offen  lds
 v_mfma_f32_16x16x32_bf16 v[100:103], a[92:95], v[156:159], v[100:103]
 s_waitcnt lgkmcnt(9)
 ds_read_b64_tr_b16 a[90:91], v8 offset:37376
 v_mul_f32 v73, v30, v73
 v_mfma_f32_16x16x32_bf16 v[104:107], a[96:99], v[152:155], v[104:107]
 ds_read_b64_tr_b16 a[92:93], v9 offset:36864
 v_mul_f32 v74, v30, v74
 v_mfma_f32_16x16x32_bf16 v[108:111], a[96:99], v[156:159], v[108:111]
 s_waitcnt lgkmcnt(9)
 ds_read_b64_tr_b16 a[94:95], v9 offset:37376
 v_mul_f32 v75, v30, v75
 v_mfma_f32_16x16x32_bf16 v[80:83], a[72:75], v[160:163], v[80:83]
 ds_read_b64_tr_b16 a[96:97], v10 offset:36864
 v_mul_f32 v76, v31, v76
 v_mfma_f32_16x16x32_bf16 v[84:87], a[72:75], v[164:167], v[84:87]
 s_waitcnt lgkmcnt(9)
 ds_read_b64_tr_b16 a[98:99], v10 offset:37376
 s_add_u32 s78, s75, 2949120
 v_mfma_f32_16x16x32_bf16 v[88:91], a[76:79], v[160:163], v[88:91]
 s_add_u32 m0, s69, 40960
 ds_read_b64_tr_b16 a[72:73], v11 offset:36864
 buffer_load_dwordx4 v22, s[40:43], s78 offen  lds
 v_mfma_f32_16x16x32_bf16 v[92:95], a[76:79], v[164:167], v[92:95]
 s_waitcnt lgkmcnt(9)
 ds_read_b64_tr_b16 a[74:75], v11 offset:37376
 v_mul_f32 v77, v31, v77
 v_mfma_f32_16x16x32_bf16 v[96:99], a[80:83], v[160:163], v[96:99]
 ds_read_b64_tr_b16 a[76:77], v8 offset:40960
 v_mul_f32 v78, v31, v78
 v_mfma_f32_16x16x32_bf16 v[100:103], a[80:83], v[164:167], v[100:103]
 s_waitcnt lgkmcnt(9)
 ds_read_b64_tr_b16 a[78:79], v8 offset:41472
 v_mul_f32 v79, v31, v79
 v_mfma_f32_16x16x32_bf16 v[104:107], a[84:87], v[160:163], v[104:107]
 ds_read_b64_tr_b16 a[80:81], v9 offset:40960
 v_and_b32 v27, 3, v0
 v_mfma_f32_16x16x32_bf16 v[108:111], a[84:87], v[164:167], v[108:111]
 s_waitcnt lgkmcnt(9)
 ds_read_b64_tr_b16 a[82:83], v9 offset:41472
 s_add_u32 s78, s75, 3244032
 v_mfma_f32_16x16x32_bf16 v[80:83], a[88:91], v[168:171], v[80:83]
 s_add_u32 m0, s69, 45056
 ds_read_b64_tr_b16 a[84:85], v10 offset:40960
 buffer_load_dwordx4 v22, s[40:43], s78 offen  lds
 v_mfma_f32_16x16x32_bf16 v[84:87], a[88:91], v[172:175], v[84:87]
 s_waitcnt lgkmcnt(9)
 ds_read_b64_tr_b16 a[86:87], v10 offset:41472
 v_lshlrev_b32 v27, 6, v27
 v_mfma_f32_16x16x32_bf16 v[88:91], a[92:95], v[168:171], v[88:91]
 ds_read_b64_tr_b16 a[88:89], v11 offset:40960
 buffer_load_dword v26, v27, s[32:35], 0 offen sc1
 v_mfma_f32_16x16x32_bf16 v[92:95], a[92:95], v[172:175], v[92:95]
 s_waitcnt lgkmcnt(9)
 ds_read_b64_tr_b16 a[90:91], v11 offset:41472
 v_mfma_f32_16x16x32_bf16 v[96:99], a[96:99], v[168:171], v[96:99]
 ds_read_b64_tr_b16 a[92:93], v8 offset:45056
 v_mfma_f32_16x16x32_bf16 v[100:103], a[96:99], v[172:175], v[100:103]
 s_waitcnt lgkmcnt(9)
 ds_read_b64_tr_b16 a[94:95], v8 offset:45568
 s_add_u32 s78, s75, 3538944
 v_mfma_f32_16x16x32_bf16 v[104:107], a[72:75], v[168:171], v[104:107]
 s_add_u32 m0, s69, 49152
 ds_read_b64_tr_b16 a[96:97], v9 offset:45056
 buffer_load_dwordx4 v22, s[40:43], s78 offen  lds
 v_mfma_f32_16x16x32_bf16 v[108:111], a[72:75], v[172:175], v[108:111]
 s_waitcnt lgkmcnt(9)
 ds_read_b64_tr_b16 a[98:99], v9 offset:45568
 v_mfma_f32_16x16x32_bf16 v[80:83], a[76:79], v[176:179], v[80:83]
 ds_read_b64_tr_b16 a[72:73], v10 offset:45056
 v_mfma_f32_16x16x32_bf16 v[84:87], a[76:79], v[180:183], v[84:87]
 s_waitcnt lgkmcnt(9)
 ds_read_b64_tr_b16 a[74:75], v10 offset:45568
 v_mfma_f32_16x16x32_bf16 v[88:91], a[80:83], v[176:179], v[88:91]
 ds_read_b64_tr_b16 a[76:77], v11 offset:45056
 v_mfma_f32_16x16x32_bf16 v[92:95], a[80:83], v[180:183], v[92:95]
 s_waitcnt lgkmcnt(9)
 ds_read_b64_tr_b16 a[78:79], v11 offset:45568
 s_add_u32 s78, s75, 3833856
 v_mfma_f32_16x16x32_bf16 v[96:99], a[84:87], v[176:179], v[96:99]
 s_add_u32 m0, s69, 53248
 ds_read_b64_tr_b16 a[80:81], v8 offset:49152
 buffer_load_dwordx4 v22, s[40:43], s78 offen  lds
 v_mfma_f32_16x16x32_bf16 v[100:103], a[84:87], v[180:183], v[100:103]
 s_waitcnt lgkmcnt(9)
 ds_read_b64_tr_b16 a[82:83], v8 offset:49664
 v_mfma_f32_16x16x32_bf16 v[104:107], a[88:91], v[176:179], v[104:107]
 ds_read_b64_tr_b16 a[84:85], v9 offset:49152
 v_mfma_f32_16x16x32_bf16 v[108:111], a[88:91], v[180:183], v[108:111]
 s_waitcnt lgkmcnt(9)
 ds_read_b64_tr_b16 a[86:87], v9 offset:49664
 v_mfma_f32_16x16x32_bf16 v[80:83], a[92:95], v[184:187], v[80:83]
 ds_read_b64_tr_b16 a[88:89], v10 offset:49152
 buffer_load_dword a170, v34, s[24:27], 0 offen offset:1024
 v_mfma_f32_16x16x32_bf16 v[84:87], a[92:95], v[188:191], v[84:87]
 s_waitcnt lgkmcnt(9)
 ds_read_b64_tr_b16 a[90:91], v10 offset:49664
 buffer_load_dword a171, v35, s[12:15], 0 offen offset:0
 v_mfma_f32_16x16x32_bf16 v[88:91], a[96:99], v[184:187], v[88:91]
 s_add_u32 s78, s75, 4128768
 ds_read_b64_tr_b16 a[92:93], v11 offset:49152
 v_mfma_f32_16x16x32_bf16 v[92:95], a[96:99], v[188:191], v[92:95]
 s_waitcnt lgkmcnt(9)
 ds_read_b64_tr_b16 a[94:95], v11 offset:49664
 v_mfma_f32_16x16x32_bf16 v[96:99], a[72:75], v[184:187], v[96:99]
 s_add_u32 m0, s69, 57344
 ds_read_b64_tr_b16 a[96:97], v8 offset:53248
 buffer_load_dwordx4 v22, s[40:43], s78 offen  lds
 v_mfma_f32_16x16x32_bf16 v[100:103], a[72:75], v[188:191], v[100:103]
 s_waitcnt lgkmcnt(9)
 ds_read_b64_tr_b16 a[98:99], v8 offset:53760
 v_mfma_f32_16x16x32_bf16 v[104:107], a[76:79], v[184:187], v[104:107]
 ds_read_b64_tr_b16 a[72:73], v9 offset:53248
 v_mfma_f32_16x16x32_bf16 v[108:111], a[76:79], v[188:191], v[108:111]
 s_waitcnt lgkmcnt(9)
 ds_read_b64_tr_b16 a[74:75], v9 offset:53760
 v_mfma_f32_16x16x32_bf16 v[80:83], a[80:83], v[192:195], v[80:83]
L_cp2:
 s_add_u32 s84, s82, L_cp2-parallel_sum__mha_block__glu_gated_bilinear__prompt_kernel+8192
 ds_read_b64_tr_b16 a[76:77], v10 offset:53248
 buffer_load_dword a246, off, s[44:47], s84
 v_mfma_f32_16x16x32_bf16 v[84:87], a[80:83], v[196:199], v[84:87]
 s_waitcnt lgkmcnt(9)
 ds_read_b64_tr_b16 a[78:79], v10 offset:53760
 v_mfma_f32_16x16x32_bf16 v[88:91], a[84:87], v[192:195], v[88:91]
 ds_read_b64_tr_b16 a[80:81], v11 offset:53248
 v_mfma_f32_16x16x32_bf16 v[92:95], a[84:87], v[196:199], v[92:95]
 s_waitcnt lgkmcnt(9)
 ds_read_b64_tr_b16 a[82:83], v11 offset:53760
 v_mfma_f32_16x16x32_bf16 v[96:99], a[88:91], v[192:195], v[96:99]
 s_waitcnt vmcnt(19)
 s_barrier
 ds_read_b64_tr_b16 a[84:85], v8 offset:57344
 v_accvgpr_read_b32 v40, a142
 v_mfma_f32_16x16x32_bf16 v[100:103], a[88:91], v[196:199], v[100:103]
 s_waitcnt lgkmcnt(9)
 ds_read_b64_tr_b16 a[86:87], v8 offset:57856
 s_add_u32 s78, s75, 4423680
 v_mfma_f32_16x16x32_bf16 v[104:107], a[92:95], v[192:195], v[104:107]
 s_add_u32 m0, s69, 61440
 ds_read_b64_tr_b16 a[88:89], v9 offset:57344
 buffer_load_dwordx4 v22, s[40:43], s78 offen  lds
 v_mfma_f32_16x16x32_bf16 v[108:111], a[92:95], v[196:199], v[108:111]
 s_waitcnt lgkmcnt(9)
 ds_read_b64_tr_b16 a[90:91], v9 offset:57856
 v_accvgpr_read_b32 v41, a143
 v_mfma_f32_16x16x32_bf16 v[80:83], a[96:99], v[200:203], v[80:83]
 ds_read_b64_tr_b16 a[92:93], v10 offset:57344
 v_accvgpr_read_b32 v42, a144
 v_mfma_f32_16x16x32_bf16 v[84:87], a[96:99], v[204:207], v[84:87]
 s_waitcnt lgkmcnt(9)
 ds_read_b64_tr_b16 a[94:95], v10 offset:57856
 v_accvgpr_read_b32 v43, a145
 v_mfma_f32_16x16x32_bf16 v[88:91], a[72:75], v[200:203], v[88:91]
 ds_read_b64_tr_b16 a[96:97], v11 offset:57344
 v_accvgpr_read_b32 v44, a146
 v_mfma_f32_16x16x32_bf16 v[92:95], a[72:75], v[204:207], v[92:95]
 s_waitcnt lgkmcnt(9)
 ds_read_b64_tr_b16 a[98:99], v11 offset:57856
 v_mfma_f32_16x16x32_bf16 v[96:99], a[76:79], v[200:203], v[96:99]
 ds_read_b64_tr_b16 a[72:73], v8 offset:61440
 v_mfma_f32_16x16x32_bf16 v[100:103], a[76:79], v[204:207], v[100:103]
 s_waitcnt lgkmcnt(9)
 ds_read_b64_tr_b16 a[74:75], v8 offset:61952
 v_mfma_f32_16x16x32_bf16 v[104:107], a[80:83], v[200:203], v[104:107]
 ds_read_b64_tr_b16 a[76:77], v9 offset:61440
 v_mfma_f32_16x16x32_bf16 v[108:111], a[80:83], v[204:207], v[108:111]
 s_waitcnt lgkmcnt(9)
 ds_read_b64_tr_b16 a[78:79], v9 offset:61952
 v_mfma_f32_16x16x32_bf16 v[80:83], a[84:87], v[208:211], v[80:83]
 ds_read_b64_tr_b16 a[80:81], v10 offset:61440
 v_mfma_f32_16x16x32_bf16 v[84:87], a[84:87], v[212:215], v[84:87]
 s_waitcnt lgkmcnt(9)
 ds_read_b64_tr_b16 a[82:83], v10 offset:61952
 s_add_u32 s78, s75, 4718592
 v_mfma_f32_16x16x32_bf16 v[88:91], a[88:91], v[208:211], v[88:91]
 s_add_u32 m0, s69, 65536
 ds_read_b64_tr_b16 a[84:85], v11 offset:61440
 buffer_load_dwordx4 v22, s[40:43], s78 offen  lds
 v_mfma_f32_16x16x32_bf16 v[92:95], a[88:91], v[212:215], v[92:95]
 s_waitcnt lgkmcnt(9)
 ds_read_b64_tr_b16 a[86:87], v11 offset:61952
 v_mfma_f32_16x16x32_bf16 v[96:99], a[92:95], v[208:211], v[96:99]
 ds_read_b64_tr_b16 a[88:89], v12 offset:0
 v_mfma_f32_16x16x32_bf16 v[100:103], a[92:95], v[212:215], v[100:103]
 s_waitcnt lgkmcnt(9)
 ds_read_b64_tr_b16 a[90:91], v12 offset:512
 v_mfma_f32_16x16x32_bf16 v[104:107], a[96:99], v[208:211], v[104:107]
 ds_read_b64_tr_b16 a[92:93], v13 offset:0
 v_mfma_f32_16x16x32_bf16 v[108:111], a[96:99], v[212:215], v[108:111]
 s_waitcnt lgkmcnt(9)
 ds_read_b64_tr_b16 a[94:95], v13 offset:512
 v_mfma_f32_16x16x32_bf16 v[80:83], a[72:75], v[216:219], v[80:83]
 ds_read_b64_tr_b16 a[96:97], v14 offset:0
 v_mfma_f32_16x16x32_bf16 v[84:87], a[72:75], v[220:223], v[84:87]
 s_waitcnt lgkmcnt(9)
 ds_read_b64_tr_b16 a[98:99], v14 offset:512
 v_mfma_f32_16x16x32_bf16 v[88:91], a[76:79], v[216:219], v[88:91]
 ds_read_b64_tr_b16 a[72:73], v15 offset:0
 v_mfma_f32_16x16x32_bf16 v[92:95], a[76:79], v[220:223], v[92:95]
 s_waitcnt lgkmcnt(9)
 ds_read_b64_tr_b16 a[74:75], v15 offset:512
 v_mfma_f32_16x16x32_bf16 v[96:99], a[80:83], v[216:219], v[96:99]
 ds_read_b64_tr_b16 a[76:77], v12 offset:4096
 v_mfma_f32_16x16x32_bf16 v[100:103], a[80:83], v[220:223], v[100:103]
 s_waitcnt lgkmcnt(9)
 ds_read_b64_tr_b16 a[78:79], v12 offset:4608
 s_add_u32 s78, s75, 5013504
 v_mfma_f32_16x16x32_bf16 v[104:107], a[84:87], v[216:219], v[104:107]
 s_add_u32 m0, s69, 69632
 ds_read_b64_tr_b16 a[80:81], v12 offset:8192
 buffer_load_dwordx4 v22, s[40:43], s78 offen  lds
 v_mfma_f32_16x16x32_bf16 v[108:111], a[84:87], v[220:223], v[108:111]
 s_waitcnt lgkmcnt(9)
 ds_read_b64_tr_b16 a[82:83], v12 offset:8704
 v_mfma_f32_16x16x32_bf16 v[80:83], a[88:91], v[224:227], v[80:83]
 ds_read_b64_tr_b16 a[84:85], v12 offset:12288
 v_mfma_f32_16x16x32_bf16 v[84:87], a[88:91], v[228:231], v[84:87]
 s_waitcnt lgkmcnt(9)
 ds_read_b64_tr_b16 a[86:87], v12 offset:12800
 v_mfma_f32_16x16x32_bf16 v[88:91], a[92:95], v[224:227], v[88:91]
 ds_read_b64_tr_b16 a[88:89], v13 offset:4096
 v_mfma_f32_16x16x32_bf16 v[92:95], a[92:95], v[228:231], v[92:95]
 s_waitcnt lgkmcnt(9)
 ds_read_b64_tr_b16 a[90:91], v13 offset:4608
 s_add_u32 s78, s76, 0
 v_mfma_f32_16x16x32_bf16 v[96:99], a[96:99], v[224:227], v[96:99]
 s_add_u32 m0, s69, 73728
 ds_read_b64_tr_b16 a[92:93], v13 offset:8192
 buffer_load_dwordx4 v23, s[24:27], s78 offen  lds
 v_mfma_f32_16x16x32_bf16 v[100:103], a[96:99], v[228:231], v[100:103]
 s_waitcnt lgkmcnt(9)
 ds_read_b64_tr_b16 a[94:95], v13 offset:8704
 v_mfma_f32_16x16x32_bf16 v[104:107], a[72:75], v[224:227], v[104:107]
 ds_read_b64_tr_b16 a[96:97], v13 offset:12288
 v_mfma_f32_16x16x32_bf16 v[108:111], a[72:75], v[228:231], v[108:111]
 s_waitcnt lgkmcnt(9)
 ds_read_b64_tr_b16 a[98:99], v13 offset:12800
 v_mfma_f32_16x16x32_bf16 v[80:83], a[76:79], v[232:235], v[80:83]
 ds_read_b64_tr_b16 a[72:73], v14 offset:4096
 v_mfma_f32_16x16x32_bf16 v[84:87], a[76:79], v[236:239], v[84:87]
 s_waitcnt lgkmcnt(9)
 ds_read_b64_tr_b16 a[74:75], v14 offset:4608
 v_mfma_f32_16x16x32_bf16 v[80:83], a[80:83], v[240:243], v[80:83]
 ds_read_b64_tr_b16 a[76:77], v14 offset:8192
 v_mfma_f32_16x16x32_bf16 v[84:87], a[80:83], v[244:247], v[84:87]
 s_waitcnt lgkmcnt(9)
 ds_read_b64_tr_b16 a[78:79], v14 offset:8704
 v_mfma_f32_16x16x32_bf16 v[80:83], a[84:87], v[248:251], v[80:83]
 ds_read_b64_tr_b16 a[80:81], v14 offset:12288
 v_mfma_f32_16x16x32_bf16 v[84:87], a[84:87], v[252:255], v[84:87]
 s_waitcnt lgkmcnt(9)
 ds_read_b64_tr_b16 a[82:83], v14 offset:12800
 v_mfma_f32_16x16x32_bf16 v[88:91], a[88:91], v[232:235], v[88:91]
 ds_read_b64_tr_b16 a[84:85], v15 offset:4096
 v_mfma_f32_16x16x32_bf16 v[92:95], a[88:91], v[236:239], v[92:95]
 s_waitcnt lgkmcnt(9)
 ds_read_b64_tr_b16 a[86:87], v15 offset:4608
 s_add_u32 s78, s76, 36864
 v_mfma_f32_16x16x32_bf16 v[88:91], a[92:95], v[240:243], v[88:91]
 s_add_u32 m0, s69, 77824
 ds_read_b64_tr_b16 a[88:89], v15 offset:8192
 buffer_load_dwordx4 v23, s[24:27], s78 offen  lds
 v_mfma_f32_16x16x32_bf16 v[92:95], a[92:95], v[244:247], v[92:95]
 s_waitcnt lgkmcnt(9)
 ds_read_b64_tr_b16 a[90:91], v15 offset:8704
 v_mul_f32 v80, v48, v80
 v_mfma_f32_16x16x32_bf16 v[88:91], a[96:99], v[248:251], v[88:91]
 ds_read_b64_tr_b16 a[92:93], v15 offset:12288
 v_mul_f32 v81, v49, v81
 v_mfma_f32_16x16x32_bf16 v[92:95], a[96:99], v[252:255], v[92:95]
 s_waitcnt lgkmcnt(9)
 ds_read_b64_tr_b16 a[94:95], v15 offset:12800
 v_mul_f32 v82, v50, v82
 v_mfma_f32_16x16x32_bf16 v[96:99], a[72:75], v[232:235], v[96:99]
 s_waitcnt vmcnt(11)
 s_barrier
 ds_read_b64_tr_b16 a[96:97], v16 offset:0
 v_mul_f32 v83, v51, v83
 v_mfma_f32_16x16x32_bf16 v[100:103], a[72:75], v[236:239], v[100:103]
 s_waitcnt lgkmcnt(9)
 ds_read_b64_tr_b16 a[98:99], v16 offset:256
 v_mul_f32 v84, v52, v84
 v_mfma_f32_16x16x32_bf16 v[96:99], a[76:79], v[240:243], v[96:99]
 ds_read_b64_tr_b16 a[72:73], v16 offset:4096
 v_mul_f32 v85, v53, v85
 v_mfma_f32_16x16x32_bf16 v[100:103], a[76:79], v[244:247], v[100:103]
 s_waitcnt lgkmcnt(9)
 ds_read_b64_tr_b16 a[74:75], v16 offset:4352
 v_mul_f32 v86, v54, v86
 v_mfma_f32_16x16x32_bf16 v[96:99], a[80:83], v[248:251], v[96:99]
 ds_read_b64_tr_b16 a[76:77], v16 offset:8192
 v_mul_f32 v87, v55, v87
 v_mfma_f32_16x16x32_bf16 v[100:103], a[80:83], v[252:255], v[100:103]
 s_waitcnt lgkmcnt(9)
 ds_read_b64_tr_b16 a[78:79], v16 offset:8448
 v_mul_f32 v88, v56, v88
 v_mfma_f32_16x16x32_bf16 v[104:107], a[84:87], v[232:235], v[104:107]
 ds_read_b64_tr_b16 a[80:81], v17 offset:0
 v_mul_f32 v89, v57, v89
 v_mfma_f32_16x16x32_bf16 v[108:111], a[84:87], v[236:239], v[108:111]
 s_waitcnt lgkmcnt(9)
 ds_read_b64_tr_b16 a[82:83], v17 offset:256
 s_add_u32 s78, s76, 73728
 v_mfma_f32_16x16x32_bf16 v[104:107], a[88:91], v[240:243], v[104:107]
 s_add_u32 m0, s69, 81920
 ds_read_b64_tr_b16 a[84:85], v17 offset:4096
 buffer_load_dwordx4 v23, s[24:27], s78 offen  lds
 v_mfma_f32_16x16x32_bf16 v[108:111], a[88:91], v[244:247], v[108:111]
 s_waitcnt lgkmcnt(9)
 ds_read_b64_tr_b16 a[86:87], v17 offset:4352
 v_mul_f32 v90, v58, v90
 v_mfma_f32_16x16x32_bf16 v[104:107], a[92:95], v[248:251], v[104:107]
 ds_read_b64_tr_b16 a[88:89], v17 offset:8192
 v_mul_f32 v91, v59, v91
 v_mfma_f32_16x16x32_bf16 v[108:111], a[92:95], v[252:255], v[108:111]
 s_waitcnt lgkmcnt(9)
 ds_read_b64_tr_b16 a[90:91], v17 offset:8448
 v_mul_f32 v92, v60, v92
 v_mul_f32 v93, v61, v93
 v_mfma_f32_16x16x32_bf16 v[48:51], a[96:99], v[112:115], 0
 ds_read_b64_tr_b16 a[92:93], v16 offset:2048
 v_mul_f32 v94, v62, v94
 v_mul_f32 v95, v63, v95
 v_mfma_f32_16x16x32_bf16 v[52:55], a[96:99], v[116:119], 0
 s_waitcnt lgkmcnt(9)
 ds_read_b64_tr_b16 a[94:95], v16 offset:2304
 v_mul_f32 v96, v64, v96
 v_mul_f32 v97, v65, v97
 v_mfma_f32_16x16x32_bf16 v[48:51], a[72:75], v[120:123], v[48:51]
 ds_read_b64_tr_b16 a[96:97], v16 offset:6144
 v_mul_f32 v98, v66, v98
 v_mul_f32 v99, v67, v99
 v_mfma_f32_16x16x32_bf16 v[52:55], a[72:75], v[124:127], v[52:55]
 s_waitcnt lgkmcnt(9)
 ds_read_b64_tr_b16 a[98:99], v16 offset:6400
 v_mul_f32 v100, v68, v100
 v_mul_f32 v101, v69, v101
 v_mfma_f32_16x16x32_bf16 v[48:51], a[76:79], v[128:131], v[48:51]
 ds_read_b64_tr_b16 a[72:73], v16 offset:10240
 v_mul_f32 v102, v70, v102
 v_mul_f32 v103, v71, v103
 v_mfma_f32_16x16x32_bf16 v[52:55], a[76:79], v[132:135], v[52:55]
 s_waitcnt lgkmcnt(9)
 ds_read_b64_tr_b16 a[74:75], v16 offset:10496
 v_mul_f32 v104, v72, v104
 v_mfma_f32_16x16x32_bf16 v[56:59], a[80:83], v[112:115], 0
 ds_read_b64_tr_b16 a[76:77], v17 offset:2048
 v_mul_f32 v105, v73, v105
 v_mfma_f32_16x16x32_bf16 v[60:63], a[80:83], v[116:119], 0
 s_waitcnt lgkmcnt(9)
 ds_read_b64_tr_b16 a[78:79], v17 offset:2304
 s_add_u32 s78, s76, 110592
 v_mfma_f32_16x16x32_bf16 v[56:59], a[84:87], v[120:123], v[56:59]
 s_add_u32 m0, s69, 86016
 ds_read_b64_tr_b16 a[80:81], v17 offset:6144
 buffer_load_dwordx4 v23, s[24:27], s78 offen  lds
 v_mfma_f32_16x16x32_bf16 v[60:63], a[84:87], v[124:127], v[60:63]
 s_waitcnt lgkmcnt(9)
 ds_read_b64_tr_b16 a[82:83], v17 offset:6400
 v_mul_f32 v106, v74, v106
 v_mfma_f32_16x16x32_bf16 v[56:59], a[88:91], v[128:131], v[56:59]
 ds_read_b64_tr_b16 a[84:85], v17 offset:10240
 v_mul_f32 v107, v75, v107
 v_mfma_f32_16x16x32_bf16 v[60:63], a[88:91], v[132:135], v[60:63]
 s_waitcnt lgkmcnt(9)
 ds_read_b64_tr_b16 a[86:87], v17 offset:10496
 v_mul_f32 v108, v76, v108
 v_mul_f32 v109, v77, v109
 v_mfma_f32_16x16x32_bf16 v[64:67], a[92:95], v[112:115], 0
 ds_read_b64_tr_b16 a[88:89], v16 offset:12288
 v_mul_f32 v110, v78, v110
 v_mul_f32 v111, v79, v111
 v_mfma_f32_16x16x32_bf16 v[68:71], a[92:95], v[116:119], 0
 s_waitcnt lgkmcnt(9)
 ds_read_b64_tr_b16 a[90:91], v16 offset:12544
 v_cvt_pk_bf16_f32 v32, v80, v81
 v_mfma_f32_16x16x32_bf16 v[64:67], a[96:99], v[120:123], v[64:67]
 ds_read_b64_tr_b16 a[92:93], v17 offset:12288
 v_accvgpr_write_b32 a48, v32
 v_mfma_f32_16x16x32_bf16 v[68:71], a[96:99], v[124:127], v[68:71]
 s_waitcnt lgkmcnt(9)
 ds_read_b64_tr_b16 a[94:95], v17 offset:12544
 v_cvt_pk_bf16_f32 v33, v82, v83
 v_mfma_f32_16x16x32_bf16 v[64:67], a[72:75], v[128:131], v[64:67]
 ds_read_b64_tr_b16 a[96:97], v16 offset:14336
 v_accvgpr_write_b32 a49, v33
 v_mfma_f32_16x16x32_bf16 v[68:71], a[72:75], v[132:135], v[68:71]
 s_waitcnt lgkmcnt(9)
 ds_read_b64_tr_b16 a[98:99], v16 offset:14592
 v_cvt_pk_bf16_f32 v32, v84, v85
 v_mfma_f32_16x16x32_bf16 v[72:75], a[76:79], v[112:115], 0
 ds_read_b64_tr_b16 a[72:73], v17 offset:14336
 v_accvgpr_write_b32 a52, v32
 v_mfma_f32_16x16x32_bf16 v[76:79], a[76:79], v[116:119], 0
 s_waitcnt lgkmcnt(9)
 ds_read_b64_tr_b16 a[74:75], v17 offset:14592
 s_add_u32 s78, s76, 147456
 v_mfma_f32_16x16x32_bf16 v[72:75], a[80:83], v[120:123], v[72:75]
 s_add_u32 m0, s69, 90112
 ds_read_b64_tr_b16 a[76:77], v16 offset:16384
 buffer_load_dwordx4 v23, s[24:27], s78 offen  lds
 v_mfma_f32_16x16x32_bf16 v[76:79], a[80:83], v[124:127], v[76:79]
 s_waitcnt lgkmcnt(9)
 ds_read_b64_tr_b16 a[78:79], v16 offset:16640
 v_cvt_pk_bf16_f32 v33, v86, v87
 v_mfma_f32_16x16x32_bf16 v[72:75], a[84:87], v[128:131], v[72:75]
 ds_read_b64_tr_b16 a[80:81], v17 offset:16384
 v_accvgpr_write_b32 a53, v33
 v_mfma_f32_16x16x32_bf16 v[76:79], a[84:87], v[132:135], v[76:79]
 s_waitcnt lgkmcnt(9)
 ds_read_b64_tr_b16 a[82:83], v17 offset:16640
 v_cvt_pk_bf16_f32 v32, v88, v89
 v_mfma_f32_16x16x32_bf16 v[48:51], a[88:91], v[136:139], v[48:51]
 ds_read_b64_tr_b16 a[84:85], v16 offset:18432
 v_accvgpr_write_b32 a50, v32
 v_mfma_f32_16x16x32_bf16 v[52:55], a[88:91], v[140:143], v[52:55]
 s_waitcnt lgkmcnt(9)
 ds_read_b64_tr_b16 a[86:87], v16 offset:18688
 s_add_u32 s78, s76, 184320
 v_mfma_f32_16x16x32_bf16 v[56:59], a[92:95], v[136:139], v[56:59]
 s_add_u32 m0, s69, 94208
 ds_read_b64_tr_b16 a[88:89], v17 offset:18432
 buffer_load_dwordx4 v23, s[24:27], s78 offen  lds
 v_mfma_f32_16x16x32_bf16 v[60:63], a[92:95], v[140:143], v[60:63]
 s_waitcnt lgkmcnt(9)
 ds_read_b64_tr_b16 a[90:91], v17 offset:18688
 v_cvt_pk_bf16_f32 v33, v90, v91
 v_mfma_f32_16x16x32_bf16 v[64:67], a[96:99], v[136:139], v[64:67]
 ds_read_b64_tr_b16 a[92:93], v16 offset:20480
 v_accvgpr_write_b32 a51, v33
 v_mfma_f32_16x16x32_bf16 v[68:71], a[96:99], v[140:143], v[68:71]
 s_waitcnt lgkmcnt(9)
 ds_read_b64_tr_b16 a[94:95], v16 offset:20736
 v_cvt_pk_bf16_f32 v32, v92, v93
 v_mfma_f32_16x16x32_bf16 v[72:75], a[72:75], v[136:139], v[72:75]
 ds_read_b64_tr_b16 a[96:97], v17 offset:20480
 v_accvgpr_write_b32 a54, v32
 v_mfma_f32_16x16x32_bf16 v[76:79], a[72:75], v[140:143], v[76:79]
 s_waitcnt lgkmcnt(9)
 ds_read_b64_tr_b16 a[98:99], v17 offset:20736
 s_add_u32 s78, s76, 221184
 v_mfma_f32_16x16x32_bf16 v[48:51], a[76:79], v[144:147], v[48:51]
 s_add_u32 m0, s69, 98304
 ds_read_b64_tr_b16 a[72:73], v16 offset:22528
 buffer_load_dwordx4 v23, s[24:27], s78 offen  lds
 v_mfma_f32_16x16x32_bf16 v[52:55], a[76:79], v[148:151], v[52:55]
 s_waitcnt lgkmcnt(9)
 ds_read_b64_tr_b16 a[74:75], v16 offset:22784
 v_cvt_pk_bf16_f32 v33, v94, v95
 v_mfma_f32_16x16x32_bf16 v[56:59], a[80:83], v[144:147], v[56:59]
 ds_read_b64_tr_b16 a[76:77], v17 offset:22528
 v_accvgpr_write_b32 a55, v33
 v_mfma_f32_16x16x32_bf16 v[60:63], a[80:83], v[148:151], v[60:63]
 s_waitcnt lgkmcnt(9)
 ds_read_b64_tr_b16 a[78:79], v17 offset:22784
 v_cvt_pk_bf16_f32 v32, v96, v97
 v_mfma_f32_16x16x32_bf16 v[64:67], a[84:87], v[144:147], v[64:67]
 s_barrier
 ds_read_b64_tr_b16 a[80:81], v16 offset:24576
 v_accvgpr_write_b32 a56, v32
 v_mfma_f32_16x16x32_bf16 v[68:71], a[84:87], v[148:151], v[68:71]
 s_waitcnt lgkmcnt(9)
 ds_read_b64_tr_b16 a[82:83], v16 offset:24832
 s_add_u32 s78, s76, 258048
 v_mfma_f32_16x16x32_bf16 v[72:75], a[88:91], v[144:147], v[72:75]
 s_add_u32 m0, s69, 102400
 ds_read_b64_tr_b16 a[84:85], v17 offset:24576
 buffer_load_dwordx4 v23, s[24:27], s78 offen  lds
 v_mfma_f32_16x16x32_bf16 v[76:79], a[88:91], v[148:151], v[76:79]
 s_waitcnt lgkmcnt(9)
 ds_read_b64_tr_b16 a[86:87], v17 offset:24832
 v_cvt_pk_bf16_f32 v33, v98, v99
 v_mfma_f32_16x16x32_bf16 v[48:51], a[92:95], v[152:155], v[48:51]
 ds_read_b64_tr_b16 a[88:89], v16 offset:26624
 v_accvgpr_write_b32 a57, v33
 v_mfma_f32_16x16x32_bf16 v[52:55], a[92:95], v[156:159], v[52:55]
 s_waitcnt lgkmcnt(9)
 ds_read_b64_tr_b16 a[90:91], v16 offset:26880
 v_cvt_pk_bf16_f32 v32, v100, v101
 v_mfma_f32_16x16x32_bf16 v[56:59], a[96:99], v[152:155], v[56:59]
 ds_read_b64_tr_b16 a[92:93], v17 offset:26624
 v_accvgpr_write_b32 a60, v32
 v_mfma_f32_16x16x32_bf16 v[60:63], a[96:99], v[156:159], v[60:63]
 s_waitcnt lgkmcnt(9)
 ds_read_b64_tr_b16 a[94:95], v17 offset:26880
 s_add_u32 s78, s77, 0
 v_mfma_f32_16x16x32_bf16 v[64:67], a[72:75], v[152:155], v[64:67]
 s_add_u32 m0, s69, 106496
 ds_read_b64_tr_b16 a[96:97], v16 offset:28672
 buffer_load_dwordx4 v23, s[24:27], s78 offen  lds
 v_mfma_f32_16x16x32_bf16 v[68:71], a[72:75], v[156:159], v[68:71]
 s_waitcnt lgkmcnt(9)
 ds_read_b64_tr_b16 a[98:99], v16 offset:28928
 v_cvt_pk_bf16_f32 v33, v102, v103
 v_mfma_f32_16x16x32_bf16 v[72:75], a[76:79], v[152:155], v[72:75]
 ds_read_b64_tr_b16 a[72:73], v17 offset:28672
 v_accvgpr_write_b32 a61, v33
 v_mfma_f32_16x16x32_bf16 v[76:79], a[76:79], v[156:159], v[76:79]
 s_waitcnt lgkmcnt(9)
 ds_read_b64_tr_b16 a[74:75], v17 offset:28928
 v_cvt_pk_bf16_f32 v32, v104, v105
 v_mfma_f32_16x16x32_bf16 v[48:51], a[80:83], v[160:163], v[48:51]
 ds_read_b64_tr_b16 a[76:77], v16 offset:30720
 v_accvgpr_write_b32 a58, v32
 v_mfma_f32_16x16x32_bf16 v[52:55], a[80:83], v[164:167], v[52:55]
 s_waitcnt lgkmcnt(9)
 ds_read_b64_tr_b16 a[78:79], v16 offset:30976
 s_add_u32 s78, s76, 128
 v_mfma_f32_16x16x32_bf16 v[56:59], a[84:87], v[160:163], v[56:59]
 s_add_u32 m0, s69, 0
 ds_read_b64_tr_b16 a[80:81], v17 offset:30720
 buffer_load_dwordx4 v23, s[24:27], s78 offen  lds
 v_mfma_f32_16x16x32_bf16 v[60:63], a[84:87], v[164:167], v[60:63]
 s_waitcnt lgkmcnt(9)
 ds_read_b64_tr_b16 a[82:83], v17 offset:30976
 v_cvt_pk_bf16_f32 v33, v106, v107
 v_mfma_f32_16x16x32_bf16 v[64:67], a[88:91], v[160:163], v[64:67]
 ds_read_b64_tr_b16 a[84:85], v16 offset:32768
 v_accvgpr_write_b32 a59, v33
 v_mfma_f32_16x16x32_bf16 v[68:71], a[88:91], v[164:167], v[68:71]
 s_waitcnt lgkmcnt(9)
 ds_read_b64_tr_b16 a[86:87], v16 offset:33024
 v_cvt_pk_bf16_f32 v32, v108, v109
 v_mfma_f32_16x16x32_bf16 v[72:75], a[92:95], v[160:163], v[72:75]
 ds_read_b64_tr_b16 a[88:89], v17 offset:32768
 v_accvgpr_write_b32 a62, v32
 v_mfma_f32_16x16x32_bf16 v[76:79], a[92:95], v[164:167], v[76:79]
 s_waitcnt lgkmcnt(9)
 ds_read_b64_tr_b16 a[90:91], v17 offset:33024
 s_add_u32 s78, s76, 36992
 v_mfma_f32_16x16x32_bf16 v[48:51], a[96:99], v[168:171], v[48:51]
 s_add_u32 m0, s69, 4096
 ds_read_b64_tr_b16 a[92:93], v16 offset:34816
 buffer_load_dwordx4 v23, s[24:27], s78 offen  lds
 v_mfma_f32_16x16x32_bf16 v[52:55], a[96:99], v[172:175], v[52:55]
 s_waitcnt lgkmcnt(9)
 ds_read_b64_tr_b16 a[94:95], v16 offset:35072
 v_cvt_pk_bf16_f32 v33, v110, v111
 v_mfma_f32_16x16x32_bf16 v[56:59], a[72:75], v[168:171], v[56:59]
 ds_read_b64_tr_b16 a[96:97], v17 offset:34816
 v_accvgpr_write_b32 a63, v33
 v_mfma_f32_16x16x32_bf16 v[60:63], a[72:75], v[172:175], v[60:63]
 s_waitcnt lgkmcnt(9)
 ds_read_b64_tr_b16 a[98:99], v17 offset:35072
 v_cmp_gt_u32 vcc, 64, v26
 v_mfma_f32_16x16x32_bf16 v[64:67], a[76:79], v[168:171], v[64:67]
 ds_read_b64_tr_b16 a[72:73], v16 offset:36864
 v_mfma_f32_16x16x32_bf16 v[68:71], a[76:79], v[172:175], v[68:71]
 s_waitcnt lgkmcnt(9)
 ds_read_b64_tr_b16 a[74:75], v16 offset:37120
 s_add_u32 s78, s76, 73856
 v_mfma_f32_16x16x32_bf16 v[72:75], a[80:83], v[168:171], v[72:75]
 s_add_u32 m0, s69, 8192
 ds_read_b64_tr_b16 a[76:77], v17 offset:36864
 buffer_load_dwordx4 v23, s[24:27], s78 offen  lds
 v_mfma_f32_16x16x32_bf16 v[76:79], a[80:83], v[172:175], v[76:79]
 s_waitcnt lgkmcnt(9)
 ds_read_b64_tr_b16 a[78:79], v17 offset:37120
 v_mfma_f32_16x16x32_bf16 v[48:51], a[84:87], v[176:179], v[48:51]
 s_cbranch_vccnz L_spin1
L_back1:
 ds_read_b64_tr_b16 a[80:81], v16 offset:38912
 s_add_u32 s99, s86, 0
 v_mfma_f32_16x16x32_bf16 v[52:55], a[84:87], v[180:183], v[52:55]
 s_waitcnt lgkmcnt(9)
 ds_read_b64_tr_b16 a[82:83], v16 offset:39168
 v_mfma_f32_16x16x32_bf16 v[56:59], a[88:91], v[176:179], v[56:59]
 s_add_u32 m0, s87, 122880
 ds_read_b64_tr_b16 a[84:85], v17 offset:38912
 buffer_load_dwordx4 v40, s[36:39], s99 offen sc1 lds
 v_mfma_f32_16x16x32_bf16 v[60:63], a[88:91], v[180:183], v[60:63]
 s_waitcnt lgkmcnt(9)
 ds_read_b64_tr_b16 a[86:87], v17 offset:39168
 v_mfma_f32_16x16x32_bf16 v[64:67], a[92:95], v[176:179], v[64:67]
 ds_read_b64_tr_b16 a[88:89], v16 offset:40960
 v_mfma_f32_16x16x32_bf16 v[68:71], a[92:95], v[180:183], v[68:71]
 s_waitcnt lgkmcnt(9)
 ds_read_b64_tr_b16 a[90:91], v16 offset:41216
 v_mfma_f32_16x16x32_bf16 v[72:75], a[96:99], v[176:179], v[72:75]
 ds_read_b64_tr_b16 a[92:93], v17 offset:40960
 v_mfma_f32_16x16x32_bf16 v[76:79], a[96:99], v[180:183], v[76:79]
 s_waitcnt lgkmcnt(9)
 ds_read_b64_tr_b16 a[94:95], v17 offset:41216
 v_mfma_f32_16x16x32_bf16 v[48:51], a[72:75], v[184:187], v[48:51]
 s_add_u32 m0, s87, 123904
 ds_read_b64_tr_b16 a[96:97], v16 offset:43008
 buffer_load_dwordx4 v41, s[36:39], s99 offen sc1 lds
 v_mfma_f32_16x16x32_bf16 v[52:55], a[72:75], v[188:191], v[52:55]
 s_waitcnt lgkmcnt(9)
 ds_read_b64_tr_b16 a[98:99], v16 offset:43264
 v_mfma_f32_16x16x32_bf16 v[56:59], a[76:79], v[184:187], v[56:59]
 ds_read_b64_tr_b16 a[72:73], v17 offset:43008
 v_mfma_f32_16x16x32_bf16 v[60:63], a[76:79], v[188:191], v[60:63]
 s_waitcnt lgkmcnt(9)
 ds_read_b64_tr_b16 a[74:75], v17 offset:43264
 v_mfma_f32_16x16x32_bf16 v[64:67], a[80:83], v[184:187], v[64:67]
 ds_read_b64_tr_b16 a[76:77], v16 offset:45056
 v_mfma_f32_16x16x32_bf16 v[68:71], a[80:83], v[188:191], v[68:71]
 s_waitcnt lgkmcnt(9)
 ds_read_b64_tr_b16 a[78:79], v16 offset:45312
 v_mfma_f32_16x16x32_bf16 v[72:75], a[84:87], v[184:187], v[72:75]
 s_add_u32 m0, s87, 124928
 ds_read_b64_tr_b16 a[80:81], v17 offset:45056
 buffer_load_dwordx4 v42, s[36:39], s99 offen sc1 lds
 v_mfma_f32_16x16x32_bf16 v[76:79], a[84:87], v[188:191], v[76:79]
 s_waitcnt lgkmcnt(9)
 ds_read_b64_tr_b16 a[82:83], v17 offset:45312
 v_mfma_f32_16x16x32_bf16 v[48:51], a[88:91], v[192:195], v[48:51]
 ds_read_b64_tr_b16 a[84:85], v16 offset:47104
 v_mfma_f32_16x16x32_bf16 v[52:55], a[88:91], v[196:199], v[52:55]
 s_waitcnt lgkmcnt(9)
 ds_read_b64_tr_b16 a[86:87], v16 offset:47360
 v_mfma_f32_16x16x32_bf16 v[56:59], a[92:95], v[192:195], v[56:59]
 ds_read_b64_tr_b16 a[88:89], v17 offset:47104
 v_mfma_f32_16x16x32_bf16 v[60:63], a[92:95], v[196:199], v[60:63]
 s_waitcnt lgkmcnt(9)
 ds_read_b64_tr_b16 a[90:91], v17 offset:47360
 v_mfma_f32_16x16x32_bf16 v[64:67], a[96:99], v[192:195], v[64:67]
 s_waitcnt vmcnt(15)
 s_barrier
 ds_read_b64_tr_b16 a[92:93], v16 offset:49152
 v_mfma_f32_16x16x32_bf16 v[68:71], a[96:99], v[196:199], v[68:71]
 s_waitcnt lgkmcnt(9)
 ds_read_b64_tr_b16 a[94:95], v16 offset:49408
 s_add_u32 s78, s76, 110720
 v_mfma_f32_16x16x32_bf16 v[72:75], a[72:75], v[192:195], v[72:75]
 s_add_u32 m0, s69, 12288
 ds_read_b64_tr_b16 a[96:97], v17 offset:49152
 buffer_load_dwordx4 v23, s[24:27], s78 offen  lds
 v_mfma_f32_16x16x32_bf16 v[76:79], a[72:75], v[196:199], v[76:79]
 s_waitcnt lgkmcnt(9)
 ds_read_b64_tr_b16 a[98:99], v17 offset:49408
 v_mfma_f32_16x16x32_bf16 v[48:51], a[76:79], v[200:203], v[48:51]
 s_add_u32 m0, s87, 125952
 ds_read_b64_tr_b16 a[72:73], v16 offset:51200
 buffer_load_dwordx4 v43, s[36:39], s99 offen sc1 lds
 v_mfma_f32_16x16x32_bf16 v[52:55], a[76:79], v[204:207], v[52:55]
 s_waitcnt lgkmcnt(9)
 ds_read_b64_tr_b16 a[74:75], v16 offset:51456
 v_mfma_f32_16x16x32_bf16 v[56:59], a[80:83], v[200:203], v[56:59]
 ds_read_b64_tr_b16 a[76:77], v17 offset:51200
 v_mfma_f32_16x16x32_bf16 v[60:63], a[80:83], v[204:207], v[60:63]
 s_waitcnt lgkmcnt(9)
 ds_read_b64_tr_b16 a[78:79], v17 offset:51456
 s_add_u32 s78, s76, 147584
 v_mfma_f32_16x16x32_bf16 v[64:67], a[84:87], v[200:203], v[64:67]
 s_add_u32 m0, s69, 16384
 ds_read_b64_tr_b16 a[80:81], v16 offset:53248
 buffer_load_dwordx4 v23, s[24:27], s78 offen  lds
 v_mfma_f32_16x16x32_bf16 v[68:71], a[84:87], v[204:207], v[68:71]
 s_waitcnt lgkmcnt(9)
 ds_read_b64_tr_b16 a[82:83], v16 offset:53504
 v_mfma_f32_16x16x32_bf16 v[72:75], a[88:91], v[200:203], v[72:75]
 s_add_u32 m0, s87, 126976
 ds_read_b64_tr_b16 a[84:85], v17 offset:53248
 buffer_load_dwordx4 v44, s[36:39], s99 offen sc1 lds
 v_mfma_f32_16x16x32_bf16 v[76:79], a[88:91], v[204:207], v[76:79]
 s_waitcnt lgkmcnt(9)
 ds_read_b64_tr_b16 a[86:87], v17 offset:53504
 v_mfma_f32_16x16x32_bf16 v[48:51], a[92:95], v[208:211], v[48:51]
 ds_read_b64_tr_b16 a[88:89], v16 offset:55296
 v_mfma_f32_16x16x32_bf16 v[52:55], a[92:95], v[212:215], v[52:55]
 s_waitcnt lgkmcnt(9)
 ds_read_b64_tr_b16 a[90:91], v16 offset:55552
 s_add_u32 s78, s76, 184448
 v_mfma_f32_16x16x32_bf16 v[56:59], a[96:99], v[208:211], v[56:59]
 s_add_u32 m0, s69, 20480
 ds_read_b64_tr_b16 a[92:93], v17 offset:55296
 buffer_load_dwordx4 v23, s[24:27], s78 offen  lds
 v_mfma_f32_16x16x32_bf16 v[60:63], a[96:99], v[212:215], v[60:63]
 s_waitcnt lgkmcnt(9)
 ds_read_b64_tr_b16 a[94:95], v17 offset:55552
 v_mfma_f32_16x16x32_bf16 v[64:67], a[72:75], v[208:211], v[64:67]
 s_add_u32 s99, s86, 304128
 ds_read_b64_tr_b16 a[96:97], v16 offset:57344
 v_mfma_f32_16x16x32_bf16 v[68:71], a[72:75], v[212:215], v[68:71]
 s_waitcnt lgkmcnt(9)
 ds_read_b64_tr_b16 a[98:99], v16 offset:57600
 v_mfma_f32_16x16x32_bf16 v[72:75], a[76:79], v[208:211], v[72:75]
 s_add_u32 m0, s87, 143360
 ds_read_b64_tr_b16 a[72:73], v17 offset:57344
 buffer_load_dwordx4 v40, s[36:39], s99 offen sc1 lds
 v_mfma_f32_16x16x32_bf16 v[76:79], a[76:79], v[212:215], v[76:79]
 s_waitcnt lgkmcnt(9)
 ds_read_b64_tr_b16 a[74:75], v17 offset:57600
 s_add_u32 s78, s76, 221312
 v_mfma_f32_16x16x32_bf16 v[48:51], a[80:83], v[216:219], v[48:51]
 s_add_u32 m0, s69, 24576
 ds_read_b64_tr_b16 a[76:77], v16 offset:59392
 buffer_load_dwordx4 v23, s[24:27], s78 offen  lds
 v_mfma_f32_16x16x32_bf16 v[52:55], a[80:83], v[220:223], v[52:55]
 s_waitcnt lgkmcnt(9)
 ds_read_b64_tr_b16 a[78:79], v16 offset:59648
 v_mfma_f32_16x16x32_bf16 v[56:59], a[84:87], v[216:219], v[56:59]
 ds_read_b64_tr_b16 a[80:81], v17 offset:59392
 v_mfma_f32_16x16x32_bf16 v[60:63], a[84:87], v[220:223], v[60:63]
 s_waitcnt lgkmcnt(9)
 ds_read_b64_tr_b16 a[82:83], v17 offset:59648
 v_mfma_f32_16x16x32_bf16 v[64:67], a[88:91], v[216:219], v[64:67]
 s_add_u32 m0, s87, 144384
 ds_read_b64_tr_b16 a[84:85], v16 offset:61440
 buffer_load_dwordx4 v41, s[36:39], s99 offen sc1 lds
 v_mfma_f32_16x16x32_bf16 v[68:71], a[88:91], v[220:223], v[68:71]
 s_waitcnt lgkmcnt(9)
 ds_read_b64_tr_b16 a[86:87], v16 offset:61696
 s_add_u32 s78, s76, 258176
 v_mfma_f32_16x16x32_bf16 v[72:75], a[92:95], v[216:219], v[72:75]
 s_add_u32 m0, s69, 28672
 ds_read_b64_tr_b16 a[88:89], v17 offset:61440
 buffer_load_dwordx4 v23, s[24:27], s78 offen  lds
 v_mfma_f32_16x16x32_bf16 v[76:79], a[92:95], v[220:223], v[76:79]
 s_waitcnt lgkmcnt(9)
 ds_read_b64_tr_b16 a[90:91], v17 offset:61696
 v_mfma_f32_16x16x32_bf16 v[48:51], a[96:99], v[224:227], v[48:51]
 ds_read_b64_tr_b16 a[92:93], v16 offset:63488
 v_mfma_f32_16x16x32_bf16 v[52:55], a[96:99], v[228:231], v[52:55]
 s_waitcnt lgkmcnt(9)
 ds_read_b64_tr_b16 a[94:95], v16 offset:63744
 v_mfma_f32_16x16x32_bf16 v[56:59], a[72:75], v[224:227], v[56:59]
 s_add_u32 m0, s87, 145408
 ds_read_b64_tr_b16 a[96:97], v17 offset:63488
 buffer_load_dwordx4 v42, s[36:39], s99 offen sc1 lds
 v_mfma_f32_16x16x32_bf16 v[60:63], a[72:75], v[228:231], v[60:63]
 s_waitcnt lgkmcnt(9)
 ds_read_b64_tr_b16 a[98:99], v17 offset:63744
 s_add_u32 s78, s77, 128
 v_mfma_f32_16x16x32_bf16 v[64:67], a[76:79], v[224:227], v[64:67]
 s_add_u32 m0, s69, 32768
 ds_read_b64_tr_b16 a[72:73], v18 offset:0
 buffer_load_dwordx4 v23, s[24:27], s78 offen  lds
 v_mfma_f32_16x16x32_bf16 v[68:71], a[76:79], v[228:231], v[68:71]
 s_waitcnt lgkmcnt(9)
 ds_read_b64_tr_b16 a[74:75], v18 offset:256
 v_mfma_f32_16x16x32_bf16 v[72:75], a[80:83], v[224:227], v[72:75]
 ds_read_b64_tr_b16 a[76:77], v19 offset:0
 v_mfma_f32_16x16x32_bf16 v[76:79], a[80:83], v[228:231], v[76:79]
 s_waitcnt lgkmcnt(9)
 ds_read_b64_tr_b16 a[78:79], v19 offset:256
 v_mfma_f32_16x16x32_bf16 v[48:51], a[84:87], v[232:235], v[48:51]
 s_add_u32 m0, s87, 146432
 ds_read_b64_tr_b16 a[80:81], v18 offset:2048
 buffer_load_dwordx4 v43, s[36:39], s99 offen sc1 lds
 v_mfma_f32_16x16x32_bf16 v[52:55], a[84:87], v[236:239], v[52:55]
 s_waitcnt lgkmcnt(9)
 ds_read_b64_tr_b16 a[82:83], v18 offset:2304
 v_mfma_f32_16x16x32_bf16 v[56:59], a[88:91], v[232:235], v[56:59]
 ds_read_b64_tr_b16 a[84:85], v19 offset:2048
 v_mfma_f32_16x16x32_bf16 v[60:63], a[88:91], v[236:239], v[60:63]
 s_waitcnt lgkmcnt(9)
 ds_read_b64_tr_b16 a[86:87], v19 offset:2304
 v_mfma_f32_16x16x32_bf16 v[64:67], a[92:95], v[232:235], v[64:67]
 ds_read_b64_tr_b16 a[88:89], v18 offset:4096
 v_mfma_f32_16x16x32_bf16 v[68:71], a[92:95], v[236:239], v[68:71]
 s_waitcnt lgkmcnt(9)
 ds_read_b64_tr_b16 a[90:91], v18 offset:4352
 v_mfma_f32_16x16x32_bf16 v[72:75], a[96:99], v[232:235], v[72:75]
 s_add_u32 m0, s87, 147456
 ds_read_b64_tr_b16 a[92:93], v19 offset:4096
 buffer_load_dwordx4 v44, s[36:39], s99 offen sc1 lds
 v_mfma_f32_16x16x32_bf16 v[76:79], a[96:99], v[236:239], v[76:79]
 s_waitcnt lgkmcnt(9)
 ds_read_b64_tr_b16 a[94:95], v19 offset:4352
 v_mfma_f32_16x16x32_bf16 v[48:51], a[72:75], v[240:243], v[48:51]
 ds_read_b64_tr_b16 a[96:97], v18 offset:6144
 v_mfma_f32_16x16x32_bf16 v[52:55], a[72:75], v[244:247], v[52:55]
 s_waitcnt lgkmcnt(9)
 ds_read_b64_tr_b16 a[98:99], v18 offset:6400
 v_mfma_f32_16x16x32_bf16 v[56:59], a[76:79], v[240:243], v[56:59]
 ds_read_b64_tr_b16 a[72:73], v19 offset:6144
 v_mfma_f32_16x16x32_bf16 v[60:63], a[76:79], v[244:247], v[60:63]
 s_waitcnt lgkmcnt(9)
 ds_read_b64_tr_b16 a[74:75], v19 offset:6400
 v_mfma_f32_16x16x32_bf16 v[64:67], a[80:83], v[240:243], v[64:67]
 s_waitcnt vmcnt(22)
 s_barrier
 ds_read_b64_tr_b16 a[76:77], v8 offset:8192
 v_mfma_f32_16x16x32_bf16 v[68:71], a[80:83], v[244:247], v[68:71]
 s_waitcnt lgkmcnt(9)
 ds_read_b64_tr_b16 a[78:79], v8 offset:8704
 s_add_u32 s78, s76, 256
 v_mfma_f32_16x16x32_bf16 v[72:75], a[84:87], v[240:243], v[72:75]
 s_add_u32 m0, s69, 36864
 ds_read_b64_tr_b16 a[80:81], v9 offset:8192
 buffer_load_dwordx4 v23, s[24:27], s78 offen  lds
 v_mfma_f32_16x16x32_bf16 v[76:79], a[84:87], v[244:247], v[76:79]
 s_waitcnt lgkmcnt(9)
 ds_read_b64_tr_b16 a[82:83], v9 offset:8704
 v_mfma_f32_16x16x32_bf16 v[48:51], a[88:91], v[248:251], v[48:51]
 ds_read_b64_tr_b16 a[84:85], v10 offset:8192
 v_mfma_f32_16x16x32_bf16 v[52:55], a[88:91], v[252:255], v[52:55]
 s_waitcnt lgkmcnt(9)
 ds_read_b64_tr_b16 a[86:87], v10 offset:8704
 v_mfma_f32_16x16x32_bf16 v[56:59], a[92:95], v[248:251], v[56:59]
 ds_read_b64_tr_b16 a[88:89], v11 offset:8192
 v_mfma_f32_16x16x32_bf16 v[60:63], a[92:95], v[252:255], v[60:63]
 s_waitcnt lgkmcnt(9)
 ds_read_b64_tr_b16 a[90:91], v11 offset:8704
 s_add_u32 s78, s76, 37120
 v_mfma_f32_16x16x32_bf16 v[64:67], a[96:99], v[248:251], v[64:67]
 s_add_u32 m0, s69, 40960
 ds_read_b64_tr_b16 a[92:93], v8 offset:12288
 buffer_load_dwordx4 v23, s[24:27], s78 offen  lds
 v_mfma_f32_16x16x32_bf16 v[68:71], a[96:99], v[252:255], v[68:71]
 s_waitcnt lgkmcnt(9)
 ds_read_b64_tr_b16 a[94:95], v8 offset:12800
 v_mul_f32 v48, v30, v48
 v_mfma_f32_16x16x32_bf16 v[72:75], a[72:75], v[248:251], v[72:75]
 ds_read_b64_tr_b16 a[96:97], v9 offset:12288
 v_mul_f32 v49, v30, v49
 v_mfma_f32_16x16x32_bf16 v[76:79], a[72:75], v[252:255], v[76:79]
 s_waitcnt lgkmcnt(9)
 ds_read_b64_tr_b16 a[98:99], v9 offset:12800
 v_mul_f32 v50, v30, v50
 v_mfma_f32_16x16x32_bf16 v[80:83], a[76:79], a[0:3], 0
 ds_read_b64_tr_b16 a[72:73], v10 offset:12288
 v_mul_f32 v51, v30, v51
 v_mfma_f32_16x16x32_bf16 v[84:87], a[76:79], a[4:7], 0
 s_waitcnt lgkmcnt(9)
 ds_read_b64_tr_b16 a[74:75], v10 offset:12800
 s_add_u32 s78, s76, 73984
 v_mfma_f32_16x16x32_bf16 v[88:91], a[80:83], a[0:3], 0
 s_add_u32 m0, s69, 45056
 ds_read_b64_tr_b16 a[76:77], v11 offset:12288
 buffer_load_dwordx4 v23, s[24:27], s78 offen  lds
 v_mfma_f32_16x16x32_bf16 v[92:95], a[80:83], a[4:7], 0
 s_waitcnt lgkmcnt(9)
 ds_read_b64_tr_b16 a[78:79], v11 offset:12800
 v_mul_f32 v52, v31, v52
 v_mfma_f32_16x16x32_bf16 v[96:99], a[84:87], a[0:3], 0
 ds_read_b64_tr_b16 a[80:81], v8 offset:16384
 v_mul_f32 v53, v31, v53
 v_mfma_f32_16x16x32_bf16 v[100:103], a[84:87], a[4:7], 0
 s_waitcnt lgkmcnt(9)
 ds_read_b64_tr_b16 a[82:83], v8 offset:16896
 v_mul_f32 v54, v31, v54
 v_mfma_f32_16x16x32_bf16 v[104:107], a[88:91], a[0:3], 0
 ds_read_b64_tr_b16 a[84:85], v9 offset:16384
 v_mul_f32 v55, v31, v55
 v_mfma_f32_16x16x32_bf16 v[108:111], a[88:91], a[4:7], 0
 s_waitcnt lgkmcnt(9)
 ds_read_b64_tr_b16 a[86:87], v9 offset:16896
 s_add_u32 s78, s76, 110848
 v_mfma_f32_16x16x32_bf16 v[80:83], a[92:95], a[8:11], v[80:83]
 s_add_u32 m0, s69, 49152
 ds_read_b64_tr_b16 a[88:89], v10 offset:16384
 buffer_load_dwordx4 v23, s[24:27], s78 offen  lds
 v_mfma_f32_16x16x32_bf16 v[84:87], a[92:95], a[12:15], v[84:87]
 s_waitcnt lgkmcnt(9)
 ds_read_b64_tr_b16 a[90:91], v10 offset:16896
 v_mul_f32 v56, v30, v56
 v_mfma_f32_16x16x32_bf16 v[88:91], a[96:99], a[8:11], v[88:91]
 ds_read_b64_tr_b16 a[92:93], v11 offset:16384
 v_mul_f32 v57, v30, v57
 v_mfma_f32_16x16x32_bf16 v[92:95], a[96:99], a[12:15], v[92:95]
 s_waitcnt lgkmcnt(9)
 ds_read_b64_tr_b16 a[94:95], v11 offset:16896
 v_mul_f32 v58, v30, v58
 v_mfma_f32_16x16x32_bf16 v[96:99], a[72:75], a[8:11], v[96:99]
 ds_read_b64_tr_b16 a[96:97], v8 offset:20480
 v_mul_f32 v59, v30, v59
 v_mfma_f32_16x16x32_bf16 v[100:103], a[72:75], a[12:15], v[100:103]
 s_waitcnt lgkmcnt(9)
 ds_read_b64_tr_b16 a[98:99], v8 offset:20992
 s_add_u32 s78, s76, 147712
 v_mfma_f32_16x16x32_bf16 v[104:107], a[76:79], a[8:11], v[104:107]
 s_add_u32 m0, s69, 53248
 ds_read_b64_tr_b16 a[72:73], v9 offset:20480
 buffer_load_dwordx4 v23, s[24:27], s78 offen  lds
 v_mfma_f32_16x16x32_bf16 v[108:111], a[76:79], a[12:15], v[108:111]
 s_waitcnt lgkmcnt(9)
 ds_read_b64_tr_b16 a[74:75], v9 offset:20992
 v_mul_f32 v60, v31, v60
 v_mfma_f32_16x16x32_bf16 v[80:83], a[80:83], a[16:19], v[80:83]
 ds_read_b64_tr_b16 a[76:77], v10 offset:20480
 v_mul_f32 v61, v31, v61
 v_mfma_f32_16x16x32_bf16 v[84:87], a[80:83], a[20:23], v[84:87]
 s_waitcnt lgkmcnt(9)
 ds_read_b64_tr_b16 a[78:79], v10 offset:20992
 v_mul_f32 v62, v31, v62
 v_mfma_f32_16x16x32_bf16 v[88:91], a[84:87], a[16:19], v[88:91]
 ds_read_b64_tr_b16 a[80:81], v11 offset:20480
 v_mul_f32 v63, v31, v63
 v_mfma_f32_16x16x32_bf16 v[92:95], a[84:87], a[20:23], v[92:95]
 s_waitcnt lgkmcnt(9)
 ds_read_b64_tr_b16 a[82:83], v11 offset:20992
 s_add_u32 s78, s76, 184576
 v_mfma_f32_16x16x32_bf16 v[96:99], a[88:91], a[16:19], v[96:99]
 s_add_u32 m0, s69, 57344
 ds_read_b64_tr_b16 a[84:85], v8 offset:24576
 buffer_load_dwordx4 v23, s[24:27], s78 offen  lds
 v_mfma_f32_16x16x32_bf16 v[100:103], a[88:91], a[20:23], v[100:103]
 s_waitcnt lgkmcnt(9)
 ds_read_b64_tr_b16 a[86:87], v8 offset:25088
 v_mul_f32 v64, v48, v64
 v_mfma_f32_16x16x32_bf16 v[104:107], a[92:95], a[16:19], v[104:107]
 ds_read_b64_tr_b16 a[88:89], v9 offset:24576
 v_mul_f32 v65, v49, v65
 v_mfma_f32_16x16x32_bf16 v[108:111], a[92:95], a[20:23], v[108:111]
 s_waitcnt lgkmcnt(9)
 ds_read_b64_tr_b16 a[90:91], v9 offset:25088
 v_mul_f32 v66, v50, v66
 v_mfma_f32_16x16x32_bf16 v[80:83], a[96:99], a[24:27], v[80:83]
 ds_read_b64_tr_b16 a[92:93], v10 offset:24576
 v_mul_f32 v67, v51, v67
 v_mfma_f32_16x16x32_bf16 v[84:87], a[96:99], a[28:31], v[84:87]
 s_waitcnt lgkmcnt(9)
 ds_read_b64_tr_b16 a[94:95], v10 offset:25088
 v_cvt_pk_bf16_f32 v32, v64, v65
 v_mfma_f32_16x16x32_bf16 v[88:91], a[72:75], a[24:27], v[88:91]
 ds_read_b64_tr_b16 a[96:97], v11 offset:24576
 v_accvgpr_write_b32 a64, v32
 v_mfma_f32_16x16x32_bf16 v[92:95], a[72:75], a[28:31], v[92:95]
 s_waitcnt lgkmcnt(9)
 ds_read_b64_tr_b16 a[98:99], v11 offset:25088
 v_cvt_pk_bf16_f32 v33, v66, v67
 v_mfma_f32_16x16x32_bf16 v[96:99], a[76:79], a[24:27], v[96:99]
 ds_read_b64_tr_b16 a[72:73], v8 offset:28672
 v_accvgpr_write_b32 a65, v33
 v_mfma_f32_16x16x32_bf16 v[100:103], a[76:79], a[28:31], v[100:103]
 s_waitcnt lgkmcnt(9)
 ds_read_b64_tr_b16 a[74:75], v8 offset:29184
 v_mul_f32 v68, v52, v68
 v_mfma_f32_16x16x32_bf16 v[104:107], a[80:83], a[24:27], v[104:107]
 ds_read_b64_tr_b16 a[76:77], v9 offset:28672
 v_mul_f32 v69, v53, v69
 v_mfma_f32_16x16x32_bf16 v[108:111], a[80:83], a[28:31], v[108:111]
 s_waitcnt lgkmcnt(9)
 ds_read_b64_tr_b16 a[78:79], v9 offset:29184
 v_mul_f32 v70, v54, v70
 v_mfma_f32_16x16x32_bf16 v[80:83], a[84:87], a[32:35], v[80:83]
 ds_read_b64_tr_b16 a[80:81], v10 offset:28672
 v_mul_f32 v71, v55, v71
 v_mfma_f32_16x16x32_bf16 v[84:87], a[84:87], a[36:39], v[84:87]
 s_waitcnt lgkmcnt(9)
 ds_read_b64_tr_b16 a[82:83], v10 offset:29184
 v_cvt_pk_bf16_f32 v32, v68, v69
 v_mfma_f32_16x16x32_bf16 v[88:91], a[88:91], a[32:35], v[88:91]
 ds_read_b64_tr_b16 a[84:85], v11 offset:28672
 v_accvgpr_write_b32 a68, v32
 v_mfma_f32_16x16x32_bf16 v[92:95], a[88:91], a[36:39], v[92:95]
 s_waitcnt lgkmcnt(9)
 ds_read_b64_tr_b16 a[86:87], v11 offset:29184
 v_cvt_pk_bf16_f32 v33, v70, v71
 v_mfma_f32_16x16x32_bf16 v[96:99], a[92:95], a[32:35], v[96:99]
 s_waitcnt vmcnt(22)
 s_barrier
 ds_read_b64_tr_b16 a[88:89], v8 offset:32768
 v_accvgpr_write_b32 a69, v33
 v_mfma_f32_16x16x32_bf16 v[100:103], a[92:95], a[36:39], v[100:103]
 s_waitcnt lgkmcnt(9)
 ds_read_b64_tr_b16 a[90:91], v8 offset:33280
 s_add_u32 s78, s76, 221440
 v_mfma_f32_16x16x32_bf16 v[104:107], a[96:99], a[32:35], v[104:107]
 s_add_u32 m0, s69, 61440
 ds_read_b64_tr_b16 a[92:93], v9 offset:32768
 buffer_load_dwordx4 v23, s[24:27], s78 offen  lds
 v_mfma_f32_16x16x32_bf16 v[108:111], a[96:99], a[36:39], v[108:111]
 s_waitcnt lgkmcnt(9)
 ds_read_b64_tr_b16 a[94:95], v9 offset:33280
 v_mul_f32 v72, v56, v72
 v_mfma_f32_16x16x32_bf16 v[80:83], a[72:75], a[40:43], v[80:83]
 ds_read_b64_tr_b16 a[96:97], v10 offset:32768
 v_mul_f32 v73, v57, v73
 v_mfma_f32_16x16x32_bf16 v[84:87], a[72:75], a[44:47], v[84:87]
 s_waitcnt lgkmcnt(9)
 ds_read_b64_tr_b16 a[98:99], v10 offset:33280
 v_mul_f32 v74, v58, v74
 v_mfma_f32_16x16x32_bf16 v[88:91], a[76:79], a[40:43], v[88:91]
 ds_read_b64_tr_b16 a[72:73], v11 offset:32768
 v_mul_f32 v75, v59, v75
 v_mfma_f32_16x16x32_bf16 v[92:95], a[76:79], a[44:47], v[92:95]
 s_waitcnt lgkmcnt(9)
 ds_read_b64_tr_b16 a[74:75], v11 offset:33280
 s_add_u32 s78, s76, 258304
 v_mfma_f32_16x16x32_bf16 v[96:99], a[80:83], a[40:43], v[96:99]
 s_add_u32 m0, s69, 65536
 ds_read_b64_tr_b16 a[76:77], v8 offset:36864
 buffer_load_dwordx4 v23, s[24:27], s78 offen  lds
 v_mfma_f32_16x16x32_bf16 v[100:103], a[80:83], a[44:47], v[100:103]
 s_waitcnt lgkmcnt(9)
 ds_read_b64_tr_b16 a[78:79], v8 offset:37376
 v_cvt_pk_bf16_f32 v32, v72, v73
 v_mfma_f32_16x16x32_bf16 v[104:107], a[84:87], a[40:43], v[104:107]
 ds_read_b64_tr_b16 a[80:81], v9 offset:36864
 v_accvgpr_write_b32 a66, v32
 v_mfma_f32_16x16x32_bf16 v[108:111], a[84:87], a[44:47], v[108:111]
 s_waitcnt lgkmcnt(9)
 ds_read_b64_tr_b16 a[82:83], v9 offset:37376
 v_cvt_pk_bf16_f32 v33, v74, v75
 v_mfma_f32_16x16x32_bf16 v[80:83], a[88:91], a[48:51], v[80:83]
 ds_read_b64_tr_b16 a[84:85], v10 offset:36864
 v_accvgpr_write_b32 a67, v33
 v_mfma_f32_16x16x32_bf16 v[84:87], a[88:91], a[52:55], v[84:87]
 s_waitcnt lgkmcnt(9)
 ds_read_b64_tr_b16 a[86:87], v10 offset:37376
 s_add_u32 s78, s77, 256
 v_mfma_f32_16x16x32_bf16 v[88:91], a[92:95], a[48:51], v[88:91]
 s_add_u32 m0, s69, 69632
 ds_read_b64_tr_b16 a[88:89], v11 offset:36864
 buffer_load_dwordx4 v23, s[24:27], s78 offen  lds
 v_mfma_f32_16x16x32_bf16 v[92:95], a[92:95], a[52:55], v[92:95]
 s_waitcnt lgkmcnt(9)
 ds_read_b64_tr_b16 a[90:91], v11 offset:37376
 v_mul_f32 v76, v60, v76
 v_mfma_f32_16x16x32_bf16 v[96:99], a[96:99], a[48:51], v[96:99]
 ds_read_b64_tr_b16 a[92:93], v8 offset:40960
 v_mul_f32 v77, v61, v77
 v_mfma_f32_16x16x32_bf16 v[100:103], a[96:99], a[52:55], v[100:103]
 s_waitcnt lgkmcnt(9)
 ds_read_b64_tr_b16 a[94:95], v8 offset:41472
 v_mul_f32 v78, v62, v78
 v_mfma_f32_16x16x32_bf16 v[104:107], a[72:75], a[48:51], v[104:107]
 ds_read_b64_tr_b16 a[96:97], v9 offset:40960
 v_mul_f32 v79, v63, v79
 v_mfma_f32_16x16x32_bf16 v[108:111], a[72:75], a[52:55], v[108:111]
 s_waitcnt lgkmcnt(9)
 ds_read_b64_tr_b16 a[98:99], v9 offset:41472
 s_add_u32 s78, s76, 384
 v_mfma_f32_16x16x32_bf16 v[80:83], a[76:79], a[56:59], v[80:83]
 s_add_u32 m0, s69, 73728
 ds_read_b64_tr_b16 a[72:73], v10 offset:40960
 buffer_load_dwordx4 v23, s[24:27], s78 offen  lds
 v_mfma_f32_16x16x32_bf16 v[84:87], a[76:79], a[60:63], v[84:87]
 s_waitcnt lgkmcnt(9)
 ds_read_b64_tr_b16 a[74:75], v10 offset:41472
 v_cvt_pk_bf16_f32 v32, v76, v77
 v_mfma_f32_16x16x32_bf16 v[88:91], a[80:83], a[56:59], v[88:91]
 ds_read_b64_tr_b16 a[76:77], v11 offset:40960
 v_accvgpr_write_b32 a70, v32
 v_mfma_f32_16x16x32_bf16 v[92:95], a[80:83], a[60:63], v[92:95]
 s_waitcnt lgkmcnt(9)
 ds_read_b64_tr_b16 a[78:79], v11 offset:41472
 v_cvt_pk_bf16_f32 v33, v78, v79
 v_mfma_f32_16x16x32_bf16 v[96:99], a[84:87], a[56:59], v[96:99]
 ds_read_b64_tr_b16 a[80:81], v4 offset:0
 v_accvgpr_write_b32 a71, v33
 v_mfma_f32_16x16x32_bf16 v[100:103], a[84:87], a[60:63], v[100:103]
 s_waitcnt lgkmcnt(9)
 ds_read_b64_tr_b16 a[82:83], v4 offset:512
 s_add_u32 s78, s76, 37248
 v_mfma_f32_16x16x32_bf16 v[104:107], a[88:91], a[56:59], v[104:107]
 s_add_u32 m0, s69, 77824
 ds_read_b64_tr_b16 a[84:85], v5 offset:0
 buffer_load_dwordx4 v23, s[24:27], s78 offen  lds
 v_mfma_f32_16x16x32_bf16 v[108:111], a[88:91], a[60:63], v[108:111]
 s_waitcnt lgkmcnt(9)
 ds_read_b64_tr_b16 a[86:87], v5 offset:512
 v_accvgpr_read_b32 v16, a140
 v_mfma_f32_16x16x32_bf16 v[80:83], a[92:95], a[64:67], v[80:83]
 ds_read_b64_tr_b16 a[88:89], v6 offset:0
 v_accvgpr_read_b32 v17, a141
 v_mfma_f32_16x16x32_bf16 v[84:87], a[92:95], a[68:71], v[84:87]
 s_waitcnt lgkmcnt(9)
 ds_read_b64_tr_b16 a[90:91], v6 offset:512
 v_accvgpr_read_b32 v18, a142
 v_mfma_f32_16x16x32_bf16 v[88:91], a[96:99], a[64:67], v[88:91]
 ds_read_b64_tr_b16 a[92:93], v7 offset:0
 v_accvgpr_read_b32 v19, a143
 v_mfma_f32_16x16x32_bf16 v[92:95], a[96:99], a[68:71], v[92:95]
 s_waitcnt lgkmcnt(9)
 ds_read_b64_tr_b16 a[94:95], v7 offset:512
 s_add_u32 s78, s76, 74112
 v_mfma_f32_16x16x32_bf16 v[96:99], a[72:75], a[64:67], v[96:99]
 s_add_u32 m0, s69, 81920
 ds_read_b64_tr_b16 a[96:97], v4 offset:4096
 buffer_load_dwordx4 v23, s[24:27], s78 offen  lds
 v_mfma_f32_16x16x32_bf16 v[100:103], a[72:75], a[68:71], v[100:103]
 s_waitcnt lgkmcnt(9)
 ds_read_b64_tr_b16 a[98:99], v4 offset:4608
 v_accvgpr_read_b32 v20, a144
 v_mfma_f32_16x16x32_bf16 v[104:107], a[76:79], a[64:67], v[104:107]
 ds_read_b64_tr_b16 a[72:73], v5 offset:4096
 v_accvgpr_read_b32 v21, a145
 v_mfma_f32_16x16x32_bf16 v[108:111], a[76:79], a[68:71], v[108:111]
 s_waitcnt lgkmcnt(9)
 ds_read_b64_tr_b16 a[74:75], v5 offset:4608
 v_cvt_pk_bf16_f32 v28, v80, v81
 v_mfma_f32_16x16x32_bf16 v[48:51], a[80:83], a[0:3], 0
 ds_read_b64_tr_b16 a[76:77], v6 offset:4096
 v_cvt_pk_bf16_f32 v30, v88, v89
 v_mfma_f32_16x16x32_bf16 v[52:55], a[80:83], a[4:7], 0
 s_waitcnt lgkmcnt(9)
 ds_read_b64_tr_b16 a[78:79], v6 offset:4608
 v_cvt_pk_bf16_f32 v29, v82, v83
 v_mfma_f32_16x16x32_bf16 v[56:59], a[84:87], a[0:3], 0
 ds_read_b64_tr_b16 a[80:81], v7 offset:4096
 v_cvt_pk_bf16_f32 v31, v90, v91
 v_mfma_f32_16x16x32_bf16 v[60:63], a[84:87], a[4:7], 0
 s_waitcnt lgkmcnt(9)
 ds_read_b64_tr_b16 a[82:83], v7 offset:4608
 v_permlane16_swap_b32 v28, v30
 v_mfma_f32_16x16x32_bf16 v[64:67], a[88:91], a[0:3], 0
 ds_read_b64_tr_b16 a[84:85], v4 offset:8192
 v_permlane16_swap_b32 v29, v31
 v_mfma_f32_16x16x32_bf16 v[68:71], a[88:91], a[4:7], 0
 s_waitcnt lgkmcnt(9)
 ds_read_b64_tr_b16 a[86:87], v4 offset:8704
 v_accvgpr_read_b32 v22, a146
 v_mfma_f32_16x16x32_bf16 v[72:75], a[92:95], a[0:3], 0
 s_add_u32 s89, s85, 0
 ds_read_b64_tr_b16 a[88:89], v5 offset:8192
 buffer_store_dwordx4 v[28:31], v24, s[36:39], s89 offen sc1
 v_mfma_f32_16x16x32_bf16 v[76:79], a[92:95], a[4:7], 0
 s_waitcnt lgkmcnt(9)
 ds_read_b64_tr_b16 a[90:91], v5 offset:8704
 v_mfma_f32_16x16x32_bf16 v[48:51], a[96:99], a[8:11], v[48:51]
 s_lshr_b32 s79, s68, 1
 ds_read_b64_tr_b16 a[92:93], v6 offset:8192
 v_mfma_f32_16x16x32_bf16 v[52:55], a[96:99], a[12:15], v[52:55]
 s_waitcnt lgkmcnt(9)
 ds_read_b64_tr_b16 a[94:95], v6 offset:8704
 v_mfma_f32_16x16x32_bf16 v[56:59], a[72:75], a[8:11], v[56:59]
 s_mul_i32 s79, s79, 73728
 ds_read_b64_tr_b16 a[96:97], v7 offset:8192
 v_mfma_f32_16x16x32_bf16 v[60:63], a[72:75], a[12:15], v[60:63]
 s_waitcnt lgkmcnt(9)
 ds_read_b64_tr_b16 a[98:99], v7 offset:8704
 v_mfma_f32_16x16x32_bf16 v[64:67], a[76:79], a[8:11], v[64:67]
 s_waitcnt vmcnt(15)
 s_barrier
 ds_read_b64_tr_b16 a[72:73], v4 offset:12288
 v_mfma_f32_16x16x32_bf16 v[68:71], a[76:79], a[12:15], v[68:71]
 s_waitcnt lgkmcnt(9)
 ds_read_b64_tr_b16 a[74:75], v4 offset:12800
 s_add_u32 s78, s76, 110976
 v_mfma_f32_16x16x32_bf16 v[72:75], a[80:83], a[8:11], v[72:75]
 s_add_u32 m0, s69, 86016
 ds_read_b64_tr_b16 a[76:77], v5 offset:12288
 buffer_load_dwordx4 v23, s[24:27], s78 offen  lds
 v_mfma_f32_16x16x32_bf16 v[76:79], a[80:83], a[12:15], v[76:79]
 s_waitcnt lgkmcnt(9)
 ds_read_b64_tr_b16 a[78:79], v5 offset:12800
 v_cvt_pk_bf16_f32 v40, v84, v85
 v_mfma_f32_16x16x32_bf16 v[48:51], a[84:87], a[16:19], v[48:51]
 s_add_u32 s79, s79, s90
 ds_read_b64_tr_b16 a[80:81], v6 offset:12288
 v_cvt_pk_bf16_f32 v42, v92, v93
 v_mfma_f32_16x16x32_bf16 v[52:55], a[84:87], a[20:23], v[52:55]
 s_waitcnt lgkmcnt(9)
 ds_read_b64_tr_b16 a[82:83], v6 offset:12800
 v_cvt_pk_bf16_f32 v41, v86, v87
 v_mfma_f32_16x16x32_bf16 v[56:59], a[88:91], a[16:19], v[56:59]
 s_add_u32 s80, s79, 36864
 ds_read_b64_tr_b16 a[84:85], v7 offset:12288
 v_cvt_pk_bf16_f32 v43, v94, v95
 v_mfma_f32_16x16x32_bf16 v[60:63], a[88:91], a[20:23], v[60:63]
 s_waitcnt lgkmcnt(9)
 ds_read_b64_tr_b16 a[86:87], v7 offset:12800
 s_add_u32 s78, s76, 147840
 v_mfma_f32_16x16x32_bf16 v[64:67], a[92:95], a[16:19], v[64:67]
 s_add_u32 m0, s69, 90112
 ds_read_b64_tr_b16 a[88:89], v4 offset:16384
 buffer_load_dwordx4 v23, s[24:27], s78 offen  lds
 v_mfma_f32_16x16x32_bf16 v[68:71], a[92:95], a[20:23], v[68:71]
 s_waitcnt lgkmcnt(9)
 ds_read_b64_tr_b16 a[90:91], v4 offset:16896
 v_permlane16_swap_b32 v40, v42
 v_mfma_f32_16x16x32_bf16 v[72:75], a[96:99], a[16:19], v[72:75]
 ds_read_b64_tr_b16 a[92:93], v5 offset:16384
 v_permlane16_swap_b32 v41, v43
 v_mfma_f32_16x16x32_bf16 v[76:79], a[96:99], a[20:23], v[76:79]
 s_waitcnt lgkmcnt(9)
 ds_read_b64_tr_b16 a[94:95], v5 offset:16896
 buffer_load_dwordx2 v[224:225], v16, s[36:39], s79 offen sc1
 v_mfma_f32_16x16x32_bf16 v[48:51], a[72:75], a[24:27], v[48:51]
 s_add_u32 s89, s85, 294912
 ds_read_b64_tr_b16 a[96:97], v6 offset:16384
 buffer_store_dwordx4 v[40:43], v24, s[36:39], s89 offen sc1
 v_mfma_f32_16x16x32_bf16 v[52:55], a[72:75], a[28:31], v[52:55]
 s_waitcnt lgkmcnt(9)
 ds_read_b64_tr_b16 a[98:99], v6 offset:16896
 s_add_u32 s78, s76, 184704
 v_mfma_f32_16x16x32_bf16 v[56:59], a[76:79], a[24:27], v[56:59]
 s_add_u32 m0, s69, 94208
 ds_read_b64_tr_b16 a[72:73], v7 offset:16384
 buffer_load_dwordx4 v23, s[24:27], s78 offen  lds
 v_mfma_f32_16x16x32_bf16 v[60:63], a[76:79], a[28:31], v[60:63]
 s_waitcnt lgkmcnt(9)
 ds_read_b64_tr_b16 a[74:75], v7 offset:16896
 buffer_load_dwordx2 v[226:227], v16, s[36:39], s79 offen offset:512 sc1
 v_mfma_f32_16x16x32_bf16 v[64:67], a[80:83], a[24:27], v[64:67]
 ds_read_b64_tr_b16 a[76:77], v4 offset:20480
 v_mfma_f32_16x16x32_bf16 v[68:71], a[80:83], a[28:31], v[68:71]
 s_waitcnt lgkmcnt(9)
 ds_read_b64_tr_b16 a[78:79], v4 offset:20992
 v_mfma_f32_16x16x32_bf16 v[72:75], a[84:87], a[24:27], v[72:75]
 ds_read_b64_tr_b16 a[80:81], v5 offset:20480
 buffer_load_dword v36, v17, s[36:39], s79 offen sc1
 v_mfma_f32_16x16x32_bf16 v[76:79], a[84:87], a[28:31], v[76:79]
 s_waitcnt lgkmcnt(9)
 ds_read_b64_tr_b16 a[82:83], v5 offset:20992
 s_add_u32 s78, s76, 221568
 v_mfma_f32_16x16x32_bf16 v[48:51], a[88:91], a[32:35], v[48:51]
 s_add_u32 m0, s69, 98304
 ds_read_b64_tr_b16 a[84:85], v6 offset:20480
 buffer_load_dwordx4 v23, s[24:27], s78 offen  lds
 v_mfma_f32_16x16x32_bf16 v[52:55], a[88:91], a[36:39], v[52:55]
 s_waitcnt lgkmcnt(9)
 ds_read_b64_tr_b16 a[86:87], v6 offset:20992
 v_cvt_pk_bf16_f32 v44, v96, v97
 v_mfma_f32_16x16x32_bf16 v[56:59], a[92:95], a[32:35], v[56:59]
 ds_read_b64_tr_b16 a[88:89], v7 offset:20480
 v_cvt_pk_bf16_f32 v46, v104, v105
 v_mfma_f32_16x16x32_bf16 v[60:63], a[92:95], a[36:39], v[60:63]
 s_waitcnt lgkmcnt(9)
 ds_read_b64_tr_b16 a[90:91], v7 offset:20992
 v_cvt_pk_bf16_f32 v45, v98, v99
 v_mfma_f32_16x16x32_bf16 v[64:67], a[96:99], a[32:35], v[64:67]
 ds_read_b64_tr_b16 a[92:93], v4 offset:24576
 v_cvt_pk_bf16_f32 v47, v106, v107
 v_mfma_f32_16x16x32_bf16 v[68:71], a[96:99], a[36:39], v[68:71]
 s_waitcnt lgkmcnt(9)
 ds_read_b64_tr_b16 a[94:95], v4 offset:25088
 s_add_u32 s78, s76, 258432
 v_mfma_f32_16x16x32_bf16 v[72:75], a[72:75], a[32:35], v[72:75]
 s_add_u32 m0, s69, 102400
 ds_read_b64_tr_b16 a[96:97], v5 offset:24576
 buffer_load_dwordx4 v23, s[24:27], s78 offen  lds
 v_mfma_f32_16x16x32_bf16 v[76:79], a[72:75], a[36:39], v[76:79]
 s_waitcnt lgkmcnt(9)
 ds_read_b64_tr_b16 a[98:99], v5 offset:25088
 v_permlane16_swap_b32 v44, v46
 v_mfma_f32_16x16x32_bf16 v[48:51], a[76:79], a[40:43], v[48:51]
 ds_read_b64_tr_b16 a[72:73], v6 offset:24576
 v_permlane16_swap_b32 v45, v47
 v_mfma_f32_16x16x32_bf16 v[52:55], a[76:79], a[44:47], v[52:55]
 s_waitcnt lgkmcnt(9)
 ds_read_b64_tr_b16 a[74:75], v6 offset:25088
 buffer_load_dwordx2 v[228:229], v16, s[36:39], s80 offen sc1
 v_mfma_f32_16x16x32_bf16 v[56:59], a[80:83], a[40:43], v[56:59]
 s_add_u32 s89, s85, 1024
 ds_read_b64_tr_b16 a[76:77], v7 offset:24576
 buffer_store_dwordx4 v[44:47], v24, s[36:39], s89 offen sc1
 v_mfma_f32_16x16x32_bf16 v[60:63], a[80:83], a[44:47], v[60:63]
 s_waitcnt lgkmcnt(9)
 ds_read_b64_tr_b16 a[78:79], v7 offset:25088
 s_add_u32 s78, s77, 384
 v_mfma_f32_16x16x32_bf16 v[64:67], a[84:87], a[40:43], v[64:67]
 s_add_u32 m0, s69, 106496
 ds_read_b64_tr_b16 a[80:81], v4 offset:28672
 buffer_load_dwordx4 v23, s[24:27], s78 offen  lds
 v_mfma_f32_16x16x32_bf16 v[68:71], a[84:87], a[44:47], v[68:71]
 s_waitcnt lgkmcnt(9)
 ds_read_b64_tr_b16 a[82:83], v4 offset:29184
 buffer_load_dwordx2 v[230:231], v16, s[36:39], s80 offen offset:512 sc1
 v_mfma_f32_16x16x32_bf16 v[72:75], a[88:91], a[40:43], v[72:75]
 ds_read_b64_tr_b16 a[84:85], v5 offset:28672
 v_mfma_f32_16x16x32_bf16 v[76:79], a[88:91], a[44:47], v[76:79]
 s_waitcnt lgkmcnt(9)
 ds_read_b64_tr_b16 a[86:87], v5 offset:29184
 v_cvt_pk_bf16_f32 v28, v100, v101
 v_mfma_f32_16x16x32_bf16 v[48:51], a[92:95], a[48:51], v[48:51]
 ds_read_b64_tr_b16 a[88:89], v6 offset:28672
 v_cvt_pk_bf16_f32 v30, v108, v109
 v_mfma_f32_16x16x32_bf16 v[52:55], a[92:95], a[52:55], v[52:55]
 s_waitcnt lgkmcnt(9)
 ds_read_b64_tr_b16 a[90:91], v6 offset:29184
 v_cvt_pk_bf16_f32 v29, v102, v103
 v_mfma_f32_16x16x32_bf16 v[56:59], a[96:99], a[48:51], v[56:59]
 ds_read_b64_tr_b16 a[92:93], v7 offset:28672
 v_cvt_pk_bf16_f32 v31, v110, v111
 v_mfma_f32_16x16x32_bf16 v[60:63], a[96:99], a[52:55], v[60:63]
 s_waitcnt lgkmcnt(9)
 ds_read_b64_tr_b16 a[94:95], v7 offset:29184
 v_permlane16_swap_b32 v28, v30
 v_mfma_f32_16x16x32_bf16 v[64:67], a[72:75], a[48:51], v[64:67]
 ds_read_b64_tr_b16 a[96:97], v4 offset:32768
 v_permlane16_swap_b32 v29, v31
 v_mfma_f32_16x16x32_bf16 v[68:71], a[72:75], a[52:55], v[68:71]
 s_waitcnt lgkmcnt(9)
 ds_read_b64_tr_b16 a[98:99], v4 offset:33280
 buffer_load_dword v37, v17, s[36:39], s80 offen sc1
 v_mfma_f32_16x16x32_bf16 v[72:75], a[76:79], a[48:51], v[72:75]
 s_add_u32 s89, s85, 295936
 ds_read_b64_tr_b16 a[72:73], v5 offset:32768
 buffer_store_dwordx4 v[28:31], v24, s[36:39], s89 offen sc1
 v_mfma_f32_16x16x32_bf16 v[76:79], a[76:79], a[52:55], v[76:79]
 s_waitcnt lgkmcnt(9)
 ds_read_b64_tr_b16 a[74:75], v5 offset:33280
 v_mfma_f32_16x16x32_bf16 v[48:51], a[80:83], a[56:59], v[48:51]
 ds_read_b64_tr_b16 a[76:77], v6 offset:32768
 v_mfma_f32_16x16x32_bf16 v[52:55], a[80:83], a[60:63], v[52:55]
 s_waitcnt lgkmcnt(9)
 ds_read_b64_tr_b16 a[78:79], v6 offset:33280
 v_mfma_f32_16x16x32_bf16 v[56:59], a[84:87], a[56:59], v[56:59]
 ds_read_b64_tr_b16 a[80:81], v7 offset:32768
 v_mfma_f32_16x16x32_bf16 v[60:63], a[84:87], a[60:63], v[60:63]
 s_waitcnt lgkmcnt(9)
 ds_read_b64_tr_b16 a[82:83], v7 offset:33280
 v_mfma_f32_16x16x32_bf16 v[64:67], a[88:91], a[56:59], v[64:67]
 s_waitcnt vmcnt(22)
 s_barrier
 ds_read_b64_tr_b16 a[84:85], v4 offset:36864
 v_mfma_f32_16x16x32_bf16 v[68:71], a[88:91], a[60:63], v[68:71]
 s_waitcnt lgkmcnt(9)
 ds_read_b64_tr_b16 a[86:87], v4 offset:37376
 s_add_u32 s78, s76, 512
 v_mfma_f32_16x16x32_bf16 v[72:75], a[92:95], a[56:59], v[72:75]
 s_add_u32 m0, s69, 0
 ds_read_b64_tr_b16 a[88:89], v5 offset:36864
 buffer_load_dwordx4 v23, s[24:27], s78 offen  lds
 v_mfma_f32_16x16x32_bf16 v[76:79], a[92:95], a[60:63], v[76:79]
 s_waitcnt lgkmcnt(9)
 ds_read_b64_tr_b16 a[90:91], v5 offset:37376
 v_mfma_f32_16x16x32_bf16 v[48:51], a[96:99], a[64:67], v[48:51]
 ds_read_b64_tr_b16 a[92:93], v6 offset:36864
 v_mfma_f32_16x16x32_bf16 v[52:55], a[96:99], a[68:71], v[52:55]
 s_waitcnt lgkmcnt(9)
 ds_read_b64_tr_b16 a[94:95], v6 offset:37376
 v_mfma_f32_16x16x32_bf16 v[56:59], a[72:75], a[64:67], v[56:59]
 ds_read_b64_tr_b16 a[96:97], v7 offset:36864
 v_mfma_f32_16x16x32_bf16 v[60:63], a[72:75], a[68:71], v[60:63]
 s_waitcnt lgkmcnt(9)
 ds_read_b64_tr_b16 a[98:99], v7 offset:37376
 s_add_u32 s78, s76, 37376
 v_mfma_f32_16x16x32_bf16 v[64:67], a[76:79], a[64:67], v[64:67]
 s_add_u32 m0, s69, 4096
 ds_read_b64_tr_b16 a[72:73], v4 offset:40960
 buffer_load_dwordx4 v23, s[24:27], s78 offen  lds
 v_mfma_f32_16x16x32_bf16 v[68:71], a[76:79], a[68:71], v[68:71]
 s_waitcnt lgkmcnt(9)
 ds_read_b64_tr_b16 a[74:75], v4 offset:41472
 v_mfma_f32_16x16x32_bf16 v[72:75], a[80:83], a[64:67], v[72:75]
 ds_read_b64_tr_b16 a[76:77], v5 offset:40960
 v_mfma_f32_16x16x32_bf16 v[76:79], a[80:83], a[68:71], v[76:79]
 s_waitcnt lgkmcnt(9)
 ds_read_b64_tr_b16 a[78:79], v5 offset:41472
 v_cvt_pk_bf16_f32 v40, v48, v49
 v_mfma_f32_16x16x32_bf16 v[80:83], a[84:87], a[0:3], 0
 ds_read_b64_tr_b16 a[80:81], v6 offset:40960
 v_cvt_pk_bf16_f32 v42, v56, v57
 v_mfma_f32_16x16x32_bf16 v[84:87], a[84:87], a[4:7], 0
 s_waitcnt lgkmcnt(9)
 ds_read_b64_tr_b16 a[82:83], v6 offset:41472
 s_add_u32 s78, s76, 74240
 v_mfma_f32_16x16x32_bf16 v[88:91], a[88:91], a[0:3], 0
 s_add_u32 m0, s69, 8192
 ds_read_b64_tr_b16 a[84:85], v7 offset:40960
 buffer_load_dwordx4 v23, s[24:27], s78 offen  lds
 v_mfma_f32_16x16x32_bf16 v[92:95], a[88:91], a[4:7], 0
 s_waitcnt lgkmcnt(9)
 ds_read_b64_tr_b16 a[86:87], v7 offset:41472
 v_cvt_pk_bf16_f32 v41, v50, v51
 v_mfma_f32_16x16x32_bf16 v[96:99], a[92:95], a[0:3], 0
 ds_read_b64_tr_b16 a[88:89], v4 offset:45056
 v_cvt_pk_bf16_f32 v43, v58, v59
 v_mfma_f32_16x16x32_bf16 v[100:103], a[92:95], a[4:7], 0
 s_waitcnt lgkmcnt(9)
 ds_read_b64_tr_b16 a[90:91], v4 offset:45568
 v_permlane16_swap_b32 v40, v42
 v_mfma_f32_16x16x32_bf16 v[104:107], a[96:99], a[0:3], 0
 ds_read_b64_tr_b16 a[92:93], v5 offset:45056
 v_permlane16_swap_b32 v41, v43
 v_mfma_f32_16x16x32_bf16 v[108:111], a[96:99], a[4:7], 0
 s_waitcnt lgkmcnt(9)
 ds_read_b64_tr_b16 a[94:95], v5 offset:45568
 s_add_u32 s78, s76, 111104
 v_mfma_f32_16x16x32_bf16 v[80:83], a[72:75], a[8:11], v[80:83]
 s_add_u32 m0, s69, 12288
 ds_read_b64_tr_b16 a[96:97], v6 offset:45056
 buffer_load_dwordx4 v23, s[24:27], s78 offen  lds
 v_mfma_f32_16x16x32_bf16 v[84:87], a[72:75], a[12:15], v[84:87]
 s_waitcnt lgkmcnt(9)
 ds_read_b64_tr_b16 a[98:99], v6 offset:45568
 v_mfma_f32_16x16x32_bf16 v[88:91], a[76:79], a[8:11], v[88:91]
 s_add_u32 s89, s85, 2048
 ds_read_b64_tr_b16 a[72:73], v7 offset:45056
 buffer_store_dwordx4 v[40:43], v24, s[36:39], s89 offen sc1
 v_mfma_f32_16x16x32_bf16 v[92:95], a[76:79], a[12:15], v[92:95]
 s_waitcnt lgkmcnt(9)
 ds_read_b64_tr_b16 a[74:75], v7 offset:45568
 v_mfma_f32_16x16x32_bf16 v[96:99], a[80:83], a[8:11], v[96:99]
 ds_read_b64_tr_b16 a[76:77], v4 offset:49152
 v_mfma_f32_16x16x32_bf16 v[100:103], a[80:83], a[12:15], v[100:103]
 s_waitcnt lgkmcnt(9)
 ds_read_b64_tr_b16 a[78:79], v4 offset:49664
 s_add_u32 s78, s76, 147968
 v_mfma_f32_16x16x32_bf16 v[104:107], a[84:87], a[8:11], v[104:107]
 s_add_u32 m0, s69, 16384
 ds_read_b64_tr_b16 a[80:81], v5 offset:49152
 buffer_load_dwordx4 v23, s[24:27], s78 offen  lds
 v_mfma_f32_16x16x32_bf16 v[108:111], a[84:87], a[12:15], v[108:111]
 s_waitcnt lgkmcnt(9)
 ds_read_b64_tr_b16 a[82:83], v5 offset:49664
 v_cvt_pk_bf16_f32 v44, v52, v53
 v_mfma_f32_16x16x32_bf16 v[80:83], a[88:91], a[16:19], v[80:83]
 ds_read_b64_tr_b16 a[84:85], v6 offset:49152
 v_cvt_pk_bf16_f32 v46, v60, v61
 v_mfma_f32_16x16x32_bf16 v[84:87], a[88:91], a[20:23], v[84:87]
 s_waitcnt lgkmcnt(9)
 ds_read_b64_tr_b16 a[86:87], v6 offset:49664
 v_cvt_pk_bf16_f32 v45, v54, v55
 v_mfma_f32_16x16x32_bf16 v[88:91], a[92:95], a[16:19], v[88:91]
 ds_read_b64_tr_b16 a[88:89], v7 offset:49152
 v_cvt_pk_bf16_f32 v47, v62, v63
 v_mfma_f32_16x16x32_bf16 v[92:95], a[92:95], a[20:23], v[92:95]
 s_waitcnt lgkmcnt(9)
 ds_read_b64_tr_b16 a[90:91], v7 offset:49664
 s_add_u32 s78, s76, 184832
 v_mfma_f32_16x16x32_bf16 v[96:99], a[96:99], a[16:19], v[96:99]
 s_add_u32 m0, s69, 20480
 ds_read_b64_tr_b16 a[92:93], v4 offset:53248
 buffer_load_dwordx4 v23, s[24:27], s78 offen  lds
 v_mfma_f32_16x16x32_bf16 v[100:103], a[96:99], a[20:23], v[100:103]
 s_waitcnt lgkmcnt(9)
 ds_read_b64_tr_b16 a[94:95], v4 offset:53760
 v_permlane16_swap_b32 v44, v46
 v_mfma_f32_16x16x32_bf16 v[104:107], a[72:75], a[16:19], v[104:107]
 ds_read_b64_tr_b16 a[96:97], v5 offset:53248
 v_permlane16_swap_b32 v45, v47
 v_mfma_f32_16x16x32_bf16 v[108:111], a[72:75], a[20:23], v[108:111]
 s_waitcnt lgkmcnt(9)
 ds_read_b64_tr_b16 a[98:99], v5 offset:53760
 v_mfma_f32_16x16x32_bf16 v[80:83], a[76:79], a[24:27], v[80:83]
 s_add_u32 s89, s85, 296960
 ds_read_b64_tr_b16 a[72:73], v6 offset:53248
 buffer_store_dwordx4 v[44:47], v24, s[36:39], s89 offen sc1
 v_mfma_f32_16x16x32_bf16 v[84:87], a[76:79], a[28:31], v[84:87]
 s_waitcnt lgkmcnt(9)
 ds_read_b64_tr_b16 a[74:75], v6 offset:53760
 v_mfma_f32_16x16x32_bf16 v[88:91], a[80:83], a[24:27], v[88:91]
 ds_read_b64_tr_b16 a[76:77], v7 offset:53248
 v_mfma_f32_16x16x32_bf16 v[92:95], a[80:83], a[28:31], v[92:95]
 s_waitcnt lgkmcnt(9)
 ds_read_b64_tr_b16 a[78:79], v7 offset:53760
 v_mfma_f32_16x16x32_bf16 v[96:99], a[84:87], a[24:27], v[96:99]
 ds_read_b64_tr_b16 a[80:81], v4 offset:57344
 v_mfma_f32_16x16x32_bf16 v[100:103], a[84:87], a[28:31], v[100:103]
 s_waitcnt lgkmcnt(9)
 ds_read_b64_tr_b16 a[82:83], v4 offset:57856
 v_mfma_f32_16x16x32_bf16 v[104:107], a[88:91], a[24:27], v[104:107]
 ds_read_b64_tr_b16 a[84:85], v5 offset:57344
 v_mfma_f32_16x16x32_bf16 v[108:111], a[88:91], a[28:31], v[108:111]
 s_waitcnt lgkmcnt(9)
 ds_read_b64_tr_b16 a[86:87], v5 offset:57856
 v_cvt_pk_bf16_f32 v28, v64, v65
 v_mfma_f32_16x16x32_bf16 v[80:83], a[92:95], a[32:35], v[80:83]
 ds_read_b64_tr_b16 a[88:89], v6 offset:57344
 v_cvt_pk_bf16_f32 v30, v72, v73
 v_mfma_f32_16x16x32_bf16 v[84:87], a[92:95], a[36:39], v[84:87]
 s_waitcnt lgkmcnt(9)
 ds_read_b64_tr_b16 a[90:91], v6 offset:57856
 v_cvt_pk_bf16_f32 v29, v66, v67
 v_mfma_f32_16x16x32_bf16 v[88:91], a[96:99], a[32:35], v[88:91]
 ds_read_b64_tr_b16 a[92:93], v7 offset:57344
 v_cvt_pk_bf16_f32 v31, v74, v75
 v_mfma_f32_16x16x32_bf16 v[92:95], a[96:99], a[36:39], v[92:95]
 s_waitcnt lgkmcnt(9)
 ds_read_b64_tr_b16 a[94:95], v7 offset:57856
 v_permlane16_swap_b32 v28, v30
 v_mfma_f32_16x16x32_bf16 v[96:99], a[72:75], a[32:35], v[96:99]
 s_waitcnt vmcnt(24)
 s_barrier
 ds_read_b64_tr_b16 a[96:97], v4 offset:61440
 v_permlane16_swap_b32 v29, v31
 v_mfma_f32_16x16x32_bf16 v[100:103], a[72:75], a[36:39], v[100:103]
 s_waitcnt lgkmcnt(9)
 ds_read_b64_tr_b16 a[98:99], v4 offset:61952
 s_add_u32 s78, s76, 221696
 v_mfma_f32_16x16x32_bf16 v[104:107], a[76:79], a[32:35], v[104:107]
 s_add_u32 m0, s69, 24576
 ds_read_b64_tr_b16 a[72:73], v5 offset:61440
 buffer_load_dwordx4 v23, s[24:27], s78 offen  lds
 v_mfma_f32_16x16x32_bf16 v[108:111], a[76:79], a[36:39], v[108:111]
 s_waitcnt lgkmcnt(9)
 ds_read_b64_tr_b16 a[74:75], v5 offset:61952
 v_mfma_f32_16x16x32_bf16 v[80:83], a[80:83], a[40:43], v[80:83]
 s_add_u32 s89, s85, 3072
 ds_read_b64_tr_b16 a[76:77], v6 offset:61440
 buffer_store_dwordx4 v[28:31], v24, s[36:39], s89 offen sc1
 v_mfma_f32_16x16x32_bf16 v[84:87], a[80:83], a[44:47], v[84:87]
 s_waitcnt lgkmcnt(9)
 ds_read_b64_tr_b16 a[78:79], v6 offset:61952
 v_mfma_f32_16x16x32_bf16 v[88:91], a[84:87], a[40:43], v[88:91]
 ds_read_b64_tr_b16 a[80:81], v7 offset:61440
 v_mfma_f32_16x16x32_bf16 v[92:95], a[84:87], a[44:47], v[92:95]
 s_waitcnt lgkmcnt(9)
 ds_read_b64_tr_b16 a[82:83], v7 offset:61952
 s_add_u32 s78, s76, 258560
 v_mfma_f32_16x16x32_bf16 v[96:99], a[88:91], a[40:43], v[96:99]
 s_add_u32 m0, s69, 28672
 ds_read_b64_tr_b16 a[84:85], v8 offset:0
 buffer_load_dwordx4 v23, s[24:27], s78 offen  lds
 v_mfma_f32_16x16x32_bf16 v[100:103], a[88:91], a[44:47], v[100:103]
 s_waitcnt lgkmcnt(9)
 ds_read_b64_tr_b16 a[86:87], v8 offset:512
 v_mfma_f32_16x16x32_bf16 v[104:107], a[92:95], a[40:43], v[104:107]
 ds_read_b64_tr_b16 a[88:89], v9 offset:0
 v_mfma_f32_16x16x32_bf16 v[108:111], a[92:95], a[44:47], v[108:111]
 s_waitcnt lgkmcnt(9)
 ds_read_b64_tr_b16 a[90:91], v9 offset:512
 v_cvt_pk_bf16_f32 v40, v68, v69
 v_mfma_f32_16x16x32_bf16 v[80:83], a[96:99], a[48:51], v[80:83]
 ds_read_b64_tr_b16 a[92:93], v10 offset:0
 v_cvt_pk_bf16_f32 v42, v76, v77
 v_mfma_f32_16x16x32_bf16 v[84:87], a[96:99], a[52:55], v[84:87]
 s_waitcnt lgkmcnt(9)
 ds_read_b64_tr_b16 a[94:95], v10 offset:512
 s_add_u32 s78, s77, 512
 v_mfma_f32_16x16x32_bf16 v[88:91], a[72:75], a[48:51], v[88:91]
 s_add_u32 m0, s69, 32768
 ds_read_b64_tr_b16 a[96:97], v11 offset:0
 buffer_load_dwordx4 v23, s[24:27], s78 offen  lds
 v_mfma_f32_16x16x32_bf16 v[92:95], a[72:75], a[52:55], v[92:95]
 s_waitcnt lgkmcnt(9)
 ds_read_b64_tr_b16 a[98:99], v11 offset:512
 v_cvt_pk_bf16_f32 v41, v70, v71
 v_mfma_f32_16x16x32_bf16 v[96:99], a[76:79], a[48:51], v[96:99]
 ds_read_b64_tr_b16 a[72:73], v8 offset:4096
 v_cvt_pk_bf16_f32 v43, v78, v79
 v_mfma_f32_16x16x32_bf16 v[100:103], a[76:79], a[52:55], v[100:103]
 s_waitcnt lgkmcnt(9)
 ds_read_b64_tr_b16 a[74:75], v8 offset:4608
 v_permlane16_swap_b32 v40, v42
 v_mfma_f32_16x16x32_bf16 v[104:107], a[80:83], a[48:51], v[104:107]
 ds_read_b64_tr_b16 a[76:77], v9 offset:4096
 v_permlane16_swap_b32 v41, v43
 v_mfma_f32_16x16x32_bf16 v[108:111], a[80:83], a[52:55], v[108:111]
 s_waitcnt lgkmcnt(9)
 ds_read_b64_tr_b16 a[78:79], v9 offset:4608
 s_add_u32 s78, s76, 640
 v_mfma_f32_16x16x32_bf16 v[80:83], a[84:87], a[56:59], v[80:83]
 s_add_u32 m0, s69, 36864
 ds_read_b64_tr_b16 a[80:81], v10 offset:4096
 buffer_load_dwordx4 v23, s[24:27], s78 offen  lds
 v_mfma_f32_16x16x32_bf16 v[84:87], a[84:87], a[60:63], v[84:87]
 s_waitcnt lgkmcnt(9)
 ds_read_b64_tr_b16 a[82:83], v10 offset:4608
 v_mfma_f32_16x16x32_bf16 v[88:91], a[88:91], a[56:59], v[88:91]
 s_add_u32 s89, s85, 297984
 ds_read_b64_tr_b16 a[84:85], v11 offset:4096
 buffer_store_dwordx4 v[40:43], v24, s[36:39], s89 offen sc1
 v_mfma_f32_16x16x32_bf16 v[92:95], a[88:91], a[60:63], v[92:95]
 s_waitcnt lgkmcnt(9)
 ds_read_b64_tr_b16 a[86:87], v11 offset:4608
 v_mfma_f32_16x16x32_bf16 v[96:99], a[92:95], a[56:59], v[96:99]
 ds_read_b64_tr_b16 a[88:89], v8 offset:8192
 v_mfma_f32_16x16x32_bf16 v[100:103], a[92:95], a[60:63], v[100:103]
 s_waitcnt lgkmcnt(9)
 ds_read_b64_tr_b16 a[90:91], v8 offset:8704
 s_add_u32 s78, s76, 37504
 v_mfma_f32_16x16x32_bf16 v[104:107], a[96:99], a[56:59], v[104:107]
 s_add_u32 m0, s69, 40960
 ds_read_b64_tr_b16 a[92:93], v9 offset:8192
 buffer_load_dwordx4 v23, s[24:27], s78 offen  lds
 v_mfma_f32_16x16x32_bf16 v[108:111], a[96:99], a[60:63], v[108:111]
 s_waitcnt lgkmcnt(9)
 ds_read_b64_tr_b16 a[94:95], v9 offset:8704
 v_mfma_f32_16x16x32_bf16 v[80:83], a[72:75], a[64:67], v[80:83]
 ds_read_b64_tr_b16 a[96:97], v10 offset:8192
 v_mfma_f32_16x16x32_bf16 v[84:87], a[72:75], a[68:71], v[84:87]
 s_waitcnt lgkmcnt(9)
 ds_read_b64_tr_b16 a[98:99], v10 offset:8704
 v_mfma_f32_16x16x32_bf16 v[88:91], a[76:79], a[64:67], v[88:91]
 ds_read_b64_tr_b16 a[72:73], v11 offset:8192
 v_mfma_f32_16x16x32_bf16 v[92:95], a[76:79], a[68:71], v[92:95]
 s_waitcnt lgkmcnt(9)
 ds_read_b64_tr_b16 a[74:75], v11 offset:8704
 s_add_u32 s78, s76, 74368
 v_mfma_f32_16x16x32_bf16 v[96:99], a[80:83], a[64:67], v[96:99]
 s_add_u32 m0, s69, 45056
 ds_read_b64_tr_b16 a[76:77], v8 offset:12288
 buffer_load_dwordx4 v23, s[24:27], s78 offen  lds
 v_mfma_f32_16x16x32_bf16 v[100:103], a[80:83], a[68:71], v[100:103]
 s_waitcnt lgkmcnt(9)
 ds_read_b64_tr_b16 a[78:79], v8 offset:12800
 v_mfma_f32_16x16x32_bf16 v[104:107], a[84:87], a[64:67], v[104:107]
 ds_read_b64_tr_b16 a[80:81], v9 offset:12288
 v_mfma_f32_16x16x32_bf16 v[108:111], a[84:87], a[68:71], v[108:111]
 s_waitcnt lgkmcnt(9)
 ds_read_b64_tr_b16 a[82:83], v9 offset:12800
 v_cvt_pk_bf16_f32 v44, v80, v81
 v_mfma_f32_16x16x32_bf16 v[48:51], a[88:91], a[0:3], 0
 ds_read_b64_tr_b16 a[84:85], v10 offset:12288
 v_cvt_pk_bf16_f32 v46, v88, v89
 v_mfma_f32_16x16x32_bf16 v[52:55], a[88:91], a[4:7], 0
 s_waitcnt lgkmcnt(9)
 ds_read_b64_tr_b16 a[86:87], v10 offset:12800
 v_cvt_pk_bf16_f32 v45, v82, v83
 v_mfma_f32_16x16x32_bf16 v[56:59], a[92:95], a[0:3], 0
 ds_read_b64_tr_b16 a[88:89], v11 offset:12288
 v_cvt_pk_bf16_f32 v47, v90, v91
 v_mfma_f32_16x16x32_bf16 v[60:63], a[92:95], a[4:7], 0
 s_waitcnt lgkmcnt(9)
 ds_read_b64_tr_b16 a[90:91], v11 offset:12800
 v_permlane16_swap_b32 v44, v46
 v_mfma_f32_16x16x32_bf16 v[64:67], a[96:99], a[0:3], 0
 ds_read_b64_tr_b16 a[92:93], v8 offset:16384
 v_permlane16_swap_b32 v45, v47
 v_mfma_f32_16x16x32_bf16 v[68:71], a[96:99], a[4:7], 0
 s_waitcnt lgkmcnt(9)
 ds_read_b64_tr_b16 a[94:95], v8 offset:16896
 v_mfma_f32_16x16x32_bf16 v[72:75], a[72:75], a[0:3], 0
 s_add_u32 s89, s85, 4096
 ds_read_b64_tr_b16 a[96:97], v9 offset:16384
 buffer_store_dwordx4 v[44:47], v24, s[36:39], s89 offen sc1
 v_mfma_f32_16x16x32_bf16 v[76:79], a[72:75], a[4:7], 0
 s_waitcnt lgkmcnt(9)
 ds_read_b64_tr_b16 a[98:99], v9 offset:16896
 v_mfma_f32_16x16x32_bf16 v[48:51], a[76:79], a[8:11], v[48:51]
 ds_read_b64_tr_b16 a[72:73], v10 offset:16384
 v_mfma_f32_16x16x32_bf16 v[52:55], a[76:79], a[12:15], v[52:55]
 s_waitcnt lgkmcnt(9)
 ds_read_b64_tr_b16 a[74:75], v10 offset:16896
 v_mfma_f32_16x16x32_bf16 v[56:59], a[80:83], a[8:11], v[56:59]
 ds_read_b64_tr_b16 a[76:77], v11 offset:16384
 v_mfma_f32_16x16x32_bf16 v[60:63], a[80:83], a[12:15], v[60:63]
 s_waitcnt lgkmcnt(9)
 ds_read_b64_tr_b16 a[78:79], v11 offset:16896
 v_mfma_f32_16x16x32_bf16 v[64:67], a[84:87], a[8:11], v[64:67]
 s_waitcnt vmcnt(18)
 s_barrier
 ds_read_b64_tr_b16 a[80:81], v8 offset:20480
 v_mfma_f32_16x16x32_bf16 v[68:71], a[84:87], a[12:15], v[68:71]
 s_waitcnt lgkmcnt(9)
 ds_read_b64_tr_b16 a[82:83], v8 offset:20992
 s_add_u32 s78, s76, 111232
 v_mfma_f32_16x16x32_bf16 v[72:75], a[88:91], a[8:11], v[72:75]
 s_add_u32 m0, s69, 49152
 ds_read_b64_tr_b16 a[84:85], v9 offset:20480
 buffer_load_dwordx4 v23, s[24:27], s78 offen  lds
 v_mfma_f32_16x16x32_bf16 v[76:79], a[88:91], a[12:15], v[76:79]
 s_waitcnt lgkmcnt(9)
 ds_read_b64_tr_b16 a[86:87], v9 offset:20992
 v_cvt_pk_bf16_f32 v28, v84, v85
 v_mfma_f32_16x16x32_bf16 v[48:51], a[92:95], a[16:19], v[48:51]
 s_and_b32 s79, s68, 1
 ds_read_b64_tr_b16 a[88:89], v10 offset:20480
 v_cvt_pk_bf16_f32 v30, v92, v93
 v_mfma_f32_16x16x32_bf16 v[52:55], a[92:95], a[20:23], v[52:55]
 s_waitcnt lgkmcnt(9)
 ds_read_b64_tr_b16 a[90:91], v10 offset:20992
 v_cvt_pk_bf16_f32 v29, v86, v87
 v_mfma_f32_16x16x32_bf16 v[56:59], a[96:99], a[16:19], v[56:59]
 s_cmp_eq_u32 s79, 0
 s_cselect_b64 s[48:49], -1, 0
 s_cselect_b64 s[50:51], 0, -1
 ds_read_b64_tr_b16 a[92:93], v11 offset:20480
 v_cvt_pk_bf16_f32 v31, v94, v95
 v_mfma_f32_16x16x32_bf16 v[60:63], a[96:99], a[20:23], v[60:63]
 s_waitcnt lgkmcnt(9)
 ds_read_b64_tr_b16 a[94:95], v11 offset:20992
 s_add_u32 s78, s76, 148096
 v_mfma_f32_16x16x32_bf16 v[64:67], a[72:75], a[16:19], v[64:67]
 s_add_u32 m0, s69, 53248
 ds_read_b64_tr_b16 a[96:97], v8 offset:24576
 buffer_load_dwordx4 v23, s[24:27], s78 offen  lds
 v_mfma_f32_16x16x32_bf16 v[68:71], a[72:75], a[20:23], v[68:71]
 s_waitcnt lgkmcnt(9)
 ds_read_b64_tr_b16 a[98:99], v8 offset:25088
 v_permlane16_swap_b32 v28, v30
 v_mfma_f32_16x16x32_bf16 v[72:75], a[76:79], a[16:19], v[72:75]
 s_mov_b32 vcc_lo, s48
 s_mov_b32 vcc_hi, 0
 ds_read_b64_tr_b16 a[72:73], v9 offset:24576
 v_permlane16_swap_b32 v29, v31
 v_mfma_f32_16x16x32_bf16 v[76:79], a[76:79], a[20:23], v[76:79]
 s_waitcnt lgkmcnt(9)
 ds_read_b64_tr_b16 a[74:75], v9 offset:25088
 v_cndmask_b32 v232, 0, v36, vcc
 v_mfma_f32_16x16x32_bf16 v[48:51], a[80:83], a[24:27], v[48:51]
 s_add_u32 s89, s85, 299008
 ds_read_b64_tr_b16 a[76:77], v10 offset:24576
 buffer_store_dwordx4 v[28:31], v24, s[36:39], s89 offen sc1
 v_mfma_f32_16x16x32_bf16 v[52:55], a[80:83], a[28:31], v[52:55]
 s_waitcnt lgkmcnt(9)
 ds_read_b64_tr_b16 a[78:79], v10 offset:25088
 s_add_u32 s78, s76, 184960
 v_mfma_f32_16x16x32_bf16 v[56:59], a[84:87], a[24:27], v[56:59]
 s_add_u32 m0, s69, 57344
 ds_read_b64_tr_b16 a[80:81], v11 offset:24576
 buffer_load_dwordx4 v23, s[24:27], s78 offen  lds
 v_mfma_f32_16x16x32_bf16 v[60:63], a[84:87], a[28:31], v[60:63]
 s_waitcnt lgkmcnt(9)
 ds_read_b64_tr_b16 a[82:83], v11 offset:25088
 v_mfma_f32_16x16x32_bf16 v[64:67], a[88:91], a[24:27], v[64:67]
 s_mov_b32 vcc_lo, s50
 s_mov_b32 vcc_hi, 0
 ds_read_b64_tr_b16 a[84:85], v8 offset:28672
 v_cndmask_b32 v233, 0, v36, vcc
 v_mfma_f32_16x16x32_bf16 v[68:71], a[88:91], a[28:31], v[68:71]
 s_waitcnt lgkmcnt(9)
 ds_read_b64_tr_b16 a[86:87], v8 offset:29184
 v_mfma_f32_16x16x32_bf16 v[72:75], a[92:95], a[24:27], v[72:75]
 s_mov_b32 vcc_lo, 0
 s_mov_b32 vcc_hi, s49
 ds_read_b64_tr_b16 a[88:89], v9 offset:28672
 v_cndmask_b32 v234, 0, v36, vcc
 v_mfma_f32_16x16x32_bf16 v[76:79], a[92:95], a[28:31], v[76:79]
 s_waitcnt lgkmcnt(9)
 ds_read_b64_tr_b16 a[90:91], v9 offset:29184
 s_add_u32 s78, s76, 221824
 v_mfma_f32_16x16x32_bf16 v[48:51], a[96:99], a[32:35], v[48:51]
 s_add_u32 m0, s69, 61440
 ds_read_b64_tr_b16 a[92:93], v10 offset:28672
 buffer_load_dwordx4 v23, s[24:27], s78 offen  lds
 v_mfma_f32_16x16x32_bf16 v[52:55], a[96:99], a[36:39], v[52:55]
 s_waitcnt lgkmcnt(9)
 ds_read_b64_tr_b16 a[94:95], v10 offset:29184
 v_cvt_pk_bf16_f32 v40, v96, v97
 v_mfma_f32_16x16x32_bf16 v[56:59], a[72:75], a[32:35], v[56:59]
 s_mov_b32 vcc_lo, 0
 s_mov_b32 vcc_hi, s51
 ds_read_b64_tr_b16 a[96:97], v11 offset:28672
 v_cvt_pk_bf16_f32 v42, v104, v105
 v_mfma_f32_16x16x32_bf16 v[60:63], a[72:75], a[36:39], v[60:63]
 s_waitcnt lgkmcnt(9)
 ds_read_b64_tr_b16 a[98:99], v11 offset:29184
 v_cvt_pk_bf16_f32 v41, v98, v99
 v_mfma_f32_16x16x32_bf16 v[64:67], a[76:79], a[32:35], v[64:67]
 ds_read_b64_tr_b16 a[72:73], v8 offset:32768
 v_cvt_pk_bf16_f32 v43, v106, v107
 v_mfma_f32_16x16x32_bf16 v[68:71], a[76:79], a[36:39], v[68:71]
 s_waitcnt lgkmcnt(9)
 ds_read_b64_tr_b16 a[74:75], v8 offset:33280
 s_add_u32 s78, s76, 258688
 v_mfma_f32_16x16x32_bf16 v[72:75], a[80:83], a[32:35], v[72:75]
 s_add_u32 m0, s69, 65536
 ds_read_b64_tr_b16 a[76:77], v9 offset:32768
 buffer_load_dwordx4 v23, s[24:27], s78 offen  lds
 v_mfma_f32_16x16x32_bf16 v[76:79], a[80:83], a[36:39], v[76:79]
 s_waitcnt lgkmcnt(9)
 ds_read_b64_tr_b16 a[78:79], v9 offset:33280
 v_permlane16_swap_b32 v40, v42
 v_mfma_f32_16x16x32_bf16 v[48:51], a[84:87], a[40:43], v[48:51]
 ds_read_b64_tr_b16 a[80:81], v10 offset:32768
 v_permlane16_swap_b32 v41, v43
 v_mfma_f32_16x16x32_bf16 v[52:55], a[84:87], a[44:47], v[52:55]
 s_waitcnt lgkmcnt(9)
 ds_read_b64_tr_b16 a[82:83], v10 offset:33280
 v_mov_b32 v192, 0
 v_mfma_f32_16x16x32_bf16 v[56:59], a[88:91], a[40:43], v[56:59]
 s_add_u32 s89, s85, 5120
 ds_read_b64_tr_b16 a[84:85], v11 offset:32768
 buffer_store_dwordx4 v[40:43], v24, s[36:39], s89 offen sc1
 v_mfma_f32_16x16x32_bf16 v[60:63], a[88:91], a[44:47], v[60:63]
 s_waitcnt lgkmcnt(9)
 ds_read_b64_tr_b16 a[86:87], v11 offset:33280
 s_add_u32 s78, s77, 640
 v_mfma_f32_16x16x32_bf16 v[64:67], a[92:95], a[40:43], v[64:67]
 s_add_u32 m0, s69, 69632
 ds_read_b64_tr_b16 a[88:89], v8 offset:36864
 buffer_load_dwordx4 v23, s[24:27], s78 offen  lds
 v_mfma_f32_16x16x32_bf16 v[68:71], a[92:95], a[44:47], v[68:71]
 s_waitcnt lgkmcnt(9)
 ds_read_b64_tr_b16 a[90:91], v8 offset:37376
 v_mov_b32 v193, 0
 v_mfma_f32_16x16x32_bf16 v[72:75], a[96:99], a[40:43], v[72:75]
 ds_read_b64_tr_b16 a[92:93], v9 offset:36864
 v_mov_b32 v194, 0
 v_mfma_f32_16x16x32_bf16 v[76:79], a[96:99], a[44:47], v[76:79]
 s_waitcnt lgkmcnt(9)
 ds_read_b64_tr_b16 a[94:95], v9 offset:37376
 v_cvt_pk_bf16_f32 v44, v100, v101
 v_mfma_f32_16x16x32_bf16 v[48:51], a[72:75], a[48:51], v[48:51]
 ds_read_b64_tr_b16 a[96:97], v10 offset:36864
 v_cvt_pk_bf16_f32 v46, v108, v109
 v_mfma_f32_16x16x32_bf16 v[52:55], a[72:75], a[52:55], v[52:55]
 s_waitcnt lgkmcnt(9)
 ds_read_b64_tr_b16 a[98:99], v10 offset:37376
 v_cvt_pk_bf16_f32 v45, v102, v103
 v_mfma_f32_16x16x32_bf16 v[56:59], a[76:79], a[48:51], v[56:59]
 ds_read_b64_tr_b16 a[72:73], v11 offset:36864
 v_cvt_pk_bf16_f32 v47, v110, v111
 v_mfma_f32_16x16x32_bf16 v[60:63], a[76:79], a[52:55], v[60:63]
 s_waitcnt lgkmcnt(9)
 ds_read_b64_tr_b16 a[74:75], v11 offset:37376
 v_permlane16_swap_b32 v44, v46
 v_mfma_f32_16x16x32_bf16 v[64:67], a[80:83], a[48:51], v[64:67]
 ds_read_b64_tr_b16 a[76:77], v8 offset:40960
 v_permlane16_swap_b32 v45, v47
 v_mfma_f32_16x16x32_bf16 v[68:71], a[80:83], a[52:55], v[68:71]
 s_waitcnt lgkmcnt(9)
 ds_read_b64_tr_b16 a[78:79], v8 offset:41472
 v_mov_b32 v195, 0
 v_mfma_f32_16x16x32_bf16 v[72:75], a[84:87], a[48:51], v[72:75]
 s_add_u32 s89, s85, 300032
 ds_read_b64_tr_b16 a[80:81], v9 offset:40960
 buffer_store_dwordx4 v[44:47], v24, s[36:39], s89 offen sc1
 v_mfma_f32_16x16x32_bf16 v[76:79], a[84:87], a[52:55], v[76:79]
 s_waitcnt lgkmcnt(9)
 ds_read_b64_tr_b16 a[82:83], v9 offset:41472
 v_mov_b32 v196, 0
 v_mfma_f32_16x16x32_bf16 v[48:51], a[88:91], a[56:59], v[48:51]
 ds_read_b64_tr_b16 a[84:85], v10 offset:40960
 v_mov_b32 v197, 0
 v_mfma_f32_16x16x32_bf16 v[52:55], a[88:91], a[60:63], v[52:55]
 s_waitcnt lgkmcnt(9)
 ds_read_b64_tr_b16 a[86:87], v10 offset:41472
 v_mov_b32 v198, 0
 v_mfma_f32_16x16x32_bf16 v[56:59], a[92:95], a[56:59], v[56:59]
 ds_read_b64_tr_b16 a[88:89], v11 offset:40960
 v_mov_b32 v199, 0
 v_mfma_f32_16x16x32_bf16 v[60:63], a[92:95], a[60:63], v[60:63]
 s_waitcnt lgkmcnt(9)
 ds_read_b64_tr_b16 a[90:91], v11 offset:41472
 v_mov_b32 v200, 0
 v_mfma_f32_16x16x32_bf16 v[64:67], a[96:99], a[56:59], v[64:67]
 s_waitcnt vmcnt(19)
 s_barrier
 ds_read_b64_tr_b16 a[92:93], v4 offset:0
 v_mov_b32 v201, 0
 v_mfma_f32_16x16x32_bf16 v[68:71], a[96:99], a[60:63], v[68:71]
 s_waitcnt lgkmcnt(9)
 ds_read_b64_tr_b16 a[94:95], v4 offset:512
 s_add_u32 s78, s76, 768
 v_mfma_f32_16x16x32_bf16 v[72:75], a[72:75], a[56:59], v[72:75]
 s_add_u32 m0, s69, 73728
 ds_read_b64_tr_b16 a[96:97], v5 offset:0
 buffer_load_dwordx4 v23, s[24:27], s78 offen  lds
 v_mfma_f32_16x16x32_bf16 v[76:79], a[72:75], a[60:63], v[76:79]
 s_waitcnt lgkmcnt(9)
 ds_read_b64_tr_b16 a[98:99], v5 offset:512
 v_mov_b32 v202, 0
 v_mfma_f32_16x16x32_bf16 v[48:51], a[76:79], a[64:67], v[48:51]
 ds_read_b64_tr_b16 a[72:73], v6 offset:0
 v_mov_b32 v203, 0
 v_mfma_f32_16x16x32_bf16 v[52:55], a[76:79], a[68:71], v[52:55]
 s_waitcnt lgkmcnt(9)
 ds_read_b64_tr_b16 a[74:75], v6 offset:512
 v_mov_b32 v204, 0
 v_mfma_f32_16x16x32_bf16 v[56:59], a[80:83], a[64:67], v[56:59]
 ds_read_b64_tr_b16 a[76:77], v7 offset:0
 v_mov_b32 v205, 0
 v_mfma_f32_16x16x32_bf16 v[60:63], a[80:83], a[68:71], v[60:63]
 s_waitcnt lgkmcnt(9)
 ds_read_b64_tr_b16 a[78:79], v7 offset:512
 s_add_u32 s78, s76, 37632
 v_mfma_f32_16x16x32_bf16 v[64:67], a[84:87], a[64:67], v[64:67]
 s_add_u32 m0, s69, 77824
 ds_read_b64_tr_b16 a[80:81], v4 offset:4096
 buffer_load_dwordx4 v23, s[24:27], s78 offen  lds
 v_mfma_f32_16x16x32_bf16 v[68:71], a[84:87], a[68:71], v[68:71]
 s_waitcnt lgkmcnt(9)
 ds_read_b64_tr_b16 a[82:83], v4 offset:4608
 v_mov_b32 v206, 0
 v_mfma_f32_16x16x32_bf16 v[72:75], a[88:91], a[64:67], v[72:75]
 ds_read_b64_tr_b16 a[84:85], v5 offset:4096
 v_mov_b32 v207, 0
 v_mfma_f32_16x16x32_bf16 v[76:79], a[88:91], a[68:71], v[76:79]
 s_waitcnt lgkmcnt(9)
 ds_read_b64_tr_b16 a[86:87], v5 offset:4608
 v_cvt_pk_bf16_f32 v28, v48, v49
 v_mfma_f32_16x16x32_bf16 v[80:83], a[92:95], a[0:3], 0
 ds_read_b64_tr_b16 a[88:89], v6 offset:4096
 v_cvt_pk_bf16_f32 v30, v56, v57
 v_mfma_f32_16x16x32_bf16 v[84:87], a[92:95], a[4:7], 0
 s_waitcnt lgkmcnt(9)
 ds_read_b64_tr_b16 a[90:91], v6 offset:4608
 s_add_u32 s78, s76, 74496
 v_mfma_f32_16x16x32_bf16 v[88:91], a[96:99], a[0:3], 0
 s_add_u32 m0, s69, 81920
 ds_read_b64_tr_b16 a[92:93], v7 offset:4096
 buffer_load_dwordx4 v23, s[24:27], s78 offen  lds
 v_mfma_f32_16x16x32_bf16 v[92:95], a[96:99], a[4:7], 0
 s_waitcnt lgkmcnt(9)
 ds_read_b64_tr_b16 a[94:95], v7 offset:4608
 v_cvt_pk_bf16_f32 v29, v50, v51
 v_mfma_f32_16x16x32_bf16 v[96:99], a[72:75], a[0:3], 0
 ds_read_b64_tr_b16 a[96:97], v4 offset:8192
 v_cvt_pk_bf16_f32 v31, v58, v59
 v_mfma_f32_16x16x32_bf16 v[100:103], a[72:75], a[4:7], 0
 s_waitcnt lgkmcnt(9)
 ds_read_b64_tr_b16 a[98:99], v4 offset:8704
 v_permlane16_swap_b32 v28, v30
 v_mfma_f32_16x16x32_bf16 v[104:107], a[76:79], a[0:3], 0
 ds_read_b64_tr_b16 a[72:73], v5 offset:8192
 v_permlane16_swap_b32 v29, v31
 v_mfma_f32_16x16x32_bf16 v[108:111], a[76:79], a[4:7], 0
 s_waitcnt lgkmcnt(9)
 ds_read_b64_tr_b16 a[74:75], v5 offset:8704
 s_add_u32 s78, s76, 111360
 v_mfma_f32_16x16x32_bf16 v[80:83], a[80:83], a[8:11], v[80:83]
 s_add_u32 m0, s69, 86016
 ds_read_b64_tr_b16 a[76:77], v6 offset:8192
 buffer_load_dwordx4 v23, s[24:27], s78 offen  lds
 v_mfma_f32_16x16x32_bf16 v[84:87], a[80:83], a[12:15], v[84:87]
 s_waitcnt lgkmcnt(9)
 ds_read_b64_tr_b16 a[78:79], v6 offset:8704
 v_mov_b32 v208, 0
 v_mfma_f32_16x16x32_bf16 v[88:91], a[84:87], a[8:11], v[88:91]
 s_add_u32 s89, s85, 6144
 ds_read_b64_tr_b16 a[80:81], v7 offset:8192
 buffer_store_dwordx4 v[28:31], v24, s[36:39], s89 offen sc1
 v_mfma_f32_16x16x32_bf16 v[92:95], a[84:87], a[12:15], v[92:95]
 s_waitcnt lgkmcnt(9)
 ds_read_b64_tr_b16 a[82:83], v7 offset:8704
 v_mov_b32 v209, 0
 v_mfma_f32_16x16x32_bf16 v[96:99], a[88:91], a[8:11], v[96:99]
 ds_read_b64_tr_b16 a[84:85], v4 offset:12288
 v_mov_b32 v210, 0
 v_mfma_f32_16x16x32_bf16 v[100:103], a[88:91], a[12:15], v[100:103]
 s_waitcnt lgkmcnt(9)
 ds_read_b64_tr_b16 a[86:87], v4 offset:12800
 s_add_u32 s78, s76, 148224
 v_mfma_f32_16x16x32_bf16 v[104:107], a[92:95], a[8:11], v[104:107]
 s_add_u32 m0, s69, 90112
 ds_read_b64_tr_b16 a[88:89], v5 offset:12288
 buffer_load_dwordx4 v23, s[24:27], s78 offen  lds
 v_mfma_f32_16x16x32_bf16 v[108:111], a[92:95], a[12:15], v[108:111]
 s_waitcnt lgkmcnt(9)
 ds_read_b64_tr_b16 a[90:91], v5 offset:12800
 v_cvt_pk_bf16_f32 v40, v52, v53
 v_mfma_f32_16x16x32_bf16 v[80:83], a[96:99], a[16:19], v[80:83]
 ds_read_b64_tr_b16 a[92:93], v6 offset:12288
 v_cvt_pk_bf16_f32 v42, v60, v61
 v_mfma_f32_16x16x32_bf16 v[84:87], a[96:99], a[20:23], v[84:87]
 s_waitcnt lgkmcnt(9)
 ds_read_b64_tr_b16 a[94:95], v6 offset:12800
 v_cvt_pk_bf16_f32 v41, v54, v55
 v_mfma_f32_16x16x32_bf16 v[88:91], a[72:75], a[16:19], v[88:91]
 ds_read_b64_tr_b16 a[96:97], v7 offset:12288
 v_cvt_pk_bf16_f32 v43, v62, v63
 v_mfma_f32_16x16x32_bf16 v[92:95], a[72:75], a[20:23], v[92:95]
 s_waitcnt lgkmcnt(9)
 ds_read_b64_tr_b16 a[98:99], v7 offset:12800
 s_add_u32 s78, s76, 185088
 v_mfma_f32_16x16x32_bf16 v[96:99], a[76:79], a[16:19], v[96:99]
 s_add_u32 m0, s69, 94208
 ds_read_b64_tr_b16 a[72:73], v4 offset:16384
 buffer_load_dwordx4 v23, s[24:27], s78 offen  lds
 v_mfma_f32_16x16x32_bf16 v[100:103], a[76:79], a[20:23], v[100:103]
 s_waitcnt lgkmcnt(9)
 ds_read_b64_tr_b16 a[74:75], v4 offset:16896
 v_permlane16_swap_b32 v40, v42
 v_mfma_f32_16x16x32_bf16 v[104:107], a[80:83], a[16:19], v[104:107]
 ds_read_b64_tr_b16 a[76:77], v5 offset:16384
 v_permlane16_swap_b32 v41, v43
 v_mfma_f32_16x16x32_bf16 v[108:111], a[80:83], a[20:23], v[108:111]
 s_waitcnt lgkmcnt(9)
 ds_read_b64_tr_b16 a[78:79], v5 offset:16896
 v_mov_b32 v211, 0
 v_mfma_f32_16x16x32_bf16 v[80:83], a[84:87], a[24:27], v[80:83]
 s_add_u32 s89, s85, 301056
 ds_read_b64_tr_b16 a[80:81], v6 offset:16384
 buffer_store_dwordx4 v[40:43], v24, s[36:39], s89 offen sc1
 v_mfma_f32_16x16x32_bf16 v[84:87], a[84:87], a[28:31], v[84:87]
 s_waitcnt lgkmcnt(9)
 ds_read_b64_tr_b16 a[82:83], v6 offset:16896
 v_mov_b32 v212, 0
 v_mfma_f32_16x16x32_bf16 v[88:91], a[88:91], a[24:27], v[88:91]
 ds_read_b64_tr_b16 a[84:85], v7 offset:16384
 v_mov_b32 v213, 0
 v_mfma_f32_16x16x32_bf16 v[92:95], a[88:91], a[28:31], v[92:95]
 s_waitcnt lgkmcnt(9)
 ds_read_b64_tr_b16 a[86:87], v7 offset:16896
 v_mov_b32 v214, 0
 v_mfma_f32_16x16x32_bf16 v[96:99], a[92:95], a[24:27], v[96:99]
 ds_read_b64_tr_b16 a[88:89], v4 offset:20480
 v_mov_b32 v215, 0
 v_mfma_f32_16x16x32_bf16 v[100:103], a[92:95], a[28:31], v[100:103]
 s_waitcnt lgkmcnt(9)
 ds_read_b64_tr_b16 a[90:91], v4 offset:20992
 v_mov_b32 v216, 0
 v_mfma_f32_16x16x32_bf16 v[104:107], a[96:99], a[24:27], v[104:107]
 ds_read_b64_tr_b16 a[92:93], v5 offset:20480
 v_mov_b32 v217, 0
 v_mfma_f32_16x16x32_bf16 v[108:111], a[96:99], a[28:31], v[108:111]
 s_waitcnt lgkmcnt(9)
 ds_read_b64_tr_b16 a[94:95], v5 offset:20992
 v_cvt_pk_bf16_f32 v44, v64, v65
 v_mfma_f32_16x16x32_bf16 v[80:83], a[72:75], a[32:35], v[80:83]
 ds_read_b64_tr_b16 a[96:97], v6 offset:20480
 v_cvt_pk_bf16_f32 v46, v72, v73
 v_mfma_f32_16x16x32_bf16 v[84:87], a[72:75], a[36:39], v[84:87]
 s_waitcnt lgkmcnt(9)
 ds_read_b64_tr_b16 a[98:99], v6 offset:20992
 v_cvt_pk_bf16_f32 v45, v66, v67
 v_mfma_f32_16x16x32_bf16 v[88:91], a[76:79], a[32:35], v[88:91]
 ds_read_b64_tr_b16 a[72:73], v7 offset:20480
 v_cvt_pk_bf16_f32 v47, v74, v75
 v_mfma_f32_16x16x32_bf16 v[92:95], a[76:79], a[36:39], v[92:95]
 s_waitcnt lgkmcnt(9)
 ds_read_b64_tr_b16 a[74:75], v7 offset:20992
 v_permlane16_swap_b32 v44, v46
 v_mfma_f32_16x16x32_bf16 v[96:99], a[80:83], a[32:35], v[96:99]
 s_waitcnt vmcnt(18)
 s_barrier
 ds_read_b64_tr_b16 a[76:77], v4 offset:24576
 v_permlane16_swap_b32 v45, v47
 v_mfma_f32_16x16x32_bf16 v[100:103], a[80:83], a[36:39], v[100:103]
 s_waitcnt lgkmcnt(9)
 ds_read_b64_tr_b16 a[78:79], v4 offset:25088
 s_add_u32 s78, s76, 221952
 v_mfma_f32_16x16x32_bf16 v[104:107], a[84:87], a[32:35], v[104:107]
 s_add_u32 m0, s69, 98304
 ds_read_b64_tr_b16 a[80:81], v5 offset:24576
 buffer_load_dwordx4 v23, s[24:27], s78 offen  lds
 v_mfma_f32_16x16x32_bf16 v[108:111], a[84:87], a[36:39], v[108:111]
 s_waitcnt lgkmcnt(9)
 ds_read_b64_tr_b16 a[82:83], v5 offset:25088
 v_mov_b32 v218, 0
 v_mfma_f32_16x16x32_bf16 v[80:83], a[88:91], a[40:43], v[80:83]
 s_add_u32 s89, s85, 7168
 ds_read_b64_tr_b16 a[84:85], v6 offset:24576
 buffer_store_dwordx4 v[44:47], v24, s[36:39], s89 offen sc1
 v_mfma_f32_16x16x32_bf16 v[84:87], a[88:91], a[44:47], v[84:87]
 s_waitcnt lgkmcnt(9)
 ds_read_b64_tr_b16 a[86:87], v6 offset:25088
 v_mov_b32 v219, 0
 v_mfma_f32_16x16x32_bf16 v[88:91], a[92:95], a[40:43], v[88:91]
 ds_read_b64_tr_b16 a[88:89], v7 offset:24576
 v_mov_b32 v220, 0
 v_mfma_f32_16x16x32_bf16 v[92:95], a[92:95], a[44:47], v[92:95]
 s_waitcnt lgkmcnt(9)
 ds_read_b64_tr_b16 a[90:91], v7 offset:25088
 s_add_u32 s78, s76, 258816
 v_mfma_f32_16x16x32_bf16 v[96:99], a[96:99], a[40:43], v[96:99]
 s_add_u32 m0, s69, 102400
 ds_read_b64_tr_b16 a[92:93], v4 offset:28672
 buffer_load_dwordx4 v23, s[24:27], s78 offen  lds
 v_mfma_f32_16x16x32_bf16 v[100:103], a[96:99], a[44:47], v[100:103]
 s_waitcnt lgkmcnt(9)
 ds_read_b64_tr_b16 a[94:95], v4 offset:29184
 v_mov_b32 v221, 0
 v_mfma_f32_16x16x32_bf16 v[104:107], a[72:75], a[40:43], v[104:107]
 ds_read_b64_tr_b16 a[96:97], v5 offset:28672
 v_mov_b32 v222, 0
 v_mfma_f32_16x16x32_bf16 v[108:111], a[72:75], a[44:47], v[108:111]
 s_waitcnt lgkmcnt(9)
 ds_read_b64_tr_b16 a[98:99], v5 offset:29184
 v_cvt_pk_bf16_f32 v28, v68, v69
 v_mfma_f32_16x16x32_bf16 v[80:83], a[76:79], a[48:51], v[80:83]
 ds_read_b64_tr_b16 a[72:73], v6 offset:28672
 v_cvt_pk_bf16_f32 v30, v76, v77
 v_mfma_f32_16x16x32_bf16 v[84:87], a[76:79], a[52:55], v[84:87]
 s_waitcnt lgkmcnt(9)
 ds_read_b64_tr_b16 a[74:75], v6 offset:29184
 s_add_u32 s78, s77, 768
 v_mfma_f32_16x16x32_bf16 v[88:91], a[80:83], a[48:51], v[88:91]
 s_add_u32 m0, s69, 106496
 ds_read_b64_tr_b16 a[76:77], v7 offset:28672
 buffer_load_dwordx4 v23, s[24:27], s78 offen  lds
 v_mfma_f32_16x16x32_bf16 v[92:95], a[80:83], a[52:55], v[92:95]
 s_waitcnt lgkmcnt(9)
 ds_read_b64_tr_b16 a[78:79], v7 offset:29184
 v_cvt_pk_bf16_f32 v29, v70, v71
 v_mfma_f32_16x16x32_bf16 v[96:99], a[84:87], a[48:51], v[96:99]
 ds_read_b64_tr_b16 a[80:81], v4 offset:32768
 v_cvt_pk_bf16_f32 v31, v78, v79
 v_mfma_f32_16x16x32_bf16 v[100:103], a[84:87], a[52:55], v[100:103]
 s_waitcnt lgkmcnt(9)
 ds_read_b64_tr_b16 a[82:83], v4 offset:33280
 v_permlane16_swap_b32 v28, v30
 v_mfma_f32_16x16x32_bf16 v[104:107], a[88:91], a[48:51], v[104:107]
 ds_read_b64_tr_b16 a[84:85], v5 offset:32768
 v_permlane16_swap_b32 v29, v31
 v_mfma_f32_16x16x32_bf16 v[108:111], a[88:91], a[52:55], v[108:111]
 s_waitcnt lgkmcnt(9)
 ds_read_b64_tr_b16 a[86:87], v5 offset:33280
 s_add_u32 s78, s76, 896
 v_mfma_f32_16x16x32_bf16 v[80:83], a[92:95], a[56:59], v[80:83]
 s_add_u32 m0, s69, 0
 ds_read_b64_tr_b16 a[88:89], v6 offset:32768
 buffer_load_dwordx4 v23, s[24:27], s78 offen  lds
 v_mfma_f32_16x16x32_bf16 v[84:87], a[92:95], a[60:63], v[84:87]
 s_waitcnt lgkmcnt(9)
 ds_read_b64_tr_b16 a[90:91], v6 offset:33280
 v_mov_b32 v223, 0
 v_mfma_f32_16x16x32_bf16 v[88:91], a[96:99], a[56:59], v[88:91]
 s_add_u32 s89, s85, 302080
 ds_read_b64_tr_b16 a[92:93], v7 offset:32768
 buffer_store_dwordx4 v[28:31], v24, s[36:39], s89 offen sc1
 v_mfma_f32_16x16x32_bf16 v[92:95], a[96:99], a[60:63], v[92:95]
 s_waitcnt lgkmcnt(9)
 ds_read_b64_tr_b16 a[94:95], v7 offset:33280
 v_cndmask_b32 v235, 0, v36, vcc
 v_mfma_f32_16x16x32_bf16 v[96:99], a[72:75], a[56:59], v[96:99]
 s_mov_b32 vcc_lo, s48
 s_mov_b32 vcc_hi, 0
 ds_read_b64_tr_b16 a[96:97], v4 offset:36864
 v_cndmask_b32 v236, 0, v37, vcc
 v_mfma_f32_16x16x32_bf16 v[100:103], a[72:75], a[60:63], v[100:103]
 s_waitcnt lgkmcnt(9)
 ds_read_b64_tr_b16 a[98:99], v4 offset:37376
 s_add_u32 s78, s76, 37760
 v_mfma_f32_16x16x32_bf16 v[104:107], a[76:79], a[56:59], v[104:107]
 s_add_u32 m0, s69, 4096
 ds_read_b64_tr_b16 a[72:73], v5 offset:36864
 buffer_load_dwordx4 v23, s[24:27], s78 offen  lds
 v_mfma_f32_16x16x32_bf16 v[108:111], a[76:79], a[60:63], v[108:111]
 s_waitcnt lgkmcnt(9)
 ds_read_b64_tr_b16 a[74:75], v5 offset:37376
 v_mfma_f32_16x16x32_bf16 v[80:83], a[80:83], a[64:67], v[80:83]
L_cp3:
 s_add_u32 s84, s82, L_cp3-parallel_sum__mha_block__glu_gated_bilinear__prompt_kernel+8192
 ds_read_b64_tr_b16 a[76:77], v6 offset:36864
 buffer_load_dword a247, off, s[44:47], s84
 v_mfma_f32_16x16x32_bf16 v[84:87], a[80:83], a[68:71], v[84:87]
 s_waitcnt lgkmcnt(9)
 ds_read_b64_tr_b16 a[78:79], v6 offset:37376
 v_mfma_f32_16x16x32_bf16 v[88:91], a[84:87], a[64:67], v[88:91]
 s_mov_b32 vcc_lo, s50
 s_mov_b32 vcc_hi, 0
 ds_read_b64_tr_b16 a[80:81], v7 offset:36864
 v_cndmask_b32 v237, 0, v37, vcc
 v_mfma_f32_16x16x32_bf16 v[92:95], a[84:87], a[68:71], v[92:95]
 s_waitcnt lgkmcnt(9)
 ds_read_b64_tr_b16 a[82:83], v7 offset:37376
 s_add_u32 s78, s76, 74624
 v_mfma_f32_16x16x32_bf16 v[96:99], a[88:91], a[64:67], v[96:99]
 s_add_u32 m0, s69, 8192
 ds_read_b64_tr_b16 a[84:85], v4 offset:40960
 buffer_load_dwordx4 v23, s[24:27], s78 offen  lds
 v_mfma_f32_16x16x32_bf16 v[100:103], a[88:91], a[68:71], v[100:103]
 s_waitcnt lgkmcnt(9)
 ds_read_b64_tr_b16 a[86:87], v4 offset:41472
 v_mfma_f32_16x16x32_bf16 v[104:107], a[92:95], a[64:67], v[104:107]
 s_mov_b32 vcc_lo, 0
 s_mov_b32 vcc_hi, s49
 ds_read_b64_tr_b16 a[88:89], v5 offset:40960
 v_cndmask_b32 v238, 0, v37, vcc
 v_mfma_f32_16x16x32_bf16 v[108:111], a[92:95], a[68:71], v[108:111]
 s_waitcnt lgkmcnt(9)
 ds_read_b64_tr_b16 a[90:91], v5 offset:41472
 v_cvt_pk_bf16_f32 v40, v80, v81
 v_mfma_f32_16x16x32_bf16 v[48:51], a[96:99], a[0:3], 0
 s_mov_b32 vcc_lo, 0
 s_mov_b32 vcc_hi, s51
 ds_read_b64_tr_b16 a[92:93], v6 offset:40960
 v_cvt_pk_bf16_f32 v42, v88, v89
 v_mfma_f32_16x16x32_bf16 v[52:55], a[96:99], a[4:7], 0
 s_waitcnt lgkmcnt(9)
 ds_read_b64_tr_b16 a[94:95], v6 offset:41472
 v_cvt_pk_bf16_f32 v41, v82, v83
 v_mfma_f32_16x16x32_bf16 v[56:59], a[72:75], a[0:3], 0
 ds_read_b64_tr_b16 a[96:97], v7 offset:40960
 v_cvt_pk_bf16_f32 v43, v90, v91
 v_mfma_f32_16x16x32_bf16 v[60:63], a[72:75], a[4:7], 0
 s_waitcnt lgkmcnt(9)
 ds_read_b64_tr_b16 a[98:99], v7 offset:41472
 v_permlane16_swap_b32 v40, v42
 v_mfma_f32_16x16x32_bf16 v[64:67], a[76:79], a[0:3], 0
 ds_read_b64_tr_b16 a[72:73], v4 offset:45056
 v_permlane16_swap_b32 v41, v43
 v_mfma_f32_16x16x32_bf16 v[68:71], a[76:79], a[4:7], 0
 s_waitcnt lgkmcnt(9)
 ds_read_b64_tr_b16 a[74:75], v4 offset:45568
 v_cndmask_b32 v239, 0, v37, vcc
 v_mfma_f32_16x16x32_bf16 v[72:75], a[80:83], a[0:3], 0
 s_add_u32 s89, s85, 8192
 ds_read_b64_tr_b16 a[76:77], v5 offset:45056
 buffer_store_dwordx4 v[40:43], v24, s[36:39], s89 offen sc1
 v_mfma_f32_16x16x32_bf16 v[76:79], a[80:83], a[4:7], 0
 s_waitcnt lgkmcnt(9)
 ds_read_b64_tr_b16 a[78:79], v5 offset:45568
 v_accvgpr_read_b32 v34, a133
 v_mfma_f32_16x16x32_bf16 v[48:51], a[84:87], a[8:11], v[48:51]
 ds_read_b64_tr_b16 a[80:81], v6 offset:45056
 v_accvgpr_read_b32 v35, a109
 v_mfma_f32_16x16x32_bf16 v[52:55], a[84:87], a[12:15], v[52:55]
 s_waitcnt lgkmcnt(9)
 ds_read_b64_tr_b16 a[82:83], v6 offset:45568
 ds_read2st64_b64 a[156:159], v35 offset0:80 offset1:85
 v_mfma_f32_16x16x32_bf16 v[56:59], a[88:91], a[8:11], v[56:59]
 ds_read_b64_tr_b16 a[84:85], v7 offset:45056
 v_mfma_f32_16x16x32_bf16 v[60:63], a[88:91], a[12:15], v[60:63]
 s_waitcnt lgkmcnt(10)
 ds_read_b64_tr_b16 a[86:87], v7 offset:45568
 ds_read2st64_b64 a[148:151], v34 offset0:80 offset1:81
 v_mfma_f32_16x16x32_bf16 v[64:67], a[92:95], a[8:11], v[64:67]
 s_waitcnt vmcnt(19)
 s_barrier
 ds_read_b64_tr_b16 a[88:89], v4 offset:49152
 v_mfma_f32_16x16x32_bf16 v[68:71], a[92:95], a[12:15], v[68:71]
 s_waitcnt lgkmcnt(11)
 ds_read_b64_tr_b16 a[90:91], v4 offset:49664
 s_add_u32 s78, s76, 111488
 v_mfma_f32_16x16x32_bf16 v[72:75], a[96:99], a[8:11], v[72:75]
 s_add_u32 m0, s69, 12288
 ds_read_b64_tr_b16 a[92:93], v5 offset:49152
 buffer_load_dwordx4 v23, s[24:27], s78 offen  lds
 v_mfma_f32_16x16x32_bf16 v[76:79], a[96:99], a[12:15], v[76:79]
 s_waitcnt lgkmcnt(11)
 ds_read_b64_tr_b16 a[94:95], v5 offset:49664
 v_cvt_pk_bf16_f32 v44, v84, v85
 v_mfma_f32_16x16x32_bf16 v[48:51], a[72:75], a[16:19], v[48:51]
 ds_read_b64_tr_b16 a[96:97], v6 offset:49152
 v_cvt_pk_bf16_f32 v46, v92, v93
 v_mfma_f32_16x16x32_bf16 v[52:55], a[72:75], a[20:23], v[52:55]
 s_waitcnt lgkmcnt(11)
 ds_read_b64_tr_b16 a[98:99], v6 offset:49664
 v_cvt_pk_bf16_f32 v45, v86, v87
 v_mfma_f32_16x16x32_bf16 v[56:59], a[76:79], a[16:19], v[56:59]
 ds_read_b64_tr_b16 a[72:73], v7 offset:49152
 v_cvt_pk_bf16_f32 v47, v94, v95
 v_mfma_f32_16x16x32_bf16 v[60:63], a[76:79], a[20:23], v[60:63]
 s_waitcnt lgkmcnt(11)
 ds_read_b64_tr_b16 a[74:75], v7 offset:49664
 s_add_u32 s78, s76, 148352
 v_mfma_f32_16x16x32_bf16 v[64:67], a[80:83], a[16:19], v[64:67]
 s_add_u32 m0, s69, 16384
 ds_read_b64_tr_b16 a[76:77], v4 offset:53248
 buffer_load_dwordx4 v23, s[24:27], s78 offen  lds
 v_mfma_f32_16x16x32_bf16 v[68:71], a[80:83], a[20:23], v[68:71]
 s_waitcnt lgkmcnt(10)
 ds_read_b64_tr_b16 a[78:79], v4 offset:53760
 v_permlane16_swap_b32 v44, v46
 v_mfma_f32_16x16x32_bf16 v[72:75], a[84:87], a[16:19], v[72:75]
 ds_read_b64_tr_b16 a[80:81], v5 offset:53248
 v_permlane16_swap_b32 v45, v47
 v_mfma_f32_16x16x32_bf16 v[76:79], a[84:87], a[20:23], v[76:79]
 s_waitcnt lgkmcnt(9)
 ds_read_b64_tr_b16 a[82:83], v5 offset:53760
 ds_read2st64_b64 a[152:155], v34 offset0:85 offset1:86
 v_mfma_f32_16x16x32_bf16 v[48:51], a[88:91], a[24:27], v[48:51]
 s_add_u32 s89, s85, 303104
 ds_read_b64_tr_b16 a[84:85], v6 offset:53248
 buffer_store_dwordx4 v[44:47], v24, s[36:39], s89 offen sc1
 v_mfma_f32_16x16x32_bf16 v[52:55], a[88:91], a[28:31], v[52:55]
 s_waitcnt lgkmcnt(10)
 ds_read_b64_tr_b16 a[86:87], v6 offset:53760
 s_add_u32 s78, s76, 185216
 v_mfma_f32_16x16x32_bf16 v[56:59], a[92:95], a[24:27], v[56:59]
 s_add_u32 m0, s69, 20480
 ds_read_b64_tr_b16 a[88:89], v7 offset:53248
 buffer_load_dwordx4 v23, s[24:27], s78 offen  lds
 v_mfma_f32_16x16x32_bf16 v[60:63], a[92:95], a[28:31], v[60:63]
 s_waitcnt lgkmcnt(10)
 ds_read_b64_tr_b16 a[90:91], v7 offset:53760
 v_mfma_f32_16x16x32_bf16 v[64:67], a[96:99], a[24:27], v[64:67]
 ds_read_b64_tr_b16 a[92:93], v4 offset:57344
 v_mfma_f32_16x16x32_bf16 v[68:71], a[96:99], a[28:31], v[68:71]
 s_waitcnt lgkmcnt(10)
 ds_read_b64_tr_b16 a[94:95], v4 offset:57856
 v_mfma_f32_16x16x32_bf16 v[72:75], a[72:75], a[24:27], v[72:75]
 ds_read_b64_tr_b16 a[96:97], v5 offset:57344
 v_mfma_f32_16x16x32_bf16 v[76:79], a[72:75], a[28:31], v[76:79]
 s_waitcnt lgkmcnt(10)
 ds_read_b64_tr_b16 a[98:99], v5 offset:57856
 s_add_u32 s78, s76, 222080
 v_mfma_f32_16x16x32_bf16 v[48:51], a[76:79], a[32:35], v[48:51]
 s_add_u32 m0, s69, 24576
 ds_read_b64_tr_b16 a[72:73], v6 offset:57344
 buffer_load_dwordx4 v23, s[24:27], s78 offen  lds
 v_mfma_f32_16x16x32_bf16 v[52:55], a[76:79], a[36:39], v[52:55]
 s_waitcnt lgkmcnt(10)
 ds_read_b64_tr_b16 a[74:75], v6 offset:57856
 v_cvt_pk_bf16_f32 v28, v96, v97
 v_mfma_f32_16x16x32_bf16 v[56:59], a[80:83], a[32:35], v[56:59]
 ds_read_b64_tr_b16 a[76:77], v7 offset:57344
 v_cvt_pk_bf16_f32 v30, v104, v105
 v_mfma_f32_16x16x32_bf16 v[60:63], a[80:83], a[36:39], v[60:63]
 s_waitcnt lgkmcnt(9)
 ds_read_b64_tr_b16 a[78:79], v7 offset:57856
 v_cvt_pk_bf16_f32 v29, v98, v99
 v_mfma_f32_16x16x32_bf16 v[64:67], a[84:87], a[32:35], v[64:67]
 ds_read_b64_tr_b16 a[80:81], v4 offset:61440
 v_cvt_pk_bf16_f32 v31, v106, v107
 v_mfma_f32_16x16x32_bf16 v[68:71], a[84:87], a[36:39], v[68:71]
 s_waitcnt lgkmcnt(9)
 ds_read_b64_tr_b16 a[82:83], v4 offset:61952
 s_add_u32 s78, s76, 258944
 v_mfma_f32_32x32x8bf16_1k v[112:127], a[156:157], v[232:233], 0
 v_mfma_f32_16x16x32_bf16 v[72:75], a[88:91], a[32:35], v[72:75]
 s_add_u32 m0, s69, 28672
 ds_read_b64_tr_b16 a[84:85], v5 offset:61440
 buffer_load_dwordx4 v23, s[24:27], s78 offen  lds
 v_mfma_f32_32x32x16_bf16 v[112:127], a[148:151], v[224:227], v[112:127]
 v_mfma_f32_16x16x32_bf16 v[76:79], a[88:91], a[36:39], v[76:79]
 s_waitcnt lgkmcnt(9)
 ds_read_b64_tr_b16 a[86:87], v5 offset:61952
 v_permlane16_swap_b32 v28, v30
 v_mfma_f32_32x32x8bf16_1k v[128:143], a[156:157], v[236:237], 0
 v_mfma_f32_16x16x32_bf16 v[48:51], a[92:95], a[40:43], v[48:51]
 ds_read_b64_tr_b16 a[88:89], v6 offset:61440
 v_permlane16_swap_b32 v29, v31
 v_mfma_f32_32x32x16_bf16 v[128:143], a[148:151], v[228:231], v[128:143]
 v_mfma_f32_16x16x32_bf16 v[52:55], a[92:95], a[44:47], v[52:55]
 s_waitcnt lgkmcnt(9)
 ds_read_b64_tr_b16 a[90:91], v6 offset:61952
 v_mfma_f32_16x16x32_bf16 v[56:59], a[96:99], a[40:43], v[56:59]
 s_add_u32 s89, s85, 9216
 ds_read_b64_tr_b16 a[92:93], v7 offset:61440
 buffer_store_dwordx4 v[28:31], v24, s[36:39], s89 offen sc1
 v_mfma_f32_16x16x32_bf16 v[60:63], a[96:99], a[44:47], v[60:63]
 s_waitcnt lgkmcnt(9)
 ds_read_b64_tr_b16 a[94:95], v7 offset:61952
 s_add_u32 s78, s77, 896
 v_mfma_f32_16x16x32_bf16 v[64:67], a[72:75], a[40:43], v[64:67]
 s_add_u32 m0, s69, 32768
 ds_read_b64_tr_b16 a[96:97], v8 offset:0
 buffer_load_dwordx4 v23, s[24:27], s78 offen  lds
 v_mfma_f32_16x16x32_bf16 v[68:71], a[72:75], a[44:47], v[68:71]
 s_waitcnt lgkmcnt(9)
 ds_read_b64_tr_b16 a[98:99], v8 offset:512
 v_max3_f32 v38, v112, v113, v114
 v_mfma_f32_16x16x32_bf16 v[72:75], a[76:79], a[40:43], v[72:75]
 ds_read_b64_tr_b16 a[72:73], v9 offset:0
 v_max3_f32 v38, v38, v115, v116
 v_mfma_f32_16x16x32_bf16 v[76:79], a[76:79], a[44:47], v[76:79]
 s_waitcnt lgkmcnt(9)
 ds_read_b64_tr_b16 a[74:75], v9 offset:512
 v_cvt_pk_bf16_f32 v40, v100, v101
 v_mfma_f32_16x16x32_bf16 v[48:51], a[80:83], a[48:51], v[48:51]
 ds_read_b64_tr_b16 a[76:77], v10 offset:0
 v_cvt_pk_bf16_f32 v42, v108, v109
 v_mfma_f32_16x16x32_bf16 v[52:55], a[80:83], a[52:55], v[52:55]
 s_waitcnt lgkmcnt(9)
 ds_read_b64_tr_b16 a[78:79], v10 offset:512
 v_cvt_pk_bf16_f32 v41, v102, v103
 v_mfma_f32_16x16x32_bf16 v[56:59], a[84:87], a[48:51], v[56:59]
 ds_read_b64_tr_b16 a[80:81], v11 offset:0
 v_cvt_pk_bf16_f32 v43, v110, v111
 v_mfma_f32_16x16x32_bf16 v[60:63], a[84:87], a[52:55], v[60:63]
 s_waitcnt lgkmcnt(9)
 ds_read_b64_tr_b16 a[82:83], v11 offset:512
 v_permlane16_swap_b32 v40, v42
 v_mfma_f32_16x16x32_bf16 v[64:67], a[88:91], a[48:51], v[64:67]
 ds_read_b64_tr_b16 a[84:85], v8 offset:4096
 v_permlane16_swap_b32 v41, v43
 v_mfma_f32_16x16x32_bf16 v[68:71], a[88:91], a[52:55], v[68:71]
 s_waitcnt lgkmcnt(9)
 ds_read_b64_tr_b16 a[86:87], v8 offset:4608
 v_max3_f32 v38, v38, v117, v118
 v_mfma_f32_16x16x32_bf16 v[72:75], a[92:95], a[48:51], v[72:75]
 s_add_u32 s89, s85, 304128
 ds_read_b64_tr_b16 a[88:89], v9 offset:4096
 buffer_store_dwordx4 v[40:43], v24, s[36:39], s89 offen sc1
 v_mfma_f32_16x16x32_bf16 v[76:79], a[92:95], a[52:55], v[76:79]
 s_waitcnt lgkmcnt(9)
 ds_read_b64_tr_b16 a[90:91], v9 offset:4608
 v_max3_f32 v38, v38, v119, v120
 v_mfma_f32_16x16x32_bf16 v[48:51], a[96:99], a[56:59], v[48:51]
 ds_read_b64_tr_b16 a[92:93], v10 offset:4096
 v_max3_f32 v38, v38, v121, v122
 v_mfma_f32_16x16x32_bf16 v[52:55], a[96:99], a[60:63], v[52:55]
 s_waitcnt lgkmcnt(9)
 ds_read_b64_tr_b16 a[94:95], v10 offset:4608
 v_max3_f32 v38, v38, v123, v124
 v_mfma_f32_16x16x32_bf16 v[56:59], a[72:75], a[56:59], v[56:59]
 ds_read_b64_tr_b16 a[96:97], v11 offset:4096
 v_max3_f32 v38, v38, v125, v126
 v_mfma_f32_16x16x32_bf16 v[60:63], a[72:75], a[60:63], v[60:63]
 s_waitcnt lgkmcnt(9)
 ds_read_b64_tr_b16 a[98:99], v11 offset:4608
 v_max_f32 v38, v38, v127
 v_mfma_f32_16x16x32_bf16 v[64:67], a[76:79], a[56:59], v[64:67]
 s_waitcnt vmcnt(20)
 s_barrier
 ds_read_b64_tr_b16 a[72:73], v8 offset:8192
 v_max3_f32 v32, v128, v129, v130
 v_mfma_f32_16x16x32_bf16 v[68:71], a[76:79], a[60:63], v[68:71]
 s_waitcnt lgkmcnt(9)
 ds_read_b64_tr_b16 a[74:75], v8 offset:8704
 s_add_u32 s78, s76, 1024
 v_mfma_f32_16x16x32_bf16 v[72:75], a[80:83], a[56:59], v[72:75]
 s_add_u32 m0, s69, 36864
 ds_read_b64_tr_b16 a[76:77], v9 offset:8192
 buffer_load_dwordx4 v23, s[24:27], s78 offen  lds
 v_mfma_f32_16x16x32_bf16 v[76:79], a[80:83], a[60:63], v[76:79]
 s_waitcnt lgkmcnt(9)
 ds_read_b64_tr_b16 a[78:79], v9 offset:8704
 v_max3_f32 v32, v32, v131, v132
 v_mfma_f32_16x16x32_bf16 v[48:51], a[84:87], a[64:67], v[48:51]
 ds_read_b64_tr_b16 a[80:81], v10 offset:8192
 v_max3_f32 v32, v32, v133, v134
 v_mfma_f32_16x16x32_bf16 v[52:55], a[84:87], a[68:71], v[52:55]
 s_waitcnt lgkmcnt(9)
 ds_read_b64_tr_b16 a[82:83], v10 offset:8704
 v_max3_f32 v32, v32, v135, v136
 v_mfma_f32_16x16x32_bf16 v[56:59], a[88:91], a[64:67], v[56:59]
 ds_read_b64_tr_b16 a[84:85], v11 offset:8192
 v_max3_f32 v32, v32, v137, v138
 v_mfma_f32_16x16x32_bf16 v[60:63], a[88:91], a[68:71], v[60:63]
 s_waitcnt lgkmcnt(9)
 ds_read_b64_tr_b16 a[86:87], v11 offset:8704
 s_add_u32 s78, s76, 37888
 v_mfma_f32_16x16x32_bf16 v[64:67], a[92:95], a[64:67], v[64:67]
 s_add_u32 m0, s69, 40960
 ds_read_b64_tr_b16 a[88:89], v8 offset:12288
 buffer_load_dwordx4 v23, s[24:27], s78 offen  lds
 v_mfma_f32_16x16x32_bf16 v[68:71], a[92:95], a[68:71], v[68:71]
 s_waitcnt lgkmcnt(9)
 ds_read_b64_tr_b16 a[90:91], v8 offset:12800
 v_max3_f32 v32, v32, v139, v140
 v_mfma_f32_16x16x32_bf16 v[72:75], a[96:99], a[64:67], v[72:75]
 ds_read_b64_tr_b16 a[92:93], v9 offset:12288
 v_max3_f32 v32, v32, v141, v142
 v_mfma_f32_16x16x32_bf16 v[76:79], a[96:99], a[68:71], v[76:79]
 s_waitcnt lgkmcnt(9)
 ds_read_b64_tr_b16 a[94:95], v9 offset:12800
 v_cvt_pk_bf16_f32 v44, v48, v49
 v_mfma_f32_16x16x32_bf16 v[80:83], a[72:75], a[0:3], 0
 ds_read_b64_tr_b16 a[96:97], v10 offset:12288
 v_cvt_pk_bf16_f32 v46, v56, v57
 v_mfma_f32_16x16x32_bf16 v[84:87], a[72:75], a[4:7], 0
 s_waitcnt lgkmcnt(9)
 ds_read_b64_tr_b16 a[98:99], v10 offset:12800
 s_add_u32 s78, s76, 74752
 v_mfma_f32_16x16x32_bf16 v[88:91], a[76:79], a[0:3], 0
 s_add_u32 m0, s69, 45056
 ds_read_b64_tr_b16 a[72:73], v11 offset:12288
 buffer_load_dwordx4 v23, s[24:27], s78 offen  lds
 v_mfma_f32_16x16x32_bf16 v[92:95], a[76:79], a[4:7], 0
 s_waitcnt lgkmcnt(9)
 ds_read_b64_tr_b16 a[74:75], v11 offset:12800
 v_cvt_pk_bf16_f32 v45, v50, v51
 v_mfma_f32_16x16x32_bf16 v[96:99], a[80:83], a[0:3], 0
 ds_read_b64_tr_b16 a[76:77], v8 offset:16384
 v_cvt_pk_bf16_f32 v47, v58, v59
 v_mfma_f32_16x16x32_bf16 v[100:103], a[80:83], a[4:7], 0
 s_waitcnt lgkmcnt(9)
 ds_read_b64_tr_b16 a[78:79], v8 offset:16896
 v_permlane16_swap_b32 v44, v46
 v_mfma_f32_16x16x32_bf16 v[104:107], a[84:87], a[0:3], 0
 ds_read_b64_tr_b16 a[80:81], v9 offset:16384
 v_permlane16_swap_b32 v45, v47
 v_mfma_f32_16x16x32_bf16 v[108:111], a[84:87], a[4:7], 0
 s_waitcnt lgkmcnt(9)
 ds_read_b64_tr_b16 a[82:83], v9 offset:16896
 s_add_u32 s78, s76, 111616
 v_mfma_f32_16x16x32_bf16 v[80:83], a[88:91], a[8:11], v[80:83]
 s_add_u32 m0, s69, 49152
 ds_read_b64_tr_b16 a[84:85], v10 offset:16384
 buffer_load_dwordx4 v23, s[24:27], s78 offen  lds
 v_mfma_f32_16x16x32_bf16 v[84:87], a[88:91], a[12:15], v[84:87]
 s_waitcnt lgkmcnt(9)
 ds_read_b64_tr_b16 a[86:87], v10 offset:16896
 v_max_f32 v32, v32, v143
 v_mfma_f32_16x16x32_bf16 v[88:91], a[92:95], a[8:11], v[88:91]
 s_add_u32 s89, s85, 10240
 ds_read_b64_tr_b16 a[88:89], v11 offset:16384
 buffer_store_dwordx4 v[44:47], v24, s[36:39], s89 offen sc1
 v_mfma_f32_16x16x32_bf16 v[92:95], a[92:95], a[12:15], v[92:95]
 s_waitcnt lgkmcnt(9)
 ds_read_b64_tr_b16 a[90:91], v11 offset:16896
 v_mov_b32 v39, v38
 v_mfma_f32_16x16x32_bf16 v[96:99], a[96:99], a[8:11], v[96:99]
 ds_read_b64_tr_b16 a[92:93], v8 offset:20480
 v_mov_b32 v33, v32
 v_mfma_f32_16x16x32_bf16 v[100:103], a[96:99], a[12:15], v[100:103]
 s_waitcnt lgkmcnt(9)
 ds_read_b64_tr_b16 a[94:95], v8 offset:20992
 s_add_u32 s78, s76, 148480
 v_mfma_f32_16x16x32_bf16 v[104:107], a[72:75], a[8:11], v[104:107]
 s_add_u32 m0, s69, 53248
 ds_read_b64_tr_b16 a[96:97], v9 offset:20480
 buffer_load_dwordx4 v23, s[24:27], s78 offen  lds
 v_mfma_f32_16x16x32_bf16 v[108:111], a[72:75], a[12:15], v[108:111]
 s_waitcnt lgkmcnt(9)
 ds_read_b64_tr_b16 a[98:99], v9 offset:20992
 v_cvt_pk_bf16_f32 v28, v52, v53
 v_mfma_f32_16x16x32_bf16 v[80:83], a[76:79], a[16:19], v[80:83]
 ds_read_b64_tr_b16 a[72:73], v10 offset:20480
 v_cvt_pk_bf16_f32 v30, v60, v61
 v_mfma_f32_16x16x32_bf16 v[84:87], a[76:79], a[20:23], v[84:87]
 s_waitcnt lgkmcnt(9)
 ds_read_b64_tr_b16 a[74:75], v10 offset:20992
 v_cvt_pk_bf16_f32 v29, v54, v55
 v_mfma_f32_16x16x32_bf16 v[88:91], a[80:83], a[16:19], v[88:91]
 ds_read_b64_tr_b16 a[76:77], v11 offset:20480
 v_cvt_pk_bf16_f32 v31, v62, v63
 v_mfma_f32_16x16x32_bf16 v[92:95], a[80:83], a[20:23], v[92:95]
 s_waitcnt lgkmcnt(9)
 ds_read_b64_tr_b16 a[78:79], v11 offset:20992
 s_add_u32 s78, s76, 185344
 v_mfma_f32_16x16x32_bf16 v[96:99], a[84:87], a[16:19], v[96:99]
 s_add_u32 m0, s69, 57344
 ds_read_b64_tr_b16 a[80:81], v8 offset:24576
 buffer_load_dwordx4 v23, s[24:27], s78 offen  lds
 v_mfma_f32_16x16x32_bf16 v[100:103], a[84:87], a[20:23], v[100:103]
 s_waitcnt lgkmcnt(9)
 ds_read_b64_tr_b16 a[82:83], v8 offset:25088
 v_permlane16_swap_b32 v28, v30
 v_mfma_f32_16x16x32_bf16 v[104:107], a[88:91], a[16:19], v[104:107]
 ds_read_b64_tr_b16 a[84:85], v9 offset:24576
 v_permlane16_swap_b32 v29, v31
 v_mfma_f32_16x16x32_bf16 v[108:111], a[88:91], a[20:23], v[108:111]
 s_waitcnt lgkmcnt(9)
 ds_read_b64_tr_b16 a[86:87], v9 offset:25088
 v_permlane32_swap_b32 v38, v39
 v_mfma_f32_16x16x32_bf16 v[80:83], a[92:95], a[24:27], v[80:83]
 s_add_u32 s89, s85, 305152
 ds_read_b64_tr_b16 a[88:89], v10 offset:24576
 buffer_store_dwordx4 v[28:31], v24, s[36:39], s89 offen sc1
 v_mfma_f32_16x16x32_bf16 v[84:87], a[92:95], a[28:31], v[84:87]
 s_waitcnt lgkmcnt(9)
 ds_read_b64_tr_b16 a[90:91], v10 offset:25088
 v_permlane32_swap_b32 v32, v33
 v_mfma_f32_16x16x32_bf16 v[88:91], a[96:99], a[24:27], v[88:91]
 ds_read_b64_tr_b16 a[92:93], v11 offset:24576
 v_max_f32 v38, v38, v39
 v_mfma_f32_16x16x32_bf16 v[92:95], a[96:99], a[28:31], v[92:95]
 s_waitcnt lgkmcnt(9)
 ds_read_b64_tr_b16 a[94:95], v11 offset:25088
 v_max_f32 v32, v32, v33
 v_mfma_f32_16x16x32_bf16 v[96:99], a[72:75], a[24:27], v[96:99]
 ds_read_b64_tr_b16 a[96:97], v8 offset:28672
 v_sub_f32 v160, 0, v38
 v_mfma_f32_16x16x32_bf16 v[100:103], a[72:75], a[28:31], v[100:103]
 s_waitcnt lgkmcnt(9)
 ds_read_b64_tr_b16 a[98:99], v8 offset:29184
 v_sub_f32 v161, 0, v38
 v_mfma_f32_16x16x32_bf16 v[104:107], a[76:79], a[24:27], v[104:107]
 ds_read_b64_tr_b16 a[72:73], v9 offset:28672
 v_sub_f32 v162, 0, v38
 v_mfma_f32_16x16x32_bf16 v[108:111], a[76:79], a[28:31], v[108:111]
 s_waitcnt lgkmcnt(9)
 ds_read_b64_tr_b16 a[74:75], v9 offset:29184
 v_cvt_pk_bf16_f32 v40, v64, v65
 v_mfma_f32_16x16x32_bf16 v[80:83], a[80:83], a[32:35], v[80:83]
 ds_read_b64_tr_b16 a[76:77], v10 offset:28672
 v_cvt_pk_bf16_f32 v42, v72, v73
 v_mfma_f32_16x16x32_bf16 v[84:87], a[80:83], a[36:39], v[84:87]
 s_waitcnt lgkmcnt(9)
 ds_read_b64_tr_b16 a[78:79], v10 offset:29184
 v_cvt_pk_bf16_f32 v41, v66, v67
 v_mfma_f32_16x16x32_bf16 v[88:91], a[84:87], a[32:35], v[88:91]
 ds_read_b64_tr_b16 a[80:81], v11 offset:28672
 v_cvt_pk_bf16_f32 v43, v74, v75
 v_mfma_f32_16x16x32_bf16 v[92:95], a[84:87], a[36:39], v[92:95]
 s_waitcnt lgkmcnt(9)
 ds_read_b64_tr_b16 a[82:83], v11 offset:29184
 v_permlane16_swap_b32 v40, v42
 v_mfma_f32_16x16x32_bf16 v[96:99], a[88:91], a[32:35], v[96:99]
 s_waitcnt vmcnt(18)
 s_barrier
 ds_read_b64_tr_b16 a[84:85], v8 offset:32768
 v_permlane16_swap_b32 v41, v43
 v_mfma_f32_16x16x32_bf16 v[100:103], a[88:91], a[36:39], v[100:103]
 s_waitcnt lgkmcnt(9)
 ds_read_b64_tr_b16 a[86:87], v8 offset:33280
 s_add_u32 s78, s76, 222208
 v_mfma_f32_16x16x32_bf16 v[104:107], a[92:95], a[32:35], v[104:107]
 s_add_u32 m0, s69, 61440
 ds_read_b64_tr_b16 a[88:89], v9 offset:32768
 buffer_load_dwordx4 v23, s[24:27], s78 offen  lds
 v_mfma_f32_16x16x32_bf16 v[108:111], a[92:95], a[36:39], v[108:111]
 s_waitcnt lgkmcnt(9)
 ds_read_b64_tr_b16 a[90:91], v9 offset:33280
 v_sub_f32 v163, 0, v38
 v_mfma_f32_16x16x32_bf16 v[80:83], a[96:99], a[40:43], v[80:83]
 s_add_u32 s89, s85, 11264
 ds_read_b64_tr_b16 a[92:93], v10 offset:32768
 buffer_store_dwordx4 v[40:43], v24, s[36:39], s89 offen sc1
 v_mfma_f32_16x16x32_bf16 v[84:87], a[96:99], a[44:47], v[84:87]
 s_waitcnt lgkmcnt(9)
 ds_read_b64_tr_b16 a[94:95], v10 offset:33280
 v_sub_f32 v164, 0, v38
 v_mfma_f32_16x16x32_bf16 v[88:91], a[72:75], a[40:43], v[88:91]
 ds_read_b64_tr_b16 a[96:97], v11 offset:32768
 v_sub_f32 v165, 0, v38
 v_mfma_f32_16x16x32_bf16 v[92:95], a[72:75], a[44:47], v[92:95]
 s_waitcnt lgkmcnt(9)
 ds_read_b64_tr_b16 a[98:99], v11 offset:33280
 s_add_u32 s78, s76, 259072
 v_mfma_f32_16x16x32_bf16 v[96:99], a[76:79], a[40:43], v[96:99]
 s_add_u32 m0, s69, 65536
 ds_read_b64_tr_b16 a[72:73], v8 offset:36864
 buffer_load_dwordx4 v23, s[24:27], s78 offen  lds
 v_mfma_f32_16x16x32_bf16 v[100:103], a[76:79], a[44:47], v[100:103]
 s_waitcnt lgkmcnt(9)
 ds_read_b64_tr_b16 a[74:75], v8 offset:37376
 v_sub_f32 v166, 0, v38
 v_mfma_f32_16x16x32_bf16 v[104:107], a[80:83], a[40:43], v[104:107]
 ds_read_b64_tr_b16 a[76:77], v9 offset:36864
 v_sub_f32 v167, 0, v38
 v_mfma_f32_16x16x32_bf16 v[108:111], a[80:83], a[44:47], v[108:111]
 s_waitcnt lgkmcnt(9)
 ds_read_b64_tr_b16 a[78:79], v9 offset:37376
 v_cvt_pk_bf16_f32 v44, v68, v69
 v_mfma_f32_16x16x32_bf16 v[80:83], a[84:87], a[48:51], v[80:83]
 ds_read_b64_tr_b16 a[80:81], v10 offset:36864
 v_cvt_pk_bf16_f32 v46, v76, v77
 v_mfma_f32_16x16x32_bf16 v[84:87], a[84:87], a[52:55], v[84:87]
 s_waitcnt lgkmcnt(9)
 ds_read_b64_tr_b16 a[82:83], v10 offset:37376
 s_add_u32 s78, s77, 1024
 v_mfma_f32_16x16x32_bf16 v[88:91], a[88:91], a[48:51], v[88:91]
 s_add_u32 m0, s69, 69632
 ds_read_b64_tr_b16 a[84:85], v11 offset:36864
 buffer_load_dwordx4 v23, s[24:27], s78 offen  lds
 v_mfma_f32_16x16x32_bf16 v[92:95], a[88:91], a[52:55], v[92:95]
 s_waitcnt lgkmcnt(9)
 ds_read_b64_tr_b16 a[86:87], v11 offset:37376
 v_cvt_pk_bf16_f32 v45, v70, v71
 v_mfma_f32_16x16x32_bf16 v[96:99], a[92:95], a[48:51], v[96:99]
 ds_read_b64_tr_b16 a[88:89], v8 offset:40960
 v_cvt_pk_bf16_f32 v47, v78, v79
 v_mfma_f32_16x16x32_bf16 v[100:103], a[92:95], a[52:55], v[100:103]
 s_waitcnt lgkmcnt(9)
 ds_read_b64_tr_b16 a[90:91], v8 offset:41472
 v_permlane16_swap_b32 v44, v46
 v_mfma_f32_16x16x32_bf16 v[104:107], a[96:99], a[48:51], v[104:107]
 ds_read_b64_tr_b16 a[92:93], v9 offset:40960
 v_permlane16_swap_b32 v45, v47
 v_mfma_f32_16x16x32_bf16 v[108:111], a[96:99], a[52:55], v[108:111]
 s_waitcnt lgkmcnt(9)
 ds_read_b64_tr_b16 a[94:95], v9 offset:41472
 v_sub_f32 v168, 0, v38
 v_mfma_f32_16x16x32_bf16 v[80:83], a[72:75], a[56:59], v[80:83]
 s_add_u32 s89, s85, 306176
 ds_read_b64_tr_b16 a[96:97], v10 offset:40960
 buffer_store_dwordx4 v[44:47], v24, s[36:39], s89 offen sc1
 v_mfma_f32_16x16x32_bf16 v[84:87], a[72:75], a[60:63], v[84:87]
 s_waitcnt lgkmcnt(9)
 ds_read_b64_tr_b16 a[98:99], v10 offset:41472
 v_sub_f32 v169, 0, v38
 v_mfma_f32_16x16x32_bf16 v[88:91], a[76:79], a[56:59], v[88:91]
 ds_read_b64_tr_b16 a[72:73], v11 offset:40960
 v_sub_f32 v170, 0, v38
 v_mfma_f32_16x16x32_bf16 v[92:95], a[76:79], a[60:63], v[92:95]
 s_waitcnt lgkmcnt(9)
 ds_read_b64_tr_b16 a[74:75], v11 offset:41472
 v_sub_f32 v171, 0, v38
 v_mfma_f32_16x16x32_bf16 v[96:99], a[80:83], a[56:59], v[96:99]
 ds_read_b64_tr_b16 a[76:77], v4 offset:0
 v_sub_f32 v172, 0, v38
 v_mfma_f32_16x16x32_bf16 v[100:103], a[80:83], a[60:63], v[100:103]
 s_waitcnt lgkmcnt(9)
 ds_read_b64_tr_b16 a[78:79], v4 offset:512
 v_sub_f32 v173, 0, v38
 v_mfma_f32_16x16x32_bf16 v[104:107], a[84:87], a[56:59], v[104:107]
 ds_read_b64_tr_b16 a[80:81], v5 offset:0
 v_sub_f32 v174, 0, v38
 v_mfma_f32_16x16x32_bf16 v[108:111], a[84:87], a[60:63], v[108:111]
 s_waitcnt lgkmcnt(9)
 ds_read_b64_tr_b16 a[82:83], v5 offset:512
 v_sub_f32 v175, 0, v38
 v_mfma_f32_16x16x32_bf16 v[80:83], a[88:91], a[64:67], v[80:83]
 ds_read_b64_tr_b16 a[84:85], v6 offset:0
 v_sub_f32 v176, 0, v32
 v_mfma_f32_16x16x32_bf16 v[84:87], a[88:91], a[68:71], v[84:87]
 s_waitcnt lgkmcnt(9)
 ds_read_b64_tr_b16 a[86:87], v6 offset:512
 v_sub_f32 v177, 0, v32
 v_mfma_f32_16x16x32_bf16 v[88:91], a[92:95], a[64:67], v[88:91]
 ds_read_b64_tr_b16 a[88:89], v7 offset:0
 v_sub_f32 v178, 0, v32
 v_mfma_f32_16x16x32_bf16 v[92:95], a[92:95], a[68:71], v[92:95]
 s_waitcnt lgkmcnt(9)
 ds_read_b64_tr_b16 a[90:91], v7 offset:512
 v_sub_f32 v179, 0, v32
 v_mfma_f32_16x16x32_bf16 v[96:99], a[96:99], a[64:67], v[96:99]
 ds_read_b64_tr_b16 a[92:93], v4 offset:4096
 v_sub_f32 v180, 0, v32
 v_mfma_f32_16x16x32_bf16 v[100:103], a[96:99], a[68:71], v[100:103]
 s_waitcnt lgkmcnt(9)
 ds_read_b64_tr_b16 a[94:95], v4 offset:4608
 v_sub_f32 v181, 0, v32
 v_mfma_f32_16x16x32_bf16 v[104:107], a[72:75], a[64:67], v[104:107]
 ds_read_b64_tr_b16 a[96:97], v5 offset:4096
 v_sub_f32 v182, 0, v32
 v_mfma_f32_16x16x32_bf16 v[108:111], a[72:75], a[68:71], v[108:111]
 s_waitcnt lgkmcnt(9)
 ds_read_b64_tr_b16 a[98:99], v5 offset:4608
 v_cvt_pk_bf16_f32 v28, v80, v81
 v_mfma_f32_16x16x32_bf16 v[48:51], a[76:79], a[0:3], 0
 ds_read_b64_tr_b16 a[72:73], v6 offset:4096
 v_cvt_pk_bf16_f32 v30, v88, v89
 v_mfma_f32_16x16x32_bf16 v[52:55], a[76:79], a[4:7], 0
 s_waitcnt lgkmcnt(9)
 ds_read_b64_tr_b16 a[74:75], v6 offset:4608
 v_cvt_pk_bf16_f32 v29, v82, v83
 v_mfma_f32_16x16x32_bf16 v[56:59], a[80:83], a[0:3], 0
 ds_read_b64_tr_b16 a[76:77], v7 offset:4096
 v_cvt_pk_bf16_f32 v31, v90, v91
 v_mfma_f32_16x16x32_bf16 v[60:63], a[80:83], a[4:7], 0
 s_waitcnt lgkmcnt(9)
 ds_read_b64_tr_b16 a[78:79], v7 offset:4608
 v_permlane16_swap_b32 v28, v30
 v_mfma_f32_16x16x32_bf16 v[64:67], a[84:87], a[0:3], 0
 ds_read_b64_tr_b16 a[80:81], v4 offset:8192
 v_permlane16_swap_b32 v29, v31
 v_mfma_f32_16x16x32_bf16 v[68:71], a[84:87], a[4:7], 0
 s_waitcnt lgkmcnt(9)
 ds_read_b64_tr_b16 a[82:83], v4 offset:8704
 v_sub_f32 v183, 0, v32
 v_mfma_f32_16x16x32_bf16 v[72:75], a[88:91], a[0:3], 0
 s_add_u32 s89, s85, 12288
 ds_read_b64_tr_b16 a[84:85], v5 offset:8192
 buffer_store_dwordx4 v[28:31], v24, s[36:39], s89 offen sc1
 v_mfma_f32_16x16x32_bf16 v[76:79], a[88:91], a[4:7], 0
 s_waitcnt lgkmcnt(9)
 ds_read_b64_tr_b16 a[86:87], v5 offset:8704
 v_sub_f32 v184, 0, v32
 v_mfma_f32_16x16x32_bf16 v[48:51], a[92:95], a[8:11], v[48:51]
 ds_read_b64_tr_b16 a[88:89], v6 offset:8192
 v_sub_f32 v185, 0, v32
 v_mfma_f32_16x16x32_bf16 v[52:55], a[92:95], a[12:15], v[52:55]
 s_waitcnt lgkmcnt(9)
 ds_read_b64_tr_b16 a[90:91], v6 offset:8704
 v_sub_f32 v186, 0, v32
 v_mfma_f32_16x16x32_bf16 v[56:59], a[96:99], a[8:11], v[56:59]
 ds_read_b64_tr_b16 a[92:93], v7 offset:8192
 v_sub_f32 v187, 0, v32
 v_mfma_f32_16x16x32_bf16 v[60:63], a[96:99], a[12:15], v[60:63]
 s_waitcnt lgkmcnt(9)
 ds_read_b64_tr_b16 a[94:95], v7 offset:8704
 v_sub_f32 v188, 0, v32
 v_mfma_f32_16x16x32_bf16 v[64:67], a[72:75], a[8:11], v[64:67]
 s_waitcnt vmcnt(15)
 s_barrier
 ds_read_b64_tr_b16 a[96:97], v4 offset:12288
 v_sub_f32 v189, 0, v32
 v_mfma_f32_16x16x32_bf16 v[68:71], a[72:75], a[12:15], v[68:71]
 s_waitcnt lgkmcnt(9)
 ds_read_b64_tr_b16 a[98:99], v4 offset:12800
 v_sub_f32 v190, 0, v32
 v_mfma_f32_16x16x32_bf16 v[72:75], a[76:79], a[8:11], v[72:75]
 ds_read_b64_tr_b16 a[72:73], v5 offset:12288
 v_sub_f32 v191, 0, v32
 v_mfma_f32_16x16x32_bf16 v[76:79], a[76:79], a[12:15], v[76:79]
 s_waitcnt lgkmcnt(9)
 ds_read_b64_tr_b16 a[74:75], v5 offset:12800
 v_cvt_pk_bf16_f32 v40, v84, v85
 v_mfma_f32_16x16x32_bf16 v[48:51], a[80:83], a[16:19], v[48:51]
 ds_read_b64_tr_b16 a[76:77], v6 offset:12288
 v_cvt_pk_bf16_f32 v42, v92, v93
 v_mfma_f32_16x16x32_bf16 v[52:55], a[80:83], a[20:23], v[52:55]
 s_waitcnt lgkmcnt(9)
 ds_read_b64_tr_b16 a[78:79], v6 offset:12800
 v_cvt_pk_bf16_f32 v41, v86, v87
 v_mfma_f32_16x16x32_bf16 v[56:59], a[84:87], a[16:19], v[56:59]
 ds_read_b64_tr_b16 a[80:81], v7 offset:12288
 v_cvt_pk_bf16_f32 v43, v94, v95
 v_mfma_f32_16x16x32_bf16 v[60:63], a[84:87], a[20:23], v[60:63]
 s_waitcnt lgkmcnt(9)
 ds_read_b64_tr_b16 a[82:83], v7 offset:12800
 v_permlane16_swap_b32 v40, v42
 v_mfma_f32_16x16x32_bf16 v[64:67], a[88:91], a[16:19], v[64:67]
 ds_read_b64_tr_b16 a[84:85], v4 offset:16384
 v_permlane16_swap_b32 v41, v43
 v_mfma_f32_16x16x32_bf16 v[68:71], a[88:91], a[20:23], v[68:71]
 s_waitcnt lgkmcnt(9)
 ds_read_b64_tr_b16 a[86:87], v4 offset:16896
 v_mfma_f32_16x16x32_bf16 v[72:75], a[92:95], a[16:19], v[72:75]
 s_add_u32 s89, s85, 307200
 ds_read_b64_tr_b16 a[88:89], v5 offset:16384
 buffer_store_dwordx4 v[40:43], v24, s[36:39], s89 offen sc1
 v_mfma_f32_16x16x32_bf16 v[76:79], a[92:95], a[20:23], v[76:79]
 s_waitcnt lgkmcnt(9)
 ds_read_b64_tr_b16 a[90:91], v5 offset:16896
 v_mfma_f32_16x16x32_bf16 v[48:51], a[96:99], a[24:27], v[48:51]
 ds_read_b64_tr_b16 a[92:93], v6 offset:16384
 v_mfma_f32_16x16x32_bf16 v[52:55], a[96:99], a[28:31], v[52:55]
 s_waitcnt lgkmcnt(9)
 ds_read_b64_tr_b16 a[94:95], v6 offset:16896
 v_mfma_f32_16x16x32_bf16 v[56:59], a[72:75], a[24:27], v[56:59]
 ds_read_b64_tr_b16 a[96:97], v7 offset:16384
 v_mfma_f32_16x16x32_bf16 v[60:63], a[72:75], a[28:31], v[60:63]
 s_waitcnt lgkmcnt(9)
 ds_read_b64_tr_b16 a[98:99], v7 offset:16896
 v_mfma_f32_16x16x32_bf16 v[64:67], a[76:79], a[24:27], v[64:67]
 ds_read_b64_tr_b16 a[72:73], v4 offset:20480
 v_mfma_f32_16x16x32_bf16 v[68:71], a[76:79], a[28:31], v[68:71]
 s_waitcnt lgkmcnt(9)
 ds_read_b64_tr_b16 a[74:75], v4 offset:20992
 v_mfma_f32_16x16x32_bf16 v[72:75], a[80:83], a[24:27], v[72:75]
 ds_read_b64_tr_b16 a[76:77], v5 offset:20480
 v_mfma_f32_16x16x32_bf16 v[76:79], a[80:83], a[28:31], v[76:79]
 s_waitcnt lgkmcnt(9)
 ds_read_b64_tr_b16 a[78:79], v5 offset:20992
 v_cvt_pk_bf16_f32 v44, v96, v97
 v_mfma_f32_16x16x32_bf16 v[48:51], a[84:87], a[32:35], v[48:51]
 ds_read_b64_tr_b16 a[80:81], v6 offset:20480
 v_cvt_pk_bf16_f32 v46, v104, v105
 v_mfma_f32_16x16x32_bf16 v[52:55], a[84:87], a[36:39], v[52:55]
 s_waitcnt lgkmcnt(9)
 ds_read_b64_tr_b16 a[82:83], v6 offset:20992
 v_cvt_pk_bf16_f32 v45, v98, v99
 v_mfma_f32_16x16x32_bf16 v[56:59], a[88:91], a[32:35], v[56:59]
 ds_read_b64_tr_b16 a[84:85], v7 offset:20480
 v_cvt_pk_bf16_f32 v47, v106, v107
 v_mfma_f32_16x16x32_bf16 v[60:63], a[88:91], a[36:39], v[60:63]
 s_waitcnt lgkmcnt(9)
 ds_read_b64_tr_b16 a[86:87], v7 offset:20992
 v_permlane16_swap_b32 v44, v46
 v_mfma_f32_16x16x32_bf16 v[64:67], a[92:95], a[32:35], v[64:67]
 ds_read_b64_tr_b16 a[88:89], v4 offset:24576
 v_permlane16_swap_b32 v45, v47
 v_mfma_f32_16x16x32_bf16 v[68:71], a[92:95], a[36:39], v[68:71]
 s_waitcnt lgkmcnt(9)
 ds_read_b64_tr_b16 a[90:91], v4 offset:25088
 v_mfma_f32_16x16x32_bf16 v[72:75], a[96:99], a[32:35], v[72:75]
 s_add_u32 s89, s85, 13312
 ds_read_b64_tr_b16 a[92:93], v5 offset:24576
 buffer_store_dwordx4 v[44:47], v24, s[36:39], s89 offen sc1
 v_mfma_f32_16x16x32_bf16 v[76:79], a[96:99], a[36:39], v[76:79]
 s_waitcnt lgkmcnt(9)
 ds_read_b64_tr_b16 a[94:95], v5 offset:25088
 v_mfma_f32_16x16x32_bf16 v[48:51], a[72:75], a[40:43], v[48:51]
 ds_read_b64_tr_b16 a[96:97], v6 offset:24576
 v_mfma_f32_16x16x32_bf16 v[52:55], a[72:75], a[44:47], v[52:55]
 s_waitcnt lgkmcnt(9)
 ds_read_b64_tr_b16 a[98:99], v6 offset:25088
 v_mfma_f32_16x16x32_bf16 v[56:59], a[76:79], a[40:43], v[56:59]
 ds_read_b64_tr_b16 a[72:73], v7 offset:24576
 v_mfma_f32_16x16x32_bf16 v[60:63], a[76:79], a[44:47], v[60:63]
 s_waitcnt lgkmcnt(9)
 ds_read_b64_tr_b16 a[74:75], v7 offset:25088
 v_mfma_f32_16x16x32_bf16 v[64:67], a[80:83], a[40:43], v[64:67]
 ds_read_b64_tr_b16 a[76:77], v4 offset:28672
 v_mfma_f32_16x16x32_bf16 v[68:71], a[80:83], a[44:47], v[68:71]
 s_waitcnt lgkmcnt(9)
 ds_read_b64_tr_b16 a[78:79], v4 offset:29184
 v_mfma_f32_16x16x32_bf16 v[72:75], a[84:87], a[40:43], v[72:75]
 ds_read_b64_tr_b16 a[80:81], v5 offset:28672
 v_mfma_f32_16x16x32_bf16 v[76:79], a[84:87], a[44:47], v[76:79]
 s_waitcnt lgkmcnt(9)
 ds_read_b64_tr_b16 a[82:83], v5 offset:29184
 v_cvt_pk_bf16_f32 v28, v100, v101
 v_mfma_f32_16x16x32_bf16 v[48:51], a[88:91], a[48:51], v[48:51]
 ds_read_b64_tr_b16 a[84:85], v6 offset:28672
 v_cvt_pk_bf16_f32 v30, v108, v109
 v_mfma_f32_16x16x32_bf16 v[52:55], a[88:91], a[52:55], v[52:55]
 s_waitcnt lgkmcnt(9)
 ds_read_b64_tr_b16 a[86:87], v6 offset:29184
 v_cvt_pk_bf16_f32 v29, v102, v103
 v_mfma_f32_16x16x32_bf16 v[56:59], a[92:95], a[48:51], v[56:59]
 ds_read_b64_tr_b16 a[88:89], v7 offset:28672
 v_cvt_pk_bf16_f32 v31, v110, v111
 v_mfma_f32_16x16x32_bf16 v[60:63], a[92:95], a[52:55], v[60:63]
 s_waitcnt lgkmcnt(9)
 ds_read_b64_tr_b16 a[90:91], v7 offset:29184
 v_permlane16_swap_b32 v28, v30
 v_mfma_f32_16x16x32_bf16 v[64:67], a[96:99], a[48:51], v[64:67]
 ds_read_b64_tr_b16 a[92:93], v4 offset:32768
 v_permlane16_swap_b32 v29, v31
 v_mfma_f32_16x16x32_bf16 v[68:71], a[96:99], a[52:55], v[68:71]
 s_waitcnt lgkmcnt(9)
 ds_read_b64_tr_b16 a[94:95], v4 offset:33280
 v_mfma_f32_16x16x32_bf16 v[72:75], a[72:75], a[48:51], v[72:75]
 s_add_u32 s89, s85, 308224
 ds_read_b64_tr_b16 a[96:97], v5 offset:32768
 buffer_store_dwordx4 v[28:31], v24, s[36:39], s89 offen sc1
 v_mfma_f32_16x16x32_bf16 v[76:79], a[72:75], a[52:55], v[76:79]
 s_waitcnt lgkmcnt(9)
 ds_read_b64_tr_b16 a[98:99], v5 offset:33280
 v_mfma_f32_16x16x32_bf16 v[48:51], a[76:79], a[56:59], v[48:51]
 ds_read_b64_tr_b16 a[72:73], v6 offset:32768
 v_mfma_f32_16x16x32_bf16 v[52:55], a[76:79], a[60:63], v[52:55]
 s_waitcnt lgkmcnt(9)
 ds_read_b64_tr_b16 a[74:75], v6 offset:33280
 v_mfma_f32_16x16x32_bf16 v[56:59], a[80:83], a[56:59], v[56:59]
 ds_read_b64_tr_b16 a[76:77], v7 offset:32768
 v_mfma_f32_16x16x32_bf16 v[60:63], a[80:83], a[60:63], v[60:63]
 s_waitcnt lgkmcnt(9)
 ds_read_b64_tr_b16 a[78:79], v7 offset:33280
 v_mfma_f32_16x16x32_bf16 v[64:67], a[84:87], a[56:59], v[64:67]
 s_waitcnt vmcnt(10)
 s_barrier
 ds_read_b64_tr_b16 a[80:81], v4 offset:36864
 v_mfma_f32_16x16x32_bf16 v[68:71], a[84:87], a[60:63], v[68:71]
 s_waitcnt lgkmcnt(9)
 ds_read_b64_tr_b16 a[82:83], v4 offset:37376
 s_add_u32 s99, s86, 608256
 v_mfma_f32_16x16x32_bf16 v[72:75], a[88:91], a[56:59], v[72:75]
 s_add_u32 m0, s87, 0
 ds_read_b64_tr_b16 a[84:85], v5 offset:36864
 buffer_load_dwordx4 v18, s[36:39], s99 offen sc1 lds
 v_mfma_f32_16x16x32_bf16 v[76:79], a[88:91], a[60:63], v[76:79]
 s_waitcnt lgkmcnt(9)
 ds_read_b64_tr_b16 a[86:87], v5 offset:37376
 v_mfma_f32_16x16x32_bf16 v[48:51], a[92:95], a[64:67], v[48:51]
 ds_read_b64_tr_b16 a[88:89], v6 offset:36864
 v_mfma_f32_16x16x32_bf16 v[52:55], a[92:95], a[68:71], v[52:55]
 s_waitcnt lgkmcnt(9)
 ds_read_b64_tr_b16 a[90:91], v6 offset:37376
 v_mfma_f32_16x16x32_bf16 v[56:59], a[96:99], a[64:67], v[56:59]
 ds_read_b64_tr_b16 a[92:93], v7 offset:36864
 v_mfma_f32_16x16x32_bf16 v[60:63], a[96:99], a[68:71], v[60:63]
 s_waitcnt lgkmcnt(9)
 ds_read_b64_tr_b16 a[94:95], v7 offset:37376
 v_mfma_f32_16x16x32_bf16 v[64:67], a[72:75], a[64:67], v[64:67]
 s_add_u32 m0, s87, 1024
 ds_read_b64_tr_b16 a[96:97], v4 offset:40960
 buffer_load_dwordx4 v19, s[36:39], s99 offen sc1 lds
 v_mfma_f32_16x16x32_bf16 v[68:71], a[72:75], a[68:71], v[68:71]
 s_waitcnt lgkmcnt(9)
 ds_read_b64_tr_b16 a[98:99], v4 offset:41472
 v_mfma_f32_16x16x32_bf16 v[72:75], a[76:79], a[64:67], v[72:75]
 ds_read_b64_tr_b16 a[72:73], v5 offset:40960
 v_mfma_f32_16x16x32_bf16 v[76:79], a[76:79], a[68:71], v[76:79]
 s_waitcnt lgkmcnt(9)
 ds_read_b64_tr_b16 a[74:75], v5 offset:41472
 v_cvt_pk_bf16_f32 v40, v48, v49
 v_mfma_f32_16x16x32_bf16 v[80:83], a[80:83], a[0:3], 0
 ds_read_b64_tr_b16 a[76:77], v6 offset:40960
 v_cvt_pk_bf16_f32 v42, v56, v57
 v_mfma_f32_16x16x32_bf16 v[84:87], a[80:83], a[4:7], 0
 s_waitcnt lgkmcnt(9)
 ds_read_b64_tr_b16 a[78:79], v6 offset:41472
 v_cvt_pk_bf16_f32 v41, v50, v51
 v_mfma_f32_16x16x32_bf16 v[88:91], a[84:87], a[0:3], 0
 ds_read_b64_tr_b16 a[80:81], v7 offset:40960
 v_cvt_pk_bf16_f32 v43, v58, v59
 v_mfma_f32_16x16x32_bf16 v[92:95], a[84:87], a[4:7], 0
 s_waitcnt lgkmcnt(9)
 ds_read_b64_tr_b16 a[82:83], v7 offset:41472
 v_permlane16_swap_b32 v40, v42
 v_mfma_f32_16x16x32_bf16 v[96:99], a[88:91], a[0:3], 0
 ds_read_b64_tr_b16 a[84:85], v4 offset:45056
 v_permlane16_swap_b32 v41, v43
 v_mfma_f32_16x16x32_bf16 v[100:103], a[88:91], a[4:7], 0
 s_waitcnt lgkmcnt(9)
 ds_read_b64_tr_b16 a[86:87], v4 offset:45568
 v_mfma_f32_16x16x32_bf16 v[104:107], a[92:95], a[0:3], 0
 s_add_u32 s89, s85, 14336
 ds_read_b64_tr_b16 a[88:89], v5 offset:45056
 buffer_store_dwordx4 v[40:43], v24, s[36:39], s89 offen sc1
 v_mfma_f32_16x16x32_bf16 v[108:111], a[92:95], a[4:7], 0
 s_waitcnt lgkmcnt(9)
 ds_read_b64_tr_b16 a[90:91], v5 offset:45568
 v_cvt_pk_bf16_f32 v44, v52, v53
 v_mfma_f32_16x16x32_bf16 v[80:83], a[96:99], a[8:11], v[80:83]
 ds_read_b64_tr_b16 a[92:93], v6 offset:45056
 v_cvt_pk_bf16_f32 v46, v60, v61
 v_mfma_f32_16x16x32_bf16 v[84:87], a[96:99], a[12:15], v[84:87]
 s_waitcnt lgkmcnt(9)
 ds_read_b64_tr_b16 a[94:95], v6 offset:45568
 v_cvt_pk_bf16_f32 v45, v54, v55
 v_mfma_f32_16x16x32_bf16 v[88:91], a[72:75], a[8:11], v[88:91]
 ds_read_b64_tr_b16 a[96:97], v7 offset:45056
 v_cvt_pk_bf16_f32 v47, v62, v63
 v_mfma_f32_16x16x32_bf16 v[92:95], a[72:75], a[12:15], v[92:95]
 s_waitcnt lgkmcnt(9)
 ds_read_b64_tr_b16 a[98:99], v7 offset:45568
 v_permlane16_swap_b32 v44, v46
 v_mfma_f32_16x16x32_bf16 v[96:99], a[76:79], a[8:11], v[96:99]
 ds_read_b64_tr_b16 a[72:73], v4 offset:49152
 v_permlane16_swap_b32 v45, v47
 v_mfma_f32_16x16x32_bf16 v[100:103], a[76:79], a[12:15], v[100:103]
 s_waitcnt lgkmcnt(9)
 ds_read_b64_tr_b16 a[74:75], v4 offset:49664
 v_mfma_f32_16x16x32_bf16 v[104:107], a[80:83], a[8:11], v[104:107]
 s_add_u32 s89, s85, 309248
 ds_read_b64_tr_b16 a[76:77], v5 offset:49152
 buffer_store_dwordx4 v[44:47], v24, s[36:39], s89 offen sc1
 v_mfma_f32_16x16x32_bf16 v[108:111], a[80:83], a[12:15], v[108:111]
 s_waitcnt lgkmcnt(9)
 ds_read_b64_tr_b16 a[78:79], v5 offset:49664
 v_cvt_pk_bf16_f32 v28, v64, v65
 v_mfma_f32_16x16x32_bf16 v[80:83], a[84:87], a[16:19], v[80:83]
 ds_read_b64_tr_b16 a[80:81], v6 offset:49152
 v_cvt_pk_bf16_f32 v30, v72, v73
 v_mfma_f32_16x16x32_bf16 v[84:87], a[84:87], a[20:23], v[84:87]
 s_waitcnt lgkmcnt(9)
 ds_read_b64_tr_b16 a[82:83], v6 offset:49664
 v_cvt_pk_bf16_f32 v29, v66, v67
 v_mfma_f32_16x16x32_bf16 v[88:91], a[88:91], a[16:19], v[88:91]
 ds_read_b64_tr_b16 a[84:85], v7 offset:49152
 v_cvt_pk_bf16_f32 v31, v74, v75
 v_mfma_f32_16x16x32_bf16 v[92:95], a[88:91], a[20:23], v[92:95]
 s_waitcnt lgkmcnt(9)
 ds_read_b64_tr_b16 a[86:87], v7 offset:49664
 v_permlane16_swap_b32 v28, v30
 v_mfma_f32_16x16x32_bf16 v[96:99], a[92:95], a[16:19], v[96:99]
 ds_read_b64_tr_b16 a[88:89], v4 offset:53248
 v_permlane16_swap_b32 v29, v31
 v_mfma_f32_16x16x32_bf16 v[100:103], a[92:95], a[20:23], v[100:103]
 s_waitcnt lgkmcnt(9)
 ds_read_b64_tr_b16 a[90:91], v4 offset:53760
 v_mfma_f32_16x16x32_bf16 v[104:107], a[96:99], a[16:19], v[104:107]
 s_add_u32 s89, s85, 15360
 ds_read_b64_tr_b16 a[92:93], v5 offset:53248
 buffer_store_dwordx4 v[28:31], v24, s[36:39], s89 offen sc1
 v_mfma_f32_16x16x32_bf16 v[108:111], a[96:99], a[20:23], v[108:111]
 s_waitcnt lgkmcnt(9)
 ds_read_b64_tr_b16 a[94:95], v5 offset:53760
 v_cvt_pk_bf16_f32 v40, v68, v69
 v_mfma_f32_16x16x32_bf16 v[80:83], a[72:75], a[24:27], v[80:83]
 ds_read_b64_tr_b16 a[96:97], v6 offset:53248
 v_cvt_pk_bf16_f32 v42, v76, v77
 v_mfma_f32_16x16x32_bf16 v[84:87], a[72:75], a[28:31], v[84:87]
 s_waitcnt lgkmcnt(9)
 ds_read_b64_tr_b16 a[98:99], v6 offset:53760
 v_cvt_pk_bf16_f32 v41, v70, v71
 v_mfma_f32_16x16x32_bf16 v[88:91], a[76:79], a[24:27], v[88:91]
 ds_read_b64_tr_b16 a[72:73], v7 offset:53248
 v_cvt_pk_bf16_f32 v43, v78, v79
 v_mfma_f32_16x16x32_bf16 v[92:95], a[76:79], a[28:31], v[92:95]
 s_waitcnt lgkmcnt(9)
 ds_read_b64_tr_b16 a[74:75], v7 offset:53760
 v_permlane16_swap_b32 v40, v42
 v_mfma_f32_16x16x32_bf16 v[96:99], a[80:83], a[24:27], v[96:99]
 ds_read_b64_tr_b16 a[76:77], v4 offset:57344
 v_permlane16_swap_b32 v41, v43
 v_mfma_f32_16x16x32_bf16 v[100:103], a[80:83], a[28:31], v[100:103]
 s_waitcnt lgkmcnt(9)
 ds_read_b64_tr_b16 a[78:79], v4 offset:57856
 v_mfma_f32_16x16x32_bf16 v[104:107], a[84:87], a[24:27], v[104:107]
 s_add_u32 s89, s85, 310272
 ds_read_b64_tr_b16 a[80:81], v5 offset:57344
 buffer_store_dwordx4 v[40:43], v24, s[36:39], s89 offen sc1
 v_mfma_f32_16x16x32_bf16 v[108:111], a[84:87], a[28:31], v[108:111]
 s_waitcnt lgkmcnt(9)
 ds_read_b64_tr_b16 a[82:83], v5 offset:57856
 v_accvgpr_read_b32 v48, a108
 v_accvgpr_read_b32 v49, a109
 v_mfma_f32_16x16x32_bf16 v[80:83], a[88:91], a[32:35], v[80:83]
 s_add_u32 m0, s87, 2048
 ds_read_b64_tr_b16 a[84:85], v6 offset:57344
 buffer_load_dwordx4 v20, s[36:39], s99 offen sc1 lds
 v_accvgpr_read_b32 v50, a110
 v_mfma_f32_16x16x32_bf16 v[84:87], a[88:91], a[36:39], v[84:87]
 s_waitcnt lgkmcnt(9)
 ds_read_b64_tr_b16 a[86:87], v6 offset:57856
 v_accvgpr_read_b32 v51, a111
 v_accvgpr_read_b32 v52, a112
 v_mfma_f32_16x16x32_bf16 v[88:91], a[92:95], a[32:35], v[88:91]
 ds_read_b64_tr_b16 a[88:89], v7 offset:57344
 v_accvgpr_read_b32 v53, a113
 v_accvgpr_read_b32 v54, a114
 v_mfma_f32_16x16x32_bf16 v[92:95], a[92:95], a[36:39], v[92:95]
 s_waitcnt lgkmcnt(9)
 ds_read_b64_tr_b16 a[90:91], v7 offset:57856
 v_accvgpr_read_b32 v55, a115
 v_accvgpr_read_b32 v56, a116
 v_mfma_f32_16x16x32_bf16 v[96:99], a[96:99], a[32:35], v[96:99]
 s_waitcnt vmcnt(12)
 s_barrier
 ds_read_b64_tr_b16 a[92:93], v4 offset:61440
 v_accvgpr_read_b32 v57, a117
 v_accvgpr_read_b32 v58, a118
 v_mfma_f32_16x16x32_bf16 v[100:103], a[96:99], a[36:39], v[100:103]
 s_waitcnt lgkmcnt(9)
 ds_read_b64_tr_b16 a[94:95], v4 offset:61952
 v_accvgpr_read_b32 v59, a119
 v_accvgpr_read_b32 v60, a120
 v_mfma_f32_16x16x32_bf16 v[104:107], a[72:75], a[32:35], v[104:107]
 s_add_u32 m0, s87, 3072
 ds_read_b64_tr_b16 a[96:97], v5 offset:61440
 buffer_load_dwordx4 v21, s[36:39], s99 offen sc1 lds
 v_accvgpr_read_b32 v61, a121
 v_mfma_f32_16x16x32_bf16 v[108:111], a[72:75], a[36:39], v[108:111]
 s_waitcnt lgkmcnt(9)
 ds_read_b64_tr_b16 a[98:99], v5 offset:61952
 v_accvgpr_read_b32 v62, a122
 v_accvgpr_read_b32 v63, a123
 v_mfma_f32_16x16x32_bf16 v[80:83], a[76:79], a[40:43], v[80:83]
 ds_read_b64_tr_b16 a[72:73], v6 offset:61440
 v_accvgpr_read_b32 v64, a124
 v_accvgpr_read_b32 v65, a125
 v_mfma_f32_16x16x32_bf16 v[84:87], a[76:79], a[44:47], v[84:87]
 s_waitcnt lgkmcnt(9)
 ds_read_b64_tr_b16 a[74:75], v6 offset:61952
 v_accvgpr_read_b32 v66, a126
 v_accvgpr_read_b32 v67, a127
 v_mfma_f32_16x16x32_bf16 v[88:91], a[80:83], a[40:43], v[88:91]
 ds_read_b64_tr_b16 a[76:77], v7 offset:61440
 v_accvgpr_read_b32 v68, a128
 v_accvgpr_read_b32 v69, a129
 v_mfma_f32_16x16x32_bf16 v[92:95], a[80:83], a[44:47], v[92:95]
 s_waitcnt lgkmcnt(9)
 ds_read_b64_tr_b16 a[78:79], v7 offset:61952
 v_accvgpr_read_b32 v70, a130
 v_accvgpr_read_b32 v71, a131
 v_mfma_f32_16x16x32_bf16 v[96:99], a[84:87], a[40:43], v[96:99]
 s_add_u32 m0, s87, 4096
 ds_read_b64_tr_b16 a[80:81], v8 offset:0
 buffer_load_dwordx4 v22, s[36:39], s99 offen sc1 lds
 v_accvgpr_read_b32 v72, a132
 v_mfma_f32_16x16x32_bf16 v[100:103], a[84:87], a[44:47], v[100:103]
 s_waitcnt lgkmcnt(9)
 ds_read_b64_tr_b16 a[82:83], v8 offset:512
 v_accvgpr_read_b32 v73, a133
 v_accvgpr_read_b32 v74, a134
 v_mfma_f32_16x16x32_bf16 v[104:107], a[88:91], a[40:43], v[104:107]
 ds_read_b64_tr_b16 a[84:85], v9 offset:0
 v_accvgpr_read_b32 v75, a135
 v_accvgpr_read_b32 v76, a136
 v_mfma_f32_16x16x32_bf16 v[108:111], a[88:91], a[44:47], v[108:111]
 s_waitcnt lgkmcnt(9)
 ds_read_b64_tr_b16 a[86:87], v9 offset:512
 v_accvgpr_read_b32 v77, a137
 v_accvgpr_read_b32 v78, a138
 v_mfma_f32_16x16x32_bf16 v[80:83], a[92:95], a[48:51], v[80:83]
 ds_read_b64_tr_b16 a[88:89], v10 offset:0
 v_accvgpr_read_b32 v79, a139
 v_mfma_f32_16x16x32_bf16 v[84:87], a[92:95], a[52:55], v[84:87]
 s_waitcnt lgkmcnt(9)
 ds_read_b64_tr_b16 a[90:91], v10 offset:512
 v_mfma_f32_16x16x32_bf16 v[88:91], a[96:99], a[48:51], v[88:91]
 ds_read_b64_tr_b16 a[92:93], v11 offset:0
 v_mfma_f32_16x16x32_bf16 v[92:95], a[96:99], a[52:55], v[92:95]
 s_waitcnt lgkmcnt(9)
 ds_read_b64_tr_b16 a[94:95], v11 offset:512
 v_mfma_f32_16x16x32_bf16 v[96:99], a[72:75], a[48:51], v[96:99]
 ds_read_b64_tr_b16 a[96:97], v8 offset:4096
 v_mfma_f32_16x16x32_bf16 v[100:103], a[72:75], a[52:55], v[100:103]
 s_waitcnt lgkmcnt(9)
 ds_read_b64_tr_b16 a[98:99], v8 offset:4608
 v_mfma_f32_16x16x32_bf16 v[104:107], a[76:79], a[48:51], v[104:107]
 ds_read_b64_tr_b16 a[72:73], v9 offset:4096
 v_mfma_f32_16x16x32_bf16 v[108:111], a[76:79], a[52:55], v[108:111]
 s_waitcnt lgkmcnt(9)
 ds_read_b64_tr_b16 a[74:75], v9 offset:4608
 v_mfma_f32_16x16x32_bf16 v[80:83], a[80:83], a[56:59], v[80:83]
 ds_read_b64_tr_b16 a[76:77], v10 offset:4096
 v_mfma_f32_16x16x32_bf16 v[84:87], a[80:83], a[60:63], v[84:87]
 s_waitcnt lgkmcnt(9)
 ds_read_b64_tr_b16 a[78:79], v10 offset:4608
 v_mfma_f32_16x16x32_bf16 v[88:91], a[84:87], a[56:59], v[88:91]
 ds_read_b64_tr_b16 a[80:81], v11 offset:4096
 v_mfma_f32_16x16x32_bf16 v[92:95], a[84:87], a[60:63], v[92:95]
 s_waitcnt lgkmcnt(9)
 ds_read_b64_tr_b16 a[82:83], v11 offset:4608
 v_mfma_f32_16x16x32_bf16 v[96:99], a[88:91], a[56:59], v[96:99]
 v_mfma_f32_16x16x32_bf16 v[100:103], a[88:91], a[60:63], v[100:103]
 s_waitcnt lgkmcnt(8)
 v_mfma_f32_16x16x32_bf16 v[104:107], a[92:95], a[56:59], v[104:107]
 v_mfma_f32_16x16x32_bf16 v[108:111], a[92:95], a[60:63], v[108:111]
 s_waitcnt lgkmcnt(6)
 v_mfma_f32_16x16x32_bf16 v[80:83], a[96:99], a[64:67], v[80:83]
 v_mfma_f32_16x16x32_bf16 v[84:87], a[96:99], a[68:71], v[84:87]
 s_waitcnt lgkmcnt(4)
 v_mfma_f32_16x16x32_bf16 v[88:91], a[72:75], a[64:67], v[88:91]
 v_mfma_f32_32x32x8bf16_1k v[112:127], a[156:157], v[232:233], v[160:175]
 v_mfma_f32_16x16x32_bf16 v[92:95], a[72:75], a[68:71], v[92:95]
 s_waitcnt lgkmcnt(2)
 v_mfma_f32_32x32x16_bf16 v[112:127], a[148:151], v[224:227], v[112:127]
 v_mfma_f32_16x16x32_bf16 v[96:99], a[76:79], a[64:67], v[96:99]
 v_mfma_f32_16x16x32_bf16 v[100:103], a[76:79], a[68:71], v[100:103]
 s_waitcnt lgkmcnt(0)
 v_mfma_f32_16x16x32_bf16 v[104:107], a[80:83], a[64:67], v[104:107]
 v_mfma_f32_16x16x32_bf16 v[108:111], a[80:83], a[68:71], v[108:111]
 s_barrier
 s_nop 3
 v_cvt_pk_bf16_f32 v4, v80, v81
 v_cvt_pk_bf16_f32 v6, v88, v89
 v_cvt_pk_bf16_f32 v5, v82, v83
 v_cvt_pk_bf16_f32 v7, v90, v91
 s_nop 0
 v_permlane16_swap_b32 v4, v6
 v_permlane16_swap_b32 v5, v7
 v_cvt_pk_bf16_f32 v8, v84, v85
 v_cvt_pk_bf16_f32 v10, v92, v93
 v_cvt_pk_bf16_f32 v9, v86, v87
 v_cvt_pk_bf16_f32 v11, v94, v95
 s_nop 0
 v_permlane16_swap_b32 v8, v10
 v_permlane16_swap_b32 v9, v11
 v_cvt_pk_bf16_f32 v12, v96, v97
 v_cvt_pk_bf16_f32 v14, v104, v105
 v_cvt_pk_bf16_f32 v13, v98, v99
 v_cvt_pk_bf16_f32 v15, v106, v107
 s_nop 0
 v_permlane16_swap_b32 v12, v14
 v_permlane16_swap_b32 v13, v15
 v_cvt_pk_bf16_f32 v28, v100, v101
 v_cvt_pk_bf16_f32 v30, v108, v109
 v_cvt_pk_bf16_f32 v29, v102, v103
 v_cvt_pk_bf16_f32 v31, v110, v111
 s_nop 0
 v_permlane16_swap_b32 v28, v30
 v_permlane16_swap_b32 v29, v31
 v_mfma_f32_32x32x8bf16_1k v[128:143], a[156:157], v[236:237], v[176:191]
 s_add_u32 s78, s86, 912384
 ds_read_b128 a[164:167], v75 offset:57344
 v_exp_f32 v112, v112
 v_exp_f32 v113, v113
 v_exp_f32 v114, v114
 v_exp_f32 v115, v115
 v_mfma_f32_32x32x16_bf16 v[128:143], a[148:151], v[228:231], v[128:143]
 s_add_u32 m0, s87, 20480
 v_exp_f32 v116, v116
 v_exp_f32 v117, v117
 v_exp_f32 v118, v118
 v_exp_f32 v119, v119
 s_add_u32 s89, s85, 16384
 ds_read_b128 a[168:171], v75 offset:58528
 v_exp_f32 v120, v120
 v_exp_f32 v121, v121
 v_exp_f32 v122, v122
 v_exp_f32 v123, v123
 buffer_store_dwordx4 v[4:7], v24, s[36:39], s89 offen sc1
 v_exp_f32 v124, v124
 v_exp_f32 v125, v125
 v_exp_f32 v126, v126
 v_exp_f32 v127, v127
 v_mfma_f32_32x32x8bf16_1k v[144:159], a[158:159], v[232:233], v[160:175]
 buffer_load_dwordx4 v18, s[36:39], s78 offen sc1 lds
 v_exp_f32 v128, v128
 v_exp_f32 v129, v129
 v_exp_f32 v130, v130
 v_exp_f32 v131, v131
 v_mfma_f32_32x32x16_bf16 v[144:159], a[152:155], v[224:227], v[144:159]
 s_waitcnt lgkmcnt(0)
 ds_read2st64_b64 a[148:151], v73 offset0:90 offset1:91
 v_exp_f32 v132, v132
 v_exp_f32 v133, v133
 v_exp_f32 v134, v134
 v_exp_f32 v135, v135
 v_smfmac_f32_32x32x32_bf16 v[192:207], a[164:167], v[112:119], v50
 s_add_u32 m0, s87, 21504
 v_exp_f32 v136, v136
 v_exp_f32 v137, v137
 v_exp_f32 v138, v138
 v_exp_f32 v139, v139
 v_smfmac_f32_32x32x32_bf16 v[192:207], a[168:171], v[120:127], v50
 buffer_load_dwordx4 v19, s[36:39], s78 offen sc1 lds
 v_exp_f32 v140, v140
 v_exp_f32 v141, v141
 v_exp_f32 v142, v142
 v_exp_f32 v143, v143
 v_mfma_f32_32x32x8bf16_1k v[112:127], a[158:159], v[236:237], v[176:191]
 s_add_u32 m0, s87, 22528
 ds_read_b128 a[172:175], v75 offset:59712
 v_exp_f32 v144, v144
 v_exp_f32 v145, v145
 v_exp_f32 v146, v146
 v_exp_f32 v147, v147
 v_mfma_f32_32x32x16_bf16 v[112:127], a[152:155], v[228:231], v[112:127]
 buffer_load_dwordx4 v20, s[36:39], s78 offen sc1 lds
 v_exp_f32 v148, v148
 v_exp_f32 v149, v149
 v_exp_f32 v150, v150
 v_exp_f32 v151, v151
 v_smfmac_f32_32x32x32_bf16 v[208:223], a[164:167], v[128:135], v50
 s_add_u32 m0, s87, 23552
 ds_read_b128 a[176:179], v75 offset:60896
 v_exp_f32 v152, v152
 v_exp_f32 v153, v153
 v_exp_f32 v154, v154
 v_exp_f32 v155, v155
 v_smfmac_f32_32x32x32_bf16 v[208:223], a[168:171], v[136:143], v50
 s_add_u32 s89, s85, 311296
 buffer_store_dwordx4 v[8:11], v24, s[36:39], s89 offen sc1
 v_exp_f32 v156, v156
 v_exp_f32 v157, v157
 v_exp_f32 v158, v158
 v_exp_f32 v159, v159
 v_mfma_f32_32x32x8bf16_1k v[128:143], a[156:157], v[234:235], v[160:175]
 s_waitcnt lgkmcnt(2)
 buffer_load_dwordx4 v21, s[36:39], s78 offen sc1 lds
 v_exp_f32 v112, v112
 v_exp_f32 v113, v113
 v_exp_f32 v114, v114
 v_exp_f32 v115, v115
 v_mfma_f32_32x32x16_bf16 v[128:143], a[148:151], v[224:227], v[128:143]
 s_waitcnt lgkmcnt(0)
 ds_read2st64_b64 a[152:155], v73 offset0:95 offset1:96
 v_exp_f32 v116, v116
 v_exp_f32 v117, v117
 v_exp_f32 v118, v118
 v_exp_f32 v119, v119
 v_smfmac_f32_32x32x32_bf16 v[192:207], a[172:175], v[144:151], v50
 s_add_u32 m0, s87, 24576
 v_exp_f32 v120, v120
 v_exp_f32 v121, v121
 v_exp_f32 v122, v122
 v_exp_f32 v123, v123
 v_smfmac_f32_32x32x32_bf16 v[192:207], a[176:179], v[152:159], v50
 buffer_load_dwordx4 v22, s[36:39], s78 offen sc1 lds
 v_exp_f32 v124, v124
 v_exp_f32 v125, v125
 v_exp_f32 v126, v126
 v_exp_f32 v127, v127
 v_mfma_f32_32x32x8bf16_1k v[144:159], a[156:157], v[238:239], v[176:191]
 ds_read_b128 a[164:167], v75 offset:62080
 v_exp_f32 v128, v128
 v_exp_f32 v129, v129
 v_exp_f32 v130, v130
 v_exp_f32 v131, v131
 v_mfma_f32_32x32x16_bf16 v[144:159], a[148:151], v[228:231], v[144:159]
 v_exp_f32 v132, v132
 v_exp_f32 v133, v133
 v_exp_f32 v134, v134
 v_exp_f32 v135, v135
 v_smfmac_f32_32x32x32_bf16 v[208:223], a[172:175], v[112:119], v50
 ds_read_b128 a[168:171], v75 offset:63264
 v_exp_f32 v136, v136
 v_exp_f32 v137, v137
 v_exp_f32 v138, v138
 v_exp_f32 v139, v139
 v_smfmac_f32_32x32x32_bf16 v[208:223], a[176:179], v[120:127], v50
 s_barrier
 v_exp_f32 v140, v140
 v_exp_f32 v141, v141
 v_exp_f32 v142, v142
 v_exp_f32 v143, v143
 v_mfma_f32_32x32x8bf16_1k v[112:127], a[158:159], v[234:235], v[160:175]
 s_waitcnt lgkmcnt(2)
 ds_read2st64_b64 a[160:163], v49 offset0:120 offset1:125
 v_exp_f32 v144, v144
 v_exp_f32 v145, v145
 v_exp_f32 v146, v146
 v_exp_f32 v147, v147
 v_mfma_f32_32x32x16_bf16 v[112:127], a[152:155], v[224:227], v[112:127]
 s_waitcnt lgkmcnt(1)
 ds_read2st64_b64 a[148:151], v73 offset0:120 offset1:121
 v_exp_f32 v148, v148
 v_exp_f32 v149, v149
 v_exp_f32 v150, v150
 v_exp_f32 v151, v151
 v_smfmac_f32_32x32x32_bf16 v[192:207], a[164:167], v[128:135], v50
 s_add_u32 s89, s85, 17408
 s_add_u32 s78, s86, 1216512
 buffer_store_dwordx4 v[12:15], v24, s[36:39], s89 offen sc1
 v_exp_f32 v152, v152
 v_exp_f32 v153, v153
 v_exp_f32 v154, v154
 v_exp_f32 v155, v155
 v_smfmac_f32_32x32x32_bf16 v[192:207], a[168:171], v[136:143], v50
 s_add_u32 m0, s87, 40960
 v_exp_f32 v156, v156
 v_exp_f32 v157, v157
 v_exp_f32 v158, v158
 v_exp_f32 v159, v159
 v_mfma_f32_32x32x8bf16_1k v[128:143], a[158:159], v[238:239], v[176:191]
 ds_read_b128 a[172:175], v75 offset:64448
 v_exp_f32 v112, v112
 v_exp_f32 v113, v113
 v_exp_f32 v114, v114
 v_exp_f32 v115, v115
 v_mfma_f32_32x32x16_bf16 v[128:143], a[152:155], v[228:231], v[128:143]
 buffer_load_dwordx4 v18, s[36:39], s78 offen sc1 lds
 v_exp_f32 v116, v116
 v_exp_f32 v117, v117
 v_exp_f32 v118, v118
 v_exp_f32 v119, v119
 v_smfmac_f32_32x32x32_bf16 v[208:223], a[164:167], v[144:151], v50
 s_add_u32 m0, s87, 41984
 ds_read_b128 a[176:179], v76 offset:96
 v_exp_f32 v120, v120
 v_exp_f32 v121, v121
 v_exp_f32 v122, v122
 v_exp_f32 v123, v123
 v_smfmac_f32_32x32x32_bf16 v[208:223], a[168:171], v[152:159], v50
 s_waitcnt lgkmcnt(3)
 buffer_load_dwordx4 v19, s[36:39], s78 offen sc1 lds
 v_exp_f32 v124, v124
 v_exp_f32 v125, v125
 v_exp_f32 v126, v126
 v_exp_f32 v127, v127
 v_mfma_f32_32x32x8bf16_1k v[144:159], a[160:161], v[232:233], v[160:175]
 s_waitcnt lgkmcnt(2)
 v_exp_f32 v128, v128
 v_exp_f32 v129, v129
 v_exp_f32 v130, v130
 v_exp_f32 v131, v131
 v_mfma_f32_32x32x16_bf16 v[144:159], a[148:151], v[224:227], v[144:159]
 s_waitcnt lgkmcnt(0)
 ds_read2st64_b64 a[152:155], v73 offset0:125 offset1:126
 v_exp_f32 v132, v132
 v_exp_f32 v133, v133
 v_exp_f32 v134, v134
 v_exp_f32 v135, v135
 v_smfmac_f32_32x32x32_bf16 v[192:207], a[172:175], v[112:119], v50
 s_add_u32 s89, s85, 312320
 s_add_u32 m0, s87, 43008
 buffer_store_dwordx4 v[28:31], v24, s[36:39], s89 offen sc1
 v_exp_f32 v136, v136
 v_exp_f32 v137, v137
 v_exp_f32 v138, v138
 v_exp_f32 v139, v139
 v_smfmac_f32_32x32x32_bf16 v[192:207], a[176:179], v[120:127], v50
 buffer_load_dwordx4 v20, s[36:39], s78 offen sc1 lds
 v_exp_f32 v140, v140
 v_exp_f32 v141, v141
 v_exp_f32 v142, v142
 v_exp_f32 v143, v143
 v_mfma_f32_32x32x8bf16_1k v[112:127], a[160:161], v[236:237], v[176:191]
 s_add_u32 m0, s87, 44032
 ds_read_b128 a[164:167], v76 offset:12288
 v_exp_f32 v144, v144
 v_exp_f32 v145, v145
 v_exp_f32 v146, v146
 v_exp_f32 v147, v147
 v_mfma_f32_32x32x16_bf16 v[112:127], a[148:151], v[228:231], v[112:127]
 buffer_load_dwordx4 v21, s[36:39], s78 offen sc1 lds
 v_exp_f32 v148, v148
 v_exp_f32 v149, v149
 v_exp_f32 v150, v150
 v_exp_f32 v151, v151
 v_smfmac_f32_32x32x32_bf16 v[208:223], a[172:175], v[128:135], v50
 s_add_u32 m0, s87, 45056
 ds_read_b128 a[168:171], v76 offset:13472
 v_exp_f32 v152, v152
 v_exp_f32 v153, v153
 v_exp_f32 v154, v154
 v_exp_f32 v155, v155
 v_smfmac_f32_32x32x32_bf16 v[208:223], a[176:179], v[136:143], v50
 buffer_load_dwordx4 v22, s[36:39], s78 offen sc1 lds
 v_exp_f32 v156, v156
 v_exp_f32 v157, v157
 v_exp_f32 v158, v158
 v_exp_f32 v159, v159
 v_mfma_f32_32x32x8bf16_1k v[128:143], a[162:163], v[232:233], v[160:175]
 s_waitcnt lgkmcnt(2)
 v_exp_f32 v112, v112
 v_exp_f32 v113, v113
 v_exp_f32 v114, v114
 v_exp_f32 v115, v115
 v_mfma_f32_32x32x16_bf16 v[128:143], a[152:155], v[224:227], v[128:143]
 s_waitcnt lgkmcnt(0)
 ds_read2st64_b64 a[148:151], v73 offset0:130 offset1:131
 v_exp_f32 v116, v116
 v_exp_f32 v117, v117
 v_exp_f32 v118, v118
 v_exp_f32 v119, v119
 v_smfmac_f32_32x32x32_bf16 v[192:207], a[164:167], v[144:151], v50
L_cp4:
 s_add_u32 s84, s82, L_cp4-parallel_sum__mha_block__glu_gated_bilinear__prompt_kernel+8192
 buffer_load_dword a248, off, s[44:47], s84
 v_exp_f32 v120, v120
 v_exp_f32 v121, v121
 v_exp_f32 v122, v122
 v_exp_f32 v123, v123
 v_smfmac_f32_32x32x32_bf16 v[192:207], a[168:171], v[152:159], v50
 v_exp_f32 v124, v124
 v_exp_f32 v125, v125
 v_exp_f32 v126, v126
 v_exp_f32 v127, v127
 v_mfma_f32_32x32x8bf16_1k v[144:159], a[162:163], v[236:237], v[176:191]
 ds_read_b128 a[172:175], v76 offset:14656
 v_exp_f32 v128, v128
 v_exp_f32 v129, v129
 v_exp_f32 v130, v130
 v_exp_f32 v131, v131
 v_mfma_f32_32x32x16_bf16 v[144:159], a[152:155], v[228:231], v[144:159]
 v_exp_f32 v132, v132
 v_exp_f32 v133, v133
 v_exp_f32 v134, v134
 v_exp_f32 v135, v135
 v_smfmac_f32_32x32x32_bf16 v[208:223], a[164:167], v[112:119], v50
 ds_read_b128 a[176:179], v76 offset:15840
 v_exp_f32 v136, v136
 v_exp_f32 v137, v137
 v_exp_f32 v138, v138
 v_exp_f32 v139, v139
 v_smfmac_f32_32x32x32_bf16 v[208:223], a[168:171], v[120:127], v50
 v_exp_f32 v140, v140
 v_exp_f32 v141, v141
 v_exp_f32 v142, v142
 v_exp_f32 v143, v143
 v_mfma_f32_32x32x8bf16_1k v[112:127], a[160:161], v[234:235], v[160:175]
 s_waitcnt lgkmcnt(2)
 v_exp_f32 v144, v144
 v_exp_f32 v145, v145
 v_exp_f32 v146, v146
 v_exp_f32 v147, v147
 v_mfma_f32_32x32x16_bf16 v[112:127], a[148:151], v[224:227], v[112:127]
 s_waitcnt lgkmcnt(0)
 ds_read2st64_b64 a[152:155], v73 offset0:135 offset1:136
 v_exp_f32 v148, v148
 v_exp_f32 v149, v149
 v_exp_f32 v150, v150
 v_exp_f32 v151, v151
 v_smfmac_f32_32x32x32_bf16 v[192:207], a[172:175], v[128:135], v50
 v_exp_f32 v152, v152
 v_exp_f32 v153, v153
 v_exp_f32 v154, v154
 v_exp_f32 v155, v155
 v_smfmac_f32_32x32x32_bf16 v[192:207], a[176:179], v[136:143], v50
 v_exp_f32 v156, v156
 v_exp_f32 v157, v157
 v_exp_f32 v158, v158
 v_exp_f32 v159, v159
 v_mfma_f32_32x32x8bf16_1k v[128:143], a[160:161], v[238:239], v[176:191]
 ds_read_b128 a[164:167], v76 offset:17024
 v_exp_f32 v112, v112
 v_exp_f32 v113, v113
 v_exp_f32 v114, v114
 v_exp_f32 v115, v115
 v_mfma_f32_32x32x16_bf16 v[128:143], a[148:151], v[228:231], v[128:143]
 v_exp_f32 v116, v116
 v_exp_f32 v117, v117
 v_exp_f32 v118, v118
 v_exp_f32 v119, v119
 v_smfmac_f32_32x32x32_bf16 v[208:223], a[172:175], v[144:151], v50
 ds_read_b128 a[168:171], v76 offset:18208
 v_exp_f32 v120, v120
 v_exp_f32 v121, v121
 v_exp_f32 v122, v122
 v_exp_f32 v123, v123
 v_smfmac_f32_32x32x32_bf16 v[208:223], a[176:179], v[152:159], v50
 s_waitcnt vmcnt(15)
 s_barrier
 v_exp_f32 v124, v124
 v_exp_f32 v125, v125
 v_exp_f32 v126, v126
 v_exp_f32 v127, v127
 v_mfma_f32_32x32x8bf16_1k v[144:159], a[162:163], v[234:235], v[160:175]
 s_waitcnt lgkmcnt(2)
 ds_read2st64_b64 a[156:159], v48 offset0:0 offset1:5
 v_exp_f32 v128, v128
 v_exp_f32 v129, v129
 v_exp_f32 v130, v130
 v_exp_f32 v131, v131
 v_mfma_f32_32x32x16_bf16 v[144:159], a[152:155], v[224:227], v[144:159]
 s_waitcnt lgkmcnt(1)
 ds_read2st64_b64 a[148:151], v72 offset0:0 offset1:1
 v_exp_f32 v132, v132
 v_exp_f32 v133, v133
 v_exp_f32 v134, v134
 v_exp_f32 v135, v135
 v_smfmac_f32_32x32x32_bf16 v[192:207], a[164:167], v[112:119], v50
 s_add_u32 s78, s86, 1520640
 s_add_u32 m0, s87, 61440
 v_exp_f32 v136, v136
 v_exp_f32 v137, v137
 v_exp_f32 v138, v138
 v_exp_f32 v139, v139
 v_smfmac_f32_32x32x32_bf16 v[192:207], a[168:171], v[120:127], v50
 buffer_load_dwordx4 v18, s[36:39], s78 offen sc1 lds
 v_exp_f32 v140, v140
 v_exp_f32 v141, v141
 v_exp_f32 v142, v142
 v_exp_f32 v143, v143
 v_mfma_f32_32x32x8bf16_1k v[112:127], a[162:163], v[238:239], v[176:191]
 s_add_u32 m0, s87, 62464
 ds_read_b128 a[172:175], v76 offset:19392
 v_exp_f32 v144, v144
 v_exp_f32 v145, v145
 v_exp_f32 v146, v146
 v_exp_f32 v147, v147
 v_mfma_f32_32x32x16_bf16 v[112:127], a[152:155], v[228:231], v[112:127]
 buffer_load_dwordx4 v19, s[36:39], s78 offen sc1 lds
 v_exp_f32 v148, v148
 v_exp_f32 v149, v149
 v_exp_f32 v150, v150
 v_exp_f32 v151, v151
 v_smfmac_f32_32x32x32_bf16 v[208:223], a[164:167], v[128:135], v50
 s_add_u32 m0, s87, 63488
 ds_read_b128 a[176:179], v76 offset:20576
 v_exp_f32 v152, v152
 v_exp_f32 v153, v153
 v_exp_f32 v154, v154
 v_exp_f32 v155, v155
 v_smfmac_f32_32x32x32_bf16 v[208:223], a[168:171], v[136:143], v50
 s_waitcnt lgkmcnt(3)
 buffer_load_dwordx4 v20, s[36:39], s78 offen sc1 lds
 v_exp_f32 v156, v156
 v_exp_f32 v157, v157
 v_exp_f32 v158, v158
 v_exp_f32 v159, v159
 v_mfma_f32_32x32x8bf16_1k v[128:143], a[156:157], v[232:233], v[160:175]
 s_waitcnt lgkmcnt(2)
 v_exp_f32 v112, v112
 v_exp_f32 v113, v113
 v_exp_f32 v114, v114
 v_exp_f32 v115, v115
 v_mfma_f32_32x32x16_bf16 v[128:143], a[148:151], v[224:227], v[128:143]
 s_waitcnt lgkmcnt(0)
 ds_read2st64_b64 a[152:155], v72 offset0:5 offset1:6
 v_exp_f32 v116, v116
 v_exp_f32 v117, v117
 v_exp_f32 v118, v118
 v_exp_f32 v119, v119
 v_smfmac_f32_32x32x32_bf16 v[192:207], a[172:175], v[144:151], v50
 s_add_u32 m0, s87, 64512
 v_exp_f32 v120, v120
 v_exp_f32 v121, v121
 v_exp_f32 v122, v122
 v_exp_f32 v123, v123
 v_smfmac_f32_32x32x32_bf16 v[192:207], a[176:179], v[152:159], v50
 buffer_load_dwordx4 v21, s[36:39], s78 offen sc1 lds
 v_exp_f32 v124, v124
 v_exp_f32 v125, v125
 v_exp_f32 v126, v126
 v_exp_f32 v127, v127
 v_mfma_f32_32x32x8bf16_1k v[144:159], a[156:157], v[236:237], v[176:191]
 s_add_u32 m0, s87, 65536
 ds_read_b128 a[164:167], v74 offset:0
 v_exp_f32 v128, v128
 v_exp_f32 v129, v129
 v_exp_f32 v130, v130
 v_exp_f32 v131, v131
 v_mfma_f32_32x32x16_bf16 v[144:159], a[148:151], v[228:231], v[144:159]
 buffer_load_dwordx4 v22, s[36:39], s78 offen sc1 lds
 v_exp_f32 v132, v132
 v_exp_f32 v133, v133
 v_exp_f32 v134, v134
 v_exp_f32 v135, v135
 v_smfmac_f32_32x32x32_bf16 v[208:223], a[172:175], v[112:119], v50
 ds_read_b128 a[168:171], v74 offset:1184
 v_exp_f32 v136, v136
 v_exp_f32 v137, v137
 v_exp_f32 v138, v138
 v_exp_f32 v139, v139
 v_smfmac_f32_32x32x32_bf16 v[208:223], a[176:179], v[120:127], v50
 v_exp_f32 v140, v140
 v_exp_f32 v141, v141
 v_exp_f32 v142, v142
 v_exp_f32 v143, v143
 v_mfma_f32_32x32x8bf16_1k v[112:127], a[158:159], v[232:233], v[160:175]
 s_waitcnt lgkmcnt(2)
 buffer_load_dwordx4 a[0:3], v53, s[4:7], s92 offen offset:0
 v_exp_f32 v144, v144
 v_exp_f32 v145, v145
 v_exp_f32 v146, v146
 v_exp_f32 v147, v147
 v_mfma_f32_32x32x16_bf16 v[112:127], a[152:155], v[224:227], v[112:127]
 s_waitcnt lgkmcnt(0)
 ds_read2st64_b64 a[148:151], v72 offset0:10 offset1:11
 v_exp_f32 v148, v148
 v_exp_f32 v149, v149
 v_exp_f32 v150, v150
 v_exp_f32 v151, v151
 v_smfmac_f32_32x32x32_bf16 v[192:207], a[164:167], v[128:135], v50
 v_exp_f32 v152, v152
 v_exp_f32 v153, v153
 v_exp_f32 v154, v154
 v_exp_f32 v155, v155
 v_smfmac_f32_32x32x32_bf16 v[192:207], a[168:171], v[136:143], v50
 buffer_load_dwordx4 a[4:7], v53, s[4:7], s92 offen offset:32
 v_exp_f32 v156, v156
 v_exp_f32 v157, v157
 v_exp_f32 v158, v158
 v_exp_f32 v159, v159
 v_mfma_f32_32x32x8bf16_1k v[128:143], a[158:159], v[236:237], v[176:191]
 ds_read_b128 a[172:175], v74 offset:2368
 v_exp_f32 v112, v112
 v_exp_f32 v113, v113
 v_exp_f32 v114, v114
 v_exp_f32 v115, v115
 v_mfma_f32_32x32x16_bf16 v[128:143], a[152:155], v[228:231], v[128:143]
 v_exp_f32 v116, v116
 v_exp_f32 v117, v117
 v_exp_f32 v118, v118
 v_exp_f32 v119, v119
 v_smfmac_f32_32x32x32_bf16 v[208:223], a[164:167], v[144:151], v50
 ds_read_b128 a[176:179], v74 offset:3552
 v_exp_f32 v120, v120
 v_exp_f32 v121, v121
 v_exp_f32 v122, v122
 v_exp_f32 v123, v123
 v_smfmac_f32_32x32x32_bf16 v[208:223], a[168:171], v[152:159], v50
 buffer_load_dwordx4 a[8:11], v53, s[4:7], s92 offen offset:64
 v_exp_f32 v124, v124
 v_exp_f32 v125, v125
 v_exp_f32 v126, v126
 v_exp_f32 v127, v127
 v_mfma_f32_32x32x8bf16_1k v[144:159], a[156:157], v[234:235], v[160:175]
 s_waitcnt lgkmcnt(2)
 v_exp_f32 v128, v128
 v_exp_f32 v129, v129
 v_exp_f32 v130, v130
 v_exp_f32 v131, v131
 v_mfma_f32_32x32x16_bf16 v[144:159], a[148:151], v[224:227], v[144:159]
 s_waitcnt lgkmcnt(0)
 ds_read2st64_b64 a[152:155], v72 offset0:15 offset1:16
 v_exp_f32 v132, v132
 v_exp_f32 v133, v133
 v_exp_f32 v134, v134
 v_exp_f32 v135, v135
 v_smfmac_f32_32x32x32_bf16 v[192:207], a[172:175], v[112:119], v50
 buffer_load_dwordx4 a[12:15], v53, s[4:7], s92 offen offset:96
 v_exp_f32 v136, v136
 v_exp_f32 v137, v137
 v_exp_f32 v138, v138
 v_exp_f32 v139, v139
 v_smfmac_f32_32x32x32_bf16 v[192:207], a[176:179], v[120:127], v50
 v_exp_f32 v140, v140
 v_exp_f32 v141, v141
 v_exp_f32 v142, v142
 v_exp_f32 v143, v143
 v_mfma_f32_32x32x8bf16_1k v[112:127], a[156:157], v[238:239], v[176:191]
 ds_read_b128 a[164:167], v74 offset:4736
 v_exp_f32 v144, v144
 v_exp_f32 v145, v145
 v_exp_f32 v146, v146
 v_exp_f32 v147, v147
 v_mfma_f32_32x32x16_bf16 v[112:127], a[148:151], v[228:231], v[112:127]
 buffer_load_dwordx4 a[16:19], v54, s[4:7], s92 offen offset:128
 v_exp_f32 v148, v148
 v_exp_f32 v149, v149
 v_exp_f32 v150, v150
 v_exp_f32 v151, v151
 v_smfmac_f32_32x32x32_bf16 v[208:223], a[172:175], v[128:135], v50
 ds_read_b128 a[168:171], v74 offset:5920
 v_exp_f32 v152, v152
 v_exp_f32 v153, v153
 v_exp_f32 v154, v154
 v_exp_f32 v155, v155
 v_smfmac_f32_32x32x32_bf16 v[208:223], a[176:179], v[136:143], v50
 s_waitcnt vmcnt(18)
 s_barrier
 v_exp_f32 v156, v156
 v_exp_f32 v157, v157
 v_exp_f32 v158, v158
 v_exp_f32 v159, v159
 v_mfma_f32_32x32x8bf16_1k v[128:143], a[158:159], v[234:235], v[160:175]
 s_waitcnt lgkmcnt(2)
 ds_read2st64_b64 a[160:163], v48 offset0:40 offset1:45
 v_exp_f32 v112, v112
 v_exp_f32 v113, v113
 v_exp_f32 v114, v114
 v_exp_f32 v115, v115
 v_mfma_f32_32x32x16_bf16 v[128:143], a[152:155], v[224:227], v[128:143]
 s_waitcnt lgkmcnt(1)
 ds_read2st64_b64 a[148:151], v72 offset0:40 offset1:41
 v_exp_f32 v116, v116
 v_exp_f32 v117, v117
 v_exp_f32 v118, v118
 v_exp_f32 v119, v119
 v_smfmac_f32_32x32x32_bf16 v[192:207], a[164:167], v[144:151], v50
 s_add_u32 s78, s86, 1824768
 s_add_u32 m0, s87, 81920
 v_exp_f32 v120, v120
 v_exp_f32 v121, v121
 v_exp_f32 v122, v122
 v_exp_f32 v123, v123
 v_smfmac_f32_32x32x32_bf16 v[192:207], a[168:171], v[152:159], v50
 buffer_load_dwordx4 v18, s[36:39], s78 offen sc1 lds
 v_exp_f32 v124, v124
 v_exp_f32 v125, v125
 v_exp_f32 v126, v126
 v_exp_f32 v127, v127
 v_mfma_f32_32x32x8bf16_1k v[144:159], a[158:159], v[238:239], v[176:191]
 s_add_u32 m0, s87, 82944
 ds_read_b128 a[172:175], v74 offset:7104
 v_exp_f32 v128, v128
 v_exp_f32 v129, v129
 v_exp_f32 v130, v130
 v_exp_f32 v131, v131
 v_mfma_f32_32x32x16_bf16 v[144:159], a[152:155], v[228:231], v[144:159]
 buffer_load_dwordx4 v19, s[36:39], s78 offen sc1 lds
 v_exp_f32 v132, v132
 v_exp_f32 v133, v133
 v_exp_f32 v134, v134
 v_exp_f32 v135, v135
 v_smfmac_f32_32x32x32_bf16 v[208:223], a[164:167], v[112:119], v50
 s_add_u32 m0, s87, 83968
 ds_read_b128 a[176:179], v74 offset:8288
 v_exp_f32 v136, v136
 v_exp_f32 v137, v137
 v_exp_f32 v138, v138
 v_exp_f32 v139, v139
 v_smfmac_f32_32x32x32_bf16 v[208:223], a[168:171], v[120:127], v50
 s_waitcnt lgkmcnt(3)
 buffer_load_dwordx4 v20, s[36:39], s78 offen sc1 lds
 v_exp_f32 v140, v140
 v_exp_f32 v141, v141
 v_exp_f32 v142, v142
 v_exp_f32 v143, v143
 v_mfma_f32_32x32x8bf16_1k v[112:127], a[160:161], v[232:233], v[160:175]
 s_waitcnt lgkmcnt(2)
 v_exp_f32 v144, v144
 v_exp_f32 v145, v145
 v_exp_f32 v146, v146
 v_exp_f32 v147, v147
 v_mfma_f32_32x32x16_bf16 v[112:127], a[148:151], v[224:227], v[112:127]
 s_waitcnt lgkmcnt(0)
 ds_read2st64_b64 a[152:155], v72 offset0:45 offset1:46
 v_exp_f32 v148, v148
 v_exp_f32 v149, v149
 v_exp_f32 v150, v150
 v_exp_f32 v151, v151
 v_smfmac_f32_32x32x32_bf16 v[192:207], a[172:175], v[128:135], v50
 s_add_u32 m0, s87, 84992
 v_exp_f32 v152, v152
 v_exp_f32 v153, v153
 v_exp_f32 v154, v154
 v_exp_f32 v155, v155
 v_smfmac_f32_32x32x32_bf16 v[192:207], a[176:179], v[136:143], v50
 buffer_load_dwordx4 v21, s[36:39], s78 offen sc1 lds
 v_exp_f32 v156, v156
 v_exp_f32 v157, v157
 v_exp_f32 v158, v158
 v_exp_f32 v159, v159
 v_mfma_f32_32x32x8bf16_1k v[128:143], a[160:161], v[236:237], v[176:191]
 s_add_u32 m0, s87, 86016
 ds_read_b128 a[164:167], v74 offset:20480
 v_exp_f32 v112, v112
 v_exp_f32 v113, v113
 v_exp_f32 v114, v114
 v_exp_f32 v115, v115
 v_mfma_f32_32x32x16_bf16 v[128:143], a[148:151], v[228:231], v[128:143]
 buffer_load_dwordx4 v22, s[36:39], s78 offen sc1 lds
 v_exp_f32 v116, v116
 v_exp_f32 v117, v117
 v_exp_f32 v118, v118
 v_exp_f32 v119, v119
 v_smfmac_f32_32x32x32_bf16 v[208:223], a[172:175], v[144:151], v50
 ds_read_b128 a[168:171], v74 offset:21664
 v_exp_f32 v120, v120
 v_exp_f32 v121, v121
 v_exp_f32 v122, v122
 v_exp_f32 v123, v123
 v_smfmac_f32_32x32x32_bf16 v[208:223], a[176:179], v[152:159], v50
 v_exp_f32 v124, v124
 v_exp_f32 v125, v125
 v_exp_f32 v126, v126
 v_exp_f32 v127, v127
 v_mfma_f32_32x32x8bf16_1k v[144:159], a[162:163], v[232:233], v[160:175]
 s_waitcnt lgkmcnt(2)
 v_exp_f32 v128, v128
 v_exp_f32 v129, v129
 v_exp_f32 v130, v130
 v_exp_f32 v131, v131
 v_mfma_f32_32x32x16_bf16 v[144:159], a[152:155], v[224:227], v[144:159]
 s_waitcnt lgkmcnt(0)
 ds_read2st64_b64 a[148:151], v72 offset0:50 offset1:51
 v_exp_f32 v132, v132
 v_exp_f32 v133, v133
 v_exp_f32 v134, v134
 v_exp_f32 v135, v135
 v_smfmac_f32_32x32x32_bf16 v[192:207], a[164:167], v[112:119], v50
 v_exp_f32 v136, v136
 v_exp_f32 v137, v137
 v_exp_f32 v138, v138
 v_exp_f32 v139, v139
 v_smfmac_f32_32x32x32_bf16 v[192:207], a[168:171], v[120:127], v50
 v_exp_f32 v140, v140
 v_exp_f32 v141, v141
 v_exp_f32 v142, v142
 v_exp_f32 v143, v143
 v_mfma_f32_32x32x8bf16_1k v[112:127], a[162:163], v[236:237], v[176:191]
 ds_read_b128 a[172:175], v74 offset:22848
 v_exp_f32 v144, v144
 v_exp_f32 v145, v145
 v_exp_f32 v146, v146
 v_exp_f32 v147, v147
 v_mfma_f32_32x32x16_bf16 v[112:127], a[152:155], v[228:231], v[112:127]
 v_exp_f32 v148, v148
 v_exp_f32 v149, v149
 v_exp_f32 v150, v150
 v_exp_f32 v151, v151
 v_smfmac_f32_32x32x32_bf16 v[208:223], a[164:167], v[128:135], v50
 ds_read_b128 a[176:179], v74 offset:24032
 v_exp_f32 v152, v152
 v_exp_f32 v153, v153
 v_exp_f32 v154, v154
 v_exp_f32 v155, v155
 v_smfmac_f32_32x32x32_bf16 v[208:223], a[168:171], v[136:143], v50
 v_exp_f32 v156, v156
 v_exp_f32 v157, v157
 v_exp_f32 v158, v158
 v_exp_f32 v159, v159
 v_mfma_f32_32x32x8bf16_1k v[128:143], a[160:161], v[234:235], v[160:175]
 s_waitcnt lgkmcnt(2)
 v_exp_f32 v112, v112
 v_exp_f32 v113, v113
 v_exp_f32 v114, v114
 v_exp_f32 v115, v115
 v_mfma_f32_32x32x16_bf16 v[128:143], a[148:151], v[224:227], v[128:143]
 s_waitcnt lgkmcnt(0)
 ds_read2st64_b64 a[152:155], v72 offset0:55 offset1:56
 v_exp_f32 v116, v116
 v_exp_f32 v117, v117
 v_exp_f32 v118, v118
 v_exp_f32 v119, v119
 v_smfmac_f32_32x32x32_bf16 v[192:207], a[172:175], v[144:151], v50
 v_exp_f32 v120, v120
 v_exp_f32 v121, v121
 v_exp_f32 v122, v122
 v_exp_f32 v123, v123
 v_smfmac_f32_32x32x32_bf16 v[192:207], a[176:179], v[152:159], v50
 v_exp_f32 v124, v124
 v_exp_f32 v125, v125
 v_exp_f32 v126, v126
 v_exp_f32 v127, v127
 v_mfma_f32_32x32x8bf16_1k v[144:159], a[160:161], v[238:239], v[176:191]
 ds_read_b128 a[164:167], v74 offset:25216
 v_exp_f32 v128, v128
 v_exp_f32 v129, v129
 v_exp_f32 v130, v130
 v_exp_f32 v131, v131
 v_mfma_f32_32x32x16_bf16 v[144:159], a[148:151], v[228:231], v[144:159]
 v_exp_f32 v132, v132
 v_exp_f32 v133, v133
 v_exp_f32 v134, v134
 v_exp_f32 v135, v135
 v_smfmac_f32_32x32x32_bf16 v[208:223], a[172:175], v[112:119], v50
 ds_read_b128 a[168:171], v74 offset:26400
 v_exp_f32 v136, v136
 v_exp_f32 v137, v137
 v_exp_f32 v138, v138
 v_exp_f32 v139, v139
 v_smfmac_f32_32x32x32_bf16 v[208:223], a[176:179], v[120:127], v50
 s_waitcnt vmcnt(16)
 s_barrier
 v_exp_f32 v140, v140
 v_exp_f32 v141, v141
 v_exp_f32 v142, v142
 v_exp_f32 v143, v143
 v_mfma_f32_32x32x8bf16_1k v[112:127], a[162:163], v[234:235], v[160:175]
 s_waitcnt lgkmcnt(2)
 ds_read2st64_b64 a[156:159], v48 offset0:80 offset1:85
 v_exp_f32 v144, v144
 v_exp_f32 v145, v145
 v_exp_f32 v146, v146
 v_exp_f32 v147, v147
 v_mfma_f32_32x32x16_bf16 v[112:127], a[152:155], v[224:227], v[112:127]
 s_waitcnt lgkmcnt(1)
 ds_read2st64_b64 a[148:151], v72 offset0:80 offset1:81
 v_exp_f32 v148, v148
 v_exp_f32 v149, v149
 v_exp_f32 v150, v150
 v_exp_f32 v151, v151
 v_smfmac_f32_32x32x32_bf16 v[192:207], a[164:167], v[128:135], v50
 s_add_u32 s78, s86, 2128896
 s_add_u32 m0, s87, 102400
 v_exp_f32 v152, v152
 v_exp_f32 v153, v153
 v_exp_f32 v154, v154
 v_exp_f32 v155, v155
 v_smfmac_f32_32x32x32_bf16 v[192:207], a[168:171], v[136:143], v50
 buffer_load_dwordx4 v18, s[36:39], s78 offen sc1 lds
 v_exp_f32 v156, v156
 v_exp_f32 v157, v157
 v_exp_f32 v158, v158
 v_exp_f32 v159, v159
 v_add_u32 v71, 1, v71
 v_mfma_f32_32x32x8bf16_1k v[128:143], a[162:163], v[238:239], v[176:191]
 s_add_u32 m0, s87, 103424
 ds_read_b128 a[172:175], v74 offset:27584
 v_exp_f32 v112, v112
 v_exp_f32 v113, v113
 v_exp_f32 v114, v114
 v_exp_f32 v115, v115
 v_mfma_f32_32x32x16_bf16 v[128:143], a[152:155], v[228:231], v[128:143]
 buffer_load_dwordx4 v19, s[36:39], s78 offen sc1 lds
 v_exp_f32 v116, v116
 v_exp_f32 v117, v117
 v_exp_f32 v118, v118
 v_exp_f32 v119, v119
 v_smfmac_f32_32x32x32_bf16 v[208:223], a[164:167], v[144:151], v50
 s_add_u32 m0, s87, 104448
 ds_read_b128 a[176:179], v74 offset:28768
 v_exp_f32 v120, v120
 v_exp_f32 v121, v121
 v_exp_f32 v122, v122
 v_exp_f32 v123, v123
 v_smfmac_f32_32x32x32_bf16 v[208:223], a[168:171], v[152:159], v50
 s_waitcnt lgkmcnt(3)
 buffer_load_dwordx4 v20, s[36:39], s78 offen sc1 lds
 v_exp_f32 v124, v124
 v_exp_f32 v125, v125
 v_exp_f32 v126, v126
 v_exp_f32 v127, v127
 v_mfma_f32_32x32x8bf16_1k v[144:159], a[156:157], v[232:233], v[160:175]
 s_waitcnt lgkmcnt(2)
 buffer_store_dword v71, v60, s[36:39], s98 offen sc1
 v_exp_f32 v128, v128
 v_exp_f32 v129, v129
 v_exp_f32 v130, v130
 v_exp_f32 v131, v131
 v_mfma_f32_32x32x16_bf16 v[144:159], a[148:151], v[224:227], v[144:159]
 s_waitcnt lgkmcnt(0)
 ds_read2st64_b64 a[152:155], v72 offset0:85 offset1:86
 v_exp_f32 v132, v132
 v_exp_f32 v133, v133
 v_exp_f32 v134, v134
 v_exp_f32 v135, v135
 v_smfmac_f32_32x32x32_bf16 v[192:207], a[172:175], v[112:119], v50
 s_add_u32 m0, s87, 105472
 v_exp_f32 v136, v136
 v_exp_f32 v137, v137
 v_exp_f32 v138, v138
 v_exp_f32 v139, v139
 v_smfmac_f32_32x32x32_bf16 v[192:207], a[176:179], v[120:127], v50
 buffer_load_dwordx4 v21, s[36:39], s78 offen sc1 lds
 v_exp_f32 v140, v140
 v_exp_f32 v141, v141
 v_exp_f32 v142, v142
 v_exp_f32 v143, v143
 v_mfma_f32_32x32x8bf16_1k v[112:127], a[156:157], v[236:237], v[176:191]
 s_add_u32 m0, s87, 106496
 ds_read_b128 a[164:167], v74 offset:40960
 v_exp_f32 v144, v144
 v_exp_f32 v145, v145
 v_exp_f32 v146, v146
 v_exp_f32 v147, v147
 v_mfma_f32_32x32x16_bf16 v[112:127], a[148:151], v[228:231], v[112:127]
 buffer_load_dwordx4 v22, s[36:39], s78 offen sc1 lds
 v_exp_f32 v148, v148
 v_exp_f32 v149, v149
 v_exp_f32 v150, v150
 v_exp_f32 v151, v151
 v_smfmac_f32_32x32x32_bf16 v[208:223], a[172:175], v[128:135], v50
 ds_read_b128 a[168:171], v74 offset:42144
 v_exp_f32 v152, v152
 v_exp_f32 v153, v153
 v_exp_f32 v154, v154
 v_exp_f32 v155, v155
 v_smfmac_f32_32x32x32_bf16 v[208:223], a[176:179], v[136:143], v50
 v_exp_f32 v156, v156
 v_exp_f32 v157, v157
 v_exp_f32 v158, v158
 v_exp_f32 v159, v159
 v_mfma_f32_32x32x8bf16_1k v[128:143], a[158:159], v[232:233], v[160:175]
 s_waitcnt lgkmcnt(2)
 v_exp_f32 v112, v112
 v_exp_f32 v113, v113
 v_exp_f32 v114, v114
 v_exp_f32 v115, v115
 v_mfma_f32_32x32x16_bf16 v[128:143], a[152:155], v[224:227], v[128:143]
 s_waitcnt lgkmcnt(0)
 ds_read2st64_b64 a[148:151], v72 offset0:90 offset1:91
 v_exp_f32 v116, v116
 v_exp_f32 v117, v117
 v_exp_f32 v118, v118
 v_exp_f32 v119, v119
 v_smfmac_f32_32x32x32_bf16 v[192:207], a[164:167], v[144:151], v50
 s_add_u32 s78, s73, 0
 s_add_u32 s78, s78, s68
 v_exp_f32 v120, v120
 v_exp_f32 v121, v121
 v_exp_f32 v122, v122
 v_exp_f32 v123, v123
 v_smfmac_f32_32x32x32_bf16 v[192:207], a[168:171], v[152:159], v50
 s_and_b32 s78, s78, 15
 s_mul_i32 s78, s78, 41472
 v_exp_f32 v124, v124
 v_exp_f32 v125, v125
 v_exp_f32 v126, v126
 v_exp_f32 v127, v127
 v_mfma_f32_32x32x8bf16_1k v[144:159], a[158:159], v[236:237], v[176:191]
 s_add_u32 s78, s78, s93
 ds_read_b128 a[172:175], v74 offset:43328
 v_exp_f32 v128, v128
 v_exp_f32 v129, v129
 v_exp_f32 v130, v130
 v_exp_f32 v131, v131
 v_mfma_f32_32x32x16_bf16 v[144:159], a[152:155], v[228:231], v[144:159]
 s_add_u32 m0, s87, 0
 v_exp_f32 v132, v132
 v_exp_f32 v133, v133
 v_exp_f32 v134, v134
 v_exp_f32 v135, v135
 v_smfmac_f32_32x32x32_bf16 v[208:223], a[164:167], v[112:119], v50
 ds_read_b128 a[176:179], v74 offset:44512
 v_exp_f32 v136, v136
 v_exp_f32 v137, v137
 v_exp_f32 v138, v138
 v_exp_f32 v139, v139
 v_smfmac_f32_32x32x32_bf16 v[208:223], a[168:171], v[120:127], v50
 buffer_load_dwordx4 v55, s[12:15], s78 offen lds
 v_exp_f32 v140, v140
 v_exp_f32 v141, v141
 v_exp_f32 v142, v142
 v_exp_f32 v143, v143
 v_mfma_f32_32x32x8bf16_1k v[112:127], a[156:157], v[234:235], v[160:175]
 s_waitcnt lgkmcnt(2)
 v_exp_f32 v144, v144
 v_exp_f32 v145, v145
 v_exp_f32 v146, v146
 v_exp_f32 v147, v147
 v_mfma_f32_32x32x16_bf16 v[112:127], a[148:151], v[224:227], v[112:127]
 s_waitcnt lgkmcnt(0)
 ds_read2st64_b64 a[152:155], v72 offset0:95 offset1:96
 v_exp_f32 v148, v148
 v_exp_f32 v149, v149
 v_exp_f32 v150, v150
 v_exp_f32 v151, v151
 v_smfmac_f32_32x32x32_bf16 v[192:207], a[172:175], v[128:135], v50
 s_add_u32 m0, s87, 1024
 v_exp_f32 v152, v152
 v_exp_f32 v153, v153
 v_exp_f32 v154, v154
 v_exp_f32 v155, v155
 v_smfmac_f32_32x32x32_bf16 v[192:207], a[176:179], v[136:143], v50
 buffer_load_dwordx4 v56, s[12:15], s78 offen lds
 v_exp_f32 v156, v156
 v_exp_f32 v157, v157
 v_exp_f32 v158, v158
 v_exp_f32 v159, v159
 v_mfma_f32_32x32x8bf16_1k v[128:143], a[156:157], v[238:239], v[176:191]
 s_add_u32 m0, s87, 2048
 ds_read_b128 a[164:167], v74 offset:45696
 v_exp_f32 v112, v112
 v_exp_f32 v113, v113
 v_exp_f32 v114, v114
 v_exp_f32 v115, v115
 v_mfma_f32_32x32x16_bf16 v[128:143], a[148:151], v[228:231], v[128:143]
 buffer_load_dwordx4 v57, s[12:15], s78 offen lds
 v_exp_f32 v116, v116
 v_exp_f32 v117, v117
 v_exp_f32 v118, v118
 v_exp_f32 v119, v119
 v_smfmac_f32_32x32x32_bf16 v[208:223], a[172:175], v[144:151], v50
 s_add_u32 m0, s87, 3072
 ds_read_b128 a[168:171], v74 offset:46880
 v_exp_f32 v120, v120
 v_exp_f32 v121, v121
 v_exp_f32 v122, v122
 v_exp_f32 v123, v123
 v_smfmac_f32_32x32x32_bf16 v[208:223], a[176:179], v[152:159], v50
 s_waitcnt vmcnt(19)
 s_barrier
 buffer_load_dwordx4 v58, s[12:15], s78 offen lds
 v_exp_f32 v124, v124
 v_exp_f32 v125, v125
 v_exp_f32 v126, v126
 v_exp_f32 v127, v127
 v_mfma_f32_32x32x8bf16_1k v[144:159], a[158:159], v[234:235], v[160:175]
 s_waitcnt lgkmcnt(2)
 ds_read2st64_b64 a[160:163], v48 offset0:120 offset1:125
 v_exp_f32 v128, v128
 v_exp_f32 v129, v129
 v_exp_f32 v130, v130
 v_exp_f32 v131, v131
 v_mfma_f32_32x32x16_bf16 v[144:159], a[152:155], v[224:227], v[144:159]
 s_waitcnt lgkmcnt(1)
 ds_read2st64_b64 a[148:151], v72 offset0:120 offset1:121
 v_exp_f32 v132, v132
 v_exp_f32 v133, v133
 v_exp_f32 v134, v134
 v_exp_f32 v135, v135
 v_smfmac_f32_32x32x32_bf16 v[192:207], a[164:167], v[112:119], v50
 s_add_u32 m0, s87, 4096
 v_exp_f32 v136, v136
 v_exp_f32 v137, v137
 v_exp_f32 v138, v138
 v_exp_f32 v139, v139
 v_smfmac_f32_32x32x32_bf16 v[192:207], a[168:171], v[120:127], v50
 buffer_load_dwordx4 v59, s[12:15], s78 offen lds
 v_exp_f32 v140, v140
 v_exp_f32 v141, v141
 v_exp_f32 v142, v142
 v_exp_f32 v143, v143
 v_mfma_f32_32x32x8bf16_1k v[112:127], a[158:159], v[238:239], v[176:191]
 s_add_u32 s78, s86, 2433024
 ds_read_b128 a[172:175], v74 offset:48064
 v_exp_f32 v144, v144
 v_exp_f32 v145, v145
 v_exp_f32 v146, v146
 v_exp_f32 v147, v147
 v_mfma_f32_32x32x16_bf16 v[112:127], a[152:155], v[228:231], v[112:127]
 s_add_u32 m0, s87, 122880
 v_exp_f32 v148, v148
 v_exp_f32 v149, v149
 v_exp_f32 v150, v150
 v_exp_f32 v151, v151
 v_smfmac_f32_32x32x32_bf16 v[208:223], a[164:167], v[128:135], v50
 ds_read_b128 a[176:179], v74 offset:49248
 v_exp_f32 v152, v152
 v_exp_f32 v153, v153
 v_exp_f32 v154, v154
 v_exp_f32 v155, v155
 v_smfmac_f32_32x32x32_bf16 v[208:223], a[168:171], v[136:143], v50
 s_waitcnt lgkmcnt(3)
 buffer_load_dwordx4 v18, s[36:39], s78 offen sc1 lds
 v_exp_f32 v156, v156
 v_exp_f32 v157, v157
 v_exp_f32 v158, v158
 v_exp_f32 v159, v159
 v_mfma_f32_32x32x8bf16_1k v[128:143], a[160:161], v[232:233], v[160:175]
 s_waitcnt lgkmcnt(2)
 v_exp_f32 v112, v112
 v_exp_f32 v113, v113
 v_exp_f32 v114, v114
 v_exp_f32 v115, v115
 v_mfma_f32_32x32x16_bf16 v[128:143], a[148:151], v[224:227], v[128:143]
 s_waitcnt lgkmcnt(0)
 ds_read2st64_b64 a[152:155], v72 offset0:125 offset1:126
 v_exp_f32 v116, v116
 v_exp_f32 v117, v117
 v_exp_f32 v118, v118
 v_exp_f32 v119, v119
 v_smfmac_f32_32x32x32_bf16 v[192:207], a[172:175], v[144:151], v50
 s_add_u32 m0, s87, 123904
 v_exp_f32 v120, v120
 v_exp_f32 v121, v121
 v_exp_f32 v122, v122
 v_exp_f32 v123, v123
 v_smfmac_f32_32x32x32_bf16 v[192:207], a[176:179], v[152:159], v50
 buffer_load_dwordx4 v19, s[36:39], s78 offen sc1 lds
 v_exp_f32 v124, v124
 v_exp_f32 v125, v125
 v_exp_f32 v126, v126
 v_exp_f32 v127, v127
 v_mfma_f32_32x32x8bf16_1k v[144:159], a[160:161], v[236:237], v[176:191]
 s_add_u32 m0, s87, 124928
 ds_read_b128 a[164:167], v74 offset:61440
 v_exp_f32 v128, v128
 v_exp_f32 v129, v129
 v_exp_f32 v130, v130
 v_exp_f32 v131, v131
 v_mfma_f32_32x32x16_bf16 v[144:159], a[148:151], v[228:231], v[144:159]
 buffer_load_dwordx4 v20, s[36:39], s78 offen sc1 lds
 v_exp_f32 v132, v132
 v_exp_f32 v133, v133
 v_exp_f32 v134, v134
 v_exp_f32 v135, v135
 v_smfmac_f32_32x32x32_bf16 v[208:223], a[172:175], v[112:119], v50
 s_add_u32 m0, s87, 125952
 ds_read_b128 a[168:171], v74 offset:62624
 v_exp_f32 v136, v136
 v_exp_f32 v137, v137
 v_exp_f32 v138, v138
 v_exp_f32 v139, v139
 v_smfmac_f32_32x32x32_bf16 v[208:223], a[176:179], v[120:127], v50
 buffer_load_dwordx4 v21, s[36:39], s78 offen sc1 lds
 v_exp_f32 v140, v140
 v_exp_f32 v141, v141
 v_exp_f32 v142, v142
 v_exp_f32 v143, v143
 v_mfma_f32_32x32x8bf16_1k v[112:127], a[162:163], v[232:233], v[160:175]
 s_waitcnt lgkmcnt(2)
 v_exp_f32 v144, v144
 v_exp_f32 v145, v145
 v_exp_f32 v146, v146
 v_exp_f32 v147, v147
 v_mfma_f32_32x32x16_bf16 v[112:127], a[152:155], v[224:227], v[112:127]
 s_waitcnt lgkmcnt(0)
 ds_read2st64_b64 a[148:151], v72 offset0:130 offset1:131
 v_exp_f32 v148, v148
 v_exp_f32 v149, v149
 v_exp_f32 v150, v150
 v_exp_f32 v151, v151
 v_smfmac_f32_32x32x32_bf16 v[192:207], a[164:167], v[128:135], v50
 s_add_u32 m0, s87, 126976
 v_exp_f32 v152, v152
 v_exp_f32 v153, v153
 v_exp_f32 v154, v154
 v_exp_f32 v155, v155
 v_smfmac_f32_32x32x32_bf16 v[192:207], a[168:171], v[136:143], v50
 buffer_load_dwordx4 v22, s[36:39], s78 offen sc1 lds
 v_exp_f32 v156, v156
 v_exp_f32 v157, v157
 v_exp_f32 v158, v158
 v_exp_f32 v159, v159
 v_mfma_f32_32x32x8bf16_1k v[128:143], a[162:163], v[236:237], v[176:191]
 s_add_u32 s78, s73, 4
 ds_read_b128 a[172:175], v74 offset:63808
 v_exp_f32 v112, v112
 v_exp_f32 v113, v113
 v_exp_f32 v114, v114
 v_exp_f32 v115, v115
 v_mfma_f32_32x32x16_bf16 v[128:143], a[152:155], v[228:231], v[128:143]
 s_add_u32 s78, s78, s68
 v_exp_f32 v116, v116
 v_exp_f32 v117, v117
 v_exp_f32 v118, v118
 v_exp_f32 v119, v119
 v_smfmac_f32_32x32x32_bf16 v[208:223], a[164:167], v[144:151], v50
 s_and_b32 s78, s78, 15
 s_mul_i32 s78, s78, 41472
 ds_read_b128 a[176:179], v74 offset:64992
 v_exp_f32 v120, v120
 v_exp_f32 v121, v121
 v_exp_f32 v122, v122
 v_exp_f32 v123, v123
 v_smfmac_f32_32x32x32_bf16 v[208:223], a[168:171], v[152:159], v50
 s_add_u32 s78, s78, s93
 s_add_u32 m0, s87, 20480
 v_exp_f32 v124, v124
 v_exp_f32 v125, v125
 v_exp_f32 v126, v126
 v_exp_f32 v127, v127
 v_mfma_f32_32x32x8bf16_1k v[144:159], a[160:161], v[234:235], v[160:175]
 s_waitcnt lgkmcnt(2)
 buffer_load_dwordx4 v55, s[12:15], s78 offen lds
 v_exp_f32 v128, v128
 v_exp_f32 v129, v129
 v_exp_f32 v130, v130
 v_exp_f32 v131, v131
 v_mfma_f32_32x32x16_bf16 v[144:159], a[148:151], v[224:227], v[144:159]
 s_waitcnt lgkmcnt(0)
 ds_read2st64_b64 a[152:155], v72 offset0:135 offset1:136
 v_exp_f32 v132, v132
 v_exp_f32 v133, v133
 v_exp_f32 v134, v134
 v_exp_f32 v135, v135
 v_smfmac_f32_32x32x32_bf16 v[192:207], a[172:175], v[112:119], v50
 s_add_u32 m0, s87, 21504
 v_exp_f32 v136, v136
 v_exp_f32 v137, v137
 v_exp_f32 v138, v138
 v_exp_f32 v139, v139
 v_smfmac_f32_32x32x32_bf16 v[192:207], a[176:179], v[120:127], v50
 buffer_load_dwordx4 v56, s[12:15], s78 offen lds
 v_exp_f32 v140, v140
 v_exp_f32 v141, v141
 v_exp_f32 v142, v142
 v_exp_f32 v143, v143
 v_mfma_f32_32x32x8bf16_1k v[112:127], a[160:161], v[238:239], v[176:191]
 s_add_u32 m0, s87, 22528
 ds_read_b128 a[164:167], v75 offset:640
 v_exp_f32 v144, v144
 v_exp_f32 v145, v145
 v_exp_f32 v146, v146
 v_exp_f32 v147, v147
 v_mfma_f32_32x32x16_bf16 v[112:127], a[148:151], v[228:231], v[112:127]
 buffer_load_dwordx4 v57, s[12:15], s78 offen lds
 v_exp_f32 v148, v148
 v_exp_f32 v149, v149
 v_exp_f32 v150, v150
 v_exp_f32 v151, v151
 v_smfmac_f32_32x32x32_bf16 v[208:223], a[172:175], v[128:135], v50
 s_add_u32 m0, s87, 23552
 ds_read_b128 a[168:171], v75 offset:1824
 v_exp_f32 v152, v152
 v_exp_f32 v153, v153
 v_exp_f32 v154, v154
 v_exp_f32 v155, v155
 v_smfmac_f32_32x32x32_bf16 v[208:223], a[176:179], v[136:143], v50
 s_waitcnt vmcnt(19)
 s_barrier
 buffer_load_dwordx4 v58, s[12:15], s78 offen lds
 v_exp_f32 v156, v156
 v_exp_f32 v157, v157
 v_exp_f32 v158, v158
 v_exp_f32 v159, v159
 v_mfma_f32_32x32x8bf16_1k v[128:143], a[162:163], v[234:235], v[160:175]
 s_waitcnt lgkmcnt(2)
 ds_read2st64_b64 a[156:159], v49 offset0:0 offset1:5
 v_exp_f32 v112, v112
 v_exp_f32 v113, v113
 v_exp_f32 v114, v114
 v_exp_f32 v115, v115
 v_mfma_f32_32x32x16_bf16 v[128:143], a[152:155], v[224:227], v[128:143]
 s_waitcnt lgkmcnt(1)
 ds_read2st64_b64 a[148:151], v73 offset0:0 offset1:1
 v_exp_f32 v116, v116
 v_exp_f32 v117, v117
 v_exp_f32 v118, v118
 v_exp_f32 v119, v119
 v_smfmac_f32_32x32x32_bf16 v[192:207], a[164:167], v[144:151], v50
 s_add_u32 m0, s87, 24576
 v_exp_f32 v120, v120
 v_exp_f32 v121, v121
 v_exp_f32 v122, v122
 v_exp_f32 v123, v123
 v_smfmac_f32_32x32x32_bf16 v[192:207], a[168:171], v[152:159], v50
 buffer_load_dwordx4 v59, s[12:15], s78 offen lds
 v_exp_f32 v124, v124
 v_exp_f32 v125, v125
 v_exp_f32 v126, v126
 v_exp_f32 v127, v127
 v_mfma_f32_32x32x8bf16_1k v[144:159], a[162:163], v[238:239], v[176:191]
 s_add_u32 s78, s86, 2737152
 ds_read_b128 a[172:175], v75 offset:3008
 v_exp_f32 v128, v128
 v_exp_f32 v129, v129
 v_exp_f32 v130, v130
 v_exp_f32 v131, v131
 v_mfma_f32_32x32x16_bf16 v[144:159], a[152:155], v[228:231], v[144:159]
 s_add_u32 m0, s87, 143360
 v_exp_f32 v132, v132
 v_exp_f32 v133, v133
 v_exp_f32 v134, v134
 v_exp_f32 v135, v135
 v_smfmac_f32_32x32x32_bf16 v[208:223], a[164:167], v[112:119], v50
 ds_read_b128 a[176:179], v75 offset:4192
 v_exp_f32 v136, v136
 v_exp_f32 v137, v137
 v_exp_f32 v138, v138
 v_exp_f32 v139, v139
 v_smfmac_f32_32x32x32_bf16 v[208:223], a[168:171], v[120:127], v50
 s_waitcnt lgkmcnt(3)
 buffer_load_dwordx4 v18, s[36:39], s78 offen sc1 lds
 v_exp_f32 v140, v140
 v_exp_f32 v141, v141
 v_exp_f32 v142, v142
 v_exp_f32 v143, v143
 v_mfma_f32_32x32x8bf16_1k v[112:127], a[156:157], v[232:233], v[160:175]
 s_waitcnt lgkmcnt(2)
 buffer_load_dword v26, v61, s[36:39], s97 offen sc1
 v_exp_f32 v144, v144
 v_exp_f32 v145, v145
 v_exp_f32 v146, v146
 v_exp_f32 v147, v147
 v_mfma_f32_32x32x16_bf16 v[112:127], a[148:151], v[224:227], v[112:127]
 s_waitcnt lgkmcnt(0)
 ds_read2st64_b64 a[152:155], v73 offset0:5 offset1:6
 v_exp_f32 v148, v148
 v_exp_f32 v149, v149
 v_exp_f32 v150, v150
 v_exp_f32 v151, v151
 v_smfmac_f32_32x32x32_bf16 v[192:207], a[172:175], v[128:135], v50
 s_add_u32 m0, s87, 144384
 v_exp_f32 v152, v152
 v_exp_f32 v153, v153
 v_exp_f32 v154, v154
 v_exp_f32 v155, v155
 v_smfmac_f32_32x32x32_bf16 v[192:207], a[176:179], v[136:143], v50
 buffer_load_dwordx4 v19, s[36:39], s78 offen sc1 lds
 v_exp_f32 v156, v156
 v_exp_f32 v157, v157
 v_exp_f32 v158, v158
 v_exp_f32 v159, v159
 v_mfma_f32_32x32x8bf16_1k v[128:143], a[156:157], v[236:237], v[176:191]
 s_add_u32 m0, s87, 145408
 ds_read_b128 a[164:167], v75 offset:16384
 v_exp_f32 v112, v112
 v_exp_f32 v113, v113
 v_exp_f32 v114, v114
 v_exp_f32 v115, v115
 v_mfma_f32_32x32x16_bf16 v[128:143], a[148:151], v[228:231], v[128:143]
 buffer_load_dwordx4 v20, s[36:39], s78 offen sc1 lds
 v_exp_f32 v116, v116
 v_exp_f32 v117, v117
 v_exp_f32 v118, v118
 v_exp_f32 v119, v119
 v_smfmac_f32_32x32x32_bf16 v[208:223], a[172:175], v[144:151], v50
 s_add_u32 m0, s87, 146432
 ds_read_b128 a[168:171], v75 offset:17568
 v_exp_f32 v120, v120
 v_exp_f32 v121, v121
 v_exp_f32 v122, v122
 v_exp_f32 v123, v123
 v_smfmac_f32_32x32x32_bf16 v[208:223], a[176:179], v[152:159], v50
 buffer_load_dwordx4 v21, s[36:39], s78 offen sc1 lds
 v_exp_f32 v124, v124
 v_exp_f32 v125, v125
 v_exp_f32 v126, v126
 v_exp_f32 v127, v127
 v_mfma_f32_32x32x8bf16_1k v[144:159], a[158:159], v[232:233], v[160:175]
 s_waitcnt lgkmcnt(2)
 v_exp_f32 v128, v128
 v_exp_f32 v129, v129
 v_exp_f32 v130, v130
 v_exp_f32 v131, v131
 v_mfma_f32_32x32x16_bf16 v[144:159], a[152:155], v[224:227], v[144:159]
 s_waitcnt lgkmcnt(0)
 ds_read2st64_b64 a[148:151], v73 offset0:10 offset1:11
 v_exp_f32 v132, v132
 v_exp_f32 v133, v133
 v_exp_f32 v134, v134
 v_exp_f32 v135, v135
 v_smfmac_f32_32x32x32_bf16 v[192:207], a[164:167], v[112:119], v50
 s_add_u32 m0, s87, 147456
 v_exp_f32 v136, v136
 v_exp_f32 v137, v137
 v_exp_f32 v138, v138
 v_exp_f32 v139, v139
 v_smfmac_f32_32x32x32_bf16 v[192:207], a[168:171], v[120:127], v50
 buffer_load_dwordx4 v22, s[36:39], s78 offen sc1 lds
 v_exp_f32 v140, v140
 v_exp_f32 v141, v141
 v_exp_f32 v142, v142
 v_exp_f32 v143, v143
 v_mfma_f32_32x32x8bf16_1k v[112:127], a[158:159], v[236:237], v[176:191]
 s_add_u32 s78, s73, 8
 ds_read_b128 a[172:175], v75 offset:18752
 v_exp_f32 v144, v144
 v_exp_f32 v145, v145
 v_exp_f32 v146, v146
 v_exp_f32 v147, v147
 v_mfma_f32_32x32x16_bf16 v[112:127], a[152:155], v[228:231], v[112:127]
 s_add_u32 s78, s78, s68
 v_exp_f32 v148, v148
 v_exp_f32 v149, v149
 v_exp_f32 v150, v150
 v_exp_f32 v151, v151
 v_smfmac_f32_32x32x32_bf16 v[208:223], a[164:167], v[128:135], v50
 s_and_b32 s78, s78, 15
 s_mul_i32 s78, s78, 41472
 ds_read_b128 a[176:179], v75 offset:19936
 v_exp_f32 v152, v152
 v_exp_f32 v153, v153
 v_exp_f32 v154, v154
 v_exp_f32 v155, v155
 v_smfmac_f32_32x32x32_bf16 v[208:223], a[168:171], v[136:143], v50
 s_add_u32 s78, s78, s93
 s_add_u32 m0, s87, 40960
 v_exp_f32 v156, v156
 v_exp_f32 v157, v157
 v_exp_f32 v158, v158
 v_exp_f32 v159, v159
 v_mfma_f32_32x32x8bf16_1k v[128:143], a[156:157], v[234:235], v[160:175]
 s_waitcnt lgkmcnt(2)
 buffer_load_dwordx4 v55, s[12:15], s78 offen lds
 v_exp_f32 v112, v112
 v_exp_f32 v113, v113
 v_exp_f32 v114, v114
 v_exp_f32 v115, v115
 v_mfma_f32_32x32x16_bf16 v[128:143], a[148:151], v[224:227], v[128:143]
 s_waitcnt lgkmcnt(0)
 ds_read2st64_b64 a[152:155], v73 offset0:15 offset1:16
 v_exp_f32 v116, v116
 v_exp_f32 v117, v117
 v_exp_f32 v118, v118
 v_exp_f32 v119, v119
 v_smfmac_f32_32x32x32_bf16 v[192:207], a[172:175], v[144:151], v50
 s_add_u32 m0, s87, 41984
 v_exp_f32 v120, v120
 v_exp_f32 v121, v121
 v_exp_f32 v122, v122
 v_exp_f32 v123, v123
 v_smfmac_f32_32x32x32_bf16 v[192:207], a[176:179], v[152:159], v50
 buffer_load_dwordx4 v56, s[12:15], s78 offen lds
 v_exp_f32 v124, v124
 v_exp_f32 v125, v125
 v_exp_f32 v126, v126
 v_exp_f32 v127, v127
 v_mfma_f32_32x32x8bf16_1k v[144:159], a[156:157], v[238:239], v[176:191]
 s_add_u32 m0, s87, 43008
 ds_read_b128 a[164:167], v75 offset:21120
 v_exp_f32 v128, v128
 v_exp_f32 v129, v129
 v_exp_f32 v130, v130
 v_exp_f32 v131, v131
 v_mfma_f32_32x32x16_bf16 v[144:159], a[148:151], v[228:231], v[144:159]
 buffer_load_dwordx4 v57, s[12:15], s78 offen lds
 v_exp_f32 v132, v132
 v_exp_f32 v133, v133
 v_exp_f32 v134, v134
 v_exp_f32 v135, v135
 v_smfmac_f32_32x32x32_bf16 v[208:223], a[172:175], v[112:119], v50
 s_add_u32 m0, s87, 44032
 ds_read_b128 a[168:171], v75 offset:22304
 v_exp_f32 v136, v136
 v_exp_f32 v137, v137
 v_exp_f32 v138, v138
 v_exp_f32 v139, v139
 v_smfmac_f32_32x32x32_bf16 v[208:223], a[176:179], v[120:127], v50
 s_waitcnt vmcnt(7)
 s_barrier
 buffer_load_dwordx4 v58, s[12:15], s78 offen lds
 v_exp_f32 v140, v140
 v_exp_f32 v141, v141
 v_exp_f32 v142, v142
 v_exp_f32 v143, v143
 v_mfma_f32_32x32x8bf16_1k v[112:127], a[158:159], v[234:235], v[160:175]
 s_waitcnt lgkmcnt(2)
 ds_read2st64_b64 a[160:163], v49 offset0:40 offset1:45
 v_exp_f32 v144, v144
 v_exp_f32 v145, v145
 v_exp_f32 v146, v146
 v_exp_f32 v147, v147
 v_mfma_f32_32x32x16_bf16 v[112:127], a[152:155], v[224:227], v[112:127]
 s_waitcnt lgkmcnt(1)
 ds_read2st64_b64 a[148:151], v73 offset0:40 offset1:41
 v_exp_f32 v148, v148
 v_exp_f32 v149, v149
 v_exp_f32 v150, v150
 v_exp_f32 v151, v151
 v_smfmac_f32_32x32x32_bf16 v[192:207], a[164:167], v[128:135], v50
 s_add_u32 m0, s87, 45056
 v_exp_f32 v152, v152
 v_exp_f32 v153, v153
 v_exp_f32 v154, v154
 v_exp_f32 v155, v155
 v_smfmac_f32_32x32x32_bf16 v[192:207], a[168:171], v[136:143], v50
 buffer_load_dwordx4 v59, s[12:15], s78 offen lds
 v_exp_f32 v156, v156
 v_exp_f32 v157, v157
 v_exp_f32 v158, v158
 v_exp_f32 v159, v159
 v_sub_u32 v26, v26, v70
 v_mfma_f32_32x32x8bf16_1k v[128:143], a[158:159], v[238:239], v[176:191]
 s_add_u32 s78, s86, 3041280
 ds_read_b128 a[172:175], v75 offset:23488
 v_exp_f32 v112, v112
 v_exp_f32 v113, v113
 v_exp_f32 v114, v114
 v_exp_f32 v115, v115
 v_mfma_f32_32x32x16_bf16 v[128:143], a[152:155], v[228:231], v[128:143]
 s_add_u32 m0, s87, 61440
 v_exp_f32 v116, v116
 v_exp_f32 v117, v117
 v_exp_f32 v118, v118
 v_exp_f32 v119, v119
 v_smfmac_f32_32x32x32_bf16 v[208:223], a[164:167], v[144:151], v50
 ds_read_b128 a[176:179], v75 offset:24672
 v_exp_f32 v120, v120
 v_exp_f32 v121, v121
 v_exp_f32 v122, v122
 v_exp_f32 v123, v123
 v_smfmac_f32_32x32x32_bf16 v[208:223], a[168:171], v[152:159], v50
 s_waitcnt lgkmcnt(3)
 buffer_load_dwordx4 v18, s[36:39], s78 offen sc1 lds
 v_exp_f32 v124, v124
 v_exp_f32 v125, v125
 v_exp_f32 v126, v126
 v_exp_f32 v127, v127
 v_cmp_eq_u32 vcc, 0, v26
 v_mfma_f32_32x32x8bf16_1k v[144:159], a[160:161], v[232:233], v[160:175]
 s_waitcnt lgkmcnt(2)
 v_exp_f32 v128, v128
 v_exp_f32 v129, v129
 v_exp_f32 v130, v130
 v_exp_f32 v131, v131
 v_mfma_f32_32x32x16_bf16 v[144:159], a[148:151], v[224:227], v[144:159]
 s_waitcnt lgkmcnt(0)
 ds_read2st64_b64 a[152:155], v73 offset0:45 offset1:46
 v_exp_f32 v132, v132
 v_exp_f32 v133, v133
 v_exp_f32 v134, v134
 v_exp_f32 v135, v135
 v_smfmac_f32_32x32x32_bf16 v[192:207], a[172:175], v[112:119], v50
 s_cbranch_vccnz L_spin2
L_back2:
 s_add_u32 s89, s91, 0
 buffer_load_dwordx4 a[20:23], v51, s[36:39], s89 offen offset:0 sc1
 v_exp_f32 v136, v136
 v_exp_f32 v137, v137
 v_exp_f32 v138, v138
 v_exp_f32 v139, v139
 v_smfmac_f32_32x32x32_bf16 v[192:207], a[176:179], v[120:127], v50
 s_add_u32 m0, s87, 62464
 v_exp_f32 v140, v140
 v_exp_f32 v141, v141
 v_exp_f32 v142, v142
 v_exp_f32 v143, v143
 v_mfma_f32_32x32x8bf16_1k v[112:127], a[160:161], v[236:237], v[176:191]
 ds_read_b128 a[164:167], v75 offset:36864
 v_exp_f32 v144, v144
 v_exp_f32 v145, v145
 v_exp_f32 v146, v146
 v_exp_f32 v147, v147
 v_mfma_f32_32x32x16_bf16 v[112:127], a[148:151], v[228:231], v[112:127]
 buffer_load_dwordx4 v19, s[36:39], s78 offen sc1 lds
 v_exp_f32 v148, v148
 v_exp_f32 v149, v149
 v_exp_f32 v150, v150
 v_exp_f32 v151, v151
 v_smfmac_f32_32x32x32_bf16 v[208:223], a[172:175], v[128:135], v50
 s_add_u32 m0, s87, 63488
 ds_read_b128 a[168:171], v75 offset:38048
 v_exp_f32 v152, v152
 v_exp_f32 v153, v153
 v_exp_f32 v154, v154
 v_exp_f32 v155, v155
 v_smfmac_f32_32x32x32_bf16 v[208:223], a[176:179], v[136:143], v50
 buffer_load_dwordx4 v20, s[36:39], s78 offen sc1 lds
 v_exp_f32 v156, v156
 v_exp_f32 v157, v157
 v_exp_f32 v158, v158
 v_exp_f32 v159, v159
 v_mfma_f32_32x32x8bf16_1k v[128:143], a[162:163], v[232:233], v[160:175]
 s_waitcnt lgkmcnt(2)
 v_exp_f32 v112, v112
 v_exp_f32 v113, v113
 v_exp_f32 v114, v114
 v_exp_f32 v115, v115
 v_mfma_f32_32x32x16_bf16 v[128:143], a[152:155], v[224:227], v[128:143]
 s_waitcnt lgkmcnt(0)
 ds_read2st64_b64 a[148:151], v73 offset0:50 offset1:51
 v_exp_f32 v116, v116
 v_exp_f32 v117, v117
 v_exp_f32 v118, v118
 v_exp_f32 v119, v119
 v_smfmac_f32_32x32x32_bf16 v[192:207], a[164:167], v[144:151], v50
 s_add_u32 m0, s87, 64512
 buffer_load_dwordx4 a[24:27], v51, s[36:39], s89 offen offset:512 sc1
 v_exp_f32 v120, v120
 v_exp_f32 v121, v121
 v_exp_f32 v122, v122
 v_exp_f32 v123, v123
 v_smfmac_f32_32x32x32_bf16 v[192:207], a[168:171], v[152:159], v50
 buffer_load_dwordx4 v21, s[36:39], s78 offen sc1 lds
 v_exp_f32 v124, v124
 v_exp_f32 v125, v125
 v_exp_f32 v126, v126
 v_exp_f32 v127, v127
 v_mfma_f32_32x32x8bf16_1k v[144:159], a[162:163], v[236:237], v[176:191]
 s_add_u32 m0, s87, 65536
 ds_read_b128 a[172:175], v75 offset:39232
 v_exp_f32 v128, v128
 v_exp_f32 v129, v129
 v_exp_f32 v130, v130
 v_exp_f32 v131, v131
 v_mfma_f32_32x32x16_bf16 v[144:159], a[152:155], v[228:231], v[144:159]
 buffer_load_dwordx4 v22, s[36:39], s78 offen sc1 lds
 v_exp_f32 v132, v132
 v_exp_f32 v133, v133
 v_exp_f32 v134, v134
 v_exp_f32 v135, v135
 v_smfmac_f32_32x32x32_bf16 v[208:223], a[164:167], v[112:119], v50
 ds_read_b128 a[176:179], v75 offset:40416
 v_exp_f32 v136, v136
 v_exp_f32 v137, v137
 v_exp_f32 v138, v138
 v_exp_f32 v139, v139
 v_smfmac_f32_32x32x32_bf16 v[208:223], a[168:171], v[120:127], v50
 v_exp_f32 v140, v140
 v_exp_f32 v141, v141
 v_exp_f32 v142, v142
 v_exp_f32 v143, v143
 v_mfma_f32_32x32x8bf16_1k v[112:127], a[160:161], v[234:235], v[160:175]
 s_waitcnt lgkmcnt(2)
 buffer_load_dwordx4 a[28:31], v51, s[36:39], s89 offen offset:1024 sc1
 v_exp_f32 v144, v144
 v_exp_f32 v145, v145
 v_exp_f32 v146, v146
 v_exp_f32 v147, v147
 v_mfma_f32_32x32x16_bf16 v[112:127], a[148:151], v[224:227], v[112:127]
 s_waitcnt lgkmcnt(0)
 ds_read2st64_b64 a[152:155], v73 offset0:55 offset1:56
 v_exp_f32 v148, v148
 v_exp_f32 v149, v149
 v_exp_f32 v150, v150
 v_exp_f32 v151, v151
 v_smfmac_f32_32x32x32_bf16 v[192:207], a[172:175], v[128:135], v50
 v_exp_f32 v152, v152
 v_exp_f32 v153, v153
 v_exp_f32 v154, v154
 v_exp_f32 v155, v155
 v_smfmac_f32_32x32x32_bf16 v[192:207], a[176:179], v[136:143], v50
 v_exp_f32 v156, v156
 v_exp_f32 v157, v157
 v_exp_f32 v158, v158
 v_exp_f32 v159, v159
 v_mfma_f32_32x32x8bf16_1k v[128:143], a[160:161], v[238:239], v[176:191]
 ds_read_b128 a[164:167], v75 offset:41600
 v_exp_f32 v112, v112
 v_exp_f32 v113, v113
 v_exp_f32 v114, v114
 v_exp_f32 v115, v115
 v_mfma_f32_32x32x16_bf16 v[128:143], a[148:151], v[228:231], v[128:143]
 v_exp_f32 v116, v116
 v_exp_f32 v117, v117
 v_exp_f32 v118, v118
 v_exp_f32 v119, v119
 v_smfmac_f32_32x32x32_bf16 v[208:223], a[172:175], v[144:151], v50
 ds_read_b128 a[168:171], v75 offset:42784
 v_exp_f32 v120, v120
 v_exp_f32 v121, v121
 v_exp_f32 v122, v122
 v_exp_f32 v123, v123
 v_smfmac_f32_32x32x32_bf16 v[208:223], a[176:179], v[152:159], v50
 s_barrier
 buffer_load_dwordx4 a[32:35], v51, s[36:39], s89 offen offset:1536 sc1
 v_exp_f32 v124, v124
 v_exp_f32 v125, v125
 v_exp_f32 v126, v126
 v_exp_f32 v127, v127
 v_mfma_f32_32x32x8bf16_1k v[144:159], a[162:163], v[234:235], v[160:175]
 s_waitcnt lgkmcnt(2)
 ds_read2st64_b64 a[156:159], v49 offset0:80 offset1:85
 v_exp_f32 v128, v128
 v_exp_f32 v129, v129
 v_exp_f32 v130, v130
 v_exp_f32 v131, v131
 v_mfma_f32_32x32x16_bf16 v[144:159], a[152:155], v[224:227], v[144:159]
 s_waitcnt lgkmcnt(1)
 ds_read2st64_b64 a[148:151], v73 offset0:80 offset1:81
 v_exp_f32 v132, v132
 v_exp_f32 v133, v133
 v_exp_f32 v134, v134
 v_exp_f32 v135, v135
 v_smfmac_f32_32x32x32_bf16 v[192:207], a[164:167], v[112:119], v50
 s_add_u32 s78, s86, 3345408
 s_add_u32 m0, s87, 81920
 v_exp_f32 v136, v136
 v_exp_f32 v137, v137
 v_exp_f32 v138, v138
 v_exp_f32 v139, v139
 v_smfmac_f32_32x32x32_bf16 v[192:207], a[168:171], v[120:127], v50
 buffer_load_dwordx4 v18, s[36:39], s78 offen sc1 lds
 v_exp_f32 v140, v140
 v_exp_f32 v141, v141
 v_exp_f32 v142, v142
 v_exp_f32 v143, v143
 v_mfma_f32_32x32x8bf16_1k v[112:127], a[162:163], v[238:239], v[176:191]
 s_add_u32 m0, s87, 82944
 ds_read_b128 a[172:175], v75 offset:43968
 v_exp_f32 v144, v144
 v_exp_f32 v145, v145
 v_exp_f32 v146, v146
 v_exp_f32 v147, v147
 v_mfma_f32_32x32x16_bf16 v[112:127], a[152:155], v[228:231], v[112:127]
 buffer_load_dwordx4 v19, s[36:39], s78 offen sc1 lds
 v_exp_f32 v148, v148
 v_exp_f32 v149, v149
 v_exp_f32 v150, v150
 v_exp_f32 v151, v151
 v_smfmac_f32_32x32x32_bf16 v[208:223], a[164:167], v[128:135], v50
 s_add_u32 s89, s91, 36864
 s_add_u32 m0, s87, 83968
 ds_read_b128 a[176:179], v75 offset:45152
 v_exp_f32 v152, v152
 v_exp_f32 v153, v153
 v_exp_f32 v154, v154
 v_exp_f32 v155, v155
 v_smfmac_f32_32x32x32_bf16 v[208:223], a[168:171], v[136:143], v50
 s_waitcnt lgkmcnt(3)
 buffer_load_dwordx4 a[36:39], v51, s[36:39], s89 offen offset:0 sc1
 v_exp_f32 v156, v156
 v_exp_f32 v157, v157
 v_exp_f32 v158, v158
 v_exp_f32 v159, v159
 v_mfma_f32_32x32x8bf16_1k v[128:143], a[156:157], v[232:233], v[160:175]
 s_waitcnt lgkmcnt(2)
 buffer_load_dwordx4 v20, s[36:39], s78 offen sc1 lds
 v_exp_f32 v112, v112
 v_exp_f32 v113, v113
 v_exp_f32 v114, v114
 v_exp_f32 v115, v115
 v_mfma_f32_32x32x16_bf16 v[128:143], a[148:151], v[224:227], v[128:143]
 s_waitcnt lgkmcnt(0)
 ds_read2st64_b64 a[152:155], v73 offset0:85 offset1:86
 v_exp_f32 v116, v116
 v_exp_f32 v117, v117
 v_exp_f32 v118, v118
 v_exp_f32 v119, v119
 v_smfmac_f32_32x32x32_bf16 v[192:207], a[172:175], v[144:151], v50
 s_add_u32 m0, s87, 84992
 v_exp_f32 v120, v120
 v_exp_f32 v121, v121
 v_exp_f32 v122, v122
 v_exp_f32 v123, v123
 v_smfmac_f32_32x32x32_bf16 v[192:207], a[176:179], v[152:159], v50
 buffer_load_dwordx4 v21, s[36:39], s78 offen sc1 lds
 v_exp_f32 v124, v124
 v_exp_f32 v125, v125
 v_exp_f32 v126, v126
 v_exp_f32 v127, v127
 v_mfma_f32_32x32x8bf16_1k v[144:159], a[156:157], v[236:237], v[176:191]
 s_add_u32 m0, s87, 86016
 ds_read_b128 a[164:167], v75 offset:57344
 v_exp_f32 v128, v128
 v_exp_f32 v129, v129
 v_exp_f32 v130, v130
 v_exp_f32 v131, v131
 v_mfma_f32_32x32x16_bf16 v[144:159], a[148:151], v[228:231], v[144:159]
 buffer_load_dwordx4 a[40:43], v51, s[36:39], s89 offen offset:512 sc1
 v_exp_f32 v132, v132
 v_exp_f32 v133, v133
 v_exp_f32 v134, v134
 v_exp_f32 v135, v135
 v_smfmac_f32_32x32x32_bf16 v[208:223], a[172:175], v[112:119], v50
 ds_read_b128 a[168:171], v75 offset:58528
 v_exp_f32 v136, v136
 v_exp_f32 v137, v137
 v_exp_f32 v138, v138
 v_exp_f32 v139, v139
 v_smfmac_f32_32x32x32_bf16 v[208:223], a[176:179], v[120:127], v50
 buffer_load_dwordx4 v22, s[36:39], s78 offen sc1 lds
 v_exp_f32 v140, v140
 v_exp_f32 v141, v141
 v_exp_f32 v142, v142
 v_exp_f32 v143, v143
 v_mfma_f32_32x32x8bf16_1k v[112:127], a[158:159], v[232:233], v[160:175]
 s_waitcnt lgkmcnt(2)
 v_exp_f32 v144, v144
 v_exp_f32 v145, v145
 v_exp_f32 v146, v146
 v_exp_f32 v147, v147
 v_mfma_f32_32x32x16_bf16 v[112:127], a[152:155], v[224:227], v[112:127]
 s_waitcnt lgkmcnt(0)
 ds_read2st64_b64 a[148:151], v73 offset0:90 offset1:91
 v_exp_f32 v148, v148
 v_exp_f32 v149, v149
 v_exp_f32 v150, v150
 v_exp_f32 v151, v151
 v_smfmac_f32_32x32x32_bf16 v[192:207], a[164:167], v[128:135], v50
 v_exp_f32 v152, v152
 v_exp_f32 v153, v153
 v_exp_f32 v154, v154
 v_exp_f32 v155, v155
 v_smfmac_f32_32x32x32_bf16 v[192:207], a[168:171], v[136:143], v50
 v_exp_f32 v156, v156
 v_exp_f32 v157, v157
 v_exp_f32 v158, v158
 v_exp_f32 v159, v159
 v_mfma_f32_32x32x8bf16_1k v[128:143], a[158:159], v[236:237], v[176:191]
 ds_read_b128 a[172:175], v75 offset:59712
 v_exp_f32 v112, v112
 v_exp_f32 v113, v113
 v_exp_f32 v114, v114
 v_exp_f32 v115, v115
 v_mfma_f32_32x32x16_bf16 v[128:143], a[152:155], v[228:231], v[128:143]
 buffer_load_dwordx4 a[44:47], v51, s[36:39], s89 offen offset:1024 sc1
 v_exp_f32 v116, v116
 v_exp_f32 v117, v117
 v_exp_f32 v118, v118
 v_exp_f32 v119, v119
 v_smfmac_f32_32x32x32_bf16 v[208:223], a[164:167], v[144:151], v50
 ds_read_b128 a[176:179], v75 offset:60896
 v_exp_f32 v120, v120
 v_exp_f32 v121, v121
 v_exp_f32 v122, v122
 v_exp_f32 v123, v123
 v_smfmac_f32_32x32x32_bf16 v[208:223], a[168:171], v[152:159], v50
 v_exp_f32 v124, v124
 v_exp_f32 v125, v125
 v_exp_f32 v126, v126
 v_exp_f32 v127, v127
 v_mfma_f32_32x32x8bf16_1k v[144:159], a[156:157], v[234:235], v[160:175]
 s_waitcnt lgkmcnt(2)
 v_exp_f32 v128, v128
 v_exp_f32 v129, v129
 v_exp_f32 v130, v130
 v_exp_f32 v131, v131
 v_mfma_f32_32x32x16_bf16 v[144:159], a[148:151], v[224:227], v[144:159]
 s_waitcnt lgkmcnt(0)
 ds_read2st64_b64 a[152:155], v73 offset0:95 offset1:96
 v_exp_f32 v132, v132
 v_exp_f32 v133, v133
 v_exp_f32 v134, v134
 v_exp_f32 v135, v135
 v_smfmac_f32_32x32x32_bf16 v[192:207], a[172:175], v[112:119], v50
 v_exp_f32 v136, v136
 v_exp_f32 v137, v137
 v_exp_f32 v138, v138
 v_exp_f32 v139, v139
 v_smfmac_f32_32x32x32_bf16 v[192:207], a[176:179], v[120:127], v50
 v_exp_f32 v140, v140
 v_exp_f32 v141, v141
 v_exp_f32 v142, v142
 v_exp_f32 v143, v143
 v_mfma_f32_32x32x8bf16_1k v[112:127], a[156:157], v[238:239], v[176:191]
 ds_read_b128 a[164:167], v75 offset:62080
 v_exp_f32 v144, v144
 v_exp_f32 v145, v145
 v_exp_f32 v146, v146
 v_exp_f32 v147, v147
 v_mfma_f32_32x32x16_bf16 v[112:127], a[148:151], v[228:231], v[112:127]
 buffer_load_dwordx4 a[48:51], v51, s[36:39], s89 offen offset:1536 sc1
 v_exp_f32 v148, v148
 v_exp_f32 v149, v149
 v_exp_f32 v150, v150
 v_exp_f32 v151, v151
 v_smfmac_f32_32x32x32_bf16 v[208:223], a[172:175], v[128:135], v50
 ds_read_b128 a[168:171], v75 offset:63264
 v_exp_f32 v152, v152
 v_exp_f32 v153, v153
 v_exp_f32 v154, v154
 v_exp_f32 v155, v155
 v_smfmac_f32_32x32x32_bf16 v[208:223], a[176:179], v[136:143], v50
 s_waitcnt vmcnt(23)
 s_barrier
 v_exp_f32 v156, v156
 v_exp_f32 v157, v157
 v_exp_f32 v158, v158
 v_exp_f32 v159, v159
 v_mfma_f32_32x32x8bf16_1k v[128:143], a[158:159], v[234:235], v[160:175]
 s_waitcnt lgkmcnt(2)
 ds_read2st64_b64 a[160:163], v49 offset0:120 offset1:125
 v_exp_f32 v112, v112
 v_exp_f32 v113, v113
 v_exp_f32 v114, v114
 v_exp_f32 v115, v115
 v_mfma_f32_32x32x16_bf16 v[128:143], a[152:155], v[224:227], v[128:143]
 s_waitcnt lgkmcnt(1)
 ds_read2st64_b64 a[148:151], v73 offset0:120 offset1:121
 v_exp_f32 v116, v116
 v_exp_f32 v117, v117
 v_exp_f32 v118, v118
 v_exp_f32 v119, v119
 v_smfmac_f32_32x32x32_bf16 v[192:207], a[164:167], v[144:151], v50
 s_add_u32 s78, s86, 3649536
 s_add_u32 m0, s87, 102400
 v_exp_f32 v120, v120
 v_exp_f32 v121, v121
 v_exp_f32 v122, v122
 v_exp_f32 v123, v123
 v_smfmac_f32_32x32x32_bf16 v[192:207], a[168:171], v[152:159], v50
 s_add_u32 s89, s91, 0
 buffer_load_dwordx4 a[52:55], v52, s[36:39], s89 offen offset:2048 sc1
 v_exp_f32 v124, v124
 v_exp_f32 v125, v125
 v_exp_f32 v126, v126
 v_exp_f32 v127, v127
 v_mfma_f32_32x32x8bf16_1k v[144:159], a[158:159], v[238:239], v[176:191]
 ds_read_b128 a[172:175], v75 offset:64448
 v_exp_f32 v128, v128
 v_exp_f32 v129, v129
 v_exp_f32 v130, v130
 v_exp_f32 v131, v131
 v_mfma_f32_32x32x16_bf16 v[144:159], a[152:155], v[228:231], v[144:159]
 buffer_load_dwordx4 v18, s[36:39], s78 offen sc1 lds
 v_exp_f32 v132, v132
 v_exp_f32 v133, v133
 v_exp_f32 v134, v134
 v_exp_f32 v135, v135
 v_smfmac_f32_32x32x32_bf16 v[208:223], a[164:167], v[112:119], v50
 s_add_u32 m0, s87, 103424
 ds_read_b128 a[176:179], v76 offset:96
 v_exp_f32 v136, v136
 v_exp_f32 v137, v137
 v_exp_f32 v138, v138
 v_exp_f32 v139, v139
 v_smfmac_f32_32x32x32_bf16 v[208:223], a[168:171], v[120:127], v50
 s_waitcnt lgkmcnt(3)
 buffer_load_dwordx4 v19, s[36:39], s78 offen sc1 lds
 v_exp_f32 v140, v140
 v_exp_f32 v141, v141
 v_exp_f32 v142, v142
 v_exp_f32 v143, v143
 v_mfma_f32_32x32x8bf16_1k v[112:127], a[160:161], v[232:233], v[160:175]
 s_waitcnt lgkmcnt(2)
 v_exp_f32 v144, v144
 v_exp_f32 v145, v145
 v_exp_f32 v146, v146
 v_exp_f32 v147, v147
 v_mfma_f32_32x32x16_bf16 v[112:127], a[148:151], v[224:227], v[112:127]
 s_waitcnt lgkmcnt(0)
 ds_read2st64_b64 a[152:155], v73 offset0:125 offset1:126
 v_exp_f32 v148, v148
 v_exp_f32 v149, v149
 v_exp_f32 v150, v150
 v_exp_f32 v151, v151
 v_smfmac_f32_32x32x32_bf16 v[192:207], a[172:175], v[128:135], v50
 s_add_u32 s89, s91, 73728
 s_add_u32 m0, s87, 104448
 buffer_load_dwordx4 a[56:59], v51, s[36:39], s89 offen offset:0 sc1
 v_exp_f32 v152, v152
 v_exp_f32 v153, v153
 v_exp_f32 v154, v154
 v_exp_f32 v155, v155
 v_smfmac_f32_32x32x32_bf16 v[192:207], a[176:179], v[136:143], v50
 buffer_load_dwordx4 v20, s[36:39], s78 offen sc1 lds
 v_exp_f32 v156, v156
 v_exp_f32 v157, v157
 v_exp_f32 v158, v158
 v_exp_f32 v159, v159
 v_mfma_f32_32x32x8bf16_1k v[128:143], a[160:161], v[236:237], v[176:191]
 s_add_u32 m0, s87, 105472
 ds_read_b128 a[164:167], v76 offset:12288
 v_exp_f32 v112, v112
 v_exp_f32 v113, v113
 v_exp_f32 v114, v114
 v_exp_f32 v115, v115
 v_mfma_f32_32x32x16_bf16 v[128:143], a[148:151], v[228:231], v[128:143]
 buffer_load_dwordx4 v21, s[36:39], s78 offen sc1 lds
 v_exp_f32 v116, v116
 v_exp_f32 v117, v117
 v_exp_f32 v118, v118
 v_exp_f32 v119, v119
 v_smfmac_f32_32x32x32_bf16 v[208:223], a[172:175], v[144:151], v50
 s_add_u32 m0, s87, 106496
 ds_read_b128 a[168:171], v76 offset:13472
 v_exp_f32 v120, v120
 v_exp_f32 v121, v121
 v_exp_f32 v122, v122
 v_exp_f32 v123, v123
 v_smfmac_f32_32x32x32_bf16 v[208:223], a[176:179], v[152:159], v50
 buffer_load_dwordx4 v22, s[36:39], s78 offen sc1 lds
 v_exp_f32 v124, v124
 v_exp_f32 v125, v125
 v_exp_f32 v126, v126
 v_exp_f32 v127, v127
 v_mfma_f32_32x32x8bf16_1k v[144:159], a[162:163], v[232:233], v[160:175]
 s_waitcnt lgkmcnt(2)
 v_exp_f32 v128, v128
 v_exp_f32 v129, v129
 v_exp_f32 v130, v130
 v_exp_f32 v131, v131
 v_mfma_f32_32x32x16_bf16 v[144:159], a[152:155], v[224:227], v[144:159]
 s_waitcnt lgkmcnt(0)
 ds_read2st64_b64 a[148:151], v73 offset0:130 offset1:131
 v_exp_f32 v132, v132
 v_exp_f32 v133, v133
 v_exp_f32 v134, v134
 v_exp_f32 v135, v135
 v_smfmac_f32_32x32x32_bf16 v[192:207], a[164:167], v[112:119], v50
L_cp5:
 s_add_u32 s84, s82, L_cp5-parallel_sum__mha_block__glu_gated_bilinear__prompt_kernel+8192
 buffer_load_dwordx4 a[60:63], v51, s[36:39], s89 offen offset:512 sc1
 v_exp_f32 v136, v136
 v_exp_f32 v137, v137
 v_exp_f32 v138, v138
 v_exp_f32 v139, v139
 v_smfmac_f32_32x32x32_bf16 v[192:207], a[168:171], v[120:127], v50
 buffer_load_dword a249, off, s[44:47], s84
 v_exp_f32 v140, v140
 v_exp_f32 v141, v141
 v_exp_f32 v142, v142
 v_exp_f32 v143, v143
 v_mfma_f32_32x32x8bf16_1k v[112:127], a[162:163], v[236:237], v[176:191]
 ds_read_b128 a[172:175], v76 offset:14656
 v_exp_f32 v144, v144
 v_exp_f32 v145, v145
 v_exp_f32 v146, v146
 v_exp_f32 v147, v147
 v_mfma_f32_32x32x16_bf16 v[112:127], a[152:155], v[228:231], v[112:127]
 v_exp_f32 v148, v148
 v_exp_f32 v149, v149
 v_exp_f32 v150, v150
 v_exp_f32 v151, v151
 v_smfmac_f32_32x32x32_bf16 v[208:223], a[164:167], v[128:135], v50
 ds_read_b128 a[176:179], v76 offset:15840
 v_exp_f32 v152, v152
 v_exp_f32 v153, v153
 v_exp_f32 v154, v154
 v_exp_f32 v155, v155
 v_smfmac_f32_32x32x32_bf16 v[208:223], a[168:171], v[136:143], v50
 v_exp_f32 v156, v156
 v_exp_f32 v157, v157
 v_exp_f32 v158, v158
 v_exp_f32 v159, v159
 v_mfma_f32_32x32x8bf16_1k v[128:143], a[160:161], v[234:235], v[160:175]
 s_waitcnt lgkmcnt(2)
 buffer_load_dwordx4 a[64:67], v51, s[36:39], s89 offen offset:1024 sc1
 v_exp_f32 v112, v112
 v_exp_f32 v113, v113
 v_exp_f32 v114, v114
 v_exp_f32 v115, v115
 v_mfma_f32_32x32x16_bf16 v[128:143], a[148:151], v[224:227], v[128:143]
 s_waitcnt lgkmcnt(0)
 ds_read2st64_b64 a[152:155], v73 offset0:135 offset1:136
 v_exp_f32 v116, v116
 v_exp_f32 v117, v117
 v_exp_f32 v118, v118
 v_exp_f32 v119, v119
 v_smfmac_f32_32x32x32_bf16 v[192:207], a[172:175], v[144:151], v50
 v_exp_f32 v120, v120
 v_exp_f32 v121, v121
 v_exp_f32 v122, v122
 v_exp_f32 v123, v123
 v_smfmac_f32_32x32x32_bf16 v[192:207], a[176:179], v[152:159], v50
 v_exp_f32 v124, v124
 v_exp_f32 v125, v125
 v_exp_f32 v126, v126
 v_exp_f32 v127, v127
 v_mfma_f32_32x32x8bf16_1k v[144:159], a[160:161], v[238:239], v[176:191]
 ds_read_b128 a[164:167], v76 offset:17024
 v_exp_f32 v128, v128
 v_exp_f32 v129, v129
 v_exp_f32 v130, v130
 v_exp_f32 v131, v131
 v_mfma_f32_32x32x16_bf16 v[144:159], a[148:151], v[228:231], v[144:159]
 v_exp_f32 v132, v132
 v_exp_f32 v133, v133
 v_exp_f32 v134, v134
 v_exp_f32 v135, v135
 v_smfmac_f32_32x32x32_bf16 v[208:223], a[172:175], v[112:119], v50
 ds_read_b128 a[168:171], v76 offset:18208
 v_exp_f32 v136, v136
 v_exp_f32 v137, v137
 v_exp_f32 v138, v138
 v_exp_f32 v139, v139
 v_smfmac_f32_32x32x32_bf16 v[208:223], a[176:179], v[120:127], v50
 s_waitcnt vmcnt(21)
 s_barrier
 v_exp_f32 v140, v140
 v_exp_f32 v141, v141
 v_exp_f32 v142, v142
 v_exp_f32 v143, v143
 v_mfma_f32_32x32x8bf16_1k v[112:127], a[162:163], v[234:235], v[160:175]
 s_waitcnt lgkmcnt(2)
 ds_read2st64_b64 a[156:159], v48 offset0:120 offset1:125
 v_exp_f32 v144, v144
 v_exp_f32 v145, v145
 v_exp_f32 v146, v146
 v_exp_f32 v147, v147
 v_mfma_f32_32x32x16_bf16 v[112:127], a[152:155], v[224:227], v[112:127]
 s_waitcnt lgkmcnt(1)
 ds_read2st64_b64 a[148:151], v72 offset0:120 offset1:121
 v_exp_f32 v148, v148
 v_exp_f32 v149, v149
 v_exp_f32 v150, v150
 v_exp_f32 v151, v151
 v_smfmac_f32_32x32x32_bf16 v[192:207], a[164:167], v[128:135], v50
 s_add_u32 s78, s86, 3953664
 s_add_u32 m0, s87, 122880
 buffer_load_dwordx4 a[68:71], v51, s[36:39], s89 offen offset:1536 sc1
 v_exp_f32 v152, v152
 v_exp_f32 v153, v153
 v_exp_f32 v154, v154
 v_exp_f32 v155, v155
 v_smfmac_f32_32x32x32_bf16 v[192:207], a[168:171], v[136:143], v50
 buffer_load_dwordx4 v18, s[36:39], s78 offen sc1 lds
 v_exp_f32 v156, v156
 v_exp_f32 v157, v157
 v_exp_f32 v158, v158
 v_exp_f32 v159, v159
 v_mfma_f32_32x32x8bf16_1k v[128:143], a[162:163], v[238:239], v[176:191]
 s_add_u32 m0, s87, 123904
 ds_read_b128 a[172:175], v76 offset:19392
 v_exp_f32 v112, v112
 v_exp_f32 v113, v113
 v_exp_f32 v114, v114
 v_exp_f32 v115, v115
 v_mfma_f32_32x32x16_bf16 v[128:143], a[152:155], v[228:231], v[128:143]
 buffer_load_dwordx4 v19, s[36:39], s78 offen sc1 lds
 v_exp_f32 v116, v116
 v_exp_f32 v117, v117
 v_exp_f32 v118, v118
 v_exp_f32 v119, v119
 v_smfmac_f32_32x32x32_bf16 v[208:223], a[164:167], v[144:151], v50
 s_add_u32 m0, s87, 124928
 ds_read_b128 a[176:179], v76 offset:20576
 v_exp_f32 v120, v120
 v_exp_f32 v121, v121
 v_exp_f32 v122, v122
 v_exp_f32 v123, v123
 v_smfmac_f32_32x32x32_bf16 v[208:223], a[168:171], v[152:159], v50
 s_waitcnt lgkmcnt(3)
 s_add_u32 s89, s91, 110592
 buffer_load_dwordx4 a[72:75], v51, s[36:39], s89 offen offset:0 sc1
 v_exp_f32 v124, v124
 v_exp_f32 v125, v125
 v_exp_f32 v126, v126
 v_exp_f32 v127, v127
 v_mfma_f32_32x32x8bf16_1k v[144:159], a[156:157], v[232:233], v[160:175]
 s_waitcnt lgkmcnt(2)
 buffer_load_dwordx4 v20, s[36:39], s78 offen sc1 lds
 v_exp_f32 v128, v128
 v_exp_f32 v129, v129
 v_exp_f32 v130, v130
 v_exp_f32 v131, v131
 v_mfma_f32_32x32x16_bf16 v[144:159], a[148:151], v[224:227], v[144:159]
 s_waitcnt lgkmcnt(0)
 ds_read2st64_b64 a[152:155], v72 offset0:125 offset1:126
 v_exp_f32 v132, v132
 v_exp_f32 v133, v133
 v_exp_f32 v134, v134
 v_exp_f32 v135, v135
 v_smfmac_f32_32x32x32_bf16 v[192:207], a[172:175], v[112:119], v50
 s_add_u32 m0, s87, 125952
 v_exp_f32 v136, v136
 v_exp_f32 v137, v137
 v_exp_f32 v138, v138
 v_exp_f32 v139, v139
 v_smfmac_f32_32x32x32_bf16 v[192:207], a[176:179], v[120:127], v50
 buffer_load_dwordx4 v21, s[36:39], s78 offen sc1 lds
 v_exp_f32 v140, v140
 v_exp_f32 v141, v141
 v_exp_f32 v142, v142
 v_exp_f32 v143, v143
 v_mfma_f32_32x32x8bf16_1k v[112:127], a[156:157], v[236:237], v[176:191]
 s_add_u32 m0, s87, 126976
 ds_read_b128 a[164:167], v74 offset:61440
 v_exp_f32 v144, v144
 v_exp_f32 v145, v145
 v_exp_f32 v146, v146
 v_exp_f32 v147, v147
 v_mfma_f32_32x32x16_bf16 v[112:127], a[148:151], v[228:231], v[112:127]
 buffer_load_dwordx4 v22, s[36:39], s78 offen sc1 lds
 v_exp_f32 v148, v148
 v_exp_f32 v149, v149
 v_exp_f32 v150, v150
 v_exp_f32 v151, v151
 v_smfmac_f32_32x32x32_bf16 v[208:223], a[172:175], v[128:135], v50
 ds_read_b128 a[168:171], v74 offset:62624
 v_exp_f32 v152, v152
 v_exp_f32 v153, v153
 v_exp_f32 v154, v154
 v_exp_f32 v155, v155
 v_smfmac_f32_32x32x32_bf16 v[208:223], a[176:179], v[136:143], v50
 buffer_load_dwordx4 a[76:79], v51, s[36:39], s89 offen offset:512 sc1
 v_exp_f32 v156, v156
 v_exp_f32 v157, v157
 v_exp_f32 v158, v158
 v_exp_f32 v159, v159
 v_mfma_f32_32x32x8bf16_1k v[128:143], a[158:159], v[232:233], v[160:175]
 s_waitcnt lgkmcnt(2)
 v_exp_f32 v112, v112
 v_exp_f32 v113, v113
 v_exp_f32 v114, v114
 v_exp_f32 v115, v115
 v_mfma_f32_32x32x16_bf16 v[128:143], a[152:155], v[224:227], v[128:143]
 s_waitcnt lgkmcnt(0)
 ds_read2st64_b64 a[148:151], v72 offset0:130 offset1:131
 v_exp_f32 v116, v116
 v_exp_f32 v117, v117
 v_exp_f32 v118, v118
 v_exp_f32 v119, v119
 v_smfmac_f32_32x32x32_bf16 v[192:207], a[164:167], v[144:151], v50
 v_exp_f32 v120, v120
 v_exp_f32 v121, v121
 v_exp_f32 v122, v122
 v_exp_f32 v123, v123
 v_smfmac_f32_32x32x32_bf16 v[192:207], a[168:171], v[152:159], v50
 v_exp_f32 v124, v124
 v_exp_f32 v125, v125
 v_exp_f32 v126, v126
 v_exp_f32 v127, v127
 v_mfma_f32_32x32x8bf16_1k v[144:159], a[158:159], v[236:237], v[176:191]
 ds_read_b128 a[172:175], v74 offset:63808
 v_exp_f32 v128, v128
 v_exp_f32 v129, v129
 v_exp_f32 v130, v130
 v_exp_f32 v131, v131
 v_mfma_f32_32x32x16_bf16 v[144:159], a[152:155], v[228:231], v[144:159]
 buffer_load_dwordx4 a[80:83], v51, s[36:39], s89 offen offset:1024 sc1
 v_exp_f32 v132, v132
 v_exp_f32 v133, v133
 v_exp_f32 v134, v134
 v_exp_f32 v135, v135
 v_smfmac_f32_32x32x32_bf16 v[208:223], a[164:167], v[112:119], v50
 ds_read_b128 a[176:179], v74 offset:64992
 v_exp_f32 v136, v136
 v_exp_f32 v137, v137
 v_exp_f32 v138, v138
 v_exp_f32 v139, v139
 v_smfmac_f32_32x32x32_bf16 v[208:223], a[168:171], v[120:127], v50
 v_exp_f32 v140, v140
 v_exp_f32 v141, v141
 v_exp_f32 v142, v142
 v_exp_f32 v143, v143
 v_mfma_f32_32x32x8bf16_1k v[112:127], a[156:157], v[234:235], v[160:175]
 s_waitcnt lgkmcnt(2)
 v_exp_f32 v144, v144
 v_exp_f32 v145, v145
 v_exp_f32 v146, v146
 v_exp_f32 v147, v147
 v_mfma_f32_32x32x16_bf16 v[112:127], a[148:151], v[224:227], v[112:127]
 s_waitcnt lgkmcnt(0)
 ds_read2st64_b64 a[152:155], v72 offset0:135 offset1:136
 v_exp_f32 v148, v148
 v_exp_f32 v149, v149
 v_exp_f32 v150, v150
 v_exp_f32 v151, v151
 v_smfmac_f32_32x32x32_bf16 v[192:207], a[172:175], v[128:135], v50
 v_exp_f32 v152, v152
 v_exp_f32 v153, v153
 v_exp_f32 v154, v154
 v_exp_f32 v155, v155
 v_smfmac_f32_32x32x32_bf16 v[192:207], a[176:179], v[136:143], v50
 v_exp_f32 v156, v156
 v_exp_f32 v157, v157
 v_exp_f32 v158, v158
 v_exp_f32 v159, v159
 v_mfma_f32_32x32x8bf16_1k v[128:143], a[156:157], v[238:239], v[176:191]
 ds_read_b128 a[164:167], v75 offset:640
 v_exp_f32 v112, v112
 v_exp_f32 v113, v113
 v_exp_f32 v114, v114
 v_exp_f32 v115, v115
 v_mfma_f32_32x32x16_bf16 v[128:143], a[148:151], v[228:231], v[128:143]
 buffer_load_dwordx4 a[84:87], v51, s[36:39], s89 offen offset:1536 sc1
 v_exp_f32 v116, v116
 v_exp_f32 v117, v117
 v_exp_f32 v118, v118
 v_exp_f32 v119, v119
 v_smfmac_f32_32x32x32_bf16 v[208:223], a[172:175], v[144:151], v50
 ds_read_b128 a[168:171], v75 offset:1824
 v_exp_f32 v120, v120
 v_exp_f32 v121, v121
 v_exp_f32 v122, v122
 v_exp_f32 v123, v123
 v_smfmac_f32_32x32x32_bf16 v[208:223], a[176:179], v[152:159], v50
 s_waitcnt vmcnt(22)
 s_barrier
 v_exp_f32 v124, v124
 v_exp_f32 v125, v125
 v_exp_f32 v126, v126
 v_exp_f32 v127, v127
 v_mfma_f32_32x32x8bf16_1k v[144:159], a[158:159], v[234:235], v[160:175]
 s_waitcnt lgkmcnt(2)
 ds_read2st64_b64 a[160:163], v49 offset0:0 offset1:5
 v_exp_f32 v128, v128
 v_exp_f32 v129, v129
 v_exp_f32 v130, v130
 v_exp_f32 v131, v131
 v_mfma_f32_32x32x16_bf16 v[144:159], a[152:155], v[224:227], v[144:159]
 s_waitcnt lgkmcnt(1)
 ds_read2st64_b64 a[148:151], v73 offset0:0 offset1:1
 v_exp_f32 v132, v132
 v_exp_f32 v133, v133
 v_exp_f32 v134, v134
 v_exp_f32 v135, v135
 v_smfmac_f32_32x32x32_bf16 v[192:207], a[164:167], v[112:119], v50
 s_add_u32 s78, s86, 4257792
 s_add_u32 m0, s87, 143360
 v_exp_f32 v136, v136
 v_exp_f32 v137, v137
 v_exp_f32 v138, v138
 v_exp_f32 v139, v139
 v_smfmac_f32_32x32x32_bf16 v[192:207], a[168:171], v[120:127], v50
 s_add_u32 s89, s91, 73728
 buffer_load_dwordx4 a[88:91], v52, s[36:39], s89 offen offset:2048 sc1
 v_exp_f32 v140, v140
 v_exp_f32 v141, v141
 v_exp_f32 v142, v142
 v_exp_f32 v143, v143
 v_mfma_f32_32x32x8bf16_1k v[112:127], a[158:159], v[238:239], v[176:191]
 ds_read_b128 a[172:175], v75 offset:3008
 v_exp_f32 v144, v144
 v_exp_f32 v145, v145
 v_exp_f32 v146, v146
 v_exp_f32 v147, v147
 v_mfma_f32_32x32x16_bf16 v[112:127], a[152:155], v[228:231], v[112:127]
 buffer_load_dwordx4 v18, s[36:39], s78 offen sc1 lds
 v_exp_f32 v148, v148
 v_exp_f32 v149, v149
 v_exp_f32 v150, v150
 v_exp_f32 v151, v151
 v_smfmac_f32_32x32x32_bf16 v[208:223], a[164:167], v[128:135], v50
 s_add_u32 m0, s87, 144384
 ds_read_b128 a[176:179], v75 offset:4192
 v_exp_f32 v152, v152
 v_exp_f32 v153, v153
 v_exp_f32 v154, v154
 v_exp_f32 v155, v155
 v_smfmac_f32_32x32x32_bf16 v[208:223], a[168:171], v[136:143], v50
 s_waitcnt lgkmcnt(3)
 buffer_load_dwordx4 v19, s[36:39], s78 offen sc1 lds
 v_exp_f32 v156, v156
 v_exp_f32 v157, v157
 v_exp_f32 v158, v158
 v_exp_f32 v159, v159
 v_mfma_f32_32x32x8bf16_1k v[128:143], a[160:161], v[232:233], v[160:175]
 s_waitcnt lgkmcnt(2)
 v_exp_f32 v112, v112
 v_exp_f32 v113, v113
 v_exp_f32 v114, v114
 v_exp_f32 v115, v115
 v_mfma_f32_32x32x16_bf16 v[128:143], a[148:151], v[224:227], v[128:143]
 s_waitcnt lgkmcnt(0)
 ds_read2st64_b64 a[152:155], v73 offset0:5 offset1:6
 v_exp_f32 v116, v116
 v_exp_f32 v117, v117
 v_exp_f32 v118, v118
 v_exp_f32 v119, v119
 v_smfmac_f32_32x32x32_bf16 v[192:207], a[172:175], v[144:151], v50
 s_add_u32 m0, s87, 145408
 v_exp_f32 v120, v120
 v_exp_f32 v121, v121
 v_exp_f32 v122, v122
 v_exp_f32 v123, v123
 v_smfmac_f32_32x32x32_bf16 v[192:207], a[176:179], v[152:159], v50
 s_add_u32 s89, s91, 147456
 buffer_load_dwordx4 a[92:95], v51, s[36:39], s89 offen offset:0 sc1
 v_exp_f32 v124, v124
 v_exp_f32 v125, v125
 v_exp_f32 v126, v126
 v_exp_f32 v127, v127
 v_mfma_f32_32x32x8bf16_1k v[144:159], a[160:161], v[236:237], v[176:191]
 ds_read_b128 a[164:167], v75 offset:16384
 v_exp_f32 v128, v128
 v_exp_f32 v129, v129
 v_exp_f32 v130, v130
 v_exp_f32 v131, v131
 v_mfma_f32_32x32x16_bf16 v[144:159], a[148:151], v[228:231], v[144:159]
 buffer_load_dwordx4 v20, s[36:39], s78 offen sc1 lds
 v_exp_f32 v132, v132
 v_exp_f32 v133, v133
 v_exp_f32 v134, v134
 v_exp_f32 v135, v135
 v_smfmac_f32_32x32x32_bf16 v[208:223], a[172:175], v[112:119], v50
 s_add_u32 m0, s87, 146432
 ds_read_b128 a[168:171], v75 offset:17568
 v_exp_f32 v136, v136
 v_exp_f32 v137, v137
 v_exp_f32 v138, v138
 v_exp_f32 v139, v139
 v_smfmac_f32_32x32x32_bf16 v[208:223], a[176:179], v[120:127], v50
 buffer_load_dwordx4 v21, s[36:39], s78 offen sc1 lds
 v_exp_f32 v140, v140
 v_exp_f32 v141, v141
 v_exp_f32 v142, v142
 v_exp_f32 v143, v143
 v_mfma_f32_32x32x8bf16_1k v[112:127], a[162:163], v[232:233], v[160:175]
 s_waitcnt lgkmcnt(2)
 v_exp_f32 v144, v144
 v_exp_f32 v145, v145
 v_exp_f32 v146, v146
 v_exp_f32 v147, v147
 v_mfma_f32_32x32x16_bf16 v[112:127], a[152:155], v[224:227], v[112:127]
 s_waitcnt lgkmcnt(0)
 ds_read2st64_b64 a[148:151], v73 offset0:10 offset1:11
 v_exp_f32 v148, v148
 v_exp_f32 v149, v149
 v_exp_f32 v150, v150
 v_exp_f32 v151, v151
 v_smfmac_f32_32x32x32_bf16 v[192:207], a[164:167], v[128:135], v50
 s_add_u32 m0, s87, 147456
 buffer_load_dwordx4 a[96:99], v51, s[36:39], s89 offen offset:512 sc1
 v_exp_f32 v152, v152
 v_exp_f32 v153, v153
 v_exp_f32 v154, v154
 v_exp_f32 v155, v155
 v_smfmac_f32_32x32x32_bf16 v[192:207], a[168:171], v[136:143], v50
 buffer_load_dwordx4 v22, s[36:39], s78 offen sc1 lds
 v_exp_f32 v156, v156
 v_exp_f32 v157, v157
 v_exp_f32 v158, v158
 v_exp_f32 v159, v159
 v_mfma_f32_32x32x8bf16_1k v[128:143], a[162:163], v[236:237], v[176:191]
 ds_read_b128 a[172:175], v75 offset:18752
 v_exp_f32 v112, v112
 v_exp_f32 v113, v113
 v_exp_f32 v114, v114
 v_exp_f32 v115, v115
 v_mfma_f32_32x32x16_bf16 v[128:143], a[152:155], v[228:231], v[128:143]
 v_exp_f32 v116, v116
 v_exp_f32 v117, v117
 v_exp_f32 v118, v118
 v_exp_f32 v119, v119
 v_smfmac_f32_32x32x32_bf16 v[208:223], a[164:167], v[144:151], v50
 ds_read_b128 a[176:179], v75 offset:19936
 v_exp_f32 v120, v120
 v_exp_f32 v121, v121
 v_exp_f32 v122, v122
 v_exp_f32 v123, v123
 v_smfmac_f32_32x32x32_bf16 v[208:223], a[168:171], v[152:159], v50
 v_exp_f32 v124, v124
 v_exp_f32 v125, v125
 v_exp_f32 v126, v126
 v_exp_f32 v127, v127
 v_mfma_f32_32x32x8bf16_1k v[144:159], a[160:161], v[234:235], v[160:175]
 s_waitcnt lgkmcnt(2)
 v_exp_f32 v128, v128
 v_exp_f32 v129, v129
 v_exp_f32 v130, v130
 v_exp_f32 v131, v131
 v_mfma_f32_32x32x16_bf16 v[144:159], a[148:151], v[224:227], v[144:159]
 s_waitcnt lgkmcnt(0)
 ds_read2st64_b64 a[152:155], v73 offset0:15 offset1:16
 v_exp_f32 v132, v132
 v_exp_f32 v133, v133
 v_exp_f32 v134, v134
 v_exp_f32 v135, v135
 v_smfmac_f32_32x32x32_bf16 v[192:207], a[172:175], v[112:119], v50
 buffer_load_dwordx4 a[180:183], v51, s[36:39], s89 offen offset:1024 sc1
 v_exp_f32 v136, v136
 v_exp_f32 v137, v137
 v_exp_f32 v138, v138
 v_exp_f32 v139, v139
 v_smfmac_f32_32x32x32_bf16 v[192:207], a[176:179], v[120:127], v50
 v_exp_f32 v140, v140
 v_exp_f32 v141, v141
 v_exp_f32 v142, v142
 v_exp_f32 v143, v143
 v_mfma_f32_32x32x8bf16_1k v[112:127], a[160:161], v[238:239], v[176:191]
 ds_read_b128 a[164:167], v75 offset:21120
 v_exp_f32 v144, v144
 v_exp_f32 v145, v145
 v_exp_f32 v146, v146
 v_exp_f32 v147, v147
 v_mfma_f32_32x32x16_bf16 v[112:127], a[148:151], v[228:231], v[112:127]
 v_exp_f32 v148, v148
 v_exp_f32 v149, v149
 v_exp_f32 v150, v150
 v_exp_f32 v151, v151
 v_smfmac_f32_32x32x32_bf16 v[208:223], a[172:175], v[128:135], v50
 ds_read_b128 a[168:171], v75 offset:22304
 v_exp_f32 v152, v152
 v_exp_f32 v153, v153
 v_exp_f32 v154, v154
 v_exp_f32 v155, v155
 v_smfmac_f32_32x32x32_bf16 v[208:223], a[176:179], v[136:143], v50
 s_waitcnt vmcnt(22)
 s_barrier
 v_exp_f32 v156, v156
 v_exp_f32 v157, v157
 v_exp_f32 v158, v158
 v_exp_f32 v159, v159
 v_mfma_f32_32x32x8bf16_1k v[128:143], a[162:163], v[234:235], v[160:175]
 s_waitcnt lgkmcnt(2)
 ds_read2st64_b64 a[156:159], v49 offset0:40 offset1:45
 v_exp_f32 v112, v112
 v_exp_f32 v113, v113
 v_exp_f32 v114, v114
 v_exp_f32 v115, v115
 v_mfma_f32_32x32x16_bf16 v[128:143], a[152:155], v[224:227], v[128:143]
 s_waitcnt lgkmcnt(1)
 ds_read2st64_b64 a[148:151], v73 offset0:40 offset1:41
 v_exp_f32 v116, v116
 v_exp_f32 v117, v117
 v_exp_f32 v118, v118
 v_exp_f32 v119, v119
 v_smfmac_f32_32x32x32_bf16 v[192:207], a[164:167], v[144:151], v50
 buffer_load_dwordx4 a[184:187], v51, s[36:39], s89 offen offset:1536 sc1
 v_exp_f32 v120, v120
 v_exp_f32 v121, v121
 v_exp_f32 v122, v122
 v_exp_f32 v123, v123
 v_smfmac_f32_32x32x32_bf16 v[192:207], a[168:171], v[152:159], v50
 v_exp_f32 v124, v124
 v_exp_f32 v125, v125
 v_exp_f32 v126, v126
 v_exp_f32 v127, v127
 v_mfma_f32_32x32x8bf16_1k v[144:159], a[162:163], v[238:239], v[176:191]
 ds_read_b128 a[172:175], v75 offset:23488
 v_exp_f32 v128, v128
 v_exp_f32 v129, v129
 v_exp_f32 v130, v130
 v_exp_f32 v131, v131
 v_mfma_f32_32x32x16_bf16 v[144:159], a[152:155], v[228:231], v[144:159]
 v_exp_f32 v132, v132
 v_exp_f32 v133, v133
 v_exp_f32 v134, v134
 v_exp_f32 v135, v135
 v_smfmac_f32_32x32x32_bf16 v[208:223], a[164:167], v[112:119], v50
 ds_read_b128 a[176:179], v75 offset:24672
 v_exp_f32 v136, v136
 v_exp_f32 v137, v137
 v_exp_f32 v138, v138
 v_exp_f32 v139, v139
 v_smfmac_f32_32x32x32_bf16 v[208:223], a[168:171], v[120:127], v50
 s_waitcnt lgkmcnt(3)
 s_add_u32 s89, s91, 184320
 buffer_load_dwordx4 a[188:191], v51, s[36:39], s89 offen offset:0 sc1
 v_exp_f32 v140, v140
 v_exp_f32 v141, v141
 v_exp_f32 v142, v142
 v_exp_f32 v143, v143
 v_mfma_f32_32x32x8bf16_1k v[112:127], a[156:157], v[232:233], v[160:175]
 s_waitcnt lgkmcnt(2)
 v_exp_f32 v144, v144
 v_exp_f32 v145, v145
 v_exp_f32 v146, v146
 v_exp_f32 v147, v147
 v_mfma_f32_32x32x16_bf16 v[112:127], a[148:151], v[224:227], v[112:127]
 s_waitcnt lgkmcnt(0)
 ds_read2st64_b64 a[152:155], v73 offset0:45 offset1:46
 v_exp_f32 v148, v148
 v_exp_f32 v149, v149
 v_exp_f32 v150, v150
 v_exp_f32 v151, v151
 v_smfmac_f32_32x32x32_bf16 v[192:207], a[172:175], v[128:135], v50
 v_exp_f32 v152, v152
 v_exp_f32 v153, v153
 v_exp_f32 v154, v154
 v_exp_f32 v155, v155
 v_smfmac_f32_32x32x32_bf16 v[192:207], a[176:179], v[136:143], v50
 v_exp_f32 v156, v156
 v_exp_f32 v157, v157
 v_exp_f32 v158, v158
 v_exp_f32 v159, v159
 v_mfma_f32_32x32x8bf16_1k v[128:143], a[156:157], v[236:237], v[176:191]
 ds_read_b128 a[164:167], v75 offset:36864
 v_exp_f32 v112, v112
 v_exp_f32 v113, v113
 v_exp_f32 v114, v114
 v_exp_f32 v115, v115
 v_mfma_f32_32x32x16_bf16 v[128:143], a[148:151], v[228:231], v[128:143]
 v_exp_f32 v116, v116
 v_exp_f32 v117, v117
 v_exp_f32 v118, v118
 v_exp_f32 v119, v119
 v_smfmac_f32_32x32x32_bf16 v[208:223], a[172:175], v[144:151], v50
 ds_read_b128 a[168:171], v75 offset:38048
 v_exp_f32 v120, v120
 v_exp_f32 v121, v121
 v_exp_f32 v122, v122
 v_exp_f32 v123, v123
 v_smfmac_f32_32x32x32_bf16 v[208:223], a[176:179], v[152:159], v50
 buffer_load_dwordx4 a[192:195], v51, s[36:39], s89 offen offset:512 sc1
 v_exp_f32 v124, v124
 v_exp_f32 v125, v125
 v_exp_f32 v126, v126
 v_exp_f32 v127, v127
 v_mfma_f32_32x32x8bf16_1k v[144:159], a[158:159], v[232:233], v[160:175]
 s_waitcnt lgkmcnt(2)
 v_exp_f32 v128, v128
 v_exp_f32 v129, v129
 v_exp_f32 v130, v130
 v_exp_f32 v131, v131
 v_mfma_f32_32x32x16_bf16 v[144:159], a[152:155], v[224:227], v[144:159]
 s_waitcnt lgkmcnt(0)
 ds_read2st64_b64 a[148:151], v73 offset0:50 offset1:51
 v_exp_f32 v132, v132
 v_exp_f32 v133, v133
 v_exp_f32 v134, v134
 v_exp_f32 v135, v135
 v_smfmac_f32_32x32x32_bf16 v[192:207], a[164:167], v[112:119], v50
 s_add_u32 s78, s73, 12
 s_add_u32 s78, s78, s68
 v_exp_f32 v136, v136
 v_exp_f32 v137, v137
 v_exp_f32 v138, v138
 v_exp_f32 v139, v139
 v_smfmac_f32_32x32x32_bf16 v[192:207], a[168:171], v[120:127], v50
 s_and_b32 s78, s78, 15
 s_mul_i32 s78, s78, 41472
 v_exp_f32 v140, v140
 v_exp_f32 v141, v141
 v_exp_f32 v142, v142
 v_exp_f32 v143, v143
 v_mfma_f32_32x32x8bf16_1k v[112:127], a[158:159], v[236:237], v[176:191]
 s_add_u32 s78, s78, s93
 ds_read_b128 a[172:175], v75 offset:39232
 v_exp_f32 v144, v144
 v_exp_f32 v145, v145
 v_exp_f32 v146, v146
 v_exp_f32 v147, v147
 v_mfma_f32_32x32x16_bf16 v[112:127], a[152:155], v[228:231], v[112:127]
 s_add_u32 m0, s87, 61440
 v_exp_f32 v148, v148
 v_exp_f32 v149, v149
 v_exp_f32 v150, v150
 v_exp_f32 v151, v151
 v_smfmac_f32_32x32x32_bf16 v[208:223], a[164:167], v[128:135], v50
 ds_read_b128 a[176:179], v75 offset:40416
 v_exp_f32 v152, v152
 v_exp_f32 v153, v153
 v_exp_f32 v154, v154
 v_exp_f32 v155, v155
 v_smfmac_f32_32x32x32_bf16 v[208:223], a[168:171], v[136:143], v50
 buffer_load_dwordx4 a[196:199], v51, s[36:39], s89 offen offset:1024 sc1
 v_exp_f32 v156, v156
 v_exp_f32 v157, v157
 v_exp_f32 v158, v158
 v_exp_f32 v159, v159
 v_mfma_f32_32x32x8bf16_1k v[128:143], a[156:157], v[234:235], v[160:175]
 s_waitcnt lgkmcnt(2)
 buffer_load_dwordx4 v55, s[12:15], s78 offen lds
 v_exp_f32 v112, v112
 v_exp_f32 v113, v113
 v_exp_f32 v114, v114
 v_exp_f32 v115, v115
 v_mfma_f32_32x32x16_bf16 v[128:143], a[148:151], v[224:227], v[128:143]
 s_waitcnt lgkmcnt(0)
 ds_read2st64_b64 a[152:155], v73 offset0:55 offset1:56
 v_exp_f32 v116, v116
 v_exp_f32 v117, v117
 v_exp_f32 v118, v118
 v_exp_f32 v119, v119
 v_smfmac_f32_32x32x32_bf16 v[192:207], a[172:175], v[144:151], v50
 s_add_u32 m0, s87, 62464
 v_exp_f32 v120, v120
 v_exp_f32 v121, v121
 v_exp_f32 v122, v122
 v_exp_f32 v123, v123
 v_smfmac_f32_32x32x32_bf16 v[192:207], a[176:179], v[152:159], v50
 buffer_load_dwordx4 v56, s[12:15], s78 offen lds
 v_exp_f32 v124, v124
 v_exp_f32 v125, v125
 v_exp_f32 v126, v126
 v_exp_f32 v127, v127
 v_mfma_f32_32x32x8bf16_1k v[144:159], a[156:157], v[238:239], v[176:191]
 s_add_u32 m0, s87, 63488
 ds_read_b128 a[164:167], v75 offset:41600
 v_exp_f32 v128, v128
 v_exp_f32 v129, v129
 v_exp_f32 v130, v130
 v_exp_f32 v131, v131
 v_mfma_f32_32x32x16_bf16 v[144:159], a[148:151], v[228:231], v[144:159]
 buffer_load_dwordx4 a[200:203], v51, s[36:39], s89 offen offset:1536 sc1
 v_exp_f32 v132, v132
 v_exp_f32 v133, v133
 v_exp_f32 v134, v134
 v_exp_f32 v135, v135
 v_smfmac_f32_32x32x32_bf16 v[208:223], a[172:175], v[112:119], v50
 ds_read_b128 a[168:171], v75 offset:42784
 v_exp_f32 v136, v136
 v_exp_f32 v137, v137
 v_exp_f32 v138, v138
 v_exp_f32 v139, v139
 v_smfmac_f32_32x32x32_bf16 v[208:223], a[176:179], v[120:127], v50
 s_waitcnt vmcnt(19)
 s_barrier
 buffer_load_dwordx4 v57, s[12:15], s78 offen lds
 v_exp_f32 v140, v140
 v_exp_f32 v141, v141
 v_exp_f32 v142, v142
 v_exp_f32 v143, v143
 v_mfma_f32_32x32x8bf16_1k v[112:127], a[158:159], v[234:235], v[160:175]
 s_waitcnt lgkmcnt(2)
 ds_read2st64_b64 a[160:163], v49 offset0:80 offset1:85
 v_exp_f32 v144, v144
 v_exp_f32 v145, v145
 v_exp_f32 v146, v146
 v_exp_f32 v147, v147
 v_mfma_f32_32x32x16_bf16 v[112:127], a[152:155], v[224:227], v[112:127]
 s_waitcnt lgkmcnt(1)
 ds_read2st64_b64 a[148:151], v73 offset0:80 offset1:81
 v_exp_f32 v148, v148
 v_exp_f32 v149, v149
 v_exp_f32 v150, v150
 v_exp_f32 v151, v151
 v_smfmac_f32_32x32x32_bf16 v[192:207], a[164:167], v[128:135], v50
 s_add_u32 m0, s87, 64512
 v_exp_f32 v152, v152
 v_exp_f32 v153, v153
 v_exp_f32 v154, v154
 v_exp_f32 v155, v155
 v_smfmac_f32_32x32x32_bf16 v[192:207], a[168:171], v[136:143], v50
 buffer_load_dwordx4 v58, s[12:15], s78 offen lds
 v_exp_f32 v156, v156
 v_exp_f32 v157, v157
 v_exp_f32 v158, v158
 v_exp_f32 v159, v159
 v_mfma_f32_32x32x8bf16_1k v[128:143], a[158:159], v[238:239], v[176:191]
 s_add_u32 s89, s91, 147456
 ds_read_b128 a[172:175], v75 offset:43968
 v_exp_f32 v112, v112
 v_exp_f32 v113, v113
 v_exp_f32 v114, v114
 v_exp_f32 v115, v115
 v_mfma_f32_32x32x16_bf16 v[128:143], a[152:155], v[228:231], v[128:143]
 s_add_u32 m0, s87, 65536
 buffer_load_dwordx4 a[204:207], v52, s[36:39], s89 offen offset:2048 sc1
 v_exp_f32 v116, v116
 v_exp_f32 v117, v117
 v_exp_f32 v118, v118
 v_exp_f32 v119, v119
 v_smfmac_f32_32x32x32_bf16 v[208:223], a[164:167], v[144:151], v50
 ds_read_b128 a[176:179], v75 offset:45152
 v_exp_f32 v120, v120
 v_exp_f32 v121, v121
 v_exp_f32 v122, v122
 v_exp_f32 v123, v123
 v_smfmac_f32_32x32x32_bf16 v[208:223], a[168:171], v[152:159], v50
 s_waitcnt lgkmcnt(3)
 buffer_load_dwordx4 v59, s[12:15], s78 offen lds
 v_exp_f32 v124, v124
 v_exp_f32 v125, v125
 v_exp_f32 v126, v126
 v_exp_f32 v127, v127
 v_mfma_f32_32x32x8bf16_1k v[144:159], a[160:161], v[232:233], v[160:175]
 s_waitcnt lgkmcnt(2)
 v_exp_f32 v128, v128
 v_exp_f32 v129, v129
 v_exp_f32 v130, v130
 v_exp_f32 v131, v131
 v_mfma_f32_32x32x16_bf16 v[144:159], a[148:151], v[224:227], v[144:159]
 s_waitcnt lgkmcnt(0)
 ds_read2st64_b64 a[152:155], v73 offset0:85 offset1:86
 v_exp_f32 v132, v132
 v_exp_f32 v133, v133
 v_exp_f32 v134, v134
 v_exp_f32 v135, v135
 v_smfmac_f32_32x32x32_bf16 v[192:207], a[172:175], v[112:119], v50
 s_add_u32 s78, s86, 4561920
 s_add_u32 m0, s87, 81920
 v_exp_f32 v136, v136
 v_exp_f32 v137, v137
 v_exp_f32 v138, v138
 v_exp_f32 v139, v139
 v_smfmac_f32_32x32x32_bf16 v[192:207], a[176:179], v[120:127], v50
 s_add_u32 s89, s91, 221184
 buffer_load_dwordx4 a[208:211], v51, s[36:39], s89 offen offset:0 sc1
 v_exp_f32 v140, v140
 v_exp_f32 v141, v141
 v_exp_f32 v142, v142
 v_exp_f32 v143, v143
 v_mfma_f32_32x32x8bf16_1k v[112:127], a[160:161], v[236:237], v[176:191]
 ds_read_b128 a[164:167], v75 offset:57344
 v_exp_f32 v144, v144
 v_exp_f32 v145, v145
 v_exp_f32 v146, v146
 v_exp_f32 v147, v147
 v_mfma_f32_32x32x16_bf16 v[112:127], a[148:151], v[228:231], v[112:127]
 buffer_load_dwordx4 v18, s[36:39], s78 offen sc1 lds
 v_exp_f32 v148, v148
 v_exp_f32 v149, v149
 v_exp_f32 v150, v150
 v_exp_f32 v151, v151
 v_smfmac_f32_32x32x32_bf16 v[208:223], a[172:175], v[128:135], v50
 s_add_u32 m0, s87, 82944
 ds_read_b128 a[168:171], v75 offset:58528
 v_exp_f32 v152, v152
 v_exp_f32 v153, v153
 v_exp_f32 v154, v154
 v_exp_f32 v155, v155
 v_smfmac_f32_32x32x32_bf16 v[208:223], a[176:179], v[136:143], v50
 buffer_load_dwordx4 v19, s[36:39], s78 offen sc1 lds
 v_exp_f32 v156, v156
 v_exp_f32 v157, v157
 v_exp_f32 v158, v158
 v_exp_f32 v159, v159
 v_mfma_f32_32x32x8bf16_1k v[128:143], a[162:163], v[232:233], v[160:175]
 s_waitcnt lgkmcnt(2)
 v_exp_f32 v112, v112
 v_exp_f32 v113, v113
 v_exp_f32 v114, v114
 v_exp_f32 v115, v115
 v_mfma_f32_32x32x16_bf16 v[128:143], a[152:155], v[224:227], v[128:143]
 s_waitcnt lgkmcnt(0)
 ds_read2st64_b64 a[148:151], v73 offset0:90 offset1:91
 v_exp_f32 v116, v116
 v_exp_f32 v117, v117
 v_exp_f32 v118, v118
 v_exp_f32 v119, v119
 v_smfmac_f32_32x32x32_bf16 v[192:207], a[164:167], v[144:151], v50
 s_add_u32 m0, s87, 83968
 buffer_load_dwordx4 a[212:215], v51, s[36:39], s89 offen offset:512 sc1
 v_exp_f32 v120, v120
 v_exp_f32 v121, v121
 v_exp_f32 v122, v122
 v_exp_f32 v123, v123
 v_smfmac_f32_32x32x32_bf16 v[192:207], a[168:171], v[152:159], v50
 buffer_load_dwordx4 v20, s[36:39], s78 offen sc1 lds
 v_exp_f32 v124, v124
 v_exp_f32 v125, v125
 v_exp_f32 v126, v126
 v_exp_f32 v127, v127
 v_mfma_f32_32x32x8bf16_1k v[144:159], a[162:163], v[236:237], v[176:191]
 s_add_u32 m0, s87, 84992
 ds_read_b128 a[172:175], v75 offset:59712
 v_exp_f32 v128, v128
 v_exp_f32 v129, v129
 v_exp_f32 v130, v130
 v_exp_f32 v131, v131
 v_mfma_f32_32x32x16_bf16 v[144:159], a[152:155], v[228:231], v[144:159]
 buffer_load_dwordx4 v21, s[36:39], s78 offen sc1 lds
 v_exp_f32 v132, v132
 v_exp_f32 v133, v133
 v_exp_f32 v134, v134
 v_exp_f32 v135, v135
 v_smfmac_f32_32x32x32_bf16 v[208:223], a[164:167], v[112:119], v50
 s_add_u32 m0, s87, 86016
 ds_read_b128 a[176:179], v75 offset:60896
 v_exp_f32 v136, v136
 v_exp_f32 v137, v137
 v_exp_f32 v138, v138
 v_exp_f32 v139, v139
 v_smfmac_f32_32x32x32_bf16 v[208:223], a[168:171], v[120:127], v50
 buffer_load_dwordx4 v22, s[36:39], s78 offen sc1 lds
 v_exp_f32 v140, v140
 v_exp_f32 v141, v141
 v_exp_f32 v142, v142
 v_exp_f32 v143, v143
 v_mfma_f32_32x32x8bf16_1k v[112:127], a[160:161], v[234:235], v[160:175]
 s_waitcnt lgkmcnt(2)
 v_exp_f32 v144, v144
 v_exp_f32 v145, v145
 v_exp_f32 v146, v146
 v_exp_f32 v147, v147
 v_mfma_f32_32x32x16_bf16 v[112:127], a[148:151], v[224:227], v[112:127]
 s_waitcnt lgkmcnt(0)
 ds_read2st64_b64 a[152:155], v73 offset0:95 offset1:96
 v_exp_f32 v148, v148
 v_exp_f32 v149, v149
 v_exp_f32 v150, v150
 v_exp_f32 v151, v151
 v_smfmac_f32_32x32x32_bf16 v[192:207], a[172:175], v[128:135], v50
 buffer_load_dwordx4 a[216:219], v51, s[36:39], s89 offen offset:1024 sc1
 v_exp_f32 v152, v152
 v_exp_f32 v153, v153
 v_exp_f32 v154, v154
 v_exp_f32 v155, v155
 v_smfmac_f32_32x32x32_bf16 v[192:207], a[176:179], v[136:143], v50
 v_exp_f32 v156, v156
 v_exp_f32 v157, v157
 v_exp_f32 v158, v158
 v_exp_f32 v159, v159
 v_mfma_f32_32x32x8bf16_1k v[128:143], a[160:161], v[238:239], v[176:191]
 ds_read_b128 a[164:167], v75 offset:62080
 v_exp_f32 v112, v112
 v_exp_f32 v113, v113
 v_exp_f32 v114, v114
 v_exp_f32 v115, v115
 v_mfma_f32_32x32x16_bf16 v[128:143], a[148:151], v[228:231], v[128:143]
 v_exp_f32 v116, v116
 v_exp_f32 v117, v117
 v_exp_f32 v118, v118
 v_exp_f32 v119, v119
 v_smfmac_f32_32x32x32_bf16 v[208:223], a[172:175], v[144:151], v50
 ds_read_b128 a[168:171], v75 offset:63264
 v_exp_f32 v120, v120
 v_exp_f32 v121, v121
 v_exp_f32 v122, v122
 v_exp_f32 v123, v123
 v_smfmac_f32_32x32x32_bf16 v[208:223], a[176:179], v[152:159], v50
 s_waitcnt vmcnt(20)
 s_barrier
 v_exp_f32 v124, v124
 v_exp_f32 v125, v125
 v_exp_f32 v126, v126
 v_exp_f32 v127, v127
 v_mfma_f32_32x32x8bf16_1k v[144:159], a[162:163], v[234:235], v[160:175]
 s_waitcnt lgkmcnt(2)
 ds_read2st64_b64 a[156:159], v49 offset0:120 offset1:125
 v_exp_f32 v128, v128
 v_exp_f32 v129, v129
 v_exp_f32 v130, v130
 v_exp_f32 v131, v131
 v_mfma_f32_32x32x16_bf16 v[144:159], a[152:155], v[224:227], v[144:159]
 s_waitcnt lgkmcnt(1)
 ds_read2st64_b64 a[148:151], v73 offset0:120 offset1:121
 v_exp_f32 v132, v132
 v_exp_f32 v133, v133
 v_exp_f32 v134, v134
 v_exp_f32 v135, v135
 v_smfmac_f32_32x32x32_bf16 v[192:207], a[164:167], v[112:119], v50
 s_mul_i32 s79, s68, 3
 s_min_u32 s79, s79, 7
 buffer_load_dwordx4 a[220:223], v51, s[36:39], s89 offen offset:1536 sc1
 v_exp_f32 v136, v136
 v_exp_f32 v137, v137
 v_exp_f32 v138, v138
 v_exp_f32 v139, v139
 v_smfmac_f32_32x32x32_bf16 v[192:207], a[168:171], v[120:127], v50
 s_lshl_b32 s79, s79, 10
 s_and_b32 s80, s71, 7
 v_exp_f32 v140, v140
 v_exp_f32 v141, v141
 v_exp_f32 v142, v142
 v_exp_f32 v143, v143
 v_mfma_f32_32x32x8bf16_1k v[112:127], a[162:163], v[238:239], v[176:191]
 s_mul_i32 s80, s80, 144
 ds_read_b128 a[172:175], v75 offset:64448
 v_exp_f32 v144, v144
 v_exp_f32 v145, v145
 v_exp_f32 v146, v146
 v_exp_f32 v147, v147
 v_mfma_f32_32x32x16_bf16 v[112:127], a[152:155], v[228:231], v[112:127]
 s_add_u32 m0, s79, 102400
 v_exp_f32 v148, v148
 v_exp_f32 v149, v149
 v_exp_f32 v150, v150
 v_exp_f32 v151, v151
 v_smfmac_f32_32x32x32_bf16 v[208:223], a[164:167], v[128:135], v50
 ds_read_b128 a[176:179], v76 offset:96
 v_exp_f32 v152, v152
 v_exp_f32 v153, v153
 v_exp_f32 v154, v154
 v_exp_f32 v155, v155
 v_smfmac_f32_32x32x32_bf16 v[208:223], a[168:171], v[136:143], v50
 s_waitcnt lgkmcnt(3)
 buffer_load_dwordx4 v77, s[12:15], s80 offen lds
 v_exp_f32 v156, v156
 v_exp_f32 v157, v157
 v_exp_f32 v158, v158
 v_exp_f32 v159, v159
 v_mfma_f32_32x32x8bf16_1k v[128:143], a[156:157], v[232:233], v[160:175]
 s_waitcnt lgkmcnt(2)
 v_exp_f32 v112, v112
 v_exp_f32 v113, v113
 v_exp_f32 v114, v114
 v_exp_f32 v115, v115
 v_mfma_f32_32x32x16_bf16 v[128:143], a[148:151], v[224:227], v[128:143]
 s_waitcnt lgkmcnt(0)
 ds_read2st64_b64 a[152:155], v73 offset0:125 offset1:126
 v_exp_f32 v116, v116
 v_exp_f32 v117, v117
 v_exp_f32 v118, v118
 v_exp_f32 v119, v119
 v_smfmac_f32_32x32x32_bf16 v[192:207], a[172:175], v[144:151], v50
 s_add_u32 s89, s91, 258048
 s_add_u32 m0, s79, 103424
 buffer_load_dwordx4 a[224:227], v51, s[36:39], s89 offen offset:0 sc1
 v_exp_f32 v120, v120
 v_exp_f32 v121, v121
 v_exp_f32 v122, v122
 v_exp_f32 v123, v123
 v_smfmac_f32_32x32x32_bf16 v[192:207], a[176:179], v[152:159], v50
 buffer_load_dwordx4 v78, s[12:15], s80 offen lds
 v_exp_f32 v124, v124
 v_exp_f32 v125, v125
 v_exp_f32 v126, v126
 v_exp_f32 v127, v127
 v_mfma_f32_32x32x8bf16_1k v[144:159], a[156:157], v[236:237], v[176:191]
 s_add_u32 m0, s79, 104448
 ds_read_b128 a[164:167], v76 offset:12288
 v_exp_f32 v128, v128
 v_exp_f32 v129, v129
 v_exp_f32 v130, v130
 v_exp_f32 v131, v131
 v_mfma_f32_32x32x16_bf16 v[144:159], a[148:151], v[228:231], v[144:159]
 buffer_load_dwordx4 v79, s[12:15], s80 offen lds
 v_exp_f32 v132, v132
 v_exp_f32 v133, v133
 v_exp_f32 v134, v134
 v_exp_f32 v135, v135
 v_smfmac_f32_32x32x32_bf16 v[208:223], a[172:175], v[112:119], v50
 ds_read_b128 a[168:171], v76 offset:13472
 v_exp_f32 v136, v136
 v_exp_f32 v137, v137
 v_exp_f32 v138, v138
 v_exp_f32 v139, v139
 v_smfmac_f32_32x32x32_bf16 v[208:223], a[176:179], v[120:127], v50
 buffer_load_dwordx4 a[228:231], v51, s[36:39], s89 offen offset:512 sc1
 v_exp_f32 v140, v140
 v_exp_f32 v141, v141
 v_exp_f32 v142, v142
 v_exp_f32 v143, v143
 v_mfma_f32_32x32x8bf16_1k v[112:127], a[158:159], v[232:233], v[160:175]
 s_waitcnt lgkmcnt(2)
 v_exp_f32 v144, v144
 v_exp_f32 v145, v145
 v_exp_f32 v146, v146
 v_exp_f32 v147, v147
 v_mfma_f32_32x32x16_bf16 v[112:127], a[152:155], v[224:227], v[112:127]
 s_waitcnt lgkmcnt(0)
 ds_read2st64_b64 a[148:151], v73 offset0:130 offset1:131
 v_exp_f32 v148, v148
 v_exp_f32 v149, v149
 v_exp_f32 v150, v150
 v_exp_f32 v151, v151
 v_smfmac_f32_32x32x32_bf16 v[192:207], a[164:167], v[128:135], v50
 v_exp_f32 v152, v152
 v_exp_f32 v153, v153
 v_exp_f32 v154, v154
 v_exp_f32 v155, v155
 v_smfmac_f32_32x32x32_bf16 v[192:207], a[168:171], v[136:143], v50
 v_exp_f32 v156, v156
 v_exp_f32 v157, v157
 v_exp_f32 v158, v158
 v_exp_f32 v159, v159
 v_mfma_f32_32x32x8bf16_1k v[128:143], a[158:159], v[236:237], v[176:191]
 ds_read_b128 a[172:175], v76 offset:14656
 v_exp_f32 v112, v112
 v_exp_f32 v113, v113
 v_exp_f32 v114, v114
 v_exp_f32 v115, v115
 v_mfma_f32_32x32x16_bf16 v[128:143], a[152:155], v[228:231], v[128:143]
 v_exp_f32 v116, v116
 v_exp_f32 v117, v117
 v_exp_f32 v118, v118
 v_exp_f32 v119, v119
 v_smfmac_f32_32x32x32_bf16 v[208:223], a[164:167], v[144:151], v50
 ds_read_b128 a[176:179], v76 offset:15840
 v_exp_f32 v120, v120
 v_exp_f32 v121, v121
 v_exp_f32 v122, v122
 v_exp_f32 v123, v123
 v_smfmac_f32_32x32x32_bf16 v[208:223], a[168:171], v[152:159], v50
 buffer_load_dwordx4 a[232:235], v51, s[36:39], s89 offen offset:1024 sc1
 v_exp_f32 v124, v124
 v_exp_f32 v125, v125
 v_exp_f32 v126, v126
 v_exp_f32 v127, v127
 v_mfma_f32_32x32x8bf16_1k v[144:159], a[156:157], v[234:235], v[160:175]
 s_waitcnt lgkmcnt(2)
 v_exp_f32 v128, v128
 v_exp_f32 v129, v129
 v_exp_f32 v130, v130
 v_exp_f32 v131, v131
 v_mfma_f32_32x32x16_bf16 v[144:159], a[148:151], v[224:227], v[144:159]
 s_waitcnt lgkmcnt(0)
 ds_read2st64_b64 a[152:155], v73 offset0:135 offset1:136
 v_exp_f32 v132, v132
 v_exp_f32 v133, v133
 v_exp_f32 v134, v134
 v_exp_f32 v135, v135
 v_smfmac_f32_32x32x32_bf16 v[192:207], a[172:175], v[112:119], v50
 v_exp_f32 v136, v136
 v_exp_f32 v137, v137
 v_exp_f32 v138, v138
 v_exp_f32 v139, v139
 v_smfmac_f32_32x32x32_bf16 v[192:207], a[176:179], v[120:127], v50
 v_exp_f32 v140, v140
 v_exp_f32 v141, v141
 v_exp_f32 v142, v142
 v_exp_f32 v143, v143
 v_mfma_f32_32x32x8bf16_1k v[112:127], a[156:157], v[238:239], v[176:191]
 ds_read_b128 a[164:167], v76 offset:17024
 v_exp_f32 v144, v144
 v_exp_f32 v145, v145
 v_exp_f32 v146, v146
 v_exp_f32 v147, v147
 v_mfma_f32_32x32x16_bf16 v[112:127], a[148:151], v[228:231], v[112:127]
 buffer_load_dwordx4 a[236:239], v51, s[36:39], s89 offen offset:1536 sc1
 v_exp_f32 v148, v148
 v_exp_f32 v149, v149
 v_exp_f32 v150, v150
 v_exp_f32 v151, v151
 v_smfmac_f32_32x32x32_bf16 v[208:223], a[172:175], v[128:135], v50
 ds_read_b128 a[168:171], v76 offset:18208
 v_exp_f32 v152, v152
 v_exp_f32 v153, v153
 v_exp_f32 v154, v154
 v_exp_f32 v155, v155
 v_smfmac_f32_32x32x32_bf16 v[208:223], a[176:179], v[136:143], v50
 s_waitcnt vmcnt(3)
 s_barrier
 v_exp_f32 v156, v156
 v_exp_f32 v157, v157
 v_exp_f32 v158, v158
 v_exp_f32 v159, v159
 v_mfma_f32_32x32x8bf16_1k v[128:143], a[158:159], v[234:235], v[160:175]
 s_waitcnt lgkmcnt(2)
 ds_read2st64_b64 a[160:163], v49 offset0:0 offset1:5
 v_exp_f32 v112, v112
 v_exp_f32 v113, v113
 v_exp_f32 v114, v114
 v_exp_f32 v115, v115
 v_mfma_f32_32x32x16_bf16 v[128:143], a[152:155], v[224:227], v[128:143]
 s_waitcnt lgkmcnt(1)
 ds_read2st64_b64 a[148:151], v73 offset0:0 offset1:1
 v_exp_f32 v116, v116
 v_exp_f32 v117, v117
 v_exp_f32 v118, v118
 v_exp_f32 v119, v119
 v_smfmac_f32_32x32x32_bf16 v[192:207], a[164:167], v[144:151], v50
 v_exp_f32 v120, v120
 v_exp_f32 v121, v121
 v_exp_f32 v122, v122
 v_exp_f32 v123, v123
 v_smfmac_f32_32x32x32_bf16 v[192:207], a[168:171], v[152:159], v50
 v_exp_f32 v124, v124
 v_exp_f32 v125, v125
 v_exp_f32 v126, v126
 v_exp_f32 v127, v127
 v_mfma_f32_32x32x8bf16_1k v[144:159], a[158:159], v[238:239], v[176:191]
 s_add_u32 s89, s91, 221184
 ds_read_b128 a[172:175], v76 offset:19392
 v_exp_f32 v128, v128
 v_exp_f32 v129, v129
 v_exp_f32 v130, v130
 v_exp_f32 v131, v131
 v_mfma_f32_32x32x16_bf16 v[144:159], a[152:155], v[228:231], v[144:159]
 buffer_load_dwordx4 a[240:243], v52, s[36:39], s89 offen offset:2048 sc1
 v_exp_f32 v132, v132
 v_exp_f32 v133, v133
 v_exp_f32 v134, v134
 v_exp_f32 v135, v135
 v_smfmac_f32_32x32x32_bf16 v[208:223], a[164:167], v[112:119], v50
 ds_read_b128 a[176:179], v76 offset:20576
 v_exp_f32 v136, v136
 v_exp_f32 v137, v137
 v_exp_f32 v138, v138
 v_exp_f32 v139, v139
 v_smfmac_f32_32x32x32_bf16 v[208:223], a[168:171], v[120:127], v50
 s_waitcnt lgkmcnt(3)
 v_exp_f32 v140, v140
 v_exp_f32 v141, v141
 v_exp_f32 v142, v142
 v_exp_f32 v143, v143
 v_mfma_f32_32x32x8bf16_1k v[112:127], a[160:161], v[232:233], v[160:175]
 s_waitcnt lgkmcnt(2)
 v_exp_f32 v144, v144
 v_exp_f32 v145, v145
 v_exp_f32 v146, v146
 v_exp_f32 v147, v147
 v_mfma_f32_32x32x16_bf16 v[112:127], a[148:151], v[224:227], v[112:127]
 s_waitcnt lgkmcnt(0)
 ds_read2st64_b64 a[152:155], v73 offset0:5 offset1:6
 v_exp_f32 v148, v148
 v_exp_f32 v149, v149
 v_exp_f32 v150, v150
 v_exp_f32 v151, v151
 v_smfmac_f32_32x32x32_bf16 v[192:207], a[172:175], v[128:135], v50
 v_exp_f32 v152, v152
 v_exp_f32 v153, v153
 v_exp_f32 v154, v154
 v_exp_f32 v155, v155
 v_smfmac_f32_32x32x32_bf16 v[192:207], a[176:179], v[136:143], v50
 v_exp_f32 v156, v156
 v_exp_f32 v157, v157
 v_exp_f32 v158, v158
 v_exp_f32 v159, v159
 v_mfma_f32_32x32x8bf16_1k v[128:143], a[160:161], v[236:237], v[176:191]
 ds_read_b128 a[164:167], v75 offset:16384
 v_exp_f32 v112, v112
 v_exp_f32 v113, v113
 v_exp_f32 v114, v114
 v_exp_f32 v115, v115
 v_mfma_f32_32x32x16_bf16 v[128:143], a[148:151], v[228:231], v[128:143]
 v_exp_f32 v116, v116
 v_exp_f32 v117, v117
 v_exp_f32 v118, v118
 v_exp_f32 v119, v119
 v_smfmac_f32_32x32x32_bf16 v[208:223], a[172:175], v[144:151], v50
 ds_read_b128 a[168:171], v75 offset:17568
 v_exp_f32 v120, v120
 v_exp_f32 v121, v121
 v_exp_f32 v122, v122
 v_exp_f32 v123, v123
 v_smfmac_f32_32x32x32_bf16 v[208:223], a[176:179], v[152:159], v50
 v_exp_f32 v124, v124
 v_exp_f32 v125, v125
 v_exp_f32 v126, v126
 v_exp_f32 v127, v127
 v_mfma_f32_32x32x8bf16_1k v[144:159], a[162:163], v[232:233], v[160:175]
 s_waitcnt lgkmcnt(2)
 v_exp_f32 v128, v128
 v_exp_f32 v129, v129
 v_exp_f32 v130, v130
 v_exp_f32 v131, v131
 v_mfma_f32_32x32x16_bf16 v[144:159], a[152:155], v[224:227], v[144:159]
 s_waitcnt lgkmcnt(0)
 ds_read2st64_b64 a[148:151], v73 offset0:10 offset1:11
 v_exp_f32 v132, v132
 v_exp_f32 v133, v133
 v_exp_f32 v134, v134
 v_exp_f32 v135, v135
 v_smfmac_f32_32x32x32_bf16 v[192:207], a[164:167], v[112:119], v50
 v_exp_f32 v136, v136
 v_exp_f32 v137, v137
 v_exp_f32 v138, v138
 v_exp_f32 v139, v139
 v_smfmac_f32_32x32x32_bf16 v[192:207], a[168:171], v[120:127], v50
 v_exp_f32 v140, v140
 v_exp_f32 v141, v141
 v_exp_f32 v142, v142
 v_exp_f32 v143, v143
 v_mfma_f32_32x32x8bf16_1k v[112:127], a[162:163], v[236:237], v[176:191]
 ds_read_b128 a[172:175], v75 offset:18752
 v_exp_f32 v144, v144
 v_exp_f32 v145, v145
 v_exp_f32 v146, v146
 v_exp_f32 v147, v147
 v_mfma_f32_32x32x16_bf16 v[112:127], a[152:155], v[228:231], v[112:127]
 v_exp_f32 v148, v148
 v_exp_f32 v149, v149
 v_exp_f32 v150, v150
 v_exp_f32 v151, v151
 v_smfmac_f32_32x32x32_bf16 v[208:223], a[164:167], v[128:135], v50
 ds_read_b128 a[176:179], v75 offset:19936
 v_exp_f32 v152, v152
 v_exp_f32 v153, v153
 v_exp_f32 v154, v154
 v_exp_f32 v155, v155
 v_smfmac_f32_32x32x32_bf16 v[208:223], a[168:171], v[136:143], v50
 v_exp_f32 v156, v156
 v_exp_f32 v157, v157
 v_exp_f32 v158, v158
 v_exp_f32 v159, v159
 v_mfma_f32_32x32x8bf16_1k v[128:143], a[160:161], v[234:235], v[160:175]
 s_waitcnt lgkmcnt(2)
 v_exp_f32 v112, v112
 v_exp_f32 v113, v113
 v_exp_f32 v114, v114
 v_exp_f32 v115, v115
 v_mfma_f32_32x32x16_bf16 v[128:143], a[148:151], v[224:227], v[128:143]
 s_waitcnt lgkmcnt(0)
 ds_read2st64_b64 a[152:155], v73 offset0:15 offset1:16
 v_exp_f32 v116, v116
 v_exp_f32 v117, v117
 v_exp_f32 v118, v118
 v_exp_f32 v119, v119
 v_smfmac_f32_32x32x32_bf16 v[192:207], a[172:175], v[144:151], v50
 v_exp_f32 v120, v120
 v_exp_f32 v121, v121
 v_exp_f32 v122, v122
 v_exp_f32 v123, v123
 v_smfmac_f32_32x32x32_bf16 v[192:207], a[176:179], v[152:159], v50
 v_exp_f32 v124, v124
 v_exp_f32 v125, v125
 v_exp_f32 v126, v126
 v_exp_f32 v127, v127
 v_mfma_f32_32x32x8bf16_1k v[144:159], a[160:161], v[238:239], v[176:191]
 ds_read_b128 a[164:167], v75 offset:21120
 v_exp_f32 v128, v128
 v_exp_f32 v129, v129
 v_exp_f32 v130, v130
 v_exp_f32 v131, v131
 v_mfma_f32_32x32x16_bf16 v[144:159], a[148:151], v[228:231], v[144:159]
 v_exp_f32 v132, v132
 v_exp_f32 v133, v133
 v_exp_f32 v134, v134
 v_exp_f32 v135, v135
 v_smfmac_f32_32x32x32_bf16 v[208:223], a[172:175], v[112:119], v50
 ds_read_b128 a[168:171], v75 offset:22304
 v_exp_f32 v136, v136
 v_exp_f32 v137, v137
 v_exp_f32 v138, v138
 v_exp_f32 v139, v139
 v_smfmac_f32_32x32x32_bf16 v[208:223], a[176:179], v[120:127], v50
 v_exp_f32 v140, v140
 v_exp_f32 v141, v141
 v_exp_f32 v142, v142
 v_exp_f32 v143, v143
 v_mfma_f32_32x32x8bf16_1k v[112:127], a[162:163], v[234:235], v[160:175]
 s_waitcnt lgkmcnt(2)
 v_exp_f32 v144, v144
 v_exp_f32 v145, v145
 v_exp_f32 v146, v146
 v_exp_f32 v147, v147
 v_mfma_f32_32x32x16_bf16 v[112:127], a[152:155], v[224:227], v[112:127]
 s_waitcnt lgkmcnt(0)
 v_exp_f32 v148, v148
 v_exp_f32 v149, v149
 v_exp_f32 v150, v150
 v_exp_f32 v151, v151
 v_smfmac_f32_32x32x32_bf16 v[192:207], a[164:167], v[128:135], v50
 v_exp_f32 v152, v152
 v_exp_f32 v153, v153
 v_exp_f32 v154, v154
 v_exp_f32 v155, v155
 v_smfmac_f32_32x32x32_bf16 v[192:207], a[168:171], v[136:143], v50
 v_exp_f32 v156, v156
 v_exp_f32 v157, v157
 v_exp_f32 v158, v158
 v_exp_f32 v159, v159
 v_mfma_f32_32x32x8bf16_1k v[128:143], a[162:163], v[238:239], v[176:191]
 ds_read_b128 a[172:175], v75 offset:23488
 v_exp_f32 v112, v112
 v_exp_f32 v113, v113
 v_exp_f32 v114, v114
 v_exp_f32 v115, v115
 v_mfma_f32_32x32x16_bf16 v[128:143], a[152:155], v[228:231], v[128:143]
 v_exp_f32 v116, v116
 v_exp_f32 v117, v117
 v_exp_f32 v118, v118
 v_exp_f32 v119, v119
 v_smfmac_f32_32x32x32_bf16 v[208:223], a[164:167], v[144:151], v50
 ds_read_b128 a[176:179], v75 offset:24672
 v_exp_f32 v120, v120
 v_exp_f32 v121, v121
 v_exp_f32 v122, v122
 v_exp_f32 v123, v123
 v_smfmac_f32_32x32x32_bf16 v[208:223], a[168:171], v[152:159], v50
 v_exp_f32 v124, v124
 v_exp_f32 v125, v125
 v_exp_f32 v126, v126
 v_exp_f32 v127, v127
 v_exp_f32 v128, v128
 v_exp_f32 v129, v129
 v_exp_f32 v130, v130
 v_exp_f32 v131, v131
 s_waitcnt lgkmcnt(0)
 v_exp_f32 v132, v132
 v_exp_f32 v133, v133
 v_exp_f32 v134, v134
 v_exp_f32 v135, v135
 v_smfmac_f32_32x32x32_bf16 v[192:207], a[172:175], v[112:119], v50
 v_exp_f32 v136, v136
 v_exp_f32 v137, v137
 v_exp_f32 v138, v138
 v_exp_f32 v139, v139
 v_smfmac_f32_32x32x32_bf16 v[192:207], a[176:179], v[120:127], v50
 v_exp_f32 v140, v140
 v_exp_f32 v141, v141
 v_exp_f32 v142, v142
 v_exp_f32 v143, v143
 s_nop 1
 v_smfmac_f32_32x32x32_bf16 v[208:223], a[172:175], v[128:135], v50
 v_smfmac_f32_32x32x32_bf16 v[208:223], a[176:179], v[136:143], v50
 s_and_b32 s48, s68, 1
 s_lshr_b32 s49, s68, 1
 s_lshl_b32 s80, s95, 1
 s_add_u32 s80, s80, s49
 s_lshl_b32 s80, s80, 7
 s_add_u32 s80, s80, s48
 s_lshl_b32 s80, s80, 2
 s_add_u32 s80, s80, 10485760
 s_mov_b32 s78, 0x71800000
 s_nop 2
 v_add_f32 v28, v202, v204
 v_pk_add_f32 v[34:35], v[192:193], v[202:203]
 v_pk_add_f32 v[34:35], v[194:195], v[34:35]
 v_pk_add_f32 v[34:35], v[196:197], v[34:35]
 v_pk_add_f32 v[34:35], v[198:199], v[34:35]
 v_pk_add_f32 v[34:35], v[200:201], v[34:35]
 v_add_f32 v30, v218, v220
 v_pk_add_f32 v[34:35], v[208:209], v[34:35]
 v_pk_add_f32 v[34:35], v[210:211], v[34:35]
 v_pk_add_f32 v[34:35], v[212:213], v[34:35]
 v_pk_add_f32 v[34:35], v[214:215], v[34:35]
 v_pk_add_f32 v[34:35], v[216:217], v[34:35]
 v_max_f32 v32, v28, v30
 v_add_f32 v33, v28, v30
 v_add_f32 v33, v33, v34
 v_add_f32 v33, v33, v35
 v_mul_f32 v33, 0, v33
 v_add_f32 v32, v32, v33
 v_cmp_nlt_f32 vcc, v32, s78
 s_cbranch_vccnz L_fallback
L_fin:
 v_rcp_f32 v28, v28
 v_rcp_f32 v30, v30
 v_add_u32 v71, 1, v71
 v_pk_mul_f32 v[192:193], v[192:193], v[28:29] op_sel_hi:[1,0]
 v_pk_mul_f32 v[194:195], v[194:195], v[28:29] op_sel_hi:[1,0]
 v_pk_mul_f32 v[196:197], v[196:197], v[28:29] op_sel_hi:[1,0]
 v_pk_mul_f32 v[198:199], v[198:199], v[28:29] op_sel_hi:[1,0]
 v_pk_mul_f32 v[200:201], v[200:201], v[28:29] op_sel_hi:[1,0]
 v_cvt_pk_bf16_f32 v40, v192, v193
 v_cvt_pk_bf16_f32 v41, v194, v195
 v_cvt_pk_bf16_f32 v42, v196, v197
 v_cvt_pk_bf16_f32 v43, v198, v199
 v_cvt_pk_bf16_f32 v29, v200, v201
 buffer_store_dwordx4 v[40:43], v62, s[36:39], s72 offen offset:0 sc1
 buffer_store_dword v29, v63, s[36:39], s80 offen offset:0 sc1
 v_pk_mul_f32 v[208:209], v[208:209], v[30:31] op_sel_hi:[1,0]
 v_pk_mul_f32 v[210:211], v[210:211], v[30:31] op_sel_hi:[1,0]
 v_pk_mul_f32 v[212:213], v[212:213], v[30:31] op_sel_hi:[1,0]
 v_pk_mul_f32 v[214:215], v[214:215], v[30:31] op_sel_hi:[1,0]
 v_pk_mul_f32 v[216:217], v[216:217], v[30:31] op_sel_hi:[1,0]
 v_cvt_pk_bf16_f32 v44, v208, v209
 v_cvt_pk_bf16_f32 v45, v210, v211
 v_cvt_pk_bf16_f32 v46, v212, v213
 v_cvt_pk_bf16_f32 v47, v214, v215
 v_cvt_pk_bf16_f32 v31, v216, v217
 buffer_store_dwordx4 v[44:47], v62, s[36:39], s72 offen offset:512 sc1
 buffer_store_dword v31, v63, s[36:39], s80 offen offset:256 sc1
 buffer_store_dword v71, v60, s[36:39], s98 offen sc1
 s_waitcnt vmcnt(5)
 v_mfma_f32_16x16x32_bf16 v[80:83], a[100:103], a[0:3], 0
 ds_read_b64_tr_b16 v[112:113], v68 offset:61568
 v_mfma_f32_16x16x32_bf16 v[84:87], a[100:103], a[4:7], 0
 ds_read_b64_tr_b16 v[114:115], v68 offset:62848
 v_mfma_f32_16x16x32_bf16 v[88:91], a[100:103], a[8:11], 0
 ds_read_b64_tr_b16 v[116:117], v69 offset:1024
 v_mfma_f32_16x16x32_bf16 v[92:95], a[100:103], a[12:15], 0
 ds_read_b64_tr_b16 v[118:119], v69 offset:2304
 v_mfma_f32_16x16x32_bf16 v[96:99], a[104:107], a[16:19], 0
 ds_read_b64_tr_b16 v[120:121], v69 offset:1056
 v_mfma_f32_16x16x32_bf16 v[80:83], a[100:103], a[20:23], v[80:83]
 ds_read_b64_tr_b16 v[122:123], v69 offset:2336
 v_mfma_f32_16x16x32_bf16 v[84:87], a[100:103], a[24:27], v[84:87]
 ds_read_b64_tr_b16 v[124:125], v69 offset:1088
 v_mfma_f32_16x16x32_bf16 v[88:91], a[100:103], a[28:31], v[88:91]
 ds_read_b64_tr_b16 v[126:127], v69 offset:2368
 v_mfma_f32_16x16x32_bf16 v[92:95], a[100:103], a[32:35], v[92:95]
 ds_read_b64_tr_b16 v[128:129], v69 offset:1120
 v_mfma_f32_16x16x32_bf16 v[80:83], a[100:103], a[36:39], v[80:83]
 ds_read_b64_tr_b16 v[130:131], v69 offset:2400
 v_mfma_f32_16x16x32_bf16 v[84:87], a[100:103], a[40:43], v[84:87]
 ds_read_b64_tr_b16 v[132:133], v69 offset:1152
 v_mfma_f32_16x16x32_bf16 v[88:91], a[100:103], a[44:47], v[88:91]
 ds_read_b64_tr_b16 v[134:135], v69 offset:2432
 v_mfma_f32_16x16x32_bf16 v[92:95], a[100:103], a[48:51], v[92:95]
 ds_read_b64_tr_b16 v[136:137], v69 offset:6144
 v_mfma_f32_16x16x32_bf16 v[96:99], a[104:107], a[52:55], v[96:99]
 ds_read_b64_tr_b16 v[138:139], v69 offset:7424
 v_mfma_f32_16x16x32_bf16 v[80:83], a[100:103], a[56:59], v[80:83]
 s_waitcnt lgkmcnt(8)
 ds_read_b64_tr_b16 v[140:141], v69 offset:6176
 v_mfma_f32_16x16x32_bf16 v[84:87], a[100:103], a[60:63], v[84:87]
 ds_read_b64_tr_b16 v[142:143], v69 offset:7456
 v_mfma_f32_16x16x32_bf16 v[88:91], a[100:103], a[64:67], v[88:91]
 ds_read_b64_tr_b16 v[144:145], v69 offset:6208
 v_mfma_f32_16x16x32_bf16 v[92:95], a[100:103], a[68:71], v[92:95]
 ds_read_b64_tr_b16 v[146:147], v69 offset:7488
 v_mfma_f32_16x16x32_bf16 v[80:83], a[100:103], a[72:75], v[80:83]
 ds_read_b64_tr_b16 v[148:149], v69 offset:6240
 v_mfma_f32_16x16x32_bf16 v[84:87], a[100:103], a[76:79], v[84:87]
 ds_read_b64_tr_b16 v[150:151], v69 offset:7520
 v_mfma_f32_16x16x32_bf16 v[88:91], a[100:103], a[80:83], v[88:91]
 s_waitcnt lgkmcnt(8)
 ds_read_b64_tr_b16 v[152:153], v69 offset:6272
 v_mfma_f32_16x16x32_bf16 v[92:95], a[100:103], a[84:87], v[92:95]
 ds_read_b64_tr_b16 v[154:155], v69 offset:7552
 v_mfma_f32_16x16x32_bf16 v[96:99], a[104:107], a[88:91], v[96:99]
 ds_read_b64_tr_b16 v[156:157], v69 offset:11264
 v_mfma_f32_16x16x32_bf16 v[80:83], a[100:103], a[92:95], v[80:83]
 ds_read_b64_tr_b16 v[158:159], v69 offset:12544
 v_mfma_f32_16x16x32_bf16 v[84:87], a[100:103], a[96:99], v[84:87]
 ds_read_b64_tr_b16 v[160:161], v69 offset:11296
 v_mfma_f32_16x16x32_bf16 v[88:91], a[100:103], a[180:183], v[88:91]
 ds_read_b64_tr_b16 v[162:163], v69 offset:12576
 v_mfma_f32_16x16x32_bf16 v[92:95], a[100:103], a[184:187], v[92:95]
 s_waitcnt lgkmcnt(8)
 ds_read_b64_tr_b16 v[164:165], v69 offset:11328
 v_mfma_f32_16x16x32_bf16 v[80:83], a[100:103], a[188:191], v[80:83]
 ds_read_b64_tr_b16 v[166:167], v69 offset:12608
 v_mfma_f32_16x16x32_bf16 v[84:87], a[100:103], a[192:195], v[84:87]
 ds_read_b64_tr_b16 v[168:169], v69 offset:11360
 v_mfma_f32_16x16x32_bf16 v[88:91], a[100:103], a[196:199], v[88:91]
 ds_read_b64_tr_b16 v[170:171], v69 offset:12640
 v_mfma_f32_16x16x32_bf16 v[92:95], a[100:103], a[200:203], v[92:95]
 ds_read_b64_tr_b16 v[172:173], v69 offset:11392
 v_mfma_f32_16x16x32_bf16 v[96:99], a[104:107], a[204:207], v[96:99]
 ds_read_b64_tr_b16 v[174:175], v69 offset:12672
 v_mfma_f32_16x16x32_bf16 v[80:83], a[100:103], a[208:211], v[80:83]
 s_waitcnt lgkmcnt(8)
 ds_read_b64_tr_b16 v[176:177], v69 offset:36864
 v_mfma_f32_16x16x32_bf16 v[84:87], a[100:103], a[212:215], v[84:87]
 ds_read_b64_tr_b16 v[178:179], v69 offset:38144
 v_mfma_f32_16x16x32_bf16 v[88:91], a[100:103], a[216:219], v[88:91]
 ds_read_b64_tr_b16 v[180:181], v69 offset:36896
 v_mfma_f32_16x16x32_bf16 v[92:95], a[100:103], a[220:223], v[92:95]
 ds_read_b64_tr_b16 v[182:183], v69 offset:38176
 v_mfma_f32_16x16x32_bf16 v[80:83], a[100:103], a[224:227], v[80:83]
 ds_read_b64_tr_b16 v[184:185], v69 offset:36928
 v_mfma_f32_16x16x32_bf16 v[84:87], a[100:103], a[228:231], v[84:87]
 ds_read_b64_tr_b16 v[186:187], v69 offset:38208
 v_mfma_f32_16x16x32_bf16 v[88:91], a[100:103], a[232:235], v[88:91]
 s_waitcnt lgkmcnt(8)
 ds_read_b64_tr_b16 v[188:189], v69 offset:36960
 v_mfma_f32_16x16x32_bf16 v[92:95], a[100:103], a[236:239], v[92:95]
 ds_read_b64_tr_b16 v[190:191], v69 offset:38240
 v_mfma_f32_16x16x32_bf16 v[96:99], a[104:107], a[240:243], v[96:99]
 ds_read_b64_tr_b16 v[192:193], v69 offset:36992
 ds_read_b64_tr_b16 v[194:195], v69 offset:38272
 ds_read_b64_tr_b16 v[196:197], v69 offset:41984
 ds_read_b64_tr_b16 v[198:199], v69 offset:43264
 s_waitcnt lgkmcnt(8)
 ds_read_b64_tr_b16 v[200:201], v69 offset:42016
 ds_read_b64_tr_b16 v[202:203], v69 offset:43296
 ds_read_b64_tr_b16 v[204:205], v69 offset:42048
 ds_read_b64_tr_b16 v[206:207], v69 offset:43328
 ds_read_b64_tr_b16 v[208:209], v69 offset:42080
 ds_read_b64_tr_b16 v[210:211], v69 offset:43360
 s_waitcnt lgkmcnt(8)
 ds_read_b64_tr_b16 v[212:213], v69 offset:42112
 ds_read_b64_tr_b16 v[214:215], v69 offset:43392
 ds_read_b64_tr_b16 a[0:1], v68 offset:0
 ds_read_b64_tr_b16 a[2:3], v68 offset:1280
 ds_read_b64_tr_b16 a[4:5], v68 offset:32
 ds_read_b64_tr_b16 a[6:7], v68 offset:1312
 s_waitcnt lgkmcnt(8)
 ds_read_b64_tr_b16 a[8:9], v68 offset:64
 ds_read_b64_tr_b16 a[10:11], v68 offset:1344
 ds_read_b64_tr_b16 a[12:13], v68 offset:96
 ds_read_b64_tr_b16 a[14:15], v68 offset:1376
 ds_read_b64_tr_b16 a[16:17], v68 offset:128
 ds_read_b64_tr_b16 a[18:19], v68 offset:1408
 s_waitcnt lgkmcnt(8)
 ds_read_b64_tr_b16 a[20:21], v68 offset:5120
 ds_read_b64_tr_b16 a[22:23], v68 offset:6400
 ds_read_b64_tr_b16 a[24:25], v68 offset:5152
 ds_read_b64_tr_b16 a[26:27], v68 offset:6432
 ds_read_b64_tr_b16 a[28:29], v68 offset:5184
 ds_read_b64_tr_b16 a[30:31], v68 offset:6464
 s_waitcnt lgkmcnt(8)
 ds_read_b64_tr_b16 a[32:33], v68 offset:5216
 ds_read_b64_tr_b16 a[34:35], v68 offset:6496
 ds_read_b64_tr_b16 a[36:37], v68 offset:5248
 ds_read_b64_tr_b16 a[38:39], v68 offset:6528
 ds_read_b64_tr_b16 a[40:41], v68 offset:10240
 ds_read_b64_tr_b16 a[42:43], v68 offset:11520
 s_waitcnt lgkmcnt(8)
 ds_read_b64_tr_b16 a[44:45], v68 offset:10272
 ds_read_b64_tr_b16 a[46:47], v68 offset:11552
 ds_read_b64_tr_b16 a[48:49], v68 offset:10304
 ds_read_b64_tr_b16 a[50:51], v68 offset:11584
 ds_read_b64_tr_b16 a[52:53], v68 offset:10336
 ds_read_b64_tr_b16 a[54:55], v68 offset:11616
 s_waitcnt lgkmcnt(8)
 ds_read_b64_tr_b16 a[56:57], v68 offset:10368
 ds_read_b64_tr_b16 a[58:59], v68 offset:11648
 ds_read_b64_tr_b16 a[60:61], v68 offset:15360
 ds_read_b64_tr_b16 a[62:63], v68 offset:16640
 ds_read_b64_tr_b16 a[64:65], v68 offset:15392
 ds_read_b64_tr_b16 a[66:67], v68 offset:16672
 s_waitcnt lgkmcnt(8)
 ds_read_b64_tr_b16 a[68:69], v68 offset:15424
 ds_read_b64_tr_b16 a[70:71], v68 offset:16704
 ds_read_b64_tr_b16 a[72:73], v68 offset:15456
 ds_read_b64_tr_b16 a[74:75], v68 offset:16736
 ds_read_b64_tr_b16 a[76:77], v68 offset:15488
 ds_read_b64_tr_b16 a[78:79], v68 offset:16768
 s_waitcnt lgkmcnt(8)
 ds_read_b64_tr_b16 a[80:81], v68 offset:20480
 ds_read_b64_tr_b16 a[82:83], v68 offset:21760
 ds_read_b64_tr_b16 a[84:85], v68 offset:20512
 ds_read_b64_tr_b16 a[86:87], v68 offset:21792
 ds_read_b64_tr_b16 a[88:89], v68 offset:20544
 ds_read_b64_tr_b16 a[90:91], v68 offset:21824
 s_waitcnt lgkmcnt(8)
 ds_read_b64_tr_b16 a[92:93], v68 offset:20576
 ds_read_b64_tr_b16 a[94:95], v68 offset:21856
 ds_read_b64_tr_b16 a[96:97], v68 offset:20608
 ds_read_b64_tr_b16 a[98:99], v68 offset:21888
 ds_read_b64_tr_b16 a[100:101], v68 offset:25600
 ds_read_b64_tr_b16 a[102:103], v68 offset:26880
 s_waitcnt lgkmcnt(8)
 ds_read_b64_tr_b16 a[104:105], v68 offset:25632
 ds_read_b64_tr_b16 a[106:107], v68 offset:26912
 ds_read_b64_tr_b16 a[108:109], v68 offset:25664
 ds_read_b64_tr_b16 a[110:111], v68 offset:26944
 ds_read_b64_tr_b16 a[112:113], v68 offset:25696
 ds_read_b64_tr_b16 a[114:115], v68 offset:26976
 s_waitcnt lgkmcnt(8)
 ds_read_b64_tr_b16 a[116:117], v68 offset:25728
 ds_read_b64_tr_b16 a[118:119], v68 offset:27008
 ds_read_b64_tr_b16 a[120:121], v68 offset:30720
 ds_read_b64_tr_b16 a[122:123], v68 offset:32000
 ds_read_b64_tr_b16 a[124:125], v68 offset:30752
 ds_read_b64_tr_b16 a[126:127], v68 offset:32032
 s_waitcnt lgkmcnt(8)
 ds_read_b64_tr_b16 a[128:129], v68 offset:30784
 ds_read_b64_tr_b16 a[130:131], v68 offset:32064
 ds_read_b64_tr_b16 a[132:133], v68 offset:30816
 ds_read_b64_tr_b16 a[134:135], v68 offset:32096
 buffer_load_dword v26, v61, s[36:39], s97 offen sc1
 ds_read_b64_tr_b16 a[136:137], v68 offset:30848
 ds_read_b64_tr_b16 a[138:139], v68 offset:32128
 s_waitcnt lgkmcnt(8)
 ds_read_b64_tr_b16 a[140:141], v68 offset:35840
 ds_read_b64_tr_b16 a[142:143], v68 offset:37120
 ds_read_b64_tr_b16 a[144:145], v68 offset:35872
 ds_read_b64_tr_b16 a[146:147], v68 offset:37152
 ds_read_b64_tr_b16 a[148:149], v68 offset:35904
 ds_read_b64_tr_b16 a[150:151], v68 offset:37184
 s_waitcnt lgkmcnt(8)
 ds_read_b64_tr_b16 a[152:153], v68 offset:35936
 ds_read_b64_tr_b16 a[154:155], v68 offset:37216
 ds_read_b64_tr_b16 a[156:157], v68 offset:35968
 ds_read_b64_tr_b16 a[158:159], v68 offset:37248
 ds_read_b64_tr_b16 a[160:161], v68 offset:40960
 ds_read_b64_tr_b16 a[162:163], v68 offset:42240
 s_waitcnt lgkmcnt(8)
 ds_read_b64_tr_b16 a[164:165], v68 offset:40992
 ds_read_b64_tr_b16 a[166:167], v68 offset:42272
 ds_read_b64_tr_b16 a[168:169], v68 offset:41024
 ds_read_b64_tr_b16 a[170:171], v68 offset:42304
 ds_read_b64_tr_b16 a[172:173], v68 offset:41056
 ds_read_b64_tr_b16 a[174:175], v68 offset:42336
 s_waitcnt lgkmcnt(8)
 ds_read_b64_tr_b16 a[176:177], v68 offset:41088
 ds_read_b64_tr_b16 a[178:179], v68 offset:42368
 ds_read_b64_tr_b16 a[180:181], v68 offset:46080
 ds_read_b64_tr_b16 a[182:183], v68 offset:47360
 ds_read_b64_tr_b16 a[184:185], v68 offset:46112
 ds_read_b64_tr_b16 a[186:187], v68 offset:47392
 s_waitcnt lgkmcnt(8)
 ds_read_b64_tr_b16 a[188:189], v68 offset:46144
 ds_read_b64_tr_b16 a[190:191], v68 offset:47424
 ds_read_b64_tr_b16 a[192:193], v68 offset:46176
 ds_read_b64_tr_b16 a[194:195], v68 offset:47456
 ds_read_b64_tr_b16 a[196:197], v68 offset:46208
 ds_read_b64_tr_b16 a[198:199], v68 offset:47488
 s_waitcnt lgkmcnt(8)
 ds_read_b64_tr_b16 a[200:201], v68 offset:51200
 ds_read_b64_tr_b16 a[202:203], v68 offset:52480
 ds_read_b64_tr_b16 a[204:205], v68 offset:51232
 ds_read_b64_tr_b16 a[206:207], v68 offset:52512
 ds_read_b64_tr_b16 a[208:209], v68 offset:51264
 ds_read_b64_tr_b16 a[210:211], v68 offset:52544
 s_waitcnt lgkmcnt(8)
 ds_read_b64_tr_b16 a[212:213], v68 offset:51296
 ds_read_b64_tr_b16 a[214:215], v68 offset:52576
 ds_read_b64_tr_b16 a[216:217], v68 offset:51328
 ds_read_b64_tr_b16 a[218:219], v68 offset:52608
 ds_read_b64_tr_b16 a[220:221], v68 offset:56320
 ds_read_b64_tr_b16 a[222:223], v68 offset:57600
 s_waitcnt lgkmcnt(8)
 ds_read_b64_tr_b16 a[224:225], v68 offset:56352
 ds_read_b64_tr_b16 a[226:227], v68 offset:57632
 ds_read_b64_tr_b16 a[228:229], v68 offset:56384
 ds_read_b64_tr_b16 a[230:231], v68 offset:57664
 ds_read_b64_tr_b16 a[232:233], v68 offset:56416
 ds_read_b64_tr_b16 a[234:235], v68 offset:57696
 s_waitcnt lgkmcnt(8)
 ds_read_b64_tr_b16 a[236:237], v68 offset:56448
 ds_read_b64_tr_b16 a[238:239], v68 offset:57728
 ds_read_b64_tr_b16 a[240:241], v68 offset:61440
 ds_read_b64_tr_b16 a[242:243], v68 offset:62720
 ds_read_b64_tr_b16 a[244:245], v68 offset:61472
 ds_read_b64_tr_b16 a[246:247], v68 offset:62752
 s_waitcnt lgkmcnt(8)
 ds_read_b64_tr_b16 a[248:249], v68 offset:61504
 ds_read_b64_tr_b16 a[250:251], v68 offset:62784
 ds_read_b64_tr_b16 a[252:253], v68 offset:61536
 ds_read_b64_tr_b16 a[254:255], v68 offset:62816
 s_mov_b32 s88, 262144
 s_lshl_b32 s48, s70, 17
 s_lshl_b32 s80, s96, 4
 s_add_u32 s48, s48, s80
 s_add_u32 s48, s48, 8388608
 s_lshl_b32 s49, s70, 14
 s_lshl_b32 s78, s96, 3
 s_add_u32 s49, s49, s78
 s_add_u32 s49, s49, 10485760
 s_add_u32 s50, s49, 8192
L_poll3:
 buffer_load_dword v27, v61, s[36:39], s97 offen sc1
 s_sub_u32 s88, s88, 1
 s_waitcnt vmcnt(1)
 v_sub_u32 v38, v26, v70
 v_cmp_ne_u32 vcc, 2, v38
 s_cmp_eq_u32 s88, 0
 s_cbranch_scc1 L_go3
 s_cbranch_vccz L_go3
 buffer_load_dword v26, v61, s[36:39], s97 offen sc1
 s_sub_u32 s88, s88, 1
 s_waitcnt vmcnt(1)
 v_sub_u32 v38, v27, v70
 v_cmp_ne_u32 vcc, 2, v38
 s_cmp_eq_u32 s88, 0
 s_cbranch_scc1 L_go3
 s_cbranch_vccnz L_poll3
L_go3:
 s_mov_b32 s88, 4096
L_again3:
 s_lshl_b32 s80, s73, 13
 s_add_u32 s79, s48, s80
 buffer_load_dwordx4 v[216:219], v64, s[36:39], s79 offen sc1
 s_add_u32 s80, s80, 8192
 s_and_b32 s80, s80, 0x1ffff
 s_add_u32 s79, s48, s80
 buffer_load_dwordx4 v[220:223], v64, s[36:39], s79 offen sc1
 s_add_u32 s80, s80, 8192
 s_and_b32 s80, s80, 0x1ffff
 s_add_u32 s79, s48, s80
 buffer_load_dwordx4 v[224:227], v64, s[36:39], s79 offen sc1
 s_add_u32 s80, s80, 8192
 s_and_b32 s80, s80, 0x1ffff
 s_add_u32 s79, s48, s80
 buffer_load_dwordx4 v[228:231], v64, s[36:39], s79 offen sc1
 s_add_u32 s80, s80, 8192
 s_and_b32 s80, s80, 0x1ffff
 s_add_u32 s79, s48, s80
 buffer_load_dwordx4 v[232:235], v64, s[36:39], s79 offen sc1
 s_add_u32 s80, s80, 8192
 s_and_b32 s80, s80, 0x1ffff
 s_add_u32 s79, s48, s80
 buffer_load_dwordx4 v[236:239], v64, s[36:39], s79 offen sc1
 s_add_u32 s80, s80, 8192
 s_and_b32 s80, s80, 0x1ffff
 s_add_u32 s79, s48, s80
 buffer_load_dwordx4 v[240:243], v64, s[36:39], s79 offen sc1
 s_waitcnt vmcnt(6)
 v_mfma_f32_16x16x32_bf16 v[104:107], a[0:3], v[216:219], v[80:83]
 s_add_u32 s80, s80, 8192
 s_and_b32 s80, s80, 0x1ffff
 s_add_u32 s79, s48, s80
 buffer_load_dwordx4 v[244:247], v64, s[36:39], s79 offen sc1
 v_mfma_f32_16x16x32_bf16 v[108:111], a[4:7], v[216:219], v[84:87]
 v_mfma_f32_16x16x32_bf16 v[16:19], a[8:11], v[216:219], v[88:91]
 v_mfma_f32_16x16x32_bf16 v[20:23], a[12:15], v[216:219], v[92:95]
 v_mfma_f32_16x16x32_bf16 v[36:39], a[16:19], v[216:219], v[96:99]
 s_waitcnt vmcnt(6)
 v_mfma_f32_16x16x32_bf16 v[104:107], a[20:23], v[220:223], v[104:107]
 s_add_u32 s80, s80, 8192
 s_and_b32 s80, s80, 0x1ffff
 s_add_u32 s79, s48, s80
 buffer_load_dwordx4 v[248:251], v64, s[36:39], s79 offen sc1
 v_mfma_f32_16x16x32_bf16 v[108:111], a[24:27], v[220:223], v[108:111]
 v_mfma_f32_16x16x32_bf16 v[16:19], a[28:31], v[220:223], v[16:19]
 v_mfma_f32_16x16x32_bf16 v[20:23], a[32:35], v[220:223], v[20:23]
 v_mfma_f32_16x16x32_bf16 v[36:39], a[36:39], v[220:223], v[36:39]
 s_waitcnt vmcnt(6)
 v_mfma_f32_16x16x32_bf16 v[104:107], a[40:43], v[224:227], v[104:107]
 s_add_u32 s80, s80, 8192
 s_and_b32 s80, s80, 0x1ffff
 s_add_u32 s79, s48, s80
 buffer_load_dwordx4 v[252:255], v64, s[36:39], s79 offen sc1
 v_mfma_f32_16x16x32_bf16 v[108:111], a[44:47], v[224:227], v[108:111]
 v_mfma_f32_16x16x32_bf16 v[16:19], a[48:51], v[224:227], v[16:19]
 v_mfma_f32_16x16x32_bf16 v[20:23], a[52:55], v[224:227], v[20:23]
 v_mfma_f32_16x16x32_bf16 v[36:39], a[56:59], v[224:227], v[36:39]
 s_waitcnt vmcnt(6)
 v_mfma_f32_16x16x32_bf16 v[104:107], a[60:63], v[228:231], v[104:107]
 s_add_u32 s80, s80, 8192
 s_and_b32 s80, s80, 0x1ffff
 s_add_u32 s79, s48, s80
 buffer_load_dwordx4 v[4:7], v64, s[36:39], s79 offen sc1
 v_mfma_f32_16x16x32_bf16 v[108:111], a[64:67], v[228:231], v[108:111]
 v_mfma_f32_16x16x32_bf16 v[16:19], a[68:71], v[228:231], v[16:19]
 v_mfma_f32_16x16x32_bf16 v[20:23], a[72:75], v[228:231], v[20:23]
 v_mfma_f32_16x16x32_bf16 v[36:39], a[76:79], v[228:231], v[36:39]
 s_waitcnt vmcnt(6)
 v_mfma_f32_16x16x32_bf16 v[104:107], a[80:83], v[232:235], v[104:107]
 s_add_u32 s80, s80, 8192
 s_and_b32 s80, s80, 0x1ffff
 s_add_u32 s79, s48, s80
 buffer_load_dwordx4 v[8:11], v64, s[36:39], s79 offen sc1
 v_mfma_f32_16x16x32_bf16 v[108:111], a[84:87], v[232:235], v[108:111]
 v_mfma_f32_16x16x32_bf16 v[16:19], a[88:91], v[232:235], v[16:19]
 v_mfma_f32_16x16x32_bf16 v[20:23], a[92:95], v[232:235], v[20:23]
 v_mfma_f32_16x16x32_bf16 v[36:39], a[96:99], v[232:235], v[36:39]
 s_waitcnt vmcnt(6)
 v_mfma_f32_16x16x32_bf16 v[104:107], a[100:103], v[236:239], v[104:107]
 s_add_u32 s80, s80, 8192
 s_and_b32 s80, s80, 0x1ffff
 s_add_u32 s79, s48, s80
 buffer_load_dwordx4 v[12:15], v64, s[36:39], s79 offen sc1
 v_mfma_f32_16x16x32_bf16 v[108:111], a[104:107], v[236:239], v[108:111]
 v_mfma_f32_16x16x32_bf16 v[16:19], a[108:111], v[236:239], v[16:19]
 v_mfma_f32_16x16x32_bf16 v[20:23], a[112:115], v[236:239], v[20:23]
 v_mfma_f32_16x16x32_bf16 v[36:39], a[116:119], v[236:239], v[36:39]
 s_waitcnt vmcnt(6)
 v_mfma_f32_16x16x32_bf16 v[104:107], a[120:123], v[240:243], v[104:107]
 s_add_u32 s80, s80, 8192
 s_and_b32 s80, s80, 0x1ffff
 s_add_u32 s79, s48, s80
 buffer_load_dwordx4 v[28:31], v64, s[36:39], s79 offen sc1
 v_mfma_f32_16x16x32_bf16 v[108:111], a[124:127], v[240:243], v[108:111]
 v_mfma_f32_16x16x32_bf16 v[16:19], a[128:131], v[240:243], v[16:19]
 v_mfma_f32_16x16x32_bf16 v[20:23], a[132:135], v[240:243], v[20:23]
 v_mfma_f32_16x16x32_bf16 v[36:39], a[136:139], v[240:243], v[36:39]
 s_waitcnt vmcnt(6)
 v_mfma_f32_16x16x32_bf16 v[104:107], a[140:143], v[244:247], v[104:107]
 s_add_u32 s80, s80, 8192
 s_and_b32 s80, s80, 0x1ffff
 s_add_u32 s79, s48, s80
 buffer_load_dwordx4 v[32:35], v64, s[36:39], s79 offen sc1
 v_mfma_f32_16x16x32_bf16 v[108:111], a[144:147], v[244:247], v[108:111]
 v_mfma_f32_16x16x32_bf16 v[16:19], a[148:151], v[244:247], v[16:19]
 v_mfma_f32_16x16x32_bf16 v[20:23], a[152:155], v[244:247], v[20:23]
 v_mfma_f32_16x16x32_bf16 v[36:39], a[156:159], v[244:247], v[36:39]
 s_waitcnt vmcnt(6)
 v_mfma_f32_16x16x32_bf16 v[104:107], a[160:163], v[248:251], v[104:107]
 s_add_u32 s80, s80, 8192
 s_and_b32 s80, s80, 0x1ffff
 s_add_u32 s79, s48, s80
 buffer_load_dwordx4 v[40:43], v64, s[36:39], s79 offen sc1
 v_mfma_f32_16x16x32_bf16 v[108:111], a[164:167], v[248:251], v[108:111]
 v_mfma_f32_16x16x32_bf16 v[16:19], a[168:171], v[248:251], v[16:19]
 v_mfma_f32_16x16x32_bf16 v[20:23], a[172:175], v[248:251], v[20:23]
 v_mfma_f32_16x16x32_bf16 v[36:39], a[176:179], v[248:251], v[36:39]
 s_waitcnt vmcnt(6)
 v_mfma_f32_16x16x32_bf16 v[104:107], a[180:183], v[252:255], v[104:107]
 buffer_load_dwordx2 v[44:45], v65, s[36:39], s49 offen offset:0 sc1
 buffer_load_dwordx2 v[46:47], v65, s[36:39], s49 offen offset:1024 sc1
 v_mfma_f32_16x16x32_bf16 v[108:111], a[184:187], v[252:255], v[108:111]
 v_mfma_f32_16x16x32_bf16 v[16:19], a[188:191], v[252:255], v[16:19]
 v_mfma_f32_16x16x32_bf16 v[20:23], a[192:195], v[252:255], v[20:23]
 v_mfma_f32_16x16x32_bf16 v[36:39], a[196:199], v[252:255], v[36:39]
 s_waitcnt vmcnt(7)
 v_mfma_f32_16x16x32_bf16 v[104:107], a[200:203], v[4:7], v[104:107]
 buffer_load_dwordx2 v[100:101], v65, s[36:39], s50 offen offset:0 sc1
 buffer_load_dwordx2 v[102:103], v65, s[36:39], s50 offen offset:1024 sc1
 v_mfma_f32_16x16x32_bf16 v[108:111], a[204:207], v[4:7], v[108:111]
 v_mfma_f32_16x16x32_bf16 v[16:19], a[208:211], v[4:7], v[16:19]
 v_mfma_f32_16x16x32_bf16 v[20:23], a[212:215], v[4:7], v[20:23]
 v_mfma_f32_16x16x32_bf16 v[36:39], a[216:219], v[4:7], v[36:39]
 s_waitcnt vmcnt(8) lgkmcnt(8)
 v_mfma_f32_16x16x32_bf16 v[104:107], a[220:223], v[8:11], v[104:107]
 v_mfma_f32_16x16x32_bf16 v[108:111], a[224:227], v[8:11], v[108:111]
 v_mfma_f32_16x16x32_bf16 v[16:19], a[228:231], v[8:11], v[16:19]
 v_mfma_f32_16x16x32_bf16 v[20:23], a[232:235], v[8:11], v[20:23]
 v_mfma_f32_16x16x32_bf16 v[36:39], a[236:239], v[8:11], v[36:39]
 s_waitcnt vmcnt(7) lgkmcnt(0)
 v_mfma_f32_16x16x32_bf16 v[104:107], a[240:243], v[12:15], v[104:107]
 v_mfma_f32_16x16x32_bf16 v[108:111], a[244:247], v[12:15], v[108:111]
 v_mfma_f32_16x16x32_bf16 v[16:19], a[248:251], v[12:15], v[16:19]
 v_mfma_f32_16x16x32_bf16 v[20:23], a[252:255], v[12:15], v[20:23]
 v_mfma_f32_16x16x32_bf16 v[36:39], v[112:115], v[12:15], v[36:39]
 s_waitcnt vmcnt(6)
 v_mfma_f32_16x16x32_bf16 v[104:107], v[116:119], v[28:31], v[104:107]
 v_mfma_f32_16x16x32_bf16 v[108:111], v[120:123], v[28:31], v[108:111]
 v_mfma_f32_16x16x32_bf16 v[16:19], v[124:127], v[28:31], v[16:19]
 v_mfma_f32_16x16x32_bf16 v[20:23], v[128:131], v[28:31], v[20:23]
 v_mfma_f32_16x16x32_bf16 v[36:39], v[132:135], v[28:31], v[36:39]
 s_waitcnt vmcnt(5)
 v_mfma_f32_16x16x32_bf16 v[104:107], v[136:139], v[32:35], v[104:107]
 v_mfma_f32_16x16x32_bf16 v[108:111], v[140:143], v[32:35], v[108:111]
 v_mfma_f32_16x16x32_bf16 v[16:19], v[144:147], v[32:35], v[16:19]
 v_mfma_f32_16x16x32_bf16 v[20:23], v[148:151], v[32:35], v[20:23]
 v_mfma_f32_16x16x32_bf16 v[36:39], v[152:155], v[32:35], v[36:39]
 s_waitcnt vmcnt(4)
 v_mfma_f32_16x16x32_bf16 v[104:107], v[156:159], v[40:43], v[104:107]
 v_mfma_f32_16x16x32_bf16 v[108:111], v[160:163], v[40:43], v[108:111]
 v_mfma_f32_16x16x32_bf16 v[16:19], v[164:167], v[40:43], v[16:19]
 v_mfma_f32_16x16x32_bf16 v[20:23], v[168:171], v[40:43], v[20:23]
 v_mfma_f32_16x16x32_bf16 v[36:39], v[172:175], v[40:43], v[36:39]
 s_waitcnt vmcnt(2)
 v_mfma_f32_16x16x32_bf16 v[104:107], v[176:179], v[44:47], v[104:107]
 v_mfma_f32_16x16x32_bf16 v[108:111], v[180:183], v[44:47], v[108:111]
 v_mfma_f32_16x16x32_bf16 v[16:19], v[184:187], v[44:47], v[16:19]
 v_mfma_f32_16x16x32_bf16 v[20:23], v[188:191], v[44:47], v[20:23]
 v_mfma_f32_16x16x32_bf16 v[36:39], v[192:195], v[44:47], v[36:39]
 s_waitcnt vmcnt(0)
 v_mfma_f32_16x16x32_bf16 v[104:107], v[196:199], v[100:103], v[104:107]
 v_mfma_f32_16x16x32_bf16 v[108:111], v[200:203], v[100:103], v[108:111]
 v_mfma_f32_16x16x32_bf16 v[16:19], v[204:207], v[100:103], v[16:19]
 v_mfma_f32_16x16x32_bf16 v[20:23], v[208:211], v[100:103], v[20:23]
 v_mfma_f32_16x16x32_bf16 v[36:39], v[212:215], v[100:103], v[36:39]
 s_sub_u32 s88, s88, 1
 s_cmp_eq_u32 s88, 0
 s_nop 1
 v_cmp_u_f32 vcc, v104, v104
 s_cbranch_scc1 L_done3
 s_cbranch_vccnz L_again3
L_done3:
 v_cvt_pk_bf16_f32 v4, v104, v105
 v_cvt_pk_bf16_f32 v5, v106, v107
 v_cvt_pk_bf16_f32 v6, v108, v109
 v_cvt_pk_bf16_f32 v7, v110, v111
 s_nop 1
 v_permlane16_swap_b32 v4, v6
 v_permlane16_swap_b32 v5, v7
 buffer_store_dwordx4 v[4:7], v66, s[28:31], s92 offen offset:0
 v_cvt_pk_bf16_f32 v8, v16, v17
 v_cvt_pk_bf16_f32 v9, v18, v19
 v_cvt_pk_bf16_f32 v10, v20, v21
 v_cvt_pk_bf16_f32 v11, v22, v23
 s_nop 1
 v_permlane16_swap_b32 v8, v10
 v_permlane16_swap_b32 v9, v11
 buffer_store_dwordx4 v[8:11], v66, s[28:31], s92 offen offset:64
 v_cvt_pk_bf16_f32 v12, v36, v37
 v_cvt_pk_bf16_f32 v13, v38, v39
 buffer_store_dwordx2 v[12:13], v67, s[28:31], s92 offen
L_exit:
 s_endpgm
.p2align 7
L_tab:
.long 0x0,0x20,0x10000,0x10020,0x8,0x28,0x10008,0x10028,0x10,0x30,0x10010,0x10030,0x18,0x38,0x10018,0x10038
.long 0x40,0x60,0x10040,0x10060,0x48,0x68,0x10048,0x10068,0x50,0x70,0x10050,0x10070,0x58,0x78,0x10058,0x10078
.long 0x80,0xa0,0x10080,0x100a0,0x88,0xa8,0x10088,0x100a8,0x90,0xb0,0x10090,0x100b0,0x98,0xb8,0x10098,0x100b8
.long 0xc0,0xe0,0x100c0,0x100e0,0xc8,0xe8,0x100c8,0x100e8,0xd0,0xf0,0x100d0,0x100f0,0xd8,0xf8,0x100d8,0x100f8
.long 0x220,0x200,0x10220,0x10200,0x228,0x208,0x10228,0x10208,0x230,0x210,0x10230,0x10210,0x238,0x218,0x10238,0x10218
.long 0x260,0x240,0x10260,0x10240,0x268,0x248,0x10268,0x10248,0x270,0x250,0x10270,0x10250,0x278,0x258,0x10278,0x10258
.long 0x2a0,0x280,0x102a0,0x10280,0x2a8,0x288,0x102a8,0x10288,0x2b0,0x290,0x102b0,0x10290,0x2b8,0x298,0x102b8,0x10298
.long 0x2e0,0x2c0,0x102e0,0x102c0,0x2e8,0x2c8,0x102e8,0x102c8,0x2f0,0x2d0,0x102f0,0x102d0,0x2f8,0x2d8,0x102f8,0x102d8
.long 0x400,0x420,0x10400,0x10420,0x408,0x428,0x10408,0x10428,0x410,0x430,0x10410,0x10430,0x418,0x438,0x10418,0x10438
.long 0x440,0x460,0x10440,0x10460,0x448,0x468,0x10448,0x10468,0x450,0x470,0x10450,0x10470,0x458,0x478,0x10458,0x10478
.long 0x480,0x4a0,0x10480,0x104a0,0x488,0x4a8,0x10488,0x104a8,0x490,0x4b0,0x10490,0x104b0,0x498,0x4b8,0x10498,0x104b8
.long 0x4c0,0x4e0,0x104c0,0x104e0,0x4c8,0x4e8,0x104c8,0x104e8,0x4d0,0x4f0,0x104d0,0x104f0,0x4d8,0x4f8,0x104d8,0x104f8
.long 0x620,0x600,0x10620,0x10600,0x628,0x608,0x10628,0x10608,0x630,0x610,0x10630,0x10610,0x638,0x618,0x10638,0x10618
.long 0x660,0x640,0x10660,0x10640,0x668,0x648,0x10668,0x10648,0x670,0x650,0x10670,0x10650,0x678,0x658,0x10678,0x10658
.long 0x6a0,0x680,0x106a0,0x10680,0x6a8,0x688,0x106a8,0x10688,0x6b0,0x690,0x106b0,0x10690,0x6b8,0x698,0x106b8,0x10698
.long 0x6e0,0x6c0,0x106e0,0x106c0,0x6e8,0x6c8,0x106e8,0x106c8,0x6f0,0x6d0,0x106f0,0x106d0,0x6f8,0x6d8,0x106f8,0x106d8
.long 0x3f80,0x0,0x0,0x0,0x3f800000,0x0,0x0,0x0,0x0,0x3f80,0x0,0x0,0x0,0x3f800000,0x0,0x0
.long 0x0,0x0,0x3f80,0x0,0x0,0x0,0x3f800000,0x0,0x0,0x0,0x0,0x3f80,0x0,0x0,0x0,0x3f800000
.long 0x0,0x0,0x0,0x0,0x0,0x0,0x0,0x0,0x0,0x0,0x0,0x0,0x0,0x0,0x0,0x0
.long 0x0,0x0,0x0,0x0,0x0,0x0,0x0,0x0,0x0,0x0,0x0,0x0,0x0,0x0,0x0,0x0
.long 0x0,0x0,0x0,0x0,0x0,0x0,0x0,0x0,0x0,0x0,0x0,0x0,0x0,0x0,0x0,0x0
.long 0x0,0x0,0x0,0x0,0x0,0x0,0x0,0x0,0x0,0x0,0x0,0x0,0x0,0x0,0x0,0x0
.long 0x3f80,0x0,0x0,0x0,0x3f800000,0x0,0x0,0x0,0x0,0x3f80,0x0,0x0,0x0,0x3f800000,0x0,0x0
.long 0x0,0x0,0x3f80,0x0,0x0,0x0,0x3f800000,0x0,0x0,0x0,0x0,0x3f80,0x0,0x0,0x0,0x3f800000
.long 0x3f80,0x0,0x0,0x0,0x3f800000,0x0,0x0,0x0,0x0,0x3f80,0x0,0x0,0x0,0x3f800000,0x0,0x0
.long 0x0,0x0,0x3f80,0x0,0x0,0x0,0x3f800000,0x0,0x0,0x0,0x0,0x3f80,0x0,0x0,0x0,0x3f800000
.long 0x0,0x0,0x0,0x0,0x0,0x0,0x0,0x0,0x0,0x0,0x0,0x0,0x0,0x0,0x0,0x0
.long 0x0,0x0,0x0,0x0,0x0,0x0,0x0,0x0,0x0,0x0,0x0,0x0,0x0,0x0,0x0,0x0
.long 0x0,0x0,0x0,0x0,0x0,0x0,0x0,0x0,0x0,0x0,0x0,0x0,0x0,0x0,0x0,0x0
.long 0x0,0x0,0x0,0x0,0x0,0x0,0x0,0x0,0x0,0x0,0x0,0x0,0x0,0x0,0x0,0x0
.long 0x3f80,0x0,0x0,0x0,0x3f800000,0x0,0x0,0x0,0x0,0x3f80,0x0,0x0,0x0,0x3f800000,0x0,0x0
.long 0x0,0x0,0x3f80,0x0,0x0,0x0,0x3f800000,0x0,0x0,0x0,0x0,0x3f80,0x0,0x0,0x0,0x3f800000
.long 0x3f80,0x0,0x0,0x0,0x3f800000,0x0,0x0,0x0,0x0,0x3f80,0x0,0x0,0x0,0x3f800000,0x0,0x0
.long 0x0,0x0,0x3f80,0x0,0x0,0x0,0x3f800000,0x0,0x0,0x0,0x0,0x3f80,0x0,0x0,0x0,0x3f800000
.long 0x0,0x0,0x0,0x0,0x0,0x0,0x0,0x0,0x0,0x0,0x0,0x0,0x0,0x0,0x0,0x0
.long 0x0,0x0,0x0,0x0,0x0,0x0,0x0,0x0,0x0,0x0,0x0,0x0,0x0,0x0,0x0,0x0
.long 0x3f80,0x0,0x0,0x0,0x3f800000,0x0,0x0,0x0,0x0,0x3f80,0x0,0x0,0x0,0x3f800000,0x0,0x0
.long 0x0,0x0,0x3f80,0x0,0x0,0x0,0x3f800000,0x0,0x0,0x0,0x0,0x3f80,0x0,0x0,0x0,0x3f800000
.long 0x0,0x0,0x0,0x0,0x0,0x0,0x0,0x0,0x0,0x0,0x0,0x0,0x0,0x0,0x0,0x0
.long 0x0,0x0,0x0,0x0,0x0,0x0,0x0,0x0,0x0,0x0,0x0,0x0,0x0,0x0,0x0,0x0
.long 0x3f80,0x0,0x0,0x0,0x3f800000,0x0,0x0,0x0,0x0,0x3f80,0x0,0x0,0x0,0x3f800000,0x0,0x0
.long 0x0,0x0,0x3f80,0x0,0x0,0x0,0x3f800000,0x0,0x0,0x0,0x0,0x3f80,0x0,0x0,0x0,0x3f800000
.long 0x0,0x0,0x0,0x0,0x0,0x0,0x0,0x0,0x0,0x0,0x0,0x0,0x0,0x0,0x0,0x0
.long 0x0,0x0,0x0,0x0,0x0,0x0,0x0,0x0,0x0,0x0,0x0,0x0,0x0,0x0,0x0,0x0
.long 0x3f80,0x0,0x0,0x0,0x3f800000,0x0,0x0,0x0,0x0,0x3f80,0x0,0x0,0x0,0x3f800000,0x0,0x0
.long 0x0,0x0,0x3f80,0x0,0x0,0x0,0x3f800000,0x0,0x0,0x0,0x0,0x3f80,0x0,0x0,0x0,0x3f800000
.long 0x0,0x0,0x0,0x0,0x0,0x0,0x0,0x0,0x0,0x0,0x0,0x0,0x0,0x0,0x0,0x0
.long 0x0,0x0,0x0,0x0,0x0,0x0,0x0,0x0,0x0,0x0,0x0,0x0,0x0,0x0,0x0,0x0
.long 0x400,0x14400,0xdddddddd,0x0,0x408,0x14408,0xdddddddd,0x10,0x410,0x14410,0xdddddddd,0x20,0x418,0x14418,0xdddddddd,0x30
.long 0x420,0x14420,0xdddddddd,0x40,0x428,0x14428,0xdddddddd,0x50,0x430,0x14430,0xdddddddd,0x60,0x438,0x14438,0xdddddddd,0x70
.long 0x440,0x14440,0xdddddddd,0x80,0x448,0x14448,0xdddddddd,0x90,0x450,0x14450,0xdddddddd,0xa0,0x458,0x14458,0xdddddddd,0xb0
.long 0x460,0x14460,0xdddddddd,0xc0,0x468,0x14468,0xdddddddd,0xd0,0x470,0x14470,0xdddddddd,0xe0,0x478,0x14478,0xdddddddd,0xf0
.long 0x480,0x14480,0xdddddddd,0x100,0x488,0x14488,0xdddddddd,0x110,0x490,0x14490,0xdddddddd,0x120,0x498,0x14498,0xdddddddd,0x130
.long 0x4a0,0x144a0,0xdddddddd,0x140,0x4a8,0x144a8,0xdddddddd,0x150,0x4b0,0x144b0,0xdddddddd,0x160,0x4b8,0x144b8,0xdddddddd,0x170
.long 0x4c0,0x144c0,0xdddddddd,0x180,0x4c8,0x144c8,0xdddddddd,0x190,0x4d0,0x144d0,0xdddddddd,0x1a0,0x4d8,0x144d8,0xdddddddd,0x1b0
.long 0x4e0,0x144e0,0xdddddddd,0x1c0,0x4e8,0x144e8,0xdddddddd,0x1d0,0x4f0,0x144f0,0xdddddddd,0x1e0,0x4f8,0x144f8,0xdddddddd,0x1f0
.long 0x1800,0x15800,0xdddddddd,0x4800,0x1808,0x15808,0xdddddddd,0x4810,0x1810,0x15810,0xdddddddd,0x4820,0x1818,0x15818,0xdddddddd,0x4830
.long 0x1820,0x15820,0xdddddddd,0x4840,0x1828,0x15828,0xdddddddd,0x4850,0x1830,0x15830,0xdddddddd,0x4860,0x1838,0x15838,0xdddddddd,0x4870
.long 0x1840,0x15840,0xdddddddd,0x4880,0x1848,0x15848,0xdddddddd,0x4890,0x1850,0x15850,0xdddddddd,0x48a0,0x1858,0x15858,0xdddddddd,0x48b0
.long 0x1860,0x15860,0xdddddddd,0x48c0,0x1868,0x15868,0xdddddddd,0x48d0,0x1870,0x15870,0xdddddddd,0x48e0,0x1878,0x15878,0xdddddddd,0x48f0
.long 0x1880,0x15880,0xdddddddd,0x4900,0x1888,0x15888,0xdddddddd,0x4910,0x1890,0x15890,0xdddddddd,0x4920,0x1898,0x15898,0xdddddddd,0x4930
.long 0x18a0,0x158a0,0xdddddddd,0x4940,0x18a8,0x158a8,0xdddddddd,0x4950,0x18b0,0x158b0,0xdddddddd,0x4960,0x18b8,0x158b8,0xdddddddd,0x4970
.long 0x18c0,0x158c0,0xdddddddd,0x4980,0x18c8,0x158c8,0xdddddddd,0x4990,0x18d0,0x158d0,0xdddddddd,0x49a0,0x18d8,0x158d8,0xdddddddd,0x49b0
.long 0x18e0,0x158e0,0xdddddddd,0x49c0,0x18e8,0x158e8,0xdddddddd,0x49d0,0x18f0,0x158f0,0xdddddddd,0x49e0,0x18f8,0x158f8,0xdddddddd,0x49f0
.long 0x0,0x0,0x0,0x0,0x10,0x480,0x480,0x10,0x20,0x900,0x900,0x20,0x30,0xd80,0xd80,0x30
.long 0x40,0x1200,0x1200,0x40,0x50,0x1680,0x1680,0x50,0x60,0x1b00,0x1b00,0x60,0x70,0x1f80,0x1f80,0x70
.long 0x80,0x2400,0x2400,0x80,0x90,0x2880,0x2880,0x90,0xa0,0x2d00,0x2d00,0x480,0xb0,0x3180,0x3180,0x490
.long 0xc0,0x3600,0x3600,0x4a0,0xd0,0x3a80,0x3a80,0x4b0,0xe0,0x3f00,0x3f00,0x4c0,0xf0,0x4380,0x4380,0x4d0
.long 0x4800,0x10,0x80000000,0x4e0,0x4810,0x490,0x80000000,0x4f0,0x4820,0x910,0x80000000,0x500,0x4830,0xd90,0x80000000,0x510
.long 0x4840,0x1210,0x80000000,0x900,0x4850,0x1690,0x80000000,0x910,0x4860,0x1b10,0x80000000,0x920,0x4870,0x1f90,0x80000000,0x930
.long 0x4880,0x2410,0x80000000,0x940,0x4890,0x2890,0x80000000,0x950,0x48a0,0x2d10,0x80000000,0x960,0x48b0,0x3190,0x80000000,0x970
.long 0x48c0,0x3610,0x80000000,0x980,0x48d0,0x3a90,0x80000000,0x990,0x48e0,0x3f10,0x80000000,0xd80,0x48f0,0x4390,0x80000000,0xd90
.long 0x9000,0x80000000,0x80000000,0xda0,0x9010,0x80000000,0x80000000,0xdb0,0x9020,0x80000000,0x80000000,0xdc0,0x9030,0x80000000,0x80000000,0xdd0
.long 0x9040,0x80000000,0x80000000,0xde0,0x9050,0x80000000,0x80000000,0xdf0,0x9060,0x80000000,0x80000000,0xe00,0x9070,0x80000000,0x80000000,0xe10
.long 0x9080,0x80000000,0x80000000,0x2400,0x9090,0x80000000,0x80000000,0x2410,0x90a0,0x80000000,0x80000000,0x2420,0x90b0,0x80000000,0x80000000,0x2430
.long 0x90c0,0x80000000,0x80000000,0x2440,0x90d0,0x80000000,0x80000000,0x2450,0x90e0,0x80000000,0x80000000,0x2460,0x90f0,0x80000000,0x80000000,0x2470
.long 0xd800,0x80000000,0x80000000,0x2480,0xd810,0x80000000,0x80000000,0x2490,0xd820,0x80000000,0x80000000,0x2880,0xd830,0x80000000,0x80000000,0x2890
.long 0xd840,0x80000000,0x80000000,0x28a0,0xd850,0x80000000,0x80000000,0x28b0,0xd860,0x80000000,0x80000000,0x28c0,0xd870,0x80000000,0x80000000,0x28d0
.long 0xd880,0x80000000,0x80000000,0x28e0,0xd890,0x80000000,0x80000000,0x28f0,0xd8a0,0x80000000,0x80000000,0x2900,0xd8b0,0x80000000,0x80000000,0x2910
.long 0xd8c0,0x80000000,0x80000000,0x2d00,0xd8d0,0x80000000,0x80000000,0x2d10,0xd8e0,0x80000000,0x80000000,0x2d20,0xd8f0,0x80000000,0x80000000,0x2d30
.long 0x2d40,0x3680,0x5ea0,0x67e0,0x2d50,0x3690,0x5eb0,0x67f0,0x2d60,0x3a80,0x5ec0,0x6800,0x2d70,0x3a90,0x5ed0,0x6810
.long 0x2d80,0x3aa0,0x5ee0,0x6c00,0x2d90,0x3ab0,0x5ef0,0x6c10,0x3180,0x3ac0,0x5f00,0x6c20,0x3190,0x3ad0,0x5f10,0x6c30
.long 0x31a0,0x3ae0,0x7500,0x6c40,0x31b0,0x3af0,0x7510,0x6c50,0x31c0,0x3b00,0x7520,0x6c60,0x31d0,0x3b10,0x7530,0x6c70
.long 0x31e0,0x3f00,0x7540,0x6c80,0x31f0,0x3f10,0x7550,0x6c90,0x3200,0x3f20,0x7560,0x7080,0x3210,0x3f30,0x7570,0x7090
.long 0x1200,0x3f40,0x7580,0x70a0,0x1210,0x3f50,0x7590,0x70b0,0x1220,0x3f60,0x7980,0x70c0,0x1230,0x3f70,0x7990,0x70d0
.long 0x1240,0x3f80,0x79a0,0x70e0,0x1250,0x3f90,0x79b0,0x70f0,0x1260,0x4380,0x79c0,0x7100,0x1270,0x4390,0x79d0,0x7110
.long 0x1280,0x43a0,0x79e0,0x8700,0x1290,0x43b0,0x79f0,0x8710,0x1680,0x43c0,0x7a00,0x8720,0x1690,0x43d0,0x7a10,0x8730
.long 0x16a0,0x43e0,0x7e00,0x8740,0x16b0,0x43f0,0x7e10,0x8750,0x16c0,0x4400,0x7e20,0x8760,0x16d0,0x4410,0x7e30,0x8770
.long 0x16e0,0x5100,0x7e40,0x8780,0x16f0,0x5110,0x7e50,0x8790,0x1700,0x5120,0x7e60,0x8b80,0x1710,0x5130,0x7e70,0x8b90
.long 0x1b00,0x5140,0x7e80,0x8ba0,0x1b10,0x5150,0x7e90,0x8bb0,0x1b20,0x5160,0x8280,0x8bc0,0x1b30,0x5170,0x8290,0x8bd0
.long 0x1b40,0x5180,0x82a0,0x8be0,0x1b50,0x5190,0x82b0,0x8bf0,0x1b60,0x5580,0x82c0,0x8c00,0x1b70,0x5590,0x82d0,0x8c10
.long 0x1b80,0x55a0,0x82e0,0x9000,0x1b90,0x55b0,0x82f0,0x9010,0x1f80,0x55c0,0x8300,0x9020,0x1f90,0x55d0,0x8310,0x9030
.long 0x1fa0,0x55e0,0x6300,0x9040,0x1fb0,0x55f0,0x6310,0x9050,0x1fc0,0x5600,0x6320,0x9060,0x1fd0,0x5610,0x6330,0x9070
.long 0x1fe0,0x5a00,0x6340,0x9080,0x1ff0,0x5a10,0x6350,0x9090,0x2000,0x5a20,0x6360,0x9480,0x2010,0x5a30,0x6370,0x9490
.long 0x3600,0x5a40,0x6380,0x94a0,0x3610,0x5a50,0x6390,0x94b0,0x3620,0x5a60,0x6780,0x94c0,0x3630,0x5a70,0x6790,0x94d0
.long 0x3640,0x5a80,0x67a0,0x94e0,0x3650,0x5a90,0x67b0,0x94f0,0x3660,0x5e80,0x67c0,0x9500,0x3670,0x5e90,0x67d0,0x9510
.long 0x0,0x0,0x0,0x0,0x80000000,0x4,0x100,0x80,0x80000000,0x80,0x10,0x8,0x80000000,0x84,0x110,0x88
.long 0x80000000,0x100,0x20,0x10,0x80000000,0x104,0x120,0x90,0x80000000,0x180,0x30,0x18,0x80000000,0x184,0x130,0x98
.long 0x80000000,0x200,0x40,0x20,0x80000000,0x204,0x140,0xa0,0x80000000,0x280,0x50,0x28,0x80000000,0x284,0x150,0xa8
.long 0x80000000,0x300,0x60,0x30,0x80000000,0x304,0x160,0xb0,0x80000000,0x380,0x70,0x38,0x80000000,0x384,0x170,0xb8
.long 0x80000000,0x400,0x80,0x40,0x80000000,0x404,0x180,0xc0,0x80000000,0x480,0x90,0x48,0x80000000,0x484,0x190,0xc8
.long 0x80000000,0x500,0xa0,0x50,0x80000000,0x504,0x1a0,0xd0,0x80000000,0x580,0xb0,0x58,0x80000000,0x584,0x1b0,0xd8
.long 0x80000000,0x600,0xc0,0x60,0x80000000,0x604,0x1c0,0xe0,0x80000000,0x680,0xd0,0x68,0x80000000,0x684,0x1d0,0xe8
.long 0x80000000,0x700,0xe0,0x70,0x80000000,0x704,0x1e0,0xf0,0x80000000,0x780,0xf0,0x78,0x80000000,0x784,0x1f0,0xf8
.long 0x80000000,0x0,0x800,0x80000000,0x80000000,0x4,0x900,0x80000000,0x80000000,0x80,0x810,0x80000000,0x80000000,0x84,0x910,0x80000000
.long 0x80000000,0x100,0x820,0x80000000,0x80000000,0x104,0x920,0x80000000,0x80000000,0x180,0x830,0x80000000,0x80000000,0x184,0x930,0x80000000
.long 0x80000000,0x200,0x840,0x80000000,0x80000000,0x204,0x940,0x80000000,0x80000000,0x280,0x850,0x80000000,0x80000000,0x284,0x950,0x80000000
.long 0x80000000,0x300,0x860,0x80000000,0x80000000,0x304,0x960,0x80000000,0x80000000,0x380,0x870,0x80000000,0x80000000,0x384,0x970,0x80000000
.long 0x80000000,0x400,0x880,0x80000000,0x80000000,0x404,0x980,0x80000000,0x80000000,0x480,0x890,0x80000000,0x80000000,0x484,0x990,0x80000000
.long 0x80000000,0x500,0x8a0,0x80000000,0x80000000,0x504,0x9a0,0x80000000,0x80000000,0x580,0x8b0,0x80000000,0x80000000,0x584,0x9b0,0x80000000
.long 0x80000000,0x600,0x8c0,0x80000000,0x80000000,0x604,0x9c0,0x80000000,0x80000000,0x680,0x8d0,0x80000000,0x80000000,0x684,0x9d0,0x80000000
.long 0x80000000,0x700,0x8e0,0x80000000,0x80000000,0x704,0x9e0,0x80000000,0x80000000,0x780,0x8f0,0x80000000,0x80000000,0x784,0x9f0,0x80000000
.long 0x0,0x0,0x0,0x80,0x10,0x8,0x480,0x500,0x20,0x10,0x900,0x980,0x30,0x18,0xd80,0xe00
.long 0x40,0x20,0x1200,0x1280,0x50,0x28,0x1680,0x1700,0x60,0x30,0x1b00,0x1b80,0x70,0x38,0x1f80,0x2000
.long 0x80,0x40,0x2400,0x2480,0x90,0x48,0x2880,0x2900,0xa0,0x50,0x2d00,0x2d80,0xb0,0x58,0x3180,0x3200
.long 0xc0,0x60,0x3600,0x3680,0xd0,0x68,0x3a80,0x3b00,0xe0,0x70,0x3f00,0x3f80,0xf0,0x78,0x4380,0x4400
.long 0x800,0x800,0x20,0x88,0x810,0x808,0x4a0,0x508,0x820,0x810,0x920,0x988,0x830,0x818,0xda0,0xe08
.long 0x840,0x820,0x1220,0x1288,0x850,0x828,0x16a0,0x1708,0x860,0x830,0x1b20,0x1b88,0x870,0x838,0x1fa0,0x2008
.long 0x880,0x840,0x2420,0x2488,0x890,0x848,0x28a0,0x2908,0x8a0,0x850,0x2d20,0x2d88,0x8b0,0x858,0x31a0,0x3208
.long 0x8c0,0x860,0x3620,0x3688,0x8d0,0x868,0x3aa0,0x3b08,0x8e0,0x870,0x3f20,0x3f88,0x8f0,0x878,0x43a0,0x4408
.long 0x1000,0x1000,0x10,0x80000000,0x1010,0x1008,0x490,0x80000000,0x1020,0x1010,0x910,0x80000000,0x1030,0x1018,0xd90,0x80000000
.long 0x1040,0x1020,0x1210,0x80000000,0x1050,0x1028,0x1690,0x80000000,0x1060,0x1030,0x1b10,0x80000000,0x1070,0x1038,0x1f90,0x80000000
.long 0x1080,0x1040,0x2410,0x80000000,0x1090,0x1048,0x2890,0x80000000,0x10a0,0x1050,0x2d10,0x80000000,0x10b0,0x1058,0x3190,0x80000000
.long 0x10c0,0x1060,0x3610,0x80000000,0x10d0,0x1068,0x3a90,0x80000000,0x10e0,0x1070,0x3f10,0x80000000,0x10f0,0x1078,0x4390,0x80000000
.long 0x1800,0x1800,0x30,0x80000000,0x1810,0x1808,0x4b0,0x80000000,0x1820,0x1810,0x930,0x80000000,0x1830,0x1818,0xdb0,0x80000000
.long 0x1840,0x1820,0x1230,0x80000000,0x1850,0x1828,0x16b0,0x80000000,0x1860,0x1830,0x1b30,0x80000000,0x1870,0x1838,0x1fb0,0x80000000
.long 0x1880,0x1840,0x2430,0x80000000,0x1890,0x1848,0x28b0,0x80000000,0x18a0,0x1850,0x2d30,0x80000000,0x18b0,0x1858,0x31b0,0x80000000
.long 0x18c0,0x1860,0x3630,0x80000000,0x18d0,0x1868,0x3ab0,0x80000000,0x18e0,0x1870,0x3f30,0x80000000,0x18f0,0x1878,0x43b0,0x80000000
.long 0x0,0x10000,0x0,0x0,0x8,0x10008,0x0,0x0,0x10,0x10010,0x0,0x0,0x18,0x10018,0x0,0x0
.long 0xa0,0x100a0,0x0,0x0,0xa8,0x100a8,0x0,0x0,0xb0,0x100b0,0x0,0x0,0xb8,0x100b8,0x0,0x0
.long 0x140,0x10140,0x0,0x0,0x148,0x10148,0x0,0x0,0x150,0x10150,0x0,0x0,0x158,0x10158,0x0,0x0
.long 0x1e0,0x101e0,0x0,0x0,0x1e8,0x101e8,0x0,0x0,0x1f0,0x101f0,0x0,0x0,0x1f8,0x101f8,0x0,0x0
.long 0x280,0x10280,0x0,0x0,0x288,0x10288,0x0,0x0,0x290,0x10290,0x0,0x0,0x298,0x10298,0x0,0x0
.long 0x320,0x10320,0x0,0x0,0x328,0x10328,0x0,0x0,0x330,0x10330,0x0,0x0,0x338,0x10338,0x0,0x0
.long 0x3c0,0x103c0,0x0,0x0,0x3c8,0x103c8,0x0,0x0,0x3d0,0x103d0,0x0,0x0,0x3d8,0x103d8,0x0,0x0
.long 0x460,0x10460,0x0,0x0,0x468,0x10468,0x0,0x0,0x470,0x10470,0x0,0x0,0x478,0x10478,0x0,0x0
.long 0xa00,0x10a00,0x0,0x0,0xa08,0x10a08,0x0,0x0,0xa10,0x10a10,0x0,0x0,0xa18,0x10a18,0x0,0x0
.long 0xaa0,0x10aa0,0x0,0x0,0xaa8,0x10aa8,0x0,0x0,0xab0,0x10ab0,0x0,0x0,0xab8,0x10ab8,0x0,0x0
.long 0xb40,0x10b40,0x0,0x0,0xb48,0x10b48,0x0,0x0,0xb50,0x10b50,0x0,0x0,0xb58,0x10b58,0x0,0x0
.long 0xbe0,0x10be0,0x0,0x0,0xbe8,0x10be8,0x0,0x0,0xbf0,0x10bf0,0x0,0x0,0xbf8,0x10bf8,0x0,0x0
.long 0xc80,0x10c80,0x0,0x0,0xc88,0x10c88,0x0,0x0,0xc90,0x10c90,0x0,0x0,0xc98,0x10c98,0x0,0x0
.long 0xd20,0x10d20,0x0,0x0,0xd28,0x10d28,0x0,0x0,0xd30,0x10d30,0x0,0x0,0xd38,0x10d38,0x0,0x0
.long 0xdc0,0x10dc0,0x0,0x0,0xdc8,0x10dc8,0x0,0x0,0xdd0,0x10dd0,0x0,0x0,0xdd8,0x10dd8,0x0,0x0
.long 0xe60,0x10e60,0x0,0x0,0xe68,0x10e68,0x0,0x0,0xe70,0x10e70,0x0,0x0,0xe78,0x10e78,0x0,0x0
L_tab_wave:
.long 0x0,0x0,0x0,0x0,0x10,0x10,0x10,0x80000000,0x20,0x20,0x20,0x80000000,0x30,0x30,0x30,0x80000000
.long 0x2400,0x40,0x40,0x80000000,0x2410,0x50,0x50,0x80000000,0x2420,0x60,0x60,0x80000000,0x2430,0x70,0x70,0x80000000
.long 0x4800,0x480,0x80,0x80000000,0x4810,0x490,0x90,0x80000000,0x4820,0x4a0,0xa0,0x80000000,0x4830,0x4b0,0xb0,0x80000000
.long 0x6c00,0x4c0,0xc0,0x80000000,0x6c10,0x4d0,0xd0,0x80000000,0x6c20,0x4e0,0xe0,0x80000000,0x6c30,0x4f0,0xf0,0x80000000
.long 0x9000,0x920,0x200,0x80000000,0x9010,0x930,0x210,0x80000000,0x9020,0x900,0x220,0x80000000,0x9030,0x910,0x230,0x80000000
.long 0xb400,0x960,0x240,0x80000000,0xb410,0x970,0x250,0x80000000,0xb420,0x940,0x260,0x80000000,0xb430,0x950,0x270,0x80000000
.long 0xd800,0xda0,0x280,0x80000000,0xd810,0xdb0,0x290,0x80000000,0xd820,0xd80,0x2a0,0x80000000,0xd830,0xd90,0x2b0,0x80000000
.long 0xfc00,0xde0,0x2c0,0x80000000,0xfc10,0xdf0,0x2d0,0x80000000,0xfc20,0xdc0,0x2e0,0x80000000,0xfc30,0xdd0,0x2f0,0x80000000
.long 0x12020,0x4800,0x100,0x80000000,0x12030,0x4810,0x110,0x80000000,0x12000,0x4820,0x120,0x80000000,0x12010,0x4830,0x130,0x80000000
.long 0x14420,0x4840,0x140,0x80000000,0x14430,0x4850,0x150,0x80000000,0x14400,0x4860,0x160,0x80000000,0x14410,0x4870,0x170,0x80000000
.long 0x16820,0x4c80,0x180,0x80000000,0x16830,0x4c90,0x190,0x80000000,0x16800,0x4ca0,0x1a0,0x80000000,0x16810,0x4cb0,0x1b0,0x80000000
.long 0x18c20,0x4cc0,0x1c0,0x80000000,0x18c30,0x4cd0,0x1d0,0x80000000,0x18c00,0x4ce0,0x1e0,0x80000000,0x18c10,0x4cf0,0x1f0,0x80000000
.long 0x1b020,0x5120,0x300,0x80000000,0x1b030,0x5130,0x310,0x80000000,0x1b000,0x5100,0x320,0x80000000,0x1b010,0x5110,0x330,0x80000000
.long 0x1d420,0x5160,0x340,0x80000000,0x1d430,0x5170,0x350,0x80000000,0x1d400,0x5140,0x360,0x80000000,0x1d410,0x5150,0x370,0x80000000
.long 0x1f820,0x55a0,0x380,0x80000000,0x1f830,0x55b0,0x390,0x80000000,0x1f800,0x5580,0x3a0,0x80000000,0x1f810,0x5590,0x3b0,0x80000000
.long 0x21c20,0x55e0,0x3c0,0x80000000,0x21c30,0x55f0,0x3d0,0x80000000,0x21c00,0x55c0,0x3e0,0x80000000,0x21c10,0x55d0,0x3f0,0x80000000
.long 0x0,0x14000,0x2800,0x12800,0x8,0x14008,0x2810,0x12810,0x10,0x14010,0x2820,0x12820,0x18,0x14018,0x2830,0x12830
.long 0x20,0x14020,0x2880,0x12880,0x28,0x14028,0x2890,0x12890,0x30,0x14030,0x28a0,0x128a0,0x38,0x14038,0x28b0,0x128b0
.long 0x40,0x14040,0x2840,0x12840,0x48,0x14048,0x2850,0x12850,0x50,0x14050,0x2860,0x12860,0x58,0x14058,0x2870,0x12870
.long 0x60,0x14060,0x28c0,0x128c0,0x68,0x14068,0x28d0,0x128d0,0x70,0x14070,0x28e0,0x128e0,0x78,0x14078,0x28f0,0x128f0
.long 0x80,0x14080,0x2900,0x12900,0x88,0x14088,0x2910,0x12910,0x90,0x14090,0x2920,0x12920,0x98,0x14098,0x80000,0x90000
.long 0xa0,0x140a0,0x80000,0x90000,0xa8,0x140a8,0x80000,0x90000,0xb0,0x140b0,0x80000,0x90000,0xb8,0x140b8,0x80000,0x90000
.long 0xc0,0x140c0,0x80000,0x90000,0xc8,0x140c8,0x80000,0x90000,0xd0,0x140d0,0x80000,0x90000,0xd8,0x140d8,0x80000,0x90000
.long 0xe0,0x140e0,0x2920,0x12920,0xe8,0x140e8,0x80000,0x90000,0xf0,0x140f0,0x80000,0x90000,0xf8,0x140f8,0x80000,0x90000
.long 0x100,0x14100,0x2a50,0x12a50,0x108,0x14108,0x2a60,0x12a60,0x110,0x14110,0x2a70,0x12a70,0x118,0x14118,0x2a80,0x12a80
.long 0x120,0x14120,0x2ad0,0x12ad0,0x128,0x14128,0x2ae0,0x12ae0,0x130,0x14130,0x2af0,0x12af0,0x138,0x14138,0x2b00,0x12b00
.long 0x140,0x14140,0x2a90,0x12a90,0x148,0x14148,0x2aa0,0x12aa0,0x150,0x14150,0x2ab0,0x12ab0,0x158,0x14158,0x2ac0,0x12ac0
.long 0x160,0x14160,0x2b10,0x12b10,0x168,0x14168,0x2b20,0x12b20,0x170,0x14170,0x2b30,0x12b30,0x178,0x14178,0x2b40,0x12b40
.long 0x180,0x14180,0x2b50,0x12b50,0x188,0x14188,0x2b60,0x12b60,0x190,0x14190,0x2b70,0x12b70,0x198,0x14198,0x80000,0x90000
.long 0x1a0,0x141a0,0x80000,0x90000,0x1a8,0x141a8,0x80000,0x90000,0x1b0,0x141b0,0x80000,0x90000,0x1b8,0x141b8,0x80000,0x90000
.long 0x1c0,0x141c0,0x80000,0x90000,0x1c8,0x141c8,0x80000,0x90000,0x1d0,0x141d0,0x80000,0x90000,0x1d8,0x141d8,0x80000,0x90000
.long 0x1e0,0x141e0,0x2b70,0x12b70,0x1e8,0x141e8,0x80000,0x90000,0x1f0,0x141f0,0x80000,0x90000,0x1f8,0x141f8,0x80000,0x90000
.long 0x22800,0x4800,0x1dd40,0x22e80,0x22810,0x4810,0x1dd50,0x22e90,0x22820,0x4820,0x1dd60,0x23280,0x22830,0x4830,0x1dd70,0x23290
.long 0x22880,0x4840,0x1dd80,0x232a0,0x22890,0x4850,0x1dd90,0x232b0,0x228a0,0x4860,0x1e180,0x232c0,0x228b0,0x4870,0x1e190,0x232d0
.long 0x22840,0x4880,0x1e1a0,0x232e0,0x22850,0x4890,0x1e1b0,0x232f0,0x22860,0x4c80,0x1e1c0,0x23300,0x22870,0x4c90,0x1e1d0,0x23310
.long 0x228c0,0x4ca0,0x1e1e0,0x27f00,0x228d0,0x4cb0,0x1e1f0,0x27f10,0x228e0,0x4cc0,0x1e200,0x27f20,0x228f0,0x4cd0,0x1e210,0x27f30
.long 0x22900,0x4ce0,0xea00,0x27f40,0x22910,0x4cf0,0xea10,0x27f50,0x22920,0x4d00,0xea20,0x27f60,0xa0000,0x4d10,0xea30,0x27f70
.long 0xa0000,0x9900,0xea40,0x27f80,0xa0000,0x9910,0xea50,0x27f90,0xa0000,0x9920,0xea60,0x28380,0xa0000,0x9930,0xea70,0x28390
.long 0xa0000,0x9940,0xea80,0x283a0,0xa0000,0x9950,0xea90,0x283b0,0xa0000,0x9960,0xee80,0x283c0,0xa0000,0x9970,0xee90,0x283d0
.long 0x22920,0x9980,0xeea0,0x283e0,0xa0000,0x9990,0xeeb0,0x283f0,0xa0000,0x9d80,0xeec0,0x28400,0xa0000,0x9d90,0xeed0,0x28410
.long 0x22a50,0x9da0,0xeee0,0x2d000,0x22a60,0x9db0,0xeef0,0x2d010,0x22a70,0x9dc0,0xef00,0x2d020,0x22a80,0x9dd0,0xef10,0x2d030
.long 0x22ad0,0x9de0,0x13b00,0x2d040,0x22ae0,0x9df0,0x13b10,0x2d050,0x22af0,0x9e00,0x13b20,0x2d060,0x22b00,0x9e10,0x13b30,0x2d070
.long 0x22a90,0x18c00,0x13b40,0x2d080,0x22aa0,0x18c10,0x13b50,0x2d090,0x22ab0,0x18c20,0x13b60,0x2d480,0x22ac0,0x18c30,0x13b70,0x2d490
.long 0x22b10,0x18c40,0x13b80,0x2d4a0,0x22b20,0x18c50,0x13b90,0x2d4b0,0x22b30,0x18c60,0x13f80,0x2d4c0,0x22b40,0x18c70,0x13f90,0x2d4d0
.long 0x22b50,0x18c80,0x13fa0,0x2d4e0,0x22b60,0x18c90,0x13fb0,0x2d4f0,0x22b70,0x19080,0x13fc0,0x2d500,0xa0000,0x19090,0x13fd0,0x2d510
.long 0xa0000,0x190a0,0x13fe0,0x32100,0xa0000,0x190b0,0x13ff0,0x32110,0xa0000,0x190c0,0x14000,0x32120,0xa0000,0x190d0,0x14010,0x32130
.long 0xa0000,0x190e0,0x22e00,0x32140,0xa0000,0x190f0,0x22e10,0x32150,0xa0000,0x19100,0x22e20,0x32160,0xa0000,0x19110,0x22e30,0x32170
.long 0x22b70,0x1dd00,0x22e40,0x32180,0xa0000,0x1dd10,0x22e50,0x32190,0xa0000,0x1dd20,0x22e60,0x32580,0xa0000,0x1dd30,0x22e70,0x32590
.long 0x0,0x400,0x0,0x400,0x8,0x408,0x10,0x410,0x10,0x410,0x20,0x420,0x18,0x418,0x30,0x430
.long 0x20,0x420,0x40,0x440,0x28,0x428,0x50,0x450,0x30,0x430,0x60,0x460,0x38,0x438,0x70,0x470
.long 0x40,0x440,0x80,0x480,0x48,0x448,0x90,0x490,0x50,0x450,0xa0,0x4a0,0x58,0x458,0xb0,0x4b0
.long 0x60,0x460,0xc0,0x4c0,0x68,0x468,0xd0,0x4d0,0x70,0x470,0xe0,0x4e0,0x78,0x478,0xf0,0x4f0
.long 0x80,0x480,0x100,0x500,0x88,0x488,0x110,0x510,0x90,0x490,0x120,0x520,0x98,0x498,0x130,0x530
.long 0xa0,0x4a0,0x140,0x540,0xa8,0x4a8,0x150,0x550,0xb0,0x4b0,0x160,0x560,0xb8,0x4b8,0x170,0x570
.long 0xc0,0x4c0,0x180,0x580,0xc8,0x4c8,0x190,0x590,0xd0,0x4d0,0x1a0,0x5a0,0xd8,0x4d8,0x1b0,0x5b0
.long 0xe0,0x4e0,0x1c0,0x5c0,0xe8,0x4e8,0x1d0,0x5d0,0xf0,0x4f0,0x1e0,0x5e0,0xf8,0x4f8,0x1f0,0x5f0
.long 0x100,0x400,0x200,0x600,0x108,0x408,0x210,0x610,0x110,0x410,0x220,0x620,0x118,0x418,0x230,0x630
.long 0x120,0x420,0x240,0x640,0x128,0x428,0x250,0x650,0x130,0x430,0x260,0x660,0x138,0x438,0x270,0x670
.long 0x140,0x440,0x280,0x680,0x148,0x448,0x290,0x690,0x150,0x450,0x2a0,0x6a0,0x158,0x458,0x2b0,0x6b0
.long 0x160,0x460,0x2c0,0x6c0,0x168,0x468,0x2d0,0x6d0,0x170,0x470,0x2e0,0x6e0,0x178,0x478,0x2f0,0x6f0
.long 0x180,0x480,0x300,0x700,0x188,0x488,0x310,0x710,0x190,0x490,0x320,0x720,0x198,0x498,0x330,0x730
.long 0x1a0,0x4a0,0x340,0x740,0x1a8,0x4a8,0x350,0x750,0x1b0,0x4b0,0x360,0x760,0x1b8,0x4b8,0x370,0x770
.long 0x1c0,0x4c0,0x380,0x780,0x1c8,0x4c8,0x390,0x790,0x1d0,0x4d0,0x3a0,0x7a0,0x1d8,0x4d8,0x3b0,0x7b0
.long 0x1e0,0x4e0,0x3c0,0x7c0,0x1e8,0x4e8,0x3d0,0x7d0,0x1f0,0x4f0,0x3e0,0x7e0,0x1f8,0x4f8,0x3f0,0x7f0
.long 0x800,0x9200,0x9600,0x0,0x810,0x9210,0x9610,0x0,0x820,0x9220,0x9620,0x0,0x830,0x9230,0x9630,0x0
.long 0x840,0x9240,0x9640,0x0,0x850,0x9250,0x9650,0x0,0x860,0x9260,0x9660,0x0,0x870,0x9270,0x9670,0x0
.long 0x880,0x9280,0x9680,0x0,0x890,0x9290,0x9690,0x0,0x8a0,0x92a0,0x96a0,0x0,0x8b0,0x92b0,0x96b0,0x0
.long 0x8c0,0x92c0,0x96c0,0x0,0x8d0,0x92d0,0x96d0,0x0,0x8e0,0x92e0,0x96e0,0x0,0x8f0,0x92f0,0x96f0,0x0
.long 0x80000000,0x9300,0x9700,0x0,0x80000000,0x9310,0x9710,0x0,0x80000000,0x9320,0x9720,0x0,0x80000000,0x9330,0x9730,0x0
.long 0x80000000,0x9340,0x9740,0x0,0x80000000,0x9350,0x9750,0x0,0x80000000,0x9360,0x9760,0x0,0x80000000,0x9370,0x9770,0x0
.long 0x80000000,0x9380,0x9780,0x0,0x80000000,0x9390,0x9790,0x0,0x80000000,0x93a0,0x97a0,0x0,0x80000000,0x93b0,0x97b0,0x0
.long 0x80000000,0x93c0,0x97c0,0x0,0x80000000,0x93d0,0x97d0,0x0,0x80000000,0x93e0,0x97e0,0x0,0x80000000,0x93f0,0x97f0,0x0
.long 0x9000,0x9400,0x9800,0x0,0x9010,0x9410,0x9810,0x0,0x9020,0x9420,0x9820,0x0,0x9030,0x9430,0x9830,0x0
.long 0x9040,0x9440,0x9840,0x0,0x9050,0x9450,0x9850,0x0,0x9060,0x9460,0x9860,0x0,0x9070,0x9470,0x9870,0x0
.long 0x9080,0x9480,0x9880,0x0,0x9090,0x9490,0x9890,0x0,0x90a0,0x94a0,0x98a0,0x0,0x90b0,0x94b0,0x98b0,0x0
.long 0x90c0,0x94c0,0x98c0,0x0,0x90d0,0x94d0,0x98d0,0x0,0x90e0,0x94e0,0x98e0,0x0,0x90f0,0x94f0,0x98f0,0x0
.long 0x9100,0x9500,0x80000000,0x0,0x9110,0x9510,0x80000000,0x0,0x9120,0x9520,0x80000000,0x0,0x9130,0x9530,0x80000000,0x0
.long 0x9140,0x9540,0x80000000,0x0,0x9150,0x9550,0x80000000,0x0,0x9160,0x9560,0x80000000,0x0,0x9170,0x9570,0x80000000,0x0
.long 0x9180,0x9580,0x80000000,0x0,0x9190,0x9590,0x80000000,0x0,0x91a0,0x95a0,0x80000000,0x0,0x91b0,0x95b0,0x80000000,0x0
.long 0x91c0,0x95c0,0x80000000,0x0,0x91d0,0x95d0,0x80000000,0x0,0x91e0,0x95e0,0x80000000,0x0,0x91f0,0x95f0,0x80000000,0x0
.long 0x24000,0x1240,0x0,0x80000000,0x24010,0x1250,0x10,0x80000000,0x24020,0x1260,0x20,0x80000000,0x24030,0x1270,0x30,0x80000000
.long 0x26400,0x1200,0x40,0x80000000,0x26410,0x1210,0x50,0x80000000,0x26420,0x1220,0x60,0x80000000,0x26430,0x1230,0x70,0x80000000
.long 0x28800,0x16c0,0x80,0x80000000,0x28810,0x16d0,0x90,0x80000000,0x28820,0x16e0,0xa0,0x80000000,0x28830,0x16f0,0xb0,0x80000000
.long 0x2ac00,0x1680,0xc0,0x80000000,0x2ac10,0x1690,0xd0,0x80000000,0x2ac20,0x16a0,0xe0,0x80000000,0x2ac30,0x16b0,0xf0,0x80000000
.long 0x2d000,0x1b60,0x200,0x80000000,0x2d010,0x1b70,0x210,0x80000000,0x2d020,0x1b40,0x220,0x80000000,0x2d030,0x1b50,0x230,0x80000000
.long 0x2f400,0x1b20,0x240,0x80000000,0x2f410,0x1b30,0x250,0x80000000,0x2f420,0x1b00,0x260,0x80000000,0x2f430,0x1b10,0x270,0x80000000
.long 0x31800,0x1fe0,0x280,0x80000000,0x31810,0x1ff0,0x290,0x80000000,0x31820,0x1fc0,0x2a0,0x80000000,0x31830,0x1fd0,0x2b0,0x80000000
.long 0x33c00,0x1fa0,0x2c0,0x80000000,0x33c10,0x1fb0,0x2d0,0x80000000,0x33c20,0x1f80,0x2e0,0x80000000,0x33c30,0x1f90,0x2f0,0x80000000
.long 0x36020,0x5a40,0x100,0x80000000,0x36030,0x5a50,0x110,0x80000000,0x36000,0x5a60,0x120,0x80000000,0x36010,0x5a70,0x130,0x80000000
.long 0x38420,0x5a00,0x140,0x80000000,0x38430,0x5a10,0x150,0x80000000,0x38400,0x5a20,0x160,0x80000000,0x38410,0x5a30,0x170,0x80000000
.long 0x3a820,0x5ec0,0x180,0x80000000,0x3a830,0x5ed0,0x190,0x80000000,0x3a800,0x5ee0,0x1a0,0x80000000,0x3a810,0x5ef0,0x1b0,0x80000000
.long 0x3cc20,0x5e80,0x1c0,0x80000000,0x3cc30,0x5e90,0x1d0,0x80000000,0x3cc00,0x5ea0,0x1e0,0x80000000,0x3cc10,0x5eb0,0x1f0,0x80000000
.long 0x3f020,0x6360,0x300,0x80000000,0x3f030,0x6370,0x310,0x80000000,0x3f000,0x6340,0x320,0x80000000,0x3f010,0x6350,0x330,0x80000000
.long 0x41420,0x6320,0x340,0x80000000,0x41430,0x6330,0x350,0x80000000,0x41400,0x6300,0x360,0x80000000,0x41410,0x6310,0x370,0x80000000
.long 0x43820,0x67e0,0x380,0x80000000,0x43830,0x67f0,0x390,0x80000000,0x43800,0x67c0,0x3a0,0x80000000,0x43810,0x67d0,0x3b0,0x80000000
.long 0x45c20,0x67a0,0x3c0,0x80000000,0x45c30,0x67b0,0x3d0,0x80000000,0x45c00,0x6780,0x3e0,0x80000000,0x45c10,0x6790,0x3f0,0x80000000
.long 0x500,0x14500,0x2930,0x12930,0x508,0x14508,0x2940,0x12940,0x510,0x14510,0x2950,0x12950,0x518,0x14518,0x2960,0x12960
.long 0x520,0x14520,0x29b0,0x129b0,0x528,0x14528,0x29c0,0x129c0,0x530,0x14530,0x29d0,0x129d0,0x538,0x14538,0x29e0,0x129e0
.long 0x540,0x14540,0x2970,0x12970,0x548,0x14548,0x2980,0x12980,0x550,0x14550,0x2990,0x12990,0x558,0x14558,0x29a0,0x129a0
.long 0x560,0x14560,0x29f0,0x129f0,0x568,0x14568,0x2a00,0x12a00,0x570,0x14570,0x2a10,0x12a10,0x578,0x14578,0x2a20,0x12a20
.long 0x580,0x14580,0x2a30,0x12a30,0x588,0x14588,0x2a40,0x12a40,0x590,0x14590,0x2920,0x12920,0x598,0x14598,0x80000,0x90000
.long 0x5a0,0x145a0,0x80000,0x90000,0x5a8,0x145a8,0x80000,0x90000,0x5b0,0x145b0,0x80000,0x90000,0x5b8,0x145b8,0x80000,0x90000
.long 0x5c0,0x145c0,0x80000,0x90000,0x5c8,0x145c8,0x80000,0x90000,0x5d0,0x145d0,0x80000,0x90000,0x5d8,0x145d8,0x80000,0x90000
.long 0x5e0,0x145e0,0x2920,0x12920,0x5e8,0x145e8,0x80000,0x90000,0x5f0,0x145f0,0x80000,0x90000,0x5f8,0x145f8,0x80000,0x90000
.long 0x600,0x14600,0x2b80,0x12b80,0x608,0x14608,0x2b90,0x12b90,0x610,0x14610,0x2ba0,0x12ba0,0x618,0x14618,0x2bb0,0x12bb0
.long 0x620,0x14620,0x2c00,0x12c00,0x628,0x14628,0x2c10,0x12c10,0x630,0x14630,0x2c20,0x12c20,0x638,0x14638,0x2c30,0x12c30
.long 0x640,0x14640,0x2bc0,0x12bc0,0x648,0x14648,0x2bd0,0x12bd0,0x650,0x14650,0x2be0,0x12be0,0x658,0x14658,0x2bf0,0x12bf0
.long 0x660,0x14660,0x2c40,0x12c40,0x668,0x14668,0x2c50,0x12c50,0x670,0x14670,0x2c60,0x12c60,0x678,0x14678,0x2c70,0x12c70
.long 0x680,0x14680,0x2c80,0x12c80,0x688,0x14688,0x2c90,0x12c90,0x690,0x14690,0x2b70,0x12b70,0x698,0x14698,0x80000,0x90000
.long 0x6a0,0x146a0,0x80000,0x90000,0x6a8,0x146a8,0x80000,0x90000,0x6b0,0x146b0,0x80000,0x90000,0x6b8,0x146b8,0x80000,0x90000
.long 0x6c0,0x146c0,0x80000,0x90000,0x6c8,0x146c8,0x80000,0x90000,0x6d0,0x146d0,0x80000,0x90000,0x6d8,0x146d8,0x80000,0x90000
.long 0x6e0,0x146e0,0x2b70,0x12b70,0x6e8,0x146e8,0x80000,0x90000,0x6f0,0x146f0,0x80000,0x90000,0x6f8,0x146f8,0x80000,0x90000
.long 0x22930,0x325a0,0x376e0,0x55800,0x22940,0x325b0,0x376f0,0x55810,0x22950,0x325c0,0x37700,0x55820,0x22960,0x325d0,0x37710,0x55830
.long 0x229b0,0x325e0,0x3c300,0x55840,0x229c0,0x325f0,0x3c310,0x55850,0x229d0,0x32600,0x3c320,0x55860,0x229e0,0x32610,0x3c330,0x55870
.long 0x22970,0x41400,0x3c340,0x55880,0x22980,0x41410,0x3c350,0x55890,0x22990,0x41420,0x3c360,0x55c80,0x229a0,0x41430,0x3c370,0x55c90
.long 0x229f0,0x41440,0x3c380,0x55ca0,0x22a00,0x41450,0x3c390,0x55cb0,0x22a10,0x41460,0x3c780,0x55cc0,0x22a20,0x41470,0x3c790,0x55cd0
.long 0x22a30,0x41480,0x3c7a0,0x55ce0,0x22a40,0x41490,0x3c7b0,0x55cf0,0x22920,0x41880,0x3c7c0,0x55d00,0xa0000,0x41890,0x3c7d0,0x55d10
.long 0xa0000,0x418a0,0x3c7e0,0x5a900,0xa0000,0x418b0,0x3c7f0,0x5a910,0xa0000,0x418c0,0x3c800,0x5a920,0xa0000,0x418d0,0x3c810,0x5a930
.long 0xa0000,0x418e0,0x4b600,0x5a940,0xa0000,0x418f0,0x4b610,0x5a950,0xa0000,0x41900,0x4b620,0x5a960,0xa0000,0x41910,0x4b630,0x5a970
.long 0x22920,0x46500,0x4b640,0x5a980,0xa0000,0x46510,0x4b650,0x5a990,0xa0000,0x46520,0x4b660,0x5ad80,0xa0000,0x46530,0x4b670,0x5ad90
.long 0x22b80,0x46540,0x4b680,0x5ada0,0x22b90,0x46550,0x4b690,0x5adb0,0x22ba0,0x46560,0x4ba80,0x5adc0,0x22bb0,0x46570,0x4ba90,0x5add0
.long 0x22c00,0x46580,0x4baa0,0x5ade0,0x22c10,0x46590,0x4bab0,0x5adf0,0x22c20,0x46980,0x4bac0,0x5ae00,0x22c30,0x46990,0x4bad0,0x5ae10
.long 0x22bc0,0x469a0,0x4bae0,0x69c00,0x22bd0,0x469b0,0x4baf0,0x69c10,0x22be0,0x469c0,0x4bb00,0x69c20,0x22bf0,0x469d0,0x4bb10,0x69c30
.long 0x22c40,0x469e0,0x50700,0x69c40,0x22c50,0x469f0,0x50710,0x69c50,0x22c60,0x46a00,0x50720,0x69c60,0x22c70,0x46a10,0x50730,0x69c70
.long 0x22c80,0x37200,0x50740,0x69c80,0x22c90,0x37210,0x50750,0x69c90,0x22b70,0x37220,0x50760,0x6a080,0xa0000,0x37230,0x50770,0x6a090
.long 0xa0000,0x37240,0x50780,0x6a0a0,0xa0000,0x37250,0x50790,0x6a0b0,0xa0000,0x37260,0x50b80,0x6a0c0,0xa0000,0x37270,0x50b90,0x6a0d0
.long 0xa0000,0x37280,0x50ba0,0x6a0e0,0xa0000,0x37290,0x50bb0,0x6a0f0,0xa0000,0x37680,0x50bc0,0x6a100,0xa0000,0x37690,0x50bd0,0x6a110
.long 0x22b70,0x376a0,0x50be0,0x6ed00,0xa0000,0x376b0,0x50bf0,0x6ed10,0xa0000,0x376c0,0x50c00,0x6ed20,0xa0000,0x376d0,0x50c10,0x6ed30
.long 0x500,0x404,0x12000,0x12400,0x508,0x40c,0x12010,0x12410,0x510,0x414,0x12020,0x12420,0x518,0x41c,0x12030,0x12430
.long 0x520,0x424,0x12040,0x12440,0x528,0x42c,0x12050,0x12450,0x530,0x434,0x12060,0x12460,0x538,0x43c,0x12070,0x12470
.long 0x540,0x444,0x12080,0x12480,0x548,0x44c,0x12090,0x12490,0x550,0x454,0x120a0,0x124a0,0x558,0x45c,0x120b0,0x124b0
.long 0x560,0x464,0x120c0,0x124c0,0x568,0x46c,0x120d0,0x124d0,0x570,0x474,0x120e0,0x124e0,0x578,0x47c,0x120f0,0x124f0
.long 0x580,0x484,0x12100,0x12500,0x588,0x48c,0x12110,0x12510,0x590,0x494,0x12120,0x12520,0x598,0x49c,0x12130,0x12530
.long 0x5a0,0x4a4,0x12140,0x12540,0x5a8,0x4ac,0x12150,0x12550,0x5b0,0x4b4,0x12160,0x12560,0x5b8,0x4bc,0x12170,0x12570
.long 0x5c0,0x4c4,0x12180,0x12580,0x5c8,0x4cc,0x12190,0x12590,0x5d0,0x4d4,0x121a0,0x125a0,0x5d8,0x4dc,0x121b0,0x125b0
.long 0x5e0,0x4e4,0x121c0,0x125c0,0x5e8,0x4ec,0x121d0,0x125d0,0x5f0,0x4f4,0x121e0,0x125e0,0x5f8,0x4fc,0x121f0,0x125f0
.long 0x600,0x404,0x12200,0x12600,0x608,0x40c,0x12210,0x12610,0x610,0x414,0x12220,0x12620,0x618,0x41c,0x12230,0x12630
.long 0x620,0x424,0x12240,0x12640,0x628,0x42c,0x12250,0x12650,0x630,0x434,0x12260,0x12660,0x638,0x43c,0x12270,0x12670
.long 0x640,0x444,0x12280,0x12680,0x648,0x44c,0x12290,0x12690,0x650,0x454,0x122a0,0x126a0,0x658,0x45c,0x122b0,0x126b0
.long 0x660,0x464,0x122c0,0x126c0,0x668,0x46c,0x122d0,0x126d0,0x670,0x474,0x122e0,0x126e0,0x678,0x47c,0x122f0,0x126f0
.long 0x680,0x484,0x12300,0x12700,0x688,0x48c,0x12310,0x12710,0x690,0x494,0x12320,0x12720,0x698,0x49c,0x12330,0x12730
.long 0x6a0,0x4a4,0x12340,0x12740,0x6a8,0x4ac,0x12350,0x12750,0x6b0,0x4b4,0x12360,0x12760,0x6b8,0x4bc,0x12370,0x12770
.long 0x6c0,0x4c4,0x12380,0x12780,0x6c8,0x4cc,0x12390,0x12790,0x6d0,0x4d4,0x123a0,0x127a0,0x6d8,0x4dc,0x123b0,0x127b0
.long 0x6e0,0x4e4,0x123c0,0x127c0,0x6e8,0x4ec,0x123d0,0x127d0,0x6f0,0x4f4,0x123e0,0x127e0,0x6f8,0x4fc,0x123f0,0x127f0
.long 0x12800,0x1b200,0x1b600,0x0,0x12810,0x1b210,0x1b610,0x0,0x12820,0x1b220,0x1b620,0x0,0x12830,0x1b230,0x1b630,0x0
.long 0x12840,0x1b240,0x1b640,0x0,0x12850,0x1b250,0x1b650,0x0,0x12860,0x1b260,0x1b660,0x0,0x12870,0x1b270,0x1b670,0x0
.long 0x12880,0x1b280,0x1b680,0x0,0x12890,0x1b290,0x1b690,0x0,0x128a0,0x1b2a0,0x1b6a0,0x0,0x128b0,0x1b2b0,0x1b6b0,0x0
.long 0x128c0,0x1b2c0,0x1b6c0,0x0,0x128d0,0x1b2d0,0x1b6d0,0x0,0x128e0,0x1b2e0,0x1b6e0,0x0,0x128f0,0x1b2f0,0x1b6f0,0x0
.long 0x80000000,0x1b300,0x1b700,0x0,0x80000000,0x1b310,0x1b710,0x0,0x80000000,0x1b320,0x1b720,0x0,0x80000000,0x1b330,0x1b730,0x0
.long 0x80000000,0x1b340,0x1b740,0x0,0x80000000,0x1b350,0x1b750,0x0,0x80000000,0x1b360,0x1b760,0x0,0x80000000,0x1b370,0x1b770,0x0
.long 0x80000000,0x1b380,0x1b780,0x0,0x80000000,0x1b390,0x1b790,0x0,0x80000000,0x1b3a0,0x1b7a0,0x0,0x80000000,0x1b3b0,0x1b7b0,0x0
.long 0x80000000,0x1b3c0,0x1b7c0,0x0,0x80000000,0x1b3d0,0x1b7d0,0x0,0x80000000,0x1b3e0,0x1b7e0,0x0,0x80000000,0x1b3f0,0x1b7f0,0x0
.long 0x1b000,0x1b400,0x1b800,0x0,0x1b010,0x1b410,0x1b810,0x0,0x1b020,0x1b420,0x1b820,0x0,0x1b030,0x1b430,0x1b830,0x0
.long 0x1b040,0x1b440,0x1b840,0x0,0x1b050,0x1b450,0x1b850,0x0,0x1b060,0x1b460,0x1b860,0x0,0x1b070,0x1b470,0x1b870,0x0
.long 0x1b080,0x1b480,0x1b880,0x0,0x1b090,0x1b490,0x1b890,0x0,0x1b0a0,0x1b4a0,0x1b8a0,0x0,0x1b0b0,0x1b4b0,0x1b8b0,0x0
.long 0x1b0c0,0x1b4c0,0x1b8c0,0x0,0x1b0d0,0x1b4d0,0x1b8d0,0x0,0x1b0e0,0x1b4e0,0x1b8e0,0x0,0x1b0f0,0x1b4f0,0x1b8f0,0x0
.long 0x1b100,0x1b500,0x80000000,0x0,0x1b110,0x1b510,0x80000000,0x0,0x1b120,0x1b520,0x80000000,0x0,0x1b130,0x1b530,0x80000000,0x0
.long 0x1b140,0x1b540,0x80000000,0x0,0x1b150,0x1b550,0x80000000,0x0,0x1b160,0x1b560,0x80000000,0x0,0x1b170,0x1b570,0x80000000,0x0
.long 0x1b180,0x1b580,0x80000000,0x0,0x1b190,0x1b590,0x80000000,0x0,0x1b1a0,0x1b5a0,0x80000000,0x0,0x1b1b0,0x1b5b0,0x80000000,0x0
.long 0x1b1c0,0x1b5c0,0x80000000,0x0,0x1b1d0,0x1b5d0,0x80000000,0x0,0x1b1e0,0x1b5e0,0x80000000,0x0,0x1b1f0,0x1b5f0,0x80000000,0x0
.long 0x0,0x2400,0x0,0x80000000,0x10,0x2410,0x10,0x80000000,0x20,0x2420,0x20,0x80000000,0x30,0x2430,0x30,0x80000000
.long 0x2400,0x2440,0x40,0x80000000,0x2410,0x2450,0x50,0x80000000,0x2420,0x2460,0x60,0x80000000,0x2430,0x2470,0x70,0x80000000
.long 0x4800,0x2880,0x80,0x80000000,0x4810,0x2890,0x90,0x80000000,0x4820,0x28a0,0xa0,0x80000000,0x4830,0x28b0,0xb0,0x80000000
.long 0x6c00,0x28c0,0xc0,0x80000000,0x6c10,0x28d0,0xd0,0x80000000,0x6c20,0x28e0,0xe0,0x80000000,0x6c30,0x28f0,0xf0,0x80000000
.long 0x9000,0x2d20,0x200,0x80000000,0x9010,0x2d30,0x210,0x80000000,0x9020,0x2d00,0x220,0x80000000,0x9030,0x2d10,0x230,0x80000000
.long 0xb400,0x2d60,0x240,0x80000000,0xb410,0x2d70,0x250,0x80000000,0xb420,0x2d40,0x260,0x80000000,0xb430,0x2d50,0x270,0x80000000
.long 0xd800,0x31a0,0x280,0x80000000,0xd810,0x31b0,0x290,0x80000000,0xd820,0x3180,0x2a0,0x80000000,0xd830,0x3190,0x2b0,0x80000000
.long 0xfc00,0x31e0,0x2c0,0x80000000,0xfc10,0x31f0,0x2d0,0x80000000,0xfc20,0x31c0,0x2e0,0x80000000,0xfc30,0x31d0,0x2f0,0x80000000
.long 0x12020,0x6c00,0x100,0x80000000,0x12030,0x6c10,0x110,0x80000000,0x12000,0x6c20,0x120,0x80000000,0x12010,0x6c30,0x130,0x80000000
.long 0x14420,0x6c40,0x140,0x80000000,0x14430,0x6c50,0x150,0x80000000,0x14400,0x6c60,0x160,0x80000000,0x14410,0x6c70,0x170,0x80000000
.long 0x16820,0x7080,0x180,0x80000000,0x16830,0x7090,0x190,0x80000000,0x16800,0x70a0,0x1a0,0x80000000,0x16810,0x70b0,0x1b0,0x80000000
.long 0x18c20,0x70c0,0x1c0,0x80000000,0x18c30,0x70d0,0x1d0,0x80000000,0x18c00,0x70e0,0x1e0,0x80000000,0x18c10,0x70f0,0x1f0,0x80000000
.long 0x1b020,0x7520,0x300,0x80000000,0x1b030,0x7530,0x310,0x80000000,0x1b000,0x7500,0x320,0x80000000,0x1b010,0x7510,0x330,0x80000000
.long 0x1d420,0x7560,0x340,0x80000000,0x1d430,0x7570,0x350,0x80000000,0x1d400,0x7540,0x360,0x80000000,0x1d410,0x7550,0x370,0x80000000
.long 0x1f820,0x79a0,0x380,0x80000000,0x1f830,0x79b0,0x390,0x80000000,0x1f800,0x7980,0x3a0,0x80000000,0x1f810,0x7990,0x3b0,0x80000000
.long 0x21c20,0x79e0,0x3c0,0x80000000,0x21c30,0x79f0,0x3d0,0x80000000,0x21c00,0x79c0,0x3e0,0x80000000,0x21c10,0x79d0,0x3f0,0x80000000
.long 0x0,0x14000,0x2800,0x12800,0x8,0x14008,0x2810,0x12810,0x10,0x14010,0x2820,0x12820,0x18,0x14018,0x2830,0x12830
.long 0x20,0x14020,0x2880,0x12880,0x28,0x14028,0x2890,0x12890,0x30,0x14030,0x28a0,0x128a0,0x38,0x14038,0x28b0,0x128b0
.long 0x40,0x14040,0x2840,0x12840,0x48,0x14048,0x2850,0x12850,0x50,0x14050,0x2860,0x12860,0x58,0x14058,0x2870,0x12870
.long 0x60,0x14060,0x28c0,0x128c0,0x68,0x14068,0x28d0,0x128d0,0x70,0x14070,0x28e0,0x128e0,0x78,0x14078,0x28f0,0x128f0
.long 0x80,0x14080,0x2900,0x12900,0x88,0x14088,0x2910,0x12910,0x90,0x14090,0x2920,0x12920,0x98,0x14098,0x80000,0x90000
.long 0xa0,0x140a0,0x80000,0x90000,0xa8,0x140a8,0x80000,0x90000,0xb0,0x140b0,0x80000,0x90000,0xb8,0x140b8,0x80000,0x90000
.long 0xc0,0x140c0,0x80000,0x90000,0xc8,0x140c8,0x80000,0x90000,0xd0,0x140d0,0x80000,0x90000,0xd8,0x140d8,0x80000,0x90000
.long 0xe0,0x140e0,0x2920,0x12920,0xe8,0x140e8,0x80000,0x90000,0xf0,0x140f0,0x80000,0x90000,0xf8,0x140f8,0x80000,0x90000
.long 0x100,0x14100,0x2a50,0x12a50,0x108,0x14108,0x2a60,0x12a60,0x110,0x14110,0x2a70,0x12a70,0x118,0x14118,0x2a80,0x12a80
.long 0x120,0x14120,0x2ad0,0x12ad0,0x128,0x14128,0x2ae0,0x12ae0,0x130,0x14130,0x2af0,0x12af0,0x138,0x14138,0x2b00,0x12b00
.long 0x140,0x14140,0x2a90,0x12a90,0x148,0x14148,0x2aa0,0x12aa0,0x150,0x14150,0x2ab0,0x12ab0,0x158,0x14158,0x2ac0,0x12ac0
.long 0x160,0x14160,0x2b10,0x12b10,0x168,0x14168,0x2b20,0x12b20,0x170,0x14170,0x2b30,0x12b30,0x178,0x14178,0x2b40,0x12b40
.long 0x180,0x14180,0x2b50,0x12b50,0x188,0x14188,0x2b60,0x12b60,0x190,0x14190,0x2b70,0x12b70,0x198,0x14198,0x80000,0x90000
.long 0x1a0,0x141a0,0x80000,0x90000,0x1a8,0x141a8,0x80000,0x90000,0x1b0,0x141b0,0x80000,0x90000,0x1b8,0x141b8,0x80000,0x90000
.long 0x1c0,0x141c0,0x80000,0x90000,0x1c8,0x141c8,0x80000,0x90000,0x1d0,0x141d0,0x80000,0x90000,0x1d8,0x141d8,0x80000,0x90000
.long 0x1e0,0x141e0,0x2b70,0x12b70,0x1e8,0x141e8,0x80000,0x90000,0x1f0,0x141f0,0x80000,0x90000,0x1f8,0x141f8,0x80000,0x90000
.long 0x22800,0x6ed40,0x73e80,0x835a0,0x22810,0x6ed50,0x73e90,0x835b0,0x22820,0x6ed60,0x74280,0x835c0,0x22830,0x6ed70,0x74290,0x835d0
.long 0x22880,0x6ed80,0x742a0,0x835e0,0x22890,0x6ed90,0x742b0,0x835f0,0x228a0,0x6f180,0x742c0,0x83600,0x228b0,0x6f190,0x742d0,0x83610
.long 0x22840,0x6f1a0,0x742e0,0x92400,0x22850,0x6f1b0,0x742f0,0x92410,0x22860,0x6f1c0,0x74300,0x92420,0x22870,0x6f1d0,0x74310,0x92430
.long 0x228c0,0x6f1e0,0x78f00,0x92440,0x228d0,0x6f1f0,0x78f10,0x92450,0x228e0,0x6f200,0x78f20,0x92460,0x228f0,0x6f210,0x78f30,0x92470
.long 0x22900,0x5fa00,0x78f40,0x92480,0x22910,0x5fa10,0x78f50,0x92490,0x22920,0x5fa20,0x78f60,0x92880,0xa0000,0x5fa30,0x78f70,0x92890
.long 0xa0000,0x5fa40,0x78f80,0x928a0,0xa0000,0x5fa50,0x78f90,0x928b0,0xa0000,0x5fa60,0x79380,0x928c0,0xa0000,0x5fa70,0x79390,0x928d0
.long 0xa0000,0x5fa80,0x793a0,0x928e0,0xa0000,0x5fa90,0x793b0,0x928f0,0xa0000,0x5fe80,0x793c0,0x92900,0xa0000,0x5fe90,0x793d0,0x92910
.long 0x22920,0x5fea0,0x793e0,0x97500,0xa0000,0x5feb0,0x793f0,0x97510,0xa0000,0x5fec0,0x79400,0x97520,0xa0000,0x5fed0,0x79410,0x97530
.long 0x22a50,0x5fee0,0x7e000,0x97540,0x22a60,0x5fef0,0x7e010,0x97550,0x22a70,0x5ff00,0x7e020,0x97560,0x22a80,0x5ff10,0x7e030,0x97570
.long 0x22ad0,0x64b00,0x7e040,0x97580,0x22ae0,0x64b10,0x7e050,0x97590,0x22af0,0x64b20,0x7e060,0x97980,0x22b00,0x64b30,0x7e070,0x97990
.long 0x22a90,0x64b40,0x7e080,0x979a0,0x22aa0,0x64b50,0x7e090,0x979b0,0x22ab0,0x64b60,0x7e480,0x979c0,0x22ac0,0x64b70,0x7e490,0x979d0
.long 0x22b10,0x64b80,0x7e4a0,0x979e0,0x22b20,0x64b90,0x7e4b0,0x979f0,0x22b30,0x64f80,0x7e4c0,0x97a00,0x22b40,0x64f90,0x7e4d0,0x97a10
.long 0x22b50,0x64fa0,0x7e4e0,0x88200,0x22b60,0x64fb0,0x7e4f0,0x88210,0x22b70,0x64fc0,0x7e500,0x88220,0xa0000,0x64fd0,0x7e510,0x88230
.long 0xa0000,0x64fe0,0x83100,0x88240,0xa0000,0x64ff0,0x83110,0x88250,0xa0000,0x65000,0x83120,0x88260,0xa0000,0x65010,0x83130,0x88270
.long 0xa0000,0x73e00,0x83140,0x88280,0xa0000,0x73e10,0x83150,0x88290,0xa0000,0x73e20,0x83160,0x88680,0xa0000,0x73e30,0x83170,0x88690
.long 0x22b70,0x73e40,0x83180,0x886a0,0xa0000,0x73e50,0x83190,0x886b0,0xa0000,0x73e60,0x83580,0x886c0,0xa0000,0x73e70,0x83590,0x886d0
.long 0x0,0x400,0x24000,0x265a0,0x8,0x408,0x24010,0x265b0,0x10,0x410,0x24020,0x265c0,0x18,0x418,0x24030,0x265d0
.long 0x20,0x420,0x24040,0x265e0,0x28,0x428,0x24050,0x265f0,0x30,0x430,0x24060,0x26600,0x38,0x438,0x24070,0x26610
.long 0x40,0x440,0x24080,0x26620,0x48,0x448,0x24090,0x26630,0x50,0x450,0x240a0,0x28800,0x58,0x458,0x240b0,0x28810
.long 0x60,0x460,0x240c0,0x28820,0x68,0x468,0x240d0,0x28830,0x70,0x470,0x240e0,0x28840,0x78,0x478,0x240f0,0x28850
.long 0x80,0x480,0x24100,0x28860,0x88,0x488,0x24110,0x28870,0x90,0x490,0x48000,0x28880,0x98,0x498,0x24120,0x28890
.long 0xa0,0x4a0,0x24130,0x288a0,0xa8,0x4a8,0x24140,0x288b0,0xb0,0x4b0,0x24150,0x288c0,0xb8,0x4b8,0x24160,0x288d0
.long 0xc0,0x4c0,0x24170,0x288e0,0xc8,0x4c8,0x24180,0x288f0,0xd0,0x4d0,0x24190,0x28900,0xd8,0x4d8,0x241a0,0x28910
.long 0xe0,0x4e0,0x241b0,0x48000,0xe8,0x4e8,0x241c0,0x28920,0xf0,0x4f0,0x241d0,0x28930,0xf8,0x4f8,0x241e0,0x28940
.long 0x100,0x400,0x241f0,0x28950,0x108,0x408,0x24200,0x28960,0x110,0x410,0x24210,0x28970,0x118,0x418,0x24220,0x28980
.long 0x120,0x420,0x24230,0x28990,0x128,0x428,0x26400,0x289a0,0x130,0x430,0x26410,0x289b0,0x138,0x438,0x26420,0x289c0
.long 0x140,0x440,0x26430,0x289d0,0x148,0x448,0x26440,0x289e0,0x150,0x450,0x26450,0x289f0,0x158,0x458,0x26460,0x28a00
.long 0x160,0x460,0x26470,0x28a10,0x168,0x468,0x26480,0x28a20,0x170,0x470,0x26490,0x28a30,0x178,0x478,0x264a0,0x2ac00
.long 0x180,0x480,0x264b0,0x2ac10,0x188,0x488,0x264c0,0x2ac20,0x190,0x490,0x264d0,0x2ac30,0x198,0x498,0x264e0,0x2ac40
.long 0x1a0,0x4a0,0x264f0,0x2ac50,0x1a8,0x4a8,0x26500,0x2ac60,0x1b0,0x4b0,0x26510,0x2ac70,0x1b8,0x4b8,0x48000,0x2ac80
.long 0x1c0,0x4c0,0x26520,0x2ac90,0x1c8,0x4c8,0x26530,0x2aca0,0x1d0,0x4d0,0x26540,0x2acb0,0x1d8,0x4d8,0x26550,0x2acc0
.long 0x1e0,0x4e0,0x26560,0x2acd0,0x1e8,0x4e8,0x26570,0x2ace0,0x1f0,0x4f0,0x26580,0x2acf0,0x1f8,0x4f8,0x26590,0x2ad00
.long 0x2ad10,0x2f470,0x31a10,0x0,0x48000,0x2f480,0x31a20,0x0,0x2ad20,0x2f490,0x31a30,0x0,0x2ad30,0x2f4a0,0x33c00,0x0
.long 0x2ad40,0x2f4b0,0x33c10,0x0,0x2ad50,0x2f4c0,0x33c20,0x0,0x2ad60,0x2f4d0,0x33c30,0x0,0x2ad70,0x2f4e0,0x33c40,0x0
.long 0x2ad80,0x2f4f0,0x33c50,0x0,0x2ad90,0x2f500,0x33c60,0x0,0x2ada0,0x2f510,0x33c70,0x0,0x2adb0,0x48000,0x33c80,0x0
.long 0x2adc0,0x2f520,0x33c90,0x0,0x2add0,0x2f530,0x33ca0,0x0,0x2ade0,0x2f540,0x33cb0,0x0,0x2adf0,0x2f550,0x33cc0,0x0
.long 0x2ae00,0x2f560,0x33cd0,0x0,0x2ae10,0x2f570,0x33ce0,0x0,0x2ae20,0x2f580,0x33cf0,0x0,0x2ae30,0x2f590,0x33d00,0x0
.long 0x2d000,0x2f5a0,0x33d10,0x0,0x2d010,0x2f5b0,0x48000,0x0,0x2d020,0x2f5c0,0x33d20,0x0,0x2d030,0x2f5d0,0x33d30,0x0
.long 0x2d040,0x2f5e0,0x33d40,0x0,0x2d050,0x2f5f0,0x33d50,0x0,0x2d060,0x2f600,0x33d60,0x0,0x2d070,0x2f610,0x33d70,0x0
.long 0x2d080,0x2f620,0x33d80,0x0,0x2d090,0x2f630,0x33d90,0x0,0x2d0a0,0x31800,0x33da0,0x0,0x2d0b0,0x31810,0x33db0,0x0
.long 0x2d0c0,0x31820,0x33dc0,0x0,0x2d0d0,0x31830,0x33dd0,0x0,0x2d0e0,0x31840,0x33de0,0x0,0x2d0f0,0x31850,0x33df0,0x0
.long 0x2d100,0x31860,0x33e00,0x0,0x2d110,0x31870,0x33e10,0x0,0x48000,0x31880,0x33e20,0x0,0x2d120,0x31890,0x33e30,0x0
.long 0x2d130,0x318a0,0x36000,0x0,0x2d140,0x318b0,0x36010,0x0,0x2d150,0x318c0,0x36020,0x0,0x2d160,0x318d0,0x36030,0x0
.long 0x2d170,0x318e0,0x36040,0x0,0x2d180,0x318f0,0x36050,0x0,0x2d190,0x31900,0x36060,0x0,0x2d1a0,0x31910,0x36070,0x0
.long 0x2d1b0,0x48000,0x36080,0x0,0x2d1c0,0x31920,0x36090,0x0,0x2d1d0,0x31930,0x360a0,0x0,0x2d1e0,0x31940,0x360b0,0x0
.long 0x2d1f0,0x31950,0x360c0,0x0,0x2d200,0x31960,0x360d0,0x0,0x2d210,0x31970,0x360e0,0x0,0x2d220,0x31980,0x360f0,0x0
.long 0x2d230,0x31990,0x36100,0x0,0x2f400,0x319a0,0x36110,0x0,0x2f410,0x319b0,0x48000,0x0,0x2f420,0x319c0,0x36120,0x0
.long 0x2f430,0x319d0,0x36130,0x0,0x2f440,0x319e0,0x36140,0x0,0x2f450,0x319f0,0x36150,0x0,0x2f460,0x31a00,0x36160,0x0
.long 0x24000,0x3640,0x0,0x80000000,0x24010,0x3650,0x10,0x80000000,0x24020,0x3660,0x20,0x80000000,0x24030,0x3670,0x30,0x80000000
.long 0x26400,0x3600,0x40,0x80000000,0x26410,0x3610,0x50,0x80000000,0x26420,0x3620,0x60,0x80000000,0x26430,0x3630,0x70,0x80000000
.long 0x28800,0x3ac0,0x80,0x80000000,0x28810,0x3ad0,0x90,0x80000000,0x28820,0x3ae0,0xa0,0x80000000,0x28830,0x3af0,0xb0,0x80000000
.long 0x2ac00,0x3a80,0xc0,0x80000000,0x2ac10,0x3a90,0xd0,0x80000000,0x2ac20,0x3aa0,0xe0,0x80000000,0x2ac30,0x3ab0,0xf0,0x80000000
.long 0x2d000,0x3f60,0x200,0x80000000,0x2d010,0x3f70,0x210,0x80000000,0x2d020,0x3f40,0x220,0x80000000,0x2d030,0x3f50,0x230,0x80000000
.long 0x2f400,0x3f20,0x240,0x80000000,0x2f410,0x3f30,0x250,0x80000000,0x2f420,0x3f00,0x260,0x80000000,0x2f430,0x3f10,0x270,0x80000000
.long 0x31800,0x43e0,0x280,0x80000000,0x31810,0x43f0,0x290,0x80000000,0x31820,0x43c0,0x2a0,0x80000000,0x31830,0x43d0,0x2b0,0x80000000
.long 0x33c00,0x43a0,0x2c0,0x80000000,0x33c10,0x43b0,0x2d0,0x80000000,0x33c20,0x4380,0x2e0,0x80000000,0x33c30,0x4390,0x2f0,0x80000000
.long 0x36020,0x7e40,0x100,0x80000000,0x36030,0x7e50,0x110,0x80000000,0x36000,0x7e60,0x120,0x80000000,0x36010,0x7e70,0x130,0x80000000
.long 0x38420,0x7e00,0x140,0x80000000,0x38430,0x7e10,0x150,0x80000000,0x38400,0x7e20,0x160,0x80000000,0x38410,0x7e30,0x170,0x80000000
.long 0x3a820,0x82c0,0x180,0x80000000,0x3a830,0x82d0,0x190,0x80000000,0x3a800,0x82e0,0x1a0,0x80000000,0x3a810,0x82f0,0x1b0,0x80000000
.long 0x3cc20,0x8280,0x1c0,0x80000000,0x3cc30,0x8290,0x1d0,0x80000000,0x3cc00,0x82a0,0x1e0,0x80000000,0x3cc10,0x82b0,0x1f0,0x80000000
.long 0x3f020,0x8760,0x300,0x80000000,0x3f030,0x8770,0x310,0x80000000,0x3f000,0x8740,0x320,0x80000000,0x3f010,0x8750,0x330,0x80000000
.long 0x41420,0x8720,0x340,0x80000000,0x41430,0x8730,0x350,0x80000000,0x41400,0x8700,0x360,0x80000000,0x41410,0x8710,0x370,0x80000000
.long 0x43820,0x8be0,0x380,0x80000000,0x43830,0x8bf0,0x390,0x80000000,0x43800,0x8bc0,0x3a0,0x80000000,0x43810,0x8bd0,0x3b0,0x80000000
.long 0x45c20,0x8ba0,0x3c0,0x80000000,0x45c30,0x8bb0,0x3d0,0x80000000,0x45c00,0x8b80,0x3e0,0x80000000,0x45c10,0x8b90,0x3f0,0x80000000
.long 0x500,0x14500,0x2930,0x12930,0x508,0x14508,0x2940,0x12940,0x510,0x14510,0x2950,0x12950,0x518,0x14518,0x2960,0x12960
.long 0x520,0x14520,0x29b0,0x129b0,0x528,0x14528,0x29c0,0x129c0,0x530,0x14530,0x29d0,0x129d0,0x538,0x14538,0x29e0,0x129e0
.long 0x540,0x14540,0x2970,0x12970,0x548,0x14548,0x2980,0x12980,0x550,0x14550,0x2990,0x12990,0x558,0x14558,0x29a0,0x129a0
.long 0x560,0x14560,0x29f0,0x129f0,0x568,0x14568,0x2a00,0x12a00,0x570,0x14570,0x2a10,0x12a10,0x578,0x14578,0x2a20,0x12a20
.long 0x580,0x14580,0x2a30,0x12a30,0x588,0x14588,0x2a40,0x12a40,0x590,0x14590,0x2920,0x12920,0x598,0x14598,0x80000,0x90000
.long 0x5a0,0x145a0,0x80000,0x90000,0x5a8,0x145a8,0x80000,0x90000,0x5b0,0x145b0,0x80000,0x90000,0x5b8,0x145b8,0x80000,0x90000
.long 0x5c0,0x145c0,0x80000,0x90000,0x5c8,0x145c8,0x80000,0x90000,0x5d0,0x145d0,0x80000,0x90000,0x5d8,0x145d8,0x80000,0x90000
.long 0x5e0,0x145e0,0x2920,0x12920,0x5e8,0x145e8,0x80000,0x90000,0x5f0,0x145f0,0x80000,0x90000,0x5f8,0x145f8,0x80000,0x90000
.long 0x600,0x14600,0x2b80,0x12b80,0x608,0x14608,0x2b90,0x12b90,0x610,0x14610,0x2ba0,0x12ba0,0x618,0x14618,0x2bb0,0x12bb0
.long 0x620,0x14620,0x2c00,0x12c00,0x628,0x14628,0x2c10,0x12c10,0x630,0x14630,0x2c20,0x12c20,0x638,0x14638,0x2c30,0x12c30
.long 0x640,0x14640,0x2bc0,0x12bc0,0x648,0x14648,0x2bd0,0x12bd0,0x650,0x14650,0x2be0,0x12be0,0x658,0x14658,0x2bf0,0x12bf0
.long 0x660,0x14660,0x2c40,0x12c40,0x668,0x14668,0x2c50,0x12c50,0x670,0x14670,0x2c60,0x12c60,0x678,0x14678,0x2c70,0x12c70
.long 0x680,0x14680,0x2c80,0x12c80,0x688,0x14688,0x2c90,0x12c90,0x690,0x14690,0x2b70,0x12b70,0x698,0x14698,0x80000,0x90000
.long 0x6a0,0x146a0,0x80000,0x90000,0x6a8,0x146a8,0x80000,0x90000,0x6b0,0x146b0,0x80000,0x90000,0x6b8,0x146b8,0x80000,0x90000
.long 0x6c0,0x146c0,0x80000,0x90000,0x6c8,0x146c8,0x80000,0x90000,0x6d0,0x146d0,0x80000,0x90000,0x6d8,0x146d8,0x80000,0x90000
.long 0x6e0,0x146e0,0x2b70,0x12b70,0x6e8,0x146e8,0x80000,0x90000,0x6f0,0x146f0,0x80000,0x90000,0x6f8,0x146f8,0x80000,0x90000
.long 0x22930,0x73e80,0x835a0,0x886e0,0x22940,0x73e90,0x835b0,0x886f0,0x22950,0x74280,0x835c0,0x88700,0x22960,0x74290,0x835d0,0x88710
.long 0x229b0,0x742a0,0x835e0,0x8d300,0x229c0,0x742b0,0x835f0,0x8d310,0x229d0,0x742c0,0x83600,0x8d320,0x229e0,0x742d0,0x83610,0x8d330
.long 0x22970,0x742e0,0x92400,0x8d340,0x22980,0x742f0,0x92410,0x8d350,0x22990,0x74300,0x92420,0x8d360,0x229a0,0x74310,0x92430,0x8d370
.long 0x229f0,0x78f00,0x92440,0x8d380,0x22a00,0x78f10,0x92450,0x8d390,0x22a10,0x78f20,0x92460,0x8d780,0x22a20,0x78f30,0x92470,0x8d790
.long 0x22a30,0x78f40,0x92480,0x8d7a0,0x22a40,0x78f50,0x92490,0x8d7b0,0x22920,0x78f60,0x92880,0x8d7c0,0xa0000,0x78f70,0x92890,0x8d7d0
.long 0xa0000,0x78f80,0x928a0,0x8d7e0,0xa0000,0x78f90,0x928b0,0x8d7f0,0xa0000,0x79380,0x928c0,0x8d800,0xa0000,0x79390,0x928d0,0x8d810
.long 0xa0000,0x793a0,0x928e0,0x9c600,0xa0000,0x793b0,0x928f0,0x9c610,0xa0000,0x793c0,0x92900,0x9c620,0xa0000,0x793d0,0x92910,0x9c630
.long 0x22920,0x793e0,0x97500,0x9c640,0xa0000,0x793f0,0x97510,0x9c650,0xa0000,0x79400,0x97520,0x9c660,0xa0000,0x79410,0x97530,0x9c670
.long 0x22b80,0x7e000,0x97540,0x9c680,0x22b90,0x7e010,0x97550,0x9c690,0x22ba0,0x7e020,0x97560,0x9ca80,0x22bb0,0x7e030,0x97570,0x9ca90
.long 0x22c00,0x7e040,0x97580,0x9caa0,0x22c10,0x7e050,0x97590,0x9cab0,0x22c20,0x7e060,0x97980,0x9cac0,0x22c30,0x7e070,0x97990,0x9cad0
.long 0x22bc0,0x7e080,0x979a0,0x9cae0,0x22bd0,0x7e090,0x979b0,0x9caf0,0x22be0,0x7e480,0x979c0,0x9cb00,0x22bf0,0x7e490,0x979d0,0x9cb10
.long 0x22c40,0x7e4a0,0x979e0,0xa1700,0x22c50,0x7e4b0,0x979f0,0xa1710,0x22c60,0x7e4c0,0x97a00,0xa1720,0x22c70,0x7e4d0,0x97a10,0xa1730
.long 0x22c80,0x7e4e0,0x88200,0xa1740,0x22c90,0x7e4f0,0x88210,0xa1750,0x22b70,0x7e500,0x88220,0xa1760,0xa0000,0x7e510,0x88230,0xa1770
.long 0xa0000,0x83100,0x88240,0xa1780,0xa0000,0x83110,0x88250,0xa1790,0xa0000,0x83120,0x88260,0xa1b80,0xa0000,0x83130,0x88270,0xa1b90
.long 0xa0000,0x83140,0x88280,0xa1ba0,0xa0000,0x83150,0x88290,0xa1bb0,0xa0000,0x83160,0x88680,0xa1bc0,0xa0000,0x83170,0x88690,0xa1bd0
.long 0x22b70,0x83180,0x886a0,0xa1be0,0xa0000,0x83190,0x886b0,0xa1bf0,0xa0000,0x83580,0x886c0,0xa1c00,0xa0000,0x83590,0x886d0,0xa1c10
.long 0x500,0x404,0x36170,0x3a8e0,0x508,0x40c,0x36180,0x3a8f0,0x510,0x414,0x36190,0x3a900,0x518,0x41c,0x361a0,0x3a910
.long 0x520,0x424,0x361b0,0x48000,0x528,0x42c,0x361c0,0x3a920,0x530,0x434,0x361d0,0x3a930,0x538,0x43c,0x361e0,0x3a940
.long 0x540,0x444,0x361f0,0x3a950,0x548,0x44c,0x36200,0x3a960,0x550,0x454,0x36210,0x3a970,0x558,0x45c,0x36220,0x3a980
.long 0x560,0x464,0x36230,0x3a990,0x568,0x46c,0x38400,0x3a9a0,0x570,0x474,0x38410,0x3a9b0,0x578,0x47c,0x38420,0x3a9c0
.long 0x580,0x484,0x38430,0x3a9d0,0x588,0x48c,0x38440,0x3a9e0,0x590,0x494,0x38450,0x3a9f0,0x598,0x49c,0x38460,0x3aa00
.long 0x5a0,0x4a4,0x38470,0x3aa10,0x5a8,0x4ac,0x38480,0x3aa20,0x5b0,0x4b4,0x38490,0x3aa30,0x5b8,0x4bc,0x384a0,0x3cc00
.long 0x5c0,0x4c4,0x384b0,0x3cc10,0x5c8,0x4cc,0x384c0,0x3cc20,0x5d0,0x4d4,0x384d0,0x3cc30,0x5d8,0x4dc,0x384e0,0x3cc40
.long 0x5e0,0x4e4,0x384f0,0x3cc50,0x5e8,0x4ec,0x38500,0x3cc60,0x5f0,0x4f4,0x38510,0x3cc70,0x5f8,0x4fc,0x48000,0x3cc80
.long 0x600,0x404,0x38520,0x3cc90,0x608,0x40c,0x38530,0x3cca0,0x610,0x414,0x38540,0x3ccb0,0x618,0x41c,0x38550,0x3ccc0
.long 0x620,0x424,0x38560,0x3ccd0,0x628,0x42c,0x38570,0x3cce0,0x630,0x434,0x38580,0x3ccf0,0x638,0x43c,0x38590,0x3cd00
.long 0x640,0x444,0x385a0,0x3cd10,0x648,0x44c,0x385b0,0x48000,0x650,0x454,0x385c0,0x3cd20,0x658,0x45c,0x385d0,0x3cd30
.long 0x660,0x464,0x385e0,0x3cd40,0x668,0x46c,0x385f0,0x3cd50,0x670,0x474,0x38600,0x3cd60,0x678,0x47c,0x38610,0x3cd70
.long 0x680,0x484,0x38620,0x3cd80,0x688,0x48c,0x38630,0x3cd90,0x690,0x494,0x3a800,0x3cda0,0x698,0x49c,0x3a810,0x3cdb0
.long 0x6a0,0x4a4,0x3a820,0x3cdc0,0x6a8,0x4ac,0x3a830,0x3cdd0,0x6b0,0x4b4,0x3a840,0x3cde0,0x6b8,0x4bc,0x3a850,0x3cdf0
.long 0x6c0,0x4c4,0x3a860,0x3ce00,0x6c8,0x4cc,0x3a870,0x3ce10,0x6d0,0x4d4,0x3a880,0x3ce20,0x6d8,0x4dc,0x3a890,0x3ce30
.long 0x6e0,0x4e4,0x3a8a0,0x3f000,0x6e8,0x4ec,0x3a8b0,0x3f010,0x6f0,0x4f4,0x3a8c0,0x3f020,0x6f8,0x4fc,0x3a8d0,0x3f030
.long 0x3f040,0x415e0,0x45d40,0x0,0x3f050,0x415f0,0x45d50,0x0,0x3f060,0x41600,0x45d60,0x0,0x3f070,0x41610,0x45d70,0x0
.long 0x3f080,0x41620,0x45d80,0x0,0x3f090,0x41630,0x45d90,0x0,0x3f0a0,0x43800,0x45da0,0x0,0x3f0b0,0x43810,0x45db0,0x0
.long 0x3f0c0,0x43820,0x45dc0,0x0,0x3f0d0,0x43830,0x45dd0,0x0,0x3f0e0,0x43840,0x45de0,0x0,0x3f0f0,0x43850,0x45df0,0x0
.long 0x3f100,0x43860,0x45e00,0x0,0x3f110,0x43870,0x45e10,0x0,0x48000,0x43880,0x45e20,0x0,0x3f120,0x43890,0x45e30,0x0
.long 0x3f130,0x438a0,0x80000000,0x0,0x3f140,0x438b0,0x80000000,0x0,0x3f150,0x438c0,0x80000000,0x0,0x3f160,0x438d0,0x80000000,0x0
.long 0x3f170,0x438e0,0x80000000,0x0,0x3f180,0x438f0,0x80000000,0x0,0x3f190,0x43900,0x80000000,0x0,0x3f1a0,0x43910,0x80000000,0x0
.long 0x3f1b0,0x48000,0x80000000,0x0,0x3f1c0,0x43920,0x80000000,0x0,0x3f1d0,0x43930,0x80000000,0x0,0x3f1e0,0x43940,0x80000000,0x0
.long 0x3f1f0,0x43950,0x80000000,0x0,0x3f200,0x43960,0x80000000,0x0,0x3f210,0x43970,0x80000000,0x0,0x3f220,0x43980,0x80000000,0x0
.long 0x3f230,0x43990,0x80000000,0x0,0x41400,0x439a0,0x80000000,0x0,0x41410,0x439b0,0x80000000,0x0,0x41420,0x439c0,0x80000000,0x0
.long 0x41430,0x439d0,0x80000000,0x0,0x41440,0x439e0,0x80000000,0x0,0x41450,0x439f0,0x80000000,0x0,0x41460,0x43a00,0x80000000,0x0
.long 0x41470,0x43a10,0x80000000,0x0,0x41480,0x43a20,0x80000000,0x0,0x41490,0x43a30,0x80000000,0x0,0x414a0,0x45c00,0x80000000,0x0
.long 0x414b0,0x45c10,0x80000000,0x0,0x414c0,0x45c20,0x80000000,0x0,0x414d0,0x45c30,0x80000000,0x0,0x414e0,0x45c40,0x80000000,0x0
.long 0x414f0,0x45c50,0x80000000,0x0,0x41500,0x45c60,0x80000000,0x0,0x41510,0x45c70,0x80000000,0x0,0x48000,0x45c80,0x80000000,0x0
.long 0x41520,0x45c90,0x80000000,0x0,0x41530,0x45ca0,0x80000000,0x0,0x41540,0x45cb0,0x80000000,0x0,0x41550,0x45cc0,0x80000000,0x0
.long 0x41560,0x45cd0,0x80000000,0x0,0x41570,0x45ce0,0x80000000,0x0,0x41580,0x45cf0,0x80000000,0x0,0x41590,0x45d00,0x80000000,0x0
.long 0x415a0,0x45d10,0x80000000,0x0,0x415b0,0x48000,0x80000000,0x0,0x415c0,0x45d20,0x80000000,0x0,0x415d0,0x45d30,0x80000000,0x0

L_spin1:
    s_mov_b32 s88, 262144
L_spin1_loop:
    buffer_load_dword v26, v27, s[32:35], 0 offen sc1
    s_sub_u32 s88, s88, 1
    s_waitcnt vmcnt(0)
    v_cmp_gt_u32 vcc, 64, v26
    s_cmp_eq_u32 s88, 0
    s_cbranch_scc1 L_back1
    s_cbranch_vccnz L_spin1_loop
    s_branch L_back1
L_spin2:
    s_mov_b32 s88, 262144
L_spin2_loop:
    buffer_load_dword v26, v61, s[36:39], s97 offen sc1
    s_sub_u32 s88, s88, 1
    s_waitcnt vmcnt(0)
    v_sub_u32 v26, v26, v70
    v_cmp_eq_u32 vcc, 0, v26
    s_cmp_eq_u32 s88, 0
    s_cbranch_scc1 L_back2
    s_cbranch_vccnz L_spin2_loop
    s_branch L_back2

L_fallback:
    s_waitcnt vmcnt(0) lgkmcnt(0)
    v_mov_b32 v28, 0xff800000
    v_mov_b32 v30, 0xff800000
    v_lshrrev_b32 v12, 5, v0
    v_and_b32 v13, 31, v0
    v_mul_u32_u24 v33, 73728, v12
    v_lshl_add_u32 v33, v13, 3, v33
    s_mul_i32 s49, s71, 2304
    s_add_u32 s48, s49, 1024
    v_add_u32 v33, s48, v33
    v_mul_u32_u24 v14, 592, v12
    v_sub_u32 v14, v74, v14
    v_subrev_u32 v14, 10240, v14
    v_subrev_u32 v15, 16, v14
    v_cmp_lt_u32 vcc, 0x120, v14
    s_mul_i32 s48, s71, 576
    s_add_u32 s48, s48, 147456
    v_cndmask_b32 v15, v14, v15, vcc
    v_mul_u32_u24 v32, 9216, v12
    v_add3_u32 v32, v32, v15, s48
    v_mov_b32 v15, 2147483648
    v_cmp_gt_u32 vcc, 524288, v74
    v_mov_b32 v34, 0
    v_mov_b32 v35, 0x3f803f80
    v_cndmask_b32 v32, v15, v32, vcc
    v_cmp_eq_u32 vcc, 0x120, v14
    s_mov_b32 s89, 2424832
    s_mov_b32 s88, 0
    v_cndmask_b32 v32, v32, v15, vcc
    v_cndmask_b32 v34, v34, v35, vcc
L_fb_max:
    s_add_u32 s48, s89, 36864
    buffer_load_dwordx2 a[156:157], v33, s[36:39], s89 offen offset:0 sc1
    buffer_load_dwordx2 a[158:159], v33, s[36:39], s48 offen offset:0 sc1
    s_add_u32 s48, s89, 0
    s_add_u32 s48, s48, s49
    buffer_load_dwordx2 a[148:149], v16, s[36:39], s48 offen offset:0 sc1
    buffer_load_dwordx2 a[150:151], v16, s[36:39], s48 offen offset:512 sc1
    s_waitcnt vmcnt(0)
    v_mfma_f32_32x32x8bf16_1k v[112:127], a[156:157], v[232:233], 0
    v_mfma_f32_32x32x16_bf16 v[112:127], a[148:151], v[224:227], v[112:127]
    v_mfma_f32_32x32x8bf16_1k v[128:143], a[156:157], v[236:237], 0
    v_mfma_f32_32x32x16_bf16 v[128:143], a[148:151], v[228:231], v[128:143]
    s_nop 11
    v_max3_f32 v28, v28, v112, v113
    v_max3_f32 v28, v28, v114, v115
    v_max3_f32 v28, v28, v116, v117
    v_max3_f32 v28, v28, v118, v119
    v_max3_f32 v28, v28, v120, v121
    v_max3_f32 v28, v28, v122, v123
    v_max3_f32 v28, v28, v124, v125
    v_max3_f32 v28, v28, v126, v127
    v_max3_f32 v30, v30, v128, v129
    v_max3_f32 v30, v30, v130, v131
    v_max3_f32 v30, v30, v132, v133
    v_max3_f32 v30, v30, v134, v135
    v_max3_f32 v30, v30, v136, v137
    v_max3_f32 v30, v30, v138, v139
    v_max3_f32 v30, v30, v140, v141
    v_max3_f32 v30, v30, v142, v143
    s_add_u32 s48, s89, 36864
    s_add_u32 s48, s48, s49
    buffer_load_dwordx2 a[152:153], v16, s[36:39], s48 offen offset:0 sc1
    buffer_load_dwordx2 a[154:155], v16, s[36:39], s48 offen offset:512 sc1
    s_waitcnt vmcnt(0)
    v_mfma_f32_32x32x8bf16_1k v[112:127], a[158:159], v[232:233], 0
    v_mfma_f32_32x32x16_bf16 v[112:127], a[152:155], v[224:227], v[112:127]
    v_mfma_f32_32x32x8bf16_1k v[128:143], a[158:159], v[236:237], 0
    v_mfma_f32_32x32x16_bf16 v[128:143], a[152:155], v[228:231], v[128:143]
    s_nop 11
    v_max3_f32 v28, v28, v112, v113
    v_max3_f32 v28, v28, v114, v115
    v_max3_f32 v28, v28, v116, v117
    v_max3_f32 v28, v28, v118, v119
    v_max3_f32 v28, v28, v120, v121
    v_max3_f32 v28, v28, v122, v123
    v_max3_f32 v28, v28, v124, v125
    v_max3_f32 v28, v28, v126, v127
    v_max3_f32 v30, v30, v128, v129
    v_max3_f32 v30, v30, v130, v131
    v_max3_f32 v30, v30, v132, v133
    v_max3_f32 v30, v30, v134, v135
    v_max3_f32 v30, v30, v136, v137
    v_max3_f32 v30, v30, v138, v139
    v_max3_f32 v30, v30, v140, v141
    v_max3_f32 v30, v30, v142, v143
    s_add_u32 s48, s89, 73728
    s_add_u32 s48, s48, s49
    buffer_load_dwordx2 a[148:149], v16, s[36:39], s48 offen offset:0 sc1
    buffer_load_dwordx2 a[150:151], v16, s[36:39], s48 offen offset:512 sc1
    s_waitcnt vmcnt(0)
    v_mfma_f32_32x32x8bf16_1k v[112:127], a[156:157], v[234:235], 0
    v_mfma_f32_32x32x16_bf16 v[112:127], a[148:151], v[224:227], v[112:127]
    v_mfma_f32_32x32x8bf16_1k v[128:143], a[156:157], v[238:239], 0
    v_mfma_f32_32x32x16_bf16 v[128:143], a[148:151], v[228:231], v[128:143]
    s_nop 11
    v_max3_f32 v28, v28, v112, v113
    v_max3_f32 v28, v28, v114, v115
    v_max3_f32 v28, v28, v116, v117
    v_max3_f32 v28, v28, v118, v119
    v_max3_f32 v28, v28, v120, v121
    v_max3_f32 v28, v28, v122, v123
    v_max3_f32 v28, v28, v124, v125
    v_max3_f32 v28, v28, v126, v127
    v_max3_f32 v30, v30, v128, v129
    v_max3_f32 v30, v30, v130, v131
    v_max3_f32 v30, v30, v132, v133
    v_max3_f32 v30, v30, v134, v135
    v_max3_f32 v30, v30, v136, v137
    v_max3_f32 v30, v30, v138, v139
    v_max3_f32 v30, v30, v140, v141
    v_max3_f32 v30, v30, v142, v143
    s_add_u32 s48, s89, 110592
    s_add_u32 s48, s48, s49
    buffer_load_dwordx2 a[152:153], v16, s[36:39], s48 offen offset:0 sc1
    buffer_load_dwordx2 a[154:155], v16, s[36:39], s48 offen offset:512 sc1
    s_waitcnt vmcnt(0)
    v_mfma_f32_32x32x8bf16_1k v[112:127], a[158:159], v[234:235], 0
    v_mfma_f32_32x32x16_bf16 v[112:127], a[152:155], v[224:227], v[112:127]
    v_mfma_f32_32x32x8bf16_1k v[128:143], a[158:159], v[238:239], 0
    v_mfma_f32_32x32x16_bf16 v[128:143], a[152:155], v[228:231], v[128:143]
    s_nop 11
    v_max3_f32 v28, v28, v112, v113
    v_max3_f32 v28, v28, v114, v115
    v_max3_f32 v28, v28, v116, v117
    v_max3_f32 v28, v28, v118, v119
    v_max3_f32 v28, v28, v120, v121
    v_max3_f32 v28, v28, v122, v123
    v_max3_f32 v28, v28, v124, v125
    v_max3_f32 v28, v28, v126, v127
    v_max3_f32 v30, v30, v128, v129
    v_max3_f32 v30, v30, v130, v131
    v_max3_f32 v30, v30, v132, v133
    v_max3_f32 v30, v30, v134, v135
    v_max3_f32 v30, v30, v136, v137
    v_max3_f32 v30, v30, v138, v139
    v_max3_f32 v30, v30, v140, v141
    v_max3_f32 v30, v30, v142, v143
    s_add_u32 s89, s89, 304128
    s_add_u32 s88, s88, 1
    s_cmp_lt_u32 s88, 16
    s_cbranch_scc1 L_fb_max
    v_mov_b32 v29, v28
    v_mov_b32 v31, v30
    s_nop 0
    v_permlane32_swap_b32 v28, v29
    v_permlane32_swap_b32 v30, v31
    v_max_f32 v28, v28, v29
    v_max_f32 v30, v30, v31
    v_sub_f32 v160, 0, v28
    v_sub_f32 v161, 0, v28
    v_sub_f32 v162, 0, v28
    v_sub_f32 v163, 0, v28
    v_sub_f32 v164, 0, v28
    v_sub_f32 v165, 0, v28
    v_sub_f32 v166, 0, v28
    v_sub_f32 v167, 0, v28
    v_sub_f32 v168, 0, v28
    v_sub_f32 v169, 0, v28
    v_sub_f32 v170, 0, v28
    v_sub_f32 v171, 0, v28
    v_sub_f32 v172, 0, v28
    v_sub_f32 v173, 0, v28
    v_sub_f32 v174, 0, v28
    v_sub_f32 v175, 0, v28
    v_sub_f32 v176, 0, v30
    v_sub_f32 v177, 0, v30
    v_sub_f32 v178, 0, v30
    v_sub_f32 v179, 0, v30
    v_sub_f32 v180, 0, v30
    v_sub_f32 v181, 0, v30
    v_sub_f32 v182, 0, v30
    v_sub_f32 v183, 0, v30
    v_sub_f32 v184, 0, v30
    v_sub_f32 v185, 0, v30
    v_sub_f32 v186, 0, v30
    v_sub_f32 v187, 0, v30
    v_sub_f32 v188, 0, v30
    v_sub_f32 v189, 0, v30
    v_sub_f32 v190, 0, v30
    v_sub_f32 v191, 0, v30
    v_mov_b32 v192, 0
    v_mov_b32 v193, 0
    v_mov_b32 v194, 0
    v_mov_b32 v195, 0
    v_mov_b32 v196, 0
    v_mov_b32 v197, 0
    v_mov_b32 v198, 0
    v_mov_b32 v199, 0
    v_mov_b32 v200, 0
    v_mov_b32 v201, 0
    v_mov_b32 v202, 0
    v_mov_b32 v203, 0
    v_mov_b32 v204, 0
    v_mov_b32 v205, 0
    v_mov_b32 v206, 0
    v_mov_b32 v207, 0
    v_mov_b32 v208, 0
    v_mov_b32 v209, 0
    v_mov_b32 v210, 0
    v_mov_b32 v211, 0
    v_mov_b32 v212, 0
    v_mov_b32 v213, 0
    v_mov_b32 v214, 0
    v_mov_b32 v215, 0
    v_mov_b32 v216, 0
    v_mov_b32 v217, 0
    v_mov_b32 v218, 0
    v_mov_b32 v219, 0
    v_mov_b32 v220, 0
    v_mov_b32 v221, 0
    v_mov_b32 v222, 0
    v_mov_b32 v223, 0
    s_mov_b32 s89, 2424832
    s_mov_b32 s88, 0
L_fb_att:
    s_add_u32 s48, s89, 36864
    buffer_load_dwordx2 a[156:157], v33, s[36:39], s89 offen offset:0 sc1
    buffer_load_dwordx2 a[158:159], v33, s[36:39], s48 offen offset:0 sc1
    s_add_u32 s48, s89, 0
    s_add_u32 s48, s48, s49
    buffer_load_dwordx2 a[148:149], v16, s[36:39], s48 offen offset:0 sc1
    buffer_load_dwordx2 a[150:151], v16, s[36:39], s48 offen offset:512 sc1
    s_add_u32 s48, s89, 0
    buffer_load_dwordx4 v[4:7], v32, s[36:39], s48 offen offset:0 sc1
    s_add_u32 s48, s89, 18432
    buffer_load_dwordx4 v[8:11], v32, s[36:39], s48 offen offset:0 sc1
    s_waitcnt vmcnt(0)
    v_or_b32 v4, v34, v4
    v_or_b32 v5, v34, v5
    v_or_b32 v6, v34, v6
    v_or_b32 v7, v34, v7
    v_or_b32 v8, v34, v8
    v_or_b32 v9, v34, v9
    v_or_b32 v10, v34, v10
    v_or_b32 v11, v34, v11
    v_mfma_f32_32x32x8bf16_1k v[112:127], a[156:157], v[232:233], v[160:175]
    v_mfma_f32_32x32x16_bf16 v[112:127], a[148:151], v[224:227], v[112:127]
    v_mfma_f32_32x32x8bf16_1k v[128:143], a[156:157], v[236:237], v[176:191]
    v_mfma_f32_32x32x16_bf16 v[128:143], a[148:151], v[228:231], v[128:143]
    s_nop 11
    v_exp_f32 v112, v112
    v_exp_f32 v113, v113
    v_exp_f32 v114, v114
    v_exp_f32 v115, v115
    v_exp_f32 v116, v116
    v_exp_f32 v117, v117
    v_exp_f32 v118, v118
    v_exp_f32 v119, v119
    v_exp_f32 v120, v120
    v_exp_f32 v121, v121
    v_exp_f32 v122, v122
    v_exp_f32 v123, v123
    v_exp_f32 v124, v124
    v_exp_f32 v125, v125
    v_exp_f32 v126, v126
    v_exp_f32 v127, v127
    v_exp_f32 v128, v128
    v_exp_f32 v129, v129
    v_exp_f32 v130, v130
    v_exp_f32 v131, v131
    v_exp_f32 v132, v132
    v_exp_f32 v133, v133
    v_exp_f32 v134, v134
    v_exp_f32 v135, v135
    v_exp_f32 v136, v136
    v_exp_f32 v137, v137
    v_exp_f32 v138, v138
    v_exp_f32 v139, v139
    v_exp_f32 v140, v140
    v_exp_f32 v141, v141
    v_exp_f32 v142, v142
    v_exp_f32 v143, v143
    s_nop 1
    v_smfmac_f32_32x32x32_bf16 v[192:207], v[4:7], v[112:119], v50
    v_smfmac_f32_32x32x32_bf16 v[192:207], v[8:11], v[120:127], v50
    v_smfmac_f32_32x32x32_bf16 v[208:223], v[4:7], v[128:135], v50
    v_smfmac_f32_32x32x32_bf16 v[208:223], v[8:11], v[136:143], v50
    s_nop 7
    s_add_u32 s48, s89, 36864
    s_add_u32 s48, s48, s49
    buffer_load_dwordx2 a[152:153], v16, s[36:39], s48 offen offset:0 sc1
    buffer_load_dwordx2 a[154:155], v16, s[36:39], s48 offen offset:512 sc1
    s_add_u32 s48, s89, 36864
    buffer_load_dwordx4 v[4:7], v32, s[36:39], s48 offen offset:0 sc1
    s_add_u32 s48, s89, 55296
    buffer_load_dwordx4 v[8:11], v32, s[36:39], s48 offen offset:0 sc1
    s_waitcnt vmcnt(0)
    v_or_b32 v4, v34, v4
    v_or_b32 v5, v34, v5
    v_or_b32 v6, v34, v6
    v_or_b32 v7, v34, v7
    v_or_b32 v8, v34, v8
    v_or_b32 v9, v34, v9
    v_or_b32 v10, v34, v10
    v_or_b32 v11, v34, v11
    v_mfma_f32_32x32x8bf16_1k v[112:127], a[158:159], v[232:233], v[160:175]
    v_mfma_f32_32x32x16_bf16 v[112:127], a[152:155], v[224:227], v[112:127]
    v_mfma_f32_32x32x8bf16_1k v[128:143], a[158:159], v[236:237], v[176:191]
    v_mfma_f32_32x32x16_bf16 v[128:143], a[152:155], v[228:231], v[128:143]
    s_nop 11
    v_exp_f32 v112, v112
    v_exp_f32 v113, v113
    v_exp_f32 v114, v114
    v_exp_f32 v115, v115
    v_exp_f32 v116, v116
    v_exp_f32 v117, v117
    v_exp_f32 v118, v118
    v_exp_f32 v119, v119
    v_exp_f32 v120, v120
    v_exp_f32 v121, v121
    v_exp_f32 v122, v122
    v_exp_f32 v123, v123
    v_exp_f32 v124, v124
    v_exp_f32 v125, v125
    v_exp_f32 v126, v126
    v_exp_f32 v127, v127
    v_exp_f32 v128, v128
    v_exp_f32 v129, v129
    v_exp_f32 v130, v130
    v_exp_f32 v131, v131
    v_exp_f32 v132, v132
    v_exp_f32 v133, v133
    v_exp_f32 v134, v134
    v_exp_f32 v135, v135
    v_exp_f32 v136, v136
    v_exp_f32 v137, v137
    v_exp_f32 v138, v138
    v_exp_f32 v139, v139
    v_exp_f32 v140, v140
    v_exp_f32 v141, v141
    v_exp_f32 v142, v142
    v_exp_f32 v143, v143
    s_nop 1
    v_smfmac_f32_32x32x32_bf16 v[192:207], v[4:7], v[112:119], v50
    v_smfmac_f32_32x32x32_bf16 v[192:207], v[8:11], v[120:127], v50
    v_smfmac_f32_32x32x32_bf16 v[208:223], v[4:7], v[128:135], v50
    v_smfmac_f32_32x32x32_bf16 v[208:223], v[8:11], v[136:143], v50
    s_nop 7
    s_add_u32 s48, s89, 73728
    s_add_u32 s48, s48, s49
    buffer_load_dwordx2 a[148:149], v16, s[36:39], s48 offen offset:0 sc1
    buffer_load_dwordx2 a[150:151], v16, s[36:39], s48 offen offset:512 sc1
    s_add_u32 s48, s89, 73728
    buffer_load_dwordx4 v[4:7], v32, s[36:39], s48 offen offset:0 sc1
    s_add_u32 s48, s89, 92160
    buffer_load_dwordx4 v[8:11], v32, s[36:39], s48 offen offset:0 sc1
    s_waitcnt vmcnt(0)
    v_or_b32 v4, v34, v4
    v_or_b32 v5, v34, v5
    v_or_b32 v6, v34, v6
    v_or_b32 v7, v34, v7
    v_or_b32 v8, v34, v8
    v_or_b32 v9, v34, v9
    v_or_b32 v10, v34, v10
    v_or_b32 v11, v34, v11
    v_mfma_f32_32x32x8bf16_1k v[112:127], a[156:157], v[234:235], v[160:175]
    v_mfma_f32_32x32x16_bf16 v[112:127], a[148:151], v[224:227], v[112:127]
    v_mfma_f32_32x32x8bf16_1k v[128:143], a[156:157], v[238:239], v[176:191]
    v_mfma_f32_32x32x16_bf16 v[128:143], a[148:151], v[228:231], v[128:143]
    s_nop 11
    v_exp_f32 v112, v112
    v_exp_f32 v113, v113
    v_exp_f32 v114, v114
    v_exp_f32 v115, v115
    v_exp_f32 v116, v116
    v_exp_f32 v117, v117
    v_exp_f32 v118, v118
    v_exp_f32 v119, v119
    v_exp_f32 v120, v120
    v_exp_f32 v121, v121
    v_exp_f32 v122, v122
    v_exp_f32 v123, v123
    v_exp_f32 v124, v124
    v_exp_f32 v125, v125
    v_exp_f32 v126, v126
    v_exp_f32 v127, v127
    v_exp_f32 v128, v128
    v_exp_f32 v129, v129
    v_exp_f32 v130, v130
    v_exp_f32 v131, v131
    v_exp_f32 v132, v132
    v_exp_f32 v133, v133
    v_exp_f32 v134, v134
    v_exp_f32 v135, v135
    v_exp_f32 v136, v136
    v_exp_f32 v137, v137
    v_exp_f32 v138, v138
    v_exp_f32 v139, v139
    v_exp_f32 v140, v140
    v_exp_f32 v141, v141
    v_exp_f32 v142, v142
    v_exp_f32 v143, v143
    s_nop 1
    v_smfmac_f32_32x32x32_bf16 v[192:207], v[4:7], v[112:119], v50
    v_smfmac_f32_32x32x32_bf16 v[192:207], v[8:11], v[120:127], v50
    v_smfmac_f32_32x32x32_bf16 v[208:223], v[4:7], v[128:135], v50
    v_smfmac_f32_32x32x32_bf16 v[208:223], v[8:11], v[136:143], v50
    s_nop 7
    s_add_u32 s48, s89, 110592
    s_add_u32 s48, s48, s49
    buffer_load_dwordx2 a[152:153], v16, s[36:39], s48 offen offset:0 sc1
    buffer_load_dwordx2 a[154:155], v16, s[36:39], s48 offen offset:512 sc1
    s_add_u32 s48, s89, 110592
    buffer_load_dwordx4 v[4:7], v32, s[36:39], s48 offen offset:0 sc1
    s_add_u32 s48, s89, 129024
    buffer_load_dwordx4 v[8:11], v32, s[36:39], s48 offen offset:0 sc1
    s_waitcnt vmcnt(0)
    v_or_b32 v4, v34, v4
    v_or_b32 v5, v34, v5
    v_or_b32 v6, v34, v6
    v_or_b32 v7, v34, v7
    v_or_b32 v8, v34, v8
    v_or_b32 v9, v34, v9
    v_or_b32 v10, v34, v10
    v_or_b32 v11, v34, v11
    v_mfma_f32_32x32x8bf16_1k v[112:127], a[158:159], v[234:235], v[160:175]
    v_mfma_f32_32x32x16_bf16 v[112:127], a[152:155], v[224:227], v[112:127]
    v_mfma_f32_32x32x8bf16_1k v[128:143], a[158:159], v[238:239], v[176:191]
    v_mfma_f32_32x32x16_bf16 v[128:143], a[152:155], v[228:231], v[128:143]
    s_nop 11
    v_exp_f32 v112, v112
    v_exp_f32 v113, v113
    v_exp_f32 v114, v114
    v_exp_f32 v115, v115
    v_exp_f32 v116, v116
    v_exp_f32 v117, v117
    v_exp_f32 v118, v118
    v_exp_f32 v119, v119
    v_exp_f32 v120, v120
    v_exp_f32 v121, v121
    v_exp_f32 v122, v122
    v_exp_f32 v123, v123
    v_exp_f32 v124, v124
    v_exp_f32 v125, v125
    v_exp_f32 v126, v126
    v_exp_f32 v127, v127
    v_exp_f32 v128, v128
    v_exp_f32 v129, v129
    v_exp_f32 v130, v130
    v_exp_f32 v131, v131
    v_exp_f32 v132, v132
    v_exp_f32 v133, v133
    v_exp_f32 v134, v134
    v_exp_f32 v135, v135
    v_exp_f32 v136, v136
    v_exp_f32 v137, v137
    v_exp_f32 v138, v138
    v_exp_f32 v139, v139
    v_exp_f32 v140, v140
    v_exp_f32 v141, v141
    v_exp_f32 v142, v142
    v_exp_f32 v143, v143
    s_nop 1
    v_smfmac_f32_32x32x32_bf16 v[192:207], v[4:7], v[112:119], v50
    v_smfmac_f32_32x32x32_bf16 v[192:207], v[8:11], v[120:127], v50
    v_smfmac_f32_32x32x32_bf16 v[208:223], v[4:7], v[128:135], v50
    v_smfmac_f32_32x32x32_bf16 v[208:223], v[8:11], v[136:143], v50
    s_nop 7
    s_add_u32 s89, s89, 304128
    s_add_u32 s88, s88, 1
    s_cmp_lt_u32 s88, 16
    s_cbranch_scc1 L_fb_att
    s_nop 11
    v_add_f32 v28, v202, v204
    v_add_f32 v30, v218, v220
    s_branch L_fin

    s_endpgm
.fill 64, 4, 0xbf800000
L_code_end:
.section .rodata,"a"
.p2align 6
.amdhsa_kernel parallel_sum__mha_block__glu_gated_bilinear__prompt_kernel
  .amdhsa_next_free_vgpr 512
  .amdhsa_next_free_sgpr 102
  .amdhsa_accum_offset 256
  .amdhsa_group_segment_fixed_size 0
  .amdhsa_kernarg_size 80
  .amdhsa_user_sgpr_count 2
  .amdhsa_user_sgpr_kernarg_segment_ptr 1
  .amdhsa_system_sgpr_workgroup_id_x 1
  .amdhsa_float_denorm_mode_32 3
.end_amdhsa_kernel
```
